```python
import torch

def _softmax(x, axis=-1):
    return torch.softmax(x, dim=axis)

def _gelu(x):
    return torch.nn.functional.gelu(x, approximate='tanh')

def _silu(x):
    return torch.nn.functional.silu(x)

def _sigmoid(x):
    return torch.sigmoid(x)

def _layernorm(x, axis=-1, eps=1e-05):
    m = x.mean(dim=axis, keepdim=True)
    v = x.var(dim=axis, keepdim=True, unbiased=False)
    return (x - m) / torch.sqrt(v + eps)

def _scatter_add(tgt, idx, src, axis=0):
    return tgt.clone().index_add_(axis, idx, src)

def _segment_sum(src, seg, n):
    out = torch.zeros((n,) + src.shape[1:], dtype=src.dtype)
    return out.index_add_(0, seg, src)

def _pad(x, pw):
    flat = tuple((v for pair in reversed(pw) for v in pair))
    return torch.nn.functional.pad(x, flat)
kernel_name = 'adaLN_cond__sliding_block_cached__mixer_gmlp__prompt'

def setup_inputs():

    _w = lambda a: (lambda t: t.to(torch.bfloat16) if t.is_floating_point() else t)(torch.as_tensor(a))

    def _A_setup():
        B, Sq, D = (1, 2048, 576)
        Hq, Hkv, Sk, Dh = (32, 16, 2048, 128)
        assert Hq % Hkv == 0, (Hq, Hkv)
        return {'x': _w((lambda *s: torch.randn(*s, dtype=torch.bfloat16) * 0.1)(B, Sq, D)), 'k_cache': _w((lambda *s: torch.randn(*s, dtype=torch.bfloat16) * 0.8)(B, Hkv, Sk, Dh)), 'v_cache': _w((lambda *s: torch.randn(*s, dtype=torch.bfloat16) * 1.6)(B, Hkv, Sk, Dh)), 'wq': _w((lambda *s: torch.randn(*s, dtype=torch.bfloat16) * 0.8)(D, Hq * Dh) * D ** (-0.5)), 'wo': _w((lambda *s: torch.randn(*s, dtype=torch.bfloat16) * 1.6)(Hq * Dh, D) * (Hq * Dh) ** (-0.5))}
    _A_in = _A_setup()

    def _B_setup():
        B, S, D, F = (1, 2048, 576, 4608)
        Fh = F // 2
        return {'x': _w((lambda *s: torch.randn(*s, dtype=torch.bfloat16) * 0.1)(B, S, D)), 'w_in': _w((lambda *s: torch.randn(*s, dtype=torch.bfloat16) * 1.6)(D, 2 * Fh)), 'w_sp': _w(0.01 * (lambda *s: torch.randn(*s, dtype=torch.bfloat16) * 1.6)(S, S)), 'b_sp': _w(1.0 + 0.01 * (lambda *s: torch.randn(*s, dtype=torch.bfloat16) * 0.2)(S)), 'w_out': _w((lambda *s: torch.randn(*s, dtype=torch.bfloat16) * 0.2)(Fh, D))}
    _B_in = _B_setup()
    return {'A_x': _A_in['x'], 'A_k_cache': _A_in['k_cache'], 'A_v_cache': _A_in['v_cache'], 'A_wq': _A_in['wq'], 'A_wo': _A_in['wo'], 'B_x': _B_in['x'], 'B_w_in': _B_in['w_in'], 'B_w_sp': _B_in['w_sp'], 'B_b_sp': _B_in['b_sp'], 'B_w_out': _B_in['w_out'], 'c': _w((lambda *s: torch.randn(*s, dtype=torch.bfloat16) * 0.8)(1, 576) * 8.0), 'w_mod': _w((lambda *s: torch.randn(*s, dtype=torch.bfloat16) * 0.8)(576, 6 * 576) * 576 ** (-0.5) * 8.0)}

def reference(A_x, A_k_cache, A_v_cache, A_wq, A_wo, B_x, B_w_in, B_w_sp, B_b_sp, B_w_out, c, w_mod):

    def _A_ref(x, k_cache, v_cache, wq, wo):
        B, Sq, D = x.shape
        Hq, Dh = (32, 128)
        Hkv, Sk = (k_cache.shape[1], k_cache.shape[2])
        W = min(4096, max(256, Sk // 4))
        rep = Hq // Hkv
        q = (lambda x, *d: x.permute(*d))((x @ wq).reshape(B, Sq, Hq, Dh), 0, 2, 1, 3)
        k = (lambda x, n, axis: torch.repeat_interleave(x, n, dim=axis))(k_cache[:, :, Sk - W:, :], rep, axis=1)
        v = (lambda x, n, axis: torch.repeat_interleave(x, n, dim=axis))(v_cache[:, :, Sk - W:, :], rep, axis=1)
        scores = torch.einsum('bhqd,bhkd->bhqk', q, k) * Dh ** (-0.5)
        p = _softmax(scores, axis=-1)
        o = torch.einsum('bhqk,bhkd->bhqd', p, v)
        return (lambda x, *d: x.permute(*d))(o, 0, 2, 1, 3).reshape(B, Sq, Hq * Dh) @ wo

    def _B_ref(x, w_in, w_sp, b_sp, w_out):
        B, S, D = x.shape
        F = w_in.shape[-1]
        Fh = F // 2
        z = _gelu(torch.einsum('bsd,df->bsf', x, w_in))
        z1 = z[..., :Fh].clone()
        z2 = _layernorm(z[..., Fh:], axis=-1)
        g = torch.einsum('ts,bsf->btf', w_sp, z2) + b_sp[None, :, None]
        return torch.einsum('bsf,fd->bsd', z1 * g, w_out)
    x = A_x
    mod = (_silu(c) @ w_mod).reshape(c.shape[0], 6, 1, -1)
    sa, ca, ga, sb, cb, gb = (mod[:, 0].clone(), mod[:, 1].clone(), mod[:, 2].clone(), mod[:, 3].clone(), mod[:, 4].clone(), mod[:, 5].clone())
    h = _layernorm(x, axis=-1) * (1 + ca) + sa
    x = x + ga * _A_ref(h, A_k_cache, A_v_cache, A_wq, A_wo)
    h = _layernorm(x, axis=-1) * (1 + cb) + sb
    x = x + gb * _B_ref(h, B_w_in, B_w_sp, B_b_sp, B_w_out)
    return x
```

```asm
; @launch kernel=k0_kernel grid=(364,1,1) block=(576,1,1) lds=2048
; @launch kernel=k1_kernel grid=(256,1,1) block=(256,1,1) lds=147456
.amdgcn_target "amdgcn-amd-amdhsa--gfx950"
.text
.globl k0_kernel
.p2align 8
.type k0_kernel,@function
k0_kernel:
s_cmp_ge_u32 s2, 364
s_cbranch_scc1 k0_kernel_end
s_load_dwordx2 s[4:5], s[0:1], 0
s_load_dwordx2 s[8:9], s[0:1], 112
s_load_dwordx2 s[12:13], s[0:1], 88
s_load_dwordx2 s[16:17], s[0:1], 80
s_load_dwordx2 s[20:21], s[0:1], 112
s_load_dwordx2 s[32:33], s[0:1], 112
s_load_dwordx2 s[36:37], s[0:1], 24
s_load_dwordx2 s[40:41], s[0:1], 8
s_load_dwordx2 s[44:45], s[0:1], 16
s_load_dwordx2 s[48:49], s[0:1], 56
s_mov_b32 s6, 2359296
s_mov_b32 s7, 0x20000
s_mov_b32 s10, 2359296
s_mov_b32 s11, 0x20000
s_mov_b32 s14, 3981312
s_mov_b32 s15, 0x20000
s_mov_b32 s18, 1152
s_mov_b32 s19, 0x20000
s_mov_b32 s22, 16384
s_mov_b32 s23, 0x20000
s_mov_b32 s34, 1310720
s_mov_b32 s35, 0x20000
s_mov_b32 s38, 4718592
s_mov_b32 s39, 0x20000
s_mov_b32 s42, 8388608
s_mov_b32 s43, 0x20000
s_mov_b32 s46, 8388608
s_mov_b32 s47, 0x20000
s_mov_b32 s50, 8388608
s_mov_b32 s51, 0x20000
s_cmp_lt_u32 s2, 108
s_cbranch_scc1 k0_gemv
s_sub_u32 s2, s2, 108
v_and_b32 v1, 7, v0
v_lshrrev_b32 v2, 3, v0
v_lshrrev_b32 v5, 6, v0
s_lshl_b32 s3, s2, 3
v_add_u32 v6, s3, v1
v_readfirstlane_b32 s24, v5
v_mul_u32_u24 v3, 1152, v6
v_lshl_add_u32 v3, v2, 4, v3
s_lshr_b32 s25, s2, 1
s_mul_i32 s25, s25, 18432
v_and_b32 v6, 15, v6
v_lshlrev_b32 v6, 4, v6
v_lshl_add_u32 v4, v2, 8, v6
v_add_u32 v4, s25, v4
v_lshlrev_b32 v5, 5, v2
s_waitcnt lgkmcnt(0)
s_add_u32 s8, s8, 65536
s_addc_u32 s9, s9, 0
s_add_u32 s32, s32, 9437184
s_addc_u32 s33, s33, 0
buffer_load_dwordx4 v[32:35], v3, s[4:7], 0 offen
v_and_b32 v60, 63, v0
v_lshlrev_b32 v60, 7, v60
s_cmp_eq_u32 s24, 0
s_cbranch_scc1 k0_t2
s_cmp_gt_u32 s24, 3
s_cbranch_scc1 k0_t2
s_mul_i32 s27, s2, 3
s_add_u32 s27, s27, s24
s_sub_u32 s27, s27, 1
s_cmp_ge_u32 s27, 256
s_cbranch_scc1 k0_t3
s_lshl_b32 s27, s27, 13
buffer_load_dword v61, v60, s[36:39], s27 offen
s_branch k0_nt
k0_t2:
s_branch k0_t3
s_cmp_gt_u32 s24, 4
s_cbranch_scc1 k0_t3
s_lshr_b32 s27, s2, 4
s_lshl_b32 s27, s27, 19
s_and_b32 s28, s2, 15
s_lshl_b32 s28, s28, 13
s_add_u32 s27, s27, s28
s_add_u32 s27, s27, 393216
s_cmp_eq_u32 s24, 0
s_cbranch_scc1 k0_t4
buffer_load_dword v61, v60, s[40:43], s27 offen
s_branch k0_nt
k0_t4:
buffer_load_dword v62, v60, s[44:47], s27 offen
s_branch k0_nt
k0_t3:
s_waitcnt vmcnt(0)
k0_nt:
s_waitcnt vmcnt(1)
v_lshlrev_b32 v40, 16, v32
v_and_b32 v41, 0xffff0000, v32
v_lshlrev_b32 v42, 16, v33
v_and_b32 v43, 0xffff0000, v33
v_lshlrev_b32 v44, 16, v34
v_and_b32 v45, 0xffff0000, v34
v_lshlrev_b32 v46, 16, v35
v_and_b32 v47, 0xffff0000, v35
v_add_f32 v6, v40, v41
v_mul_f32 v7, v40, v40
v_fmac_f32 v7, v41, v41
v_add_f32 v6, v6, v42
v_fmac_f32 v7, v42, v42
v_add_f32 v6, v6, v43
v_fmac_f32 v7, v43, v43
v_add_f32 v6, v6, v44
v_fmac_f32 v7, v44, v44
v_add_f32 v6, v6, v45
v_fmac_f32 v7, v45, v45
v_add_f32 v6, v6, v46
v_fmac_f32 v7, v46, v46
v_add_f32 v6, v6, v47
v_fmac_f32 v7, v47, v47
s_nop 0
v_add_f32_dpp v6, v6, v6 row_ror:8 row_mask:0xf bank_mask:0xf
v_add_f32_dpp v7, v7, v7 row_ror:8 row_mask:0xf bank_mask:0xf
s_nop 1
v_permlane16_swap_b32 v6, v7
v_add_f32 v6, v6, v7
v_mov_b32 v7, v6
s_nop 1
v_permlane32_swap_b32 v6, v7
v_add_f32 v6, v6, v7
v_and_b32 v8, 31, v0
v_lshlrev_b32 v8, 2, v8
s_lshl_b32 s26, s24, 7
v_add_u32 v8, s26, v8
ds_write_b32 v8, v6
v_lshlrev_b32 v9, 2, v1
s_waitcnt lgkmcnt(0)
s_barrier
ds_read2_b32 v[12:13], v9 offset0:0 offset1:16
ds_read2_b32 v[14:15], v9 offset0:32 offset1:48
ds_read2_b32 v[16:17], v9 offset0:64 offset1:80
ds_read2_b32 v[18:19], v9 offset0:96 offset1:112
ds_read2_b32 v[20:21], v9 offset0:128 offset1:144
ds_read2_b32 v[22:23], v9 offset0:160 offset1:176
ds_read2_b32 v[24:25], v9 offset0:192 offset1:208
ds_read2_b32 v[26:27], v9 offset0:224 offset1:240
v_add_u32 v9, 1024, v9
ds_read2_b32 v[28:29], v9 offset0:0 offset1:16
s_waitcnt lgkmcnt(0)
v_add_f32 v12, v12, v14
v_add_f32 v13, v13, v15
v_add_f32 v12, v12, v16
v_add_f32 v13, v13, v17
v_add_f32 v12, v12, v18
v_add_f32 v13, v13, v19
v_add_f32 v12, v12, v20
v_add_f32 v13, v13, v21
v_add_f32 v12, v12, v22
v_add_f32 v13, v13, v23
v_add_f32 v12, v12, v24
v_add_f32 v13, v13, v25
v_add_f32 v12, v12, v26
v_add_f32 v13, v13, v27
v_add_f32 v12, v12, v28
v_add_f32 v13, v13, v29
v_mul_f32 v12, 0x3ae38e39, v12
v_mul_f32 v13, 0x3ae38e39, v13
v_fma_f32 v13, -v12, v12, v13
v_max_f32 v13, 0, v13
v_add_f32 v13, 0x3727c5ac, v13
v_rsq_f32 v10, v13
s_nop 0
v_mul_f32 v11, v12, v10
v_sub_f32 v11, 0, v11
v_fma_f32 v40, v40, v10, v11
v_fma_f32 v41, v41, v10, v11
v_fma_f32 v42, v42, v10, v11
v_fma_f32 v43, v43, v10, v11
v_fma_f32 v44, v44, v10, v11
v_fma_f32 v45, v45, v10, v11
v_fma_f32 v46, v46, v10, v11
v_fma_f32 v47, v47, v10, v11
s_cmp_lt_u32 s24, 4
s_cbranch_scc1 k0_nf
v_mov_b32 v7, -1
v_and_b32 v6, 255, v0
v_lshlrev_b32 v6, 2, v6
s_lshl_b32 s27, s2, 10
s_cmp_lg_u32 s24, 8
s_cbranch_scc1 k0_cf
v_lshlrev_b32 v6, 2, v6
v_mov_b32 v12, -1
v_mov_b32 v13, -1
v_mov_b32 v14, -1
v_mov_b32 v15, -1
s_mul_i32 s27, s2, 3072
s_add_u32 s27, s27, 262144
buffer_store_dwordx4 v[12:15], v6, s[32:35], s27 offen offset:0
buffer_store_dwordx4 v[12:15], v6, s[32:35], s27 offen offset:1024
buffer_store_dwordx4 v[12:15], v6, s[32:35], s27 offen offset:2048
s_branch k0_nf
k0_cf:
buffer_store_dword v7, v6, s[32:35], s27 offen
k0_nf:
v_cvt_pk_f16_f32 v32, v40, v41
v_cvt_pk_f16_f32 v33, v42, v43
v_cvt_pk_f16_f32 v34, v44, v45
v_cvt_pk_f16_f32 v35, v46, v47
buffer_store_dwordx4 v[32:35], v4, s[8:11], 0 offen
s_add_u32 s2, s2, 108
s_branch k0_fin
k0_gemv:
s_mov_b32 s3, s2
v_and_b32 v1, 3, v0
v_lshrrev_b32 v2, 2, v0
v_lshrrev_b32 v5, 6, v0
v_mul_u32_u24 v3, 6912, v2
v_readfirstlane_b32 s24, v5
v_lshl_add_u32 v3, v1, 4, v3
v_lshlrev_b32 v4, 1, v2
s_lshl_b32 s25, s3, 6
s_waitcnt lgkmcnt(0)
s_add_u32 s8, s8, 65536
s_addc_u32 s9, s9, 0
s_add_u32 s32, s32, 9437184
s_addc_u32 s33, s33, 0
buffer_load_ushort v8, v4, s[16:19], 0 offen offset:0
buffer_load_ushort v9, v4, s[16:19], 0 offen offset:288
buffer_load_ushort v10, v4, s[16:19], 0 offen offset:576
buffer_load_ushort v11, v4, s[16:19], 0 offen offset:864
buffer_load_dwordx4 v[16:19], v3, s[12:15], s25 offen
s_add_u32 s25, s25, 995328
buffer_load_dwordx4 v[20:23], v3, s[12:15], s25 offen
s_add_u32 s25, s25, 995328
buffer_load_dwordx4 v[24:27], v3, s[12:15], s25 offen
s_add_u32 s25, s25, 995328
buffer_load_dwordx4 v[28:31], v3, s[12:15], s25 offen
s_add_u32 s25, s25, 995328
s_waitcnt vmcnt(4)
v_lshlrev_b32 v8, 16, v8
v_mul_f32 v12, 0xbfb8aa3b, v8
v_exp_f32 v12, v12
s_nop 0
v_add_f32 v12, 1.0, v12
v_rcp_f32 v12, v12
s_nop 0
v_mul_f32 v12, v12, v8
v_cvt_pk_bf16_f32 v12, v12, v12
v_lshlrev_b32 v8, 16, v12
v_lshlrev_b32 v9, 16, v9
v_mul_f32 v12, 0xbfb8aa3b, v9
v_exp_f32 v12, v12
s_nop 0
v_add_f32 v12, 1.0, v12
v_rcp_f32 v12, v12
s_nop 0
v_mul_f32 v12, v12, v9
v_cvt_pk_bf16_f32 v12, v12, v12
v_lshlrev_b32 v9, 16, v12
v_lshlrev_b32 v10, 16, v10
v_mul_f32 v12, 0xbfb8aa3b, v10
v_exp_f32 v12, v12
s_nop 0
v_add_f32 v12, 1.0, v12
v_rcp_f32 v12, v12
s_nop 0
v_mul_f32 v12, v12, v10
v_cvt_pk_bf16_f32 v12, v12, v12
v_lshlrev_b32 v10, 16, v12
v_lshlrev_b32 v11, 16, v11
v_mul_f32 v12, 0xbfb8aa3b, v11
v_exp_f32 v12, v12
s_nop 0
v_add_f32 v12, 1.0, v12
v_rcp_f32 v12, v12
s_nop 0
v_mul_f32 v12, v12, v11
v_cvt_pk_bf16_f32 v12, v12, v12
v_lshlrev_b32 v11, 16, v12
s_waitcnt vmcnt(3)
v_lshlrev_b32 v32, 16, v16
v_and_b32 v33, 0xffff0000, v16
v_lshlrev_b32 v34, 16, v17
v_and_b32 v35, 0xffff0000, v17
v_lshlrev_b32 v36, 16, v18
v_and_b32 v37, 0xffff0000, v18
v_lshlrev_b32 v38, 16, v19
v_and_b32 v39, 0xffff0000, v19
v_mul_f32 v40, v8, v32
v_mul_f32 v41, v8, v33
v_mul_f32 v42, v8, v34
v_mul_f32 v43, v8, v35
v_mul_f32 v44, v8, v36
v_mul_f32 v45, v8, v37
v_mul_f32 v46, v8, v38
v_mul_f32 v47, v8, v39
s_waitcnt vmcnt(2)
v_lshlrev_b32 v32, 16, v20
v_and_b32 v33, 0xffff0000, v20
v_lshlrev_b32 v34, 16, v21
v_and_b32 v35, 0xffff0000, v21
v_lshlrev_b32 v36, 16, v22
v_and_b32 v37, 0xffff0000, v22
v_lshlrev_b32 v38, 16, v23
v_and_b32 v39, 0xffff0000, v23
v_fmac_f32 v40, v9, v32
v_fmac_f32 v41, v9, v33
v_fmac_f32 v42, v9, v34
v_fmac_f32 v43, v9, v35
v_fmac_f32 v44, v9, v36
v_fmac_f32 v45, v9, v37
v_fmac_f32 v46, v9, v38
v_fmac_f32 v47, v9, v39
s_waitcnt vmcnt(1)
v_lshlrev_b32 v32, 16, v24
v_and_b32 v33, 0xffff0000, v24
v_lshlrev_b32 v34, 16, v25
v_and_b32 v35, 0xffff0000, v25
v_lshlrev_b32 v36, 16, v26
v_and_b32 v37, 0xffff0000, v26
v_lshlrev_b32 v38, 16, v27
v_and_b32 v39, 0xffff0000, v27
v_fmac_f32 v40, v10, v32
v_fmac_f32 v41, v10, v33
v_fmac_f32 v42, v10, v34
v_fmac_f32 v43, v10, v35
v_fmac_f32 v44, v10, v36
v_fmac_f32 v45, v10, v37
v_fmac_f32 v46, v10, v38
v_fmac_f32 v47, v10, v39
s_waitcnt vmcnt(0)
v_lshlrev_b32 v32, 16, v28
v_and_b32 v33, 0xffff0000, v28
v_lshlrev_b32 v34, 16, v29
v_and_b32 v35, 0xffff0000, v29
v_lshlrev_b32 v36, 16, v30
v_and_b32 v37, 0xffff0000, v30
v_lshlrev_b32 v38, 16, v31
v_and_b32 v39, 0xffff0000, v31
v_fmac_f32 v40, v11, v32
v_fmac_f32 v41, v11, v33
v_fmac_f32 v42, v11, v34
v_fmac_f32 v43, v11, v35
v_fmac_f32 v44, v11, v36
v_fmac_f32 v45, v11, v37
v_fmac_f32 v46, v11, v38
v_fmac_f32 v47, v11, v39
v_add_f32_dpp v40, v40, v40 row_ror:4 row_mask:0xf bank_mask:0xf
v_add_f32_dpp v41, v41, v41 row_ror:4 row_mask:0xf bank_mask:0xf
v_add_f32_dpp v42, v42, v42 row_ror:4 row_mask:0xf bank_mask:0xf
v_add_f32_dpp v43, v43, v43 row_ror:4 row_mask:0xf bank_mask:0xf
v_add_f32_dpp v44, v44, v44 row_ror:4 row_mask:0xf bank_mask:0xf
v_add_f32_dpp v45, v45, v45 row_ror:4 row_mask:0xf bank_mask:0xf
v_add_f32_dpp v46, v46, v46 row_ror:4 row_mask:0xf bank_mask:0xf
v_add_f32_dpp v47, v47, v47 row_ror:4 row_mask:0xf bank_mask:0xf
v_add_f32_dpp v40, v40, v40 row_ror:8 row_mask:0xf bank_mask:0xf
v_add_f32_dpp v41, v41, v41 row_ror:8 row_mask:0xf bank_mask:0xf
v_add_f32_dpp v42, v42, v42 row_ror:8 row_mask:0xf bank_mask:0xf
v_add_f32_dpp v43, v43, v43 row_ror:8 row_mask:0xf bank_mask:0xf
v_add_f32_dpp v44, v44, v44 row_ror:8 row_mask:0xf bank_mask:0xf
v_add_f32_dpp v45, v45, v45 row_ror:8 row_mask:0xf bank_mask:0xf
v_add_f32_dpp v46, v46, v46 row_ror:8 row_mask:0xf bank_mask:0xf
v_add_f32_dpp v47, v47, v47 row_ror:8 row_mask:0xf bank_mask:0xf
v_permlane16_swap_b32 v40, v44
v_permlane16_swap_b32 v41, v45
v_permlane16_swap_b32 v42, v46
v_permlane16_swap_b32 v43, v47
v_add_f32 v40, v40, v44
v_add_f32 v41, v41, v45
v_add_f32 v42, v42, v46
v_add_f32 v43, v43, v47
s_nop 0
v_permlane32_swap_b32 v40, v42
v_permlane32_swap_b32 v41, v43
v_add_f32 v40, v40, v42
v_add_f32 v41, v41, v43
v_and_b32 v6, 16, v0
v_bfe_u32 v7, v0, 5, 1
v_lshl_add_u32 v6, v7, 3, v6
v_lshl_add_u32 v6, v1, 5, v6
s_lshl_b32 s26, s24, 7
v_add_u32 v6, s26, v6
ds_write_b64 v6, v[40:41]
s_waitcnt lgkmcnt(0)
s_barrier
s_cmp_lg_u32 s24, 0
s_cbranch_scc1 k0_kernel_end
v_and_b32 v6, 31, v0
v_lshlrev_b32 v6, 2, v6
ds_read_b32 v16, v6 offset:0
ds_read_b32 v17, v6 offset:128
ds_read_b32 v18, v6 offset:256
ds_read_b32 v19, v6 offset:384
ds_read_b32 v20, v6 offset:512
ds_read_b32 v21, v6 offset:640
ds_read_b32 v22, v6 offset:768
ds_read_b32 v23, v6 offset:896
ds_read_b32 v24, v6 offset:1024
s_mul_i32 s26, s3, 3641
s_lshr_b32 s26, s26, 16
s_lshl_b32 s27, s3, 7
s_cmp_eq_u32 s26, 1
s_cselect_b32 s28, 1.0, 0
s_cmp_eq_u32 s26, 4
s_cselect_b32 s28, 1.0, s28
s_cmp_lt_u32 s26, 2
s_cselect_b32 s29, 0x3e0293ee, 1.0
s_waitcnt lgkmcnt(0)
v_add_f32 v16, v16, v17
v_add_f32 v16, v16, v18
v_add_f32 v16, v16, v19
v_add_f32 v16, v16, v20
v_add_f32 v16, v16, v21
v_add_f32 v16, v16, v22
v_add_f32 v16, v16, v23
v_add_f32 v16, v16, v24
v_cvt_pk_bf16_f32 v16, v16, v16
v_lshlrev_b32 v16, 16, v16
v_add_f32 v16, s28, v16
v_cvt_pk_bf16_f32 v16, v16, v16
v_lshlrev_b32 v16, 16, v16
v_mul_f32 v16, s29, v16
buffer_store_dword v16, v6, s[20:23], s27 offen
k0_fin:
k0_kernel_end:
s_endpgm
.globl k1_kernel
.p2align 8
.type k1_kernel,@function
k1_kernel:
s_cmp_ge_u32 s2, 256
s_cbranch_scc1 k1_kernel_end
s_load_dwordx2 s[4:5], s[0:1], 24
s_load_dwordx2 s[8:9], s[0:1], 112
s_load_dwordx2 s[12:13], s[0:1], 112
s_load_dwordx2 s[96:97], s[0:1], 112
s_load_dwordx2 s[16:17], s[0:1], 8
s_load_dwordx2 s[20:21], s[0:1], 16
s_load_dwordx2 s[48:49], s[0:1], 56
s_load_dwordx2 s[76:77], s[0:1], 112
s_load_dwordx2 s[80:81], s[0:1], 32
s_load_dwordx2 s[84:85], s[0:1], 48
s_load_dwordx2 s[88:89], s[0:1], 112
s_mov_b32 s6, 4718592
s_mov_b32 s7, 0x20000
s_mov_b32 s10, 2359296
s_mov_b32 s11, 0x20000
s_mov_b32 s14, 16777216
s_mov_b32 s15, 0x20000
s_mov_b32 s98, 16384
s_mov_b32 s99, 0x20000
s_mov_b32 s18, 8388608
s_mov_b32 s19, 0x20000
s_mov_b32 s22, 8388608
s_mov_b32 s23, 0x20000
s_mov_b32 s50, 8388608
s_mov_b32 s51, 0x20000
s_mov_b32 s78, 8388608
s_mov_b32 s79, 0x20000
s_mov_b32 s82, 4718592
s_mov_b32 s83, 0x20000
s_mov_b32 s86, 5308416
s_mov_b32 s87, 0x20000
s_mov_b32 s90, 1310720
s_mov_b32 s91, 0x20000
v_lshrrev_b32 v2, 6, v0
v_and_b32 v1, 63, v0
v_readfirstlane_b32 s24, v2
s_and_b32 s26, s2, 3
s_lshl_b32 s26, s26, 2
s_bfe_u32 s3, s2, 0x20003
s_add_u32 s26, s26, s3
s_bfe_u32 s25, s2, 0x10002
s_lshl_b32 s25, s25, 3
s_lshr_b32 s3, s2, 5
s_add_u32 s25, s25, s3
s_lshl_b32 s34, s25, 2
s_add_u32 s34, s34, s24
s_lshl_b32 s28, s26, 9
s_mul_i32 s29, s34, 36864
s_lshl_b32 s36, s26, 19
s_add_u32 s36, s36, 393216
s_add_u32 s37, s36, 8192
s_mov_b32 s38, s36
s_lshl_b32 s35, s34, 18
s_lshl_b32 s3, s26, 13
s_add_u32 s35, s35, s3
s_lshl_b32 s30, s24, 12
s_lshl_b32 s33, s24, 11
v_lshrrev_b32 v3, 5, v1
v_and_b32 v4, 31, v1
v_lshrrev_b32 v5, 4, v1
v_and_b32 v6, 15, v1
v_lshlrev_b32 v7, 3, v2
v_add_u32 v8, 0, v3
v_and_b32 v9, 3, v8
v_lshlrev_b32 v9, 2, v9
v_xor_b32 v9, v9, v4
v_add_u32 v8, v8, v7
v_lshlrev_b32 v8, 13, v8
v_lshl_add_u32 v240, v9, 4, v8
v_add_u32 v8, 2, v3
v_and_b32 v9, 3, v8
v_lshlrev_b32 v9, 2, v9
v_xor_b32 v9, v9, v4
v_add_u32 v8, v8, v7
v_lshlrev_b32 v8, 13, v8
v_lshl_add_u32 v241, v9, 4, v8
v_add_u32 v8, 4, v3
v_and_b32 v9, 3, v8
v_lshlrev_b32 v9, 2, v9
v_xor_b32 v9, v9, v4
v_add_u32 v8, v8, v7
v_lshlrev_b32 v8, 13, v8
v_lshl_add_u32 v242, v9, 4, v8
v_add_u32 v8, 6, v3
v_and_b32 v9, 3, v8
v_lshlrev_b32 v9, 2, v9
v_xor_b32 v9, v9, v4
v_add_u32 v8, v8, v7
v_lshlrev_b32 v8, 13, v8
v_lshl_add_u32 v243, v9, 4, v8
v_add3_u32 v8, v7, v5, 0
v_and_b32 v9, 15, v8
v_xor_b32 v9, v9, v6
v_lshlrev_b32 v8, 8, v8
v_lshl_add_u32 v244, v9, 4, v8
v_lshlrev_b32 v9, 2, v5
v_xor_b32 v9, v9, v6
v_lshl_add_u32 v246, v9, 4, v8
v_add3_u32 v8, v7, v5, 4
v_and_b32 v9, 15, v8
v_xor_b32 v9, v9, v6
v_lshlrev_b32 v8, 8, v8
v_lshl_add_u32 v245, v9, 4, v8
v_lshlrev_b32 v9, 2, v5
v_xor_b32 v9, v9, v6
v_lshl_add_u32 v247, v9, 4, v8
v_subrev_u32 v241, 1024, v241
v_subrev_u32 v242, 2048, v242
v_subrev_u32 v243, 3072, v243
v_subrev_u32 v245, 1024, v245
v_subrev_u32 v247, 1024, v247
v_and_b32 v8, 1, v5
v_lshlrev_b32 v9, 4, v6
v_lshl_add_u32 v9, v3, 8, v9
v_mul_u32_u24 v10, 18432, v8
v_add_u32 v248, v9, v10
v_lshl_add_u32 v252, v8, 17, v9
s_waitcnt lgkmcnt(0)
s_add_u32 s8, s8, 65536
s_addc_u32 s9, s9, 0
s_add_u32 s12, s12, 16777216
s_addc_u32 s13, s13, 0
s_add_u32 s76, s76, 100663296
s_addc_u32 s77, s77, 0
s_add_u32 s88, s88, 9437184
s_addc_u32 s89, s89, 0
v_lshlrev_b32 v253, 4, v1
s_lshl_b32 s3, s24, 10
s_add_u32 m0, s3, 0x20000
v_lshlrev_b32 v249, 5, v3
v_add_u32 v249, 0x20000, v249
buffer_load_dwordx4 v253, s[96:99], s3 offen lds
s_add_u32 m0, s3, 0x21000
s_add_u32 s3, s3, 4096
buffer_load_dwordx4 v253, s[96:99], s3 offen lds
s_add_u32 m0, s30, 98304
buffer_load_dwordx4 v[128:131], v248, s[8:11], s29 offen offset:0
buffer_load_dwordx4 v[132:135], v248, s[8:11], s29 offen offset:512
s_add_u32 s29, s29, 1024
buffer_load_dwordx4 v240, s[4:7], s28 offen offset:0 lds
buffer_load_dwordx4 v241, s[4:7], s28 offen offset:1024 lds
buffer_load_dwordx4 v242, s[4:7], s28 offen offset:2048 lds
buffer_load_dwordx4 v243, s[4:7], s28 offen offset:3072 lds
s_add_u32 s28, s28, 262144
s_add_u32 m0, s30, 114688
buffer_load_dwordx4 v[136:139], v248, s[8:11], s29 offen offset:0
buffer_load_dwordx4 v[140:143], v248, s[8:11], s29 offen offset:512
s_add_u32 s29, s29, 1024
buffer_load_dwordx4 v240, s[4:7], s28 offen offset:0 lds
buffer_load_dwordx4 v241, s[4:7], s28 offen offset:1024 lds
buffer_load_dwordx4 v242, s[4:7], s28 offen offset:2048 lds
buffer_load_dwordx4 v243, s[4:7], s28 offen offset:3072 lds
s_add_u32 s28, s28, 262144
s_add_u32 m0, s30, 0
buffer_load_dwordx4 v[144:147], v248, s[8:11], s29 offen offset:0
buffer_load_dwordx4 v[148:151], v248, s[8:11], s29 offen offset:512
s_add_u32 s29, s29, 1024
buffer_load_dwordx4 v240, s[4:7], s28 offen offset:0 lds
buffer_load_dwordx4 v241, s[4:7], s28 offen offset:1024 lds
buffer_load_dwordx4 v242, s[4:7], s28 offen offset:2048 lds
buffer_load_dwordx4 v243, s[4:7], s28 offen offset:3072 lds
s_add_u32 s28, s28, 262144
s_lshl_b32 s43, s25, 4
s_add_u32 s43, s43, s26
s_lshl_b32 s3, s26, 2
s_add_u32 s3, s3, s24
s_lshl_b32 s3, s3, 4
s_add_u32 s3, s3, s25
s_lshr_b32 s47, s3, 3
s_lshl_b32 s47, s47, 16
s_and_b32 s92, s3, 7
s_lshl_b32 s92, s92, 9
s_add_u32 s47, s47, s92
s_lshl_b32 s92, s3, 13
v_lshlrev_b32 v254, 12, v6
v_lshl_add_u32 v254, v5, 4, v254
v_lshlrev_b32 v255, 7, v1
s_mul_i32 s93, s3, 5248
v_add_u32 v255, s93, v255
v_mov_b32 v8, 0x40000000
v_cmp_gt_u32 vcc, 41, v1
s_nop 1
v_cndmask_b32 v255, v8, v255, vcc
s_add_u32 s94, s92, 4096
s_mov_b32 s95, 3641
v_add_u32 v15, 0, v1
v_mul_lo_u32 v16, v15, s95
v_lshrrev_b32 v16, 16, v16
v_mul_u32_u24 v17, 18, v16
v_sub_u32 v15, v15, v17
v_and_b32 v17, 0x13, v16
v_bfe_u32 v18, v16, 2, 1
v_lshl_add_u32 v17, v18, 3, v17
v_bfe_u32 v18, v16, 3, 1
v_lshl_add_u32 v17, v18, 2, v17
v_mul_u32_u24 v17, 9216, v17
v_lshl_add_u32 v17, v15, 4, v17
v_subrev_u32 v14, 0, v17
v_accvgpr_write_b32 a228, v14
v_add_u32 v15, 64, v1
v_mul_lo_u32 v16, v15, s95
v_lshrrev_b32 v16, 16, v16
v_mul_u32_u24 v17, 18, v16
v_sub_u32 v15, v15, v17
v_and_b32 v17, 0x13, v16
v_bfe_u32 v18, v16, 2, 1
v_lshl_add_u32 v17, v18, 3, v17
v_bfe_u32 v18, v16, 3, 1
v_lshl_add_u32 v17, v18, 2, v17
v_mul_u32_u24 v17, 9216, v17
v_lshl_add_u32 v17, v15, 4, v17
v_subrev_u32 v14, 1024, v17
v_accvgpr_write_b32 a229, v14
v_add_u32 v15, 128, v1
v_mul_lo_u32 v16, v15, s95
v_lshrrev_b32 v16, 16, v16
v_mul_u32_u24 v17, 18, v16
v_sub_u32 v15, v15, v17
v_and_b32 v17, 0x13, v16
v_bfe_u32 v18, v16, 2, 1
v_lshl_add_u32 v17, v18, 3, v17
v_bfe_u32 v18, v16, 3, 1
v_lshl_add_u32 v17, v18, 2, v17
v_mul_u32_u24 v17, 9216, v17
v_lshl_add_u32 v17, v15, 4, v17
v_subrev_u32 v14, 2048, v17
v_accvgpr_write_b32 a230, v14
v_add_u32 v15, 192, v1
v_mul_lo_u32 v16, v15, s95
v_lshrrev_b32 v16, 16, v16
v_mul_u32_u24 v17, 18, v16
v_sub_u32 v15, v15, v17
v_and_b32 v17, 0x13, v16
v_bfe_u32 v18, v16, 2, 1
v_lshl_add_u32 v17, v18, 3, v17
v_bfe_u32 v18, v16, 3, 1
v_lshl_add_u32 v17, v18, 2, v17
v_mul_u32_u24 v17, 9216, v17
v_lshl_add_u32 v17, v15, 4, v17
v_subrev_u32 v14, 3072, v17
v_accvgpr_write_b32 a231, v14
v_add_u32 v15, 256, v1
v_mul_lo_u32 v16, v15, s95
v_lshrrev_b32 v16, 16, v16
v_mul_u32_u24 v17, 18, v16
v_sub_u32 v15, v15, v17
v_and_b32 v17, 0x13, v16
v_bfe_u32 v18, v16, 2, 1
v_lshl_add_u32 v17, v18, 3, v17
v_bfe_u32 v18, v16, 3, 1
v_lshl_add_u32 v17, v18, 2, v17
v_mul_u32_u24 v17, 9216, v17
v_lshl_add_u32 v17, v15, 4, v17
v_subrev_u32 v14, 0, v17
v_accvgpr_write_b32 a232, v14
v_add_u32 v15, 320, v1
v_mul_lo_u32 v16, v15, s95
v_lshrrev_b32 v16, 16, v16
v_mul_u32_u24 v17, 18, v16
v_sub_u32 v15, v15, v17
v_and_b32 v17, 0x13, v16
v_bfe_u32 v18, v16, 2, 1
v_lshl_add_u32 v17, v18, 3, v17
v_bfe_u32 v18, v16, 3, 1
v_lshl_add_u32 v17, v18, 2, v17
v_mul_u32_u24 v17, 9216, v17
v_lshl_add_u32 v17, v15, 4, v17
v_subrev_u32 v14, 1024, v17
v_accvgpr_write_b32 a233, v14
v_add_u32 v15, 384, v1
v_mul_lo_u32 v16, v15, s95
v_lshrrev_b32 v16, 16, v16
v_mul_u32_u24 v17, 18, v16
v_sub_u32 v15, v15, v17
v_and_b32 v17, 0x13, v16
v_bfe_u32 v18, v16, 2, 1
v_lshl_add_u32 v17, v18, 3, v17
v_bfe_u32 v18, v16, 3, 1
v_lshl_add_u32 v17, v18, 2, v17
v_mul_u32_u24 v17, 9216, v17
v_lshl_add_u32 v17, v15, 4, v17
v_subrev_u32 v14, 2048, v17
v_accvgpr_write_b32 a234, v14
v_add_u32 v15, 448, v1
v_mul_lo_u32 v16, v15, s95
v_lshrrev_b32 v16, 16, v16
v_mul_u32_u24 v17, 18, v16
v_sub_u32 v15, v15, v17
v_and_b32 v17, 0x13, v16
v_bfe_u32 v18, v16, 2, 1
v_lshl_add_u32 v17, v18, 3, v17
v_bfe_u32 v18, v16, 3, 1
v_lshl_add_u32 v17, v18, 2, v17
v_mul_u32_u24 v17, 9216, v17
v_lshl_add_u32 v17, v15, 4, v17
v_subrev_u32 v14, 3072, v17
v_accvgpr_write_b32 a235, v14
v_add_u32 v15, 512, v1
v_mul_lo_u32 v16, v15, s95
v_lshrrev_b32 v16, 16, v16
v_mul_u32_u24 v17, 18, v16
v_sub_u32 v15, v15, v17
v_and_b32 v17, 0x13, v16
v_bfe_u32 v18, v16, 2, 1
v_lshl_add_u32 v17, v18, 3, v17
v_bfe_u32 v18, v16, 3, 1
v_lshl_add_u32 v17, v18, 2, v17
v_mul_u32_u24 v17, 9216, v17
v_lshl_add_u32 v17, v15, 4, v17
v_subrev_u32 v14, 0, v17
v_accvgpr_write_b32 a236, v14
v_bfe_u32 v8, v1, 2, 2
v_and_b32 v9, 1, v1
v_bfe_u32 v10, v1, 1, 1
v_lshl_add_u32 v9, v9, 1, v10
v_lshlrev_b32 v9, 3, v9
v_and_b32 v10, 1, v5
v_lshl_add_u32 v9, v10, 5, v9
v_lshl_add_u32 v10, v3, 3, v8
v_lshlrev_b32 v10, 9, v10
v_add_u32 v10, 0x10000, v10
v_lshl_add_u32 v11, v3, 2, v8
v_lshlrev_b32 v11, 8, v11
v_xor_b32 v12, 0, v8
v_lshl_add_u32 v12, v12, 6, v9
v_add_u32 v224, v12, v10
v_add_u32 v236, v12, v11
v_xor_b32 v12, 1, v8
v_lshl_add_u32 v12, v12, 6, v9
v_add_u32 v225, v12, v10
v_add_u32 v237, v12, v11
v_xor_b32 v12, 2, v8
v_lshl_add_u32 v12, v12, 6, v9
v_add_u32 v226, v12, v10
v_add_u32 v238, v12, v11
v_xor_b32 v12, 3, v8
v_lshl_add_u32 v12, v12, 6, v9
v_add_u32 v227, v12, v10
v_add_u32 v239, v12, v11
v_xor_b32 v8, v3, v6
v_lshlrev_b32 v8, 4, v8
v_lshl_add_u32 v228, v4, 8, v8
v_xor_b32 v229, 32, v228
v_xor_b32 v230, 64, v228
v_xor_b32 v231, 96, v228
v_xor_b32 v232, 128, v228
v_xor_b32 v233, 160, v228
v_xor_b32 v234, 192, v228
v_xor_b32 v235, 224, v228
v_accvgpr_write_b32 a0, 0
v_accvgpr_write_b32 a1, 0
v_accvgpr_write_b32 a2, 0
v_accvgpr_write_b32 a3, 0
v_accvgpr_write_b32 a4, 0
v_accvgpr_write_b32 a5, 0
v_accvgpr_write_b32 a6, 0
v_accvgpr_write_b32 a7, 0
v_accvgpr_write_b32 a8, 0
v_accvgpr_write_b32 a9, 0
v_accvgpr_write_b32 a10, 0
v_accvgpr_write_b32 a11, 0
v_accvgpr_write_b32 a12, 0
v_accvgpr_write_b32 a13, 0
v_accvgpr_write_b32 a14, 0
v_accvgpr_write_b32 a15, 0
v_accvgpr_write_b32 a16, 0
v_accvgpr_write_b32 a17, 0
v_accvgpr_write_b32 a18, 0
v_accvgpr_write_b32 a19, 0
v_accvgpr_write_b32 a20, 0
v_accvgpr_write_b32 a21, 0
v_accvgpr_write_b32 a22, 0
v_accvgpr_write_b32 a23, 0
v_accvgpr_write_b32 a24, 0
v_accvgpr_write_b32 a25, 0
v_accvgpr_write_b32 a26, 0
v_accvgpr_write_b32 a27, 0
v_accvgpr_write_b32 a28, 0
v_accvgpr_write_b32 a29, 0
v_accvgpr_write_b32 a30, 0
v_accvgpr_write_b32 a31, 0
v_accvgpr_write_b32 a32, 0
v_accvgpr_write_b32 a33, 0
v_accvgpr_write_b32 a34, 0
v_accvgpr_write_b32 a35, 0
v_accvgpr_write_b32 a36, 0
v_accvgpr_write_b32 a37, 0
v_accvgpr_write_b32 a38, 0
v_accvgpr_write_b32 a39, 0
v_accvgpr_write_b32 a40, 0
v_accvgpr_write_b32 a41, 0
v_accvgpr_write_b32 a42, 0
v_accvgpr_write_b32 a43, 0
v_accvgpr_write_b32 a44, 0
v_accvgpr_write_b32 a45, 0
v_accvgpr_write_b32 a46, 0
v_accvgpr_write_b32 a47, 0
v_accvgpr_write_b32 a48, 0
v_accvgpr_write_b32 a49, 0
v_accvgpr_write_b32 a50, 0
v_accvgpr_write_b32 a51, 0
v_accvgpr_write_b32 a52, 0
v_accvgpr_write_b32 a53, 0
v_accvgpr_write_b32 a54, 0
v_accvgpr_write_b32 a55, 0
v_accvgpr_write_b32 a56, 0
v_accvgpr_write_b32 a57, 0
v_accvgpr_write_b32 a58, 0
v_accvgpr_write_b32 a59, 0
v_accvgpr_write_b32 a60, 0
v_accvgpr_write_b32 a61, 0
v_accvgpr_write_b32 a62, 0
v_accvgpr_write_b32 a63, 0
v_accvgpr_write_b32 a64, 0
v_accvgpr_write_b32 a65, 0
v_accvgpr_write_b32 a66, 0
v_accvgpr_write_b32 a67, 0
v_accvgpr_write_b32 a68, 0
v_accvgpr_write_b32 a69, 0
v_accvgpr_write_b32 a70, 0
v_accvgpr_write_b32 a71, 0
v_accvgpr_write_b32 a72, 0
v_accvgpr_write_b32 a73, 0
v_accvgpr_write_b32 a74, 0
v_accvgpr_write_b32 a75, 0
v_accvgpr_write_b32 a76, 0
v_accvgpr_write_b32 a77, 0
v_accvgpr_write_b32 a78, 0
v_accvgpr_write_b32 a79, 0
v_accvgpr_write_b32 a80, 0
v_accvgpr_write_b32 a81, 0
v_accvgpr_write_b32 a82, 0
v_accvgpr_write_b32 a83, 0
v_accvgpr_write_b32 a84, 0
v_accvgpr_write_b32 a85, 0
v_accvgpr_write_b32 a86, 0
v_accvgpr_write_b32 a87, 0
v_accvgpr_write_b32 a88, 0
v_accvgpr_write_b32 a89, 0
v_accvgpr_write_b32 a90, 0
v_accvgpr_write_b32 a91, 0
v_accvgpr_write_b32 a92, 0
v_accvgpr_write_b32 a93, 0
v_accvgpr_write_b32 a94, 0
v_accvgpr_write_b32 a95, 0
v_accvgpr_write_b32 a96, 0
v_accvgpr_write_b32 a97, 0
v_accvgpr_write_b32 a98, 0
v_accvgpr_write_b32 a99, 0
v_accvgpr_write_b32 a100, 0
v_accvgpr_write_b32 a101, 0
v_accvgpr_write_b32 a102, 0
v_accvgpr_write_b32 a103, 0
v_accvgpr_write_b32 a104, 0
v_accvgpr_write_b32 a105, 0
v_accvgpr_write_b32 a106, 0
v_accvgpr_write_b32 a107, 0
v_accvgpr_write_b32 a108, 0
v_accvgpr_write_b32 a109, 0
v_accvgpr_write_b32 a110, 0
v_accvgpr_write_b32 a111, 0
v_accvgpr_write_b32 a112, 0
v_accvgpr_write_b32 a113, 0
v_accvgpr_write_b32 a114, 0
v_accvgpr_write_b32 a115, 0
v_accvgpr_write_b32 a116, 0
v_accvgpr_write_b32 a117, 0
v_accvgpr_write_b32 a118, 0
v_accvgpr_write_b32 a119, 0
v_accvgpr_write_b32 a120, 0
v_accvgpr_write_b32 a121, 0
v_accvgpr_write_b32 a122, 0
v_accvgpr_write_b32 a123, 0
v_accvgpr_write_b32 a124, 0
v_accvgpr_write_b32 a125, 0
v_accvgpr_write_b32 a126, 0
v_accvgpr_write_b32 a127, 0
v_mov_b32 v250, 0
v_mov_b32 v251, 0
s_mov_b32 s44, 0x42900000
s_mov_b32 s45, 0x42400000
s_waitcnt vmcnt(12)
s_barrier
ds_read_b128 v[192:195], v249 offset:0
ds_read_b128 v[196:199], v249 offset:16
ds_read_b128 v[200:203], v249 offset:2304
ds_read_b128 v[204:207], v249 offset:2320
ds_read_b128 v[208:211], v249 offset:64
ds_read_b128 v[212:215], v249 offset:80
ds_read_b128 v[216:219], v249 offset:2368
ds_read_b128 v[220:223], v249 offset:2384
ds_read_b64_tr_b16 a[128:129], v224 offset:32768
ds_read_b64_tr_b16 a[130:131], v224 offset:34816
ds_read_b64_tr_b16 a[132:133], v225 offset:32768
ds_read_b64_tr_b16 a[134:135], v225 offset:34816
ds_read_b64_tr_b16 a[136:137], v226 offset:32768
ds_read_b64_tr_b16 a[138:139], v226 offset:34816
ds_read_b64_tr_b16 a[140:141], v227 offset:32768
ds_read_b64_tr_b16 a[142:143], v227 offset:34816
ds_read_b64_tr_b16 a[144:145], v224 offset:33024
ds_read_b64_tr_b16 a[146:147], v224 offset:35072
ds_read_b64_tr_b16 a[148:149], v225 offset:33024
ds_read_b64_tr_b16 a[150:151], v225 offset:35072
ds_read_b64_tr_b16 a[152:153], v226 offset:33024
ds_read_b64_tr_b16 a[154:155], v226 offset:35072
ds_read_b64_tr_b16 a[156:157], v227 offset:33024
ds_read_b64_tr_b16 a[158:159], v227 offset:35072
s_waitcnt lgkmcnt(15)
v_fma_mix_f32 v192, v128, v200, v192 op_sel:[0,0,0] op_sel_hi:[1,0,0]
v_fma_mix_f32 v193, v128, v201, v193 op_sel:[1,0,0] op_sel_hi:[1,0,0]
v_fma_mix_f32 v194, v129, v202, v194 op_sel:[0,0,0] op_sel_hi:[1,0,0]
v_fma_mix_f32 v195, v129, v203, v195 op_sel:[1,0,0] op_sel_hi:[1,0,0]
v_fma_mix_f32 v196, v130, v204, v196 op_sel:[0,0,0] op_sel_hi:[1,0,0]
v_fma_mix_f32 v197, v130, v205, v197 op_sel:[1,0,0] op_sel_hi:[1,0,0]
v_fma_mix_f32 v198, v131, v206, v198 op_sel:[0,0,0] op_sel_hi:[1,0,0]
v_fma_mix_f32 v199, v131, v207, v199 op_sel:[1,0,0] op_sel_hi:[1,0,0]
v_cvt_pk_bf16_f32 v128, v192, v193
v_cvt_pk_bf16_f32 v129, v194, v195
v_cvt_pk_bf16_f32 v130, v196, v197
v_cvt_pk_bf16_f32 v131, v198, v199
s_waitcnt lgkmcnt(0)
s_nop 0
v_mfma_f32_32x32x16_bf16 v[0:15], a[128:131], v[128:131], 0
ds_read_b64_tr_b16 a[160:161], v224 offset:40960
ds_read_b64_tr_b16 a[162:163], v224 offset:43008
ds_read_b64_tr_b16 a[164:165], v225 offset:40960
v_fma_mix_f32 v208, v132, v216, v208 op_sel:[0,0,0] op_sel_hi:[1,0,0]
v_mfma_f32_32x32x16_bf16 v[16:31], a[132:135], v[128:131], 0
ds_read_b64_tr_b16 a[166:167], v225 offset:43008
ds_read_b64_tr_b16 a[168:169], v226 offset:40960
ds_read_b64_tr_b16 a[170:171], v226 offset:43008
v_fma_mix_f32 v209, v132, v217, v209 op_sel:[1,0,0] op_sel_hi:[1,0,0]
v_mfma_f32_32x32x16_bf16 v[32:47], a[136:139], v[128:131], 0
ds_read_b64_tr_b16 a[172:173], v227 offset:40960
ds_read_b64_tr_b16 a[174:175], v227 offset:43008
ds_read_b64_tr_b16 a[176:177], v224 offset:41216
v_fma_mix_f32 v210, v133, v218, v210 op_sel:[0,0,0] op_sel_hi:[1,0,0]
v_mfma_f32_32x32x16_bf16 v[48:63], a[140:143], v[128:131], 0
ds_read_b64_tr_b16 a[178:179], v224 offset:43264
ds_read_b64_tr_b16 a[180:181], v225 offset:41216
ds_read_b64_tr_b16 a[182:183], v225 offset:43264
v_fma_mix_f32 v211, v133, v219, v211 op_sel:[1,0,0] op_sel_hi:[1,0,0]
v_mfma_f32_32x32x16_bf16 v[64:79], a[144:147], v[128:131], 0
ds_read_b64_tr_b16 a[184:185], v226 offset:41216
ds_read_b64_tr_b16 a[186:187], v226 offset:43264
ds_read_b64_tr_b16 a[188:189], v227 offset:41216
v_fma_mix_f32 v212, v134, v220, v212 op_sel:[0,0,0] op_sel_hi:[1,0,0]
v_fma_mix_f32 v213, v134, v221, v213 op_sel:[1,0,0] op_sel_hi:[1,0,0]
v_mfma_f32_32x32x16_bf16 v[80:95], a[148:151], v[128:131], 0
ds_read_b64_tr_b16 a[190:191], v227 offset:43264
ds_read_b128 v[192:195], v249 offset:128
ds_read_b128 v[196:199], v249 offset:144
v_fma_mix_f32 v214, v135, v222, v214 op_sel:[0,0,0] op_sel_hi:[1,0,0]
v_fma_mix_f32 v215, v135, v223, v215 op_sel:[1,0,0] op_sel_hi:[1,0,0]
v_mfma_f32_32x32x16_bf16 v[96:111], a[152:155], v[128:131], 0
ds_read_b128 v[200:203], v249 offset:2432
ds_read_b128 v[204:207], v249 offset:2448
v_cvt_pk_bf16_f32 v132, v208, v209
v_mfma_f32_32x32x16_bf16 v[112:127], a[156:159], v[128:131], 0
v_cvt_pk_bf16_f32 v133, v210, v211
v_cvt_pk_bf16_f32 v134, v212, v213
v_cvt_pk_bf16_f32 v135, v214, v215
s_waitcnt vmcnt(6) lgkmcnt(0)
s_barrier
v_mfma_f32_32x32x16_bf16 v[0:15], a[160:163], v[132:135], v[0:15]
ds_read_b64_tr_b16 a[128:129], v224 offset:49152
ds_read_b64_tr_b16 a[130:131], v224 offset:51200
ds_read_b64_tr_b16 a[132:133], v225 offset:49152
v_fma_mix_f32 v192, v136, v200, v192 op_sel:[0,0,0] op_sel_hi:[1,0,0]
s_add_u32 m0, s30, 16384
v_mfma_f32_32x32x16_bf16 v[16:31], a[164:167], v[132:135], v[16:31]
ds_read_b64_tr_b16 a[134:135], v225 offset:51200
ds_read_b64_tr_b16 a[136:137], v226 offset:49152
ds_read_b64_tr_b16 a[138:139], v226 offset:51200
v_fma_mix_f32 v193, v136, v201, v193 op_sel:[1,0,0] op_sel_hi:[1,0,0]
buffer_load_dwordx4 v[152:155], v248, s[8:11], s29 offen offset:0
v_mfma_f32_32x32x16_bf16 v[32:47], a[168:171], v[132:135], v[32:47]
ds_read_b64_tr_b16 a[140:141], v227 offset:49152
ds_read_b64_tr_b16 a[142:143], v227 offset:51200
ds_read_b64_tr_b16 a[144:145], v224 offset:49408
v_fma_mix_f32 v194, v137, v202, v194 op_sel:[0,0,0] op_sel_hi:[1,0,0]
buffer_load_dwordx4 v240, s[4:7], s28 offen offset:0 lds
v_mfma_f32_32x32x16_bf16 v[48:63], a[172:175], v[132:135], v[48:63]
ds_read_b64_tr_b16 a[146:147], v224 offset:51456
ds_read_b64_tr_b16 a[148:149], v225 offset:49408
ds_read_b64_tr_b16 a[150:151], v225 offset:51456
v_fma_mix_f32 v195, v137, v203, v195 op_sel:[1,0,0] op_sel_hi:[1,0,0]
buffer_load_dwordx4 v241, s[4:7], s28 offen offset:1024 lds
v_mfma_f32_32x32x16_bf16 v[64:79], a[176:179], v[132:135], v[64:79]
ds_read_b64_tr_b16 a[152:153], v226 offset:49408
ds_read_b64_tr_b16 a[154:155], v226 offset:51456
ds_read_b64_tr_b16 a[156:157], v227 offset:49408
v_fma_mix_f32 v196, v138, v204, v196 op_sel:[0,0,0] op_sel_hi:[1,0,0]
v_fma_mix_f32 v197, v138, v205, v197 op_sel:[1,0,0] op_sel_hi:[1,0,0]
buffer_load_dwordx4 v[156:159], v248, s[8:11], s29 offen offset:512
v_mfma_f32_32x32x16_bf16 v[80:95], a[180:183], v[132:135], v[80:95]
ds_read_b64_tr_b16 a[158:159], v227 offset:51456
ds_read_b128 v[208:211], v249 offset:192
ds_read_b128 v[212:215], v249 offset:208
v_fma_mix_f32 v198, v139, v206, v198 op_sel:[0,0,0] op_sel_hi:[1,0,0]
v_fma_mix_f32 v199, v139, v207, v199 op_sel:[1,0,0] op_sel_hi:[1,0,0]
s_add_u32 s29, s29, 1024
v_mfma_f32_32x32x16_bf16 v[96:111], a[184:187], v[132:135], v[96:111]
ds_read_b128 v[216:219], v249 offset:2496
ds_read_b128 v[220:223], v249 offset:2512
v_cvt_pk_bf16_f32 v136, v192, v193
buffer_load_dwordx4 v242, s[4:7], s28 offen offset:2048 lds
v_mfma_f32_32x32x16_bf16 v[112:127], a[188:191], v[132:135], v[112:127]
v_cvt_pk_bf16_f32 v137, v194, v195
v_cvt_pk_bf16_f32 v138, v196, v197
v_cvt_pk_bf16_f32 v139, v198, v199
buffer_load_dwordx4 v243, s[4:7], s28 offen offset:3072 lds
s_add_u32 s28, s28, 262144
s_waitcnt lgkmcnt(0)
v_mfma_f32_32x32x16_bf16 v[0:15], a[128:131], v[136:139], v[0:15]
ds_read_b64_tr_b16 a[160:161], v224 offset:57344
ds_read_b64_tr_b16 a[162:163], v224 offset:59392
ds_read_b64_tr_b16 a[164:165], v225 offset:57344
v_fma_mix_f32 v208, v140, v216, v208 op_sel:[0,0,0] op_sel_hi:[1,0,0]
s_add_u32 m0, s30, 32768
v_mfma_f32_32x32x16_bf16 v[16:31], a[132:135], v[136:139], v[16:31]
ds_read_b64_tr_b16 a[166:167], v225 offset:59392
ds_read_b64_tr_b16 a[168:169], v226 offset:57344
ds_read_b64_tr_b16 a[170:171], v226 offset:59392
v_fma_mix_f32 v209, v140, v217, v209 op_sel:[1,0,0] op_sel_hi:[1,0,0]
buffer_load_dwordx4 v[160:163], v248, s[8:11], s29 offen offset:0
v_mfma_f32_32x32x16_bf16 v[32:47], a[136:139], v[136:139], v[32:47]
ds_read_b64_tr_b16 a[172:173], v227 offset:57344
ds_read_b64_tr_b16 a[174:175], v227 offset:59392
ds_read_b64_tr_b16 a[176:177], v224 offset:57600
v_fma_mix_f32 v210, v141, v218, v210 op_sel:[0,0,0] op_sel_hi:[1,0,0]
buffer_load_dwordx4 v240, s[4:7], s28 offen offset:0 lds
v_mfma_f32_32x32x16_bf16 v[48:63], a[140:143], v[136:139], v[48:63]
ds_read_b64_tr_b16 a[178:179], v224 offset:59648
ds_read_b64_tr_b16 a[180:181], v225 offset:57600
ds_read_b64_tr_b16 a[182:183], v225 offset:59648
v_fma_mix_f32 v211, v141, v219, v211 op_sel:[1,0,0] op_sel_hi:[1,0,0]
buffer_load_dwordx4 v241, s[4:7], s28 offen offset:1024 lds
v_mfma_f32_32x32x16_bf16 v[64:79], a[144:147], v[136:139], v[64:79]
ds_read_b64_tr_b16 a[184:185], v226 offset:57600
ds_read_b64_tr_b16 a[186:187], v226 offset:59648
ds_read_b64_tr_b16 a[188:189], v227 offset:57600
v_fma_mix_f32 v212, v142, v220, v212 op_sel:[0,0,0] op_sel_hi:[1,0,0]
v_fma_mix_f32 v213, v142, v221, v213 op_sel:[1,0,0] op_sel_hi:[1,0,0]
buffer_load_dwordx4 v[164:167], v248, s[8:11], s29 offen offset:512
v_mfma_f32_32x32x16_bf16 v[80:95], a[148:151], v[136:139], v[80:95]
ds_read_b64_tr_b16 a[190:191], v227 offset:59648
ds_read_b128 v[192:195], v249 offset:256
ds_read_b128 v[196:199], v249 offset:272
v_fma_mix_f32 v214, v143, v222, v214 op_sel:[0,0,0] op_sel_hi:[1,0,0]
v_fma_mix_f32 v215, v143, v223, v215 op_sel:[1,0,0] op_sel_hi:[1,0,0]
s_add_u32 s29, s29, 1024
v_mfma_f32_32x32x16_bf16 v[96:111], a[152:155], v[136:139], v[96:111]
ds_read_b128 v[200:203], v249 offset:2560
ds_read_b128 v[204:207], v249 offset:2576
v_cvt_pk_bf16_f32 v140, v208, v209
buffer_load_dwordx4 v242, s[4:7], s28 offen offset:2048 lds
v_mfma_f32_32x32x16_bf16 v[112:127], a[156:159], v[136:139], v[112:127]
v_cvt_pk_bf16_f32 v141, v210, v211
v_cvt_pk_bf16_f32 v142, v212, v213
v_cvt_pk_bf16_f32 v143, v214, v215
buffer_load_dwordx4 v243, s[4:7], s28 offen offset:3072 lds
s_add_u32 s28, s28, 262144
s_waitcnt vmcnt(12) lgkmcnt(0)
s_barrier
v_mfma_f32_32x32x16_bf16 v[0:15], a[160:163], v[140:143], v[0:15]
v_xor_b32 v224, 0x10000, v224
v_xor_b32 v225, 0x10000, v225
v_xor_b32 v226, 0x10000, v226
v_xor_b32 v227, 0x10000, v227
ds_read_b64_tr_b16 a[128:129], v224 offset:0
ds_read_b64_tr_b16 a[130:131], v224 offset:2048
ds_read_b64_tr_b16 a[132:133], v225 offset:0
v_fma_mix_f32 v192, v144, v200, v192 op_sel:[0,0,0] op_sel_hi:[1,0,0]
s_add_u32 m0, s30, 49152
v_mfma_f32_32x32x16_bf16 v[16:31], a[164:167], v[140:143], v[16:31]
ds_read_b64_tr_b16 a[134:135], v225 offset:2048
ds_read_b64_tr_b16 a[136:137], v226 offset:0
ds_read_b64_tr_b16 a[138:139], v226 offset:2048
v_fma_mix_f32 v193, v144, v201, v193 op_sel:[1,0,0] op_sel_hi:[1,0,0]
buffer_load_dwordx4 v[168:171], v248, s[8:11], s29 offen offset:0
v_mfma_f32_32x32x16_bf16 v[32:47], a[168:171], v[140:143], v[32:47]
ds_read_b64_tr_b16 a[140:141], v227 offset:0
ds_read_b64_tr_b16 a[142:143], v227 offset:2048
ds_read_b64_tr_b16 a[144:145], v224 offset:256
v_fma_mix_f32 v194, v145, v202, v194 op_sel:[0,0,0] op_sel_hi:[1,0,0]
buffer_load_dwordx4 v240, s[4:7], s28 offen offset:0 lds
v_mfma_f32_32x32x16_bf16 v[48:63], a[172:175], v[140:143], v[48:63]
ds_read_b64_tr_b16 a[146:147], v224 offset:2304
ds_read_b64_tr_b16 a[148:149], v225 offset:256
ds_read_b64_tr_b16 a[150:151], v225 offset:2304
v_fma_mix_f32 v195, v145, v203, v195 op_sel:[1,0,0] op_sel_hi:[1,0,0]
buffer_load_dwordx4 v241, s[4:7], s28 offen offset:1024 lds
v_mfma_f32_32x32x16_bf16 v[64:79], a[176:179], v[140:143], v[64:79]
ds_read_b64_tr_b16 a[152:153], v226 offset:256
ds_read_b64_tr_b16 a[154:155], v226 offset:2304
ds_read_b64_tr_b16 a[156:157], v227 offset:256
v_fma_mix_f32 v196, v146, v204, v196 op_sel:[0,0,0] op_sel_hi:[1,0,0]
v_fma_mix_f32 v197, v146, v205, v197 op_sel:[1,0,0] op_sel_hi:[1,0,0]
buffer_load_dwordx4 v[172:175], v248, s[8:11], s29 offen offset:512
v_mfma_f32_32x32x16_bf16 v[80:95], a[180:183], v[140:143], v[80:95]
ds_read_b64_tr_b16 a[158:159], v227 offset:2304
ds_read_b128 v[208:211], v249 offset:320
ds_read_b128 v[212:215], v249 offset:336
v_fma_mix_f32 v198, v147, v206, v198 op_sel:[0,0,0] op_sel_hi:[1,0,0]
v_fma_mix_f32 v199, v147, v207, v199 op_sel:[1,0,0] op_sel_hi:[1,0,0]
s_add_u32 s29, s29, 1024
v_mfma_f32_32x32x16_bf16 v[96:111], a[184:187], v[140:143], v[96:111]
ds_read_b128 v[216:219], v249 offset:2624
ds_read_b128 v[220:223], v249 offset:2640
v_cvt_pk_bf16_f32 v144, v192, v193
buffer_load_dwordx4 v242, s[4:7], s28 offen offset:2048 lds
v_mfma_f32_32x32x16_bf16 v[112:127], a[188:191], v[140:143], v[112:127]
v_cvt_pk_bf16_f32 v145, v194, v195
v_cvt_pk_bf16_f32 v146, v196, v197
v_cvt_pk_bf16_f32 v147, v198, v199
buffer_load_dwordx4 v243, s[4:7], s28 offen offset:3072 lds
s_add_u32 s28, s28, 262144
s_waitcnt lgkmcnt(0)
v_mfma_f32_32x32x16_bf16 v[0:15], a[128:131], v[144:147], v[0:15]
ds_read_b64_tr_b16 a[160:161], v224 offset:8192
ds_read_b64_tr_b16 a[162:163], v224 offset:10240
ds_read_b64_tr_b16 a[164:165], v225 offset:8192
v_fma_mix_f32 v208, v148, v216, v208 op_sel:[0,0,0] op_sel_hi:[1,0,0]
s_add_u32 m0, s30, 65536
v_mfma_f32_32x32x16_bf16 v[16:31], a[132:135], v[144:147], v[16:31]
ds_read_b64_tr_b16 a[166:167], v225 offset:10240
ds_read_b64_tr_b16 a[168:169], v226 offset:8192
ds_read_b64_tr_b16 a[170:171], v226 offset:10240
v_fma_mix_f32 v209, v148, v217, v209 op_sel:[1,0,0] op_sel_hi:[1,0,0]
buffer_load_dwordx4 v[176:179], v248, s[8:11], s29 offen offset:0
v_mfma_f32_32x32x16_bf16 v[32:47], a[136:139], v[144:147], v[32:47]
ds_read_b64_tr_b16 a[172:173], v227 offset:8192
ds_read_b64_tr_b16 a[174:175], v227 offset:10240
ds_read_b64_tr_b16 a[176:177], v224 offset:8448
v_fma_mix_f32 v210, v149, v218, v210 op_sel:[0,0,0] op_sel_hi:[1,0,0]
buffer_load_dwordx4 v240, s[4:7], s28 offen offset:0 lds
v_mfma_f32_32x32x16_bf16 v[48:63], a[140:143], v[144:147], v[48:63]
ds_read_b64_tr_b16 a[178:179], v224 offset:10496
ds_read_b64_tr_b16 a[180:181], v225 offset:8448
ds_read_b64_tr_b16 a[182:183], v225 offset:10496
v_fma_mix_f32 v211, v149, v219, v211 op_sel:[1,0,0] op_sel_hi:[1,0,0]
buffer_load_dwordx4 v241, s[4:7], s28 offen offset:1024 lds
v_mfma_f32_32x32x16_bf16 v[64:79], a[144:147], v[144:147], v[64:79]
ds_read_b64_tr_b16 a[184:185], v226 offset:8448
ds_read_b64_tr_b16 a[186:187], v226 offset:10496
ds_read_b64_tr_b16 a[188:189], v227 offset:8448
v_fma_mix_f32 v212, v150, v220, v212 op_sel:[0,0,0] op_sel_hi:[1,0,0]
v_fma_mix_f32 v213, v150, v221, v213 op_sel:[1,0,0] op_sel_hi:[1,0,0]
buffer_load_dwordx4 v[180:183], v248, s[8:11], s29 offen offset:512
v_mfma_f32_32x32x16_bf16 v[80:95], a[148:151], v[144:147], v[80:95]
ds_read_b64_tr_b16 a[190:191], v227 offset:10496
ds_read_b128 v[192:195], v249 offset:384
ds_read_b128 v[196:199], v249 offset:400
v_fma_mix_f32 v214, v151, v222, v214 op_sel:[0,0,0] op_sel_hi:[1,0,0]
v_fma_mix_f32 v215, v151, v223, v215 op_sel:[1,0,0] op_sel_hi:[1,0,0]
s_add_u32 s29, s29, 1024
v_mfma_f32_32x32x16_bf16 v[96:111], a[152:155], v[144:147], v[96:111]
ds_read_b128 v[200:203], v249 offset:2688
ds_read_b128 v[204:207], v249 offset:2704
v_cvt_pk_bf16_f32 v148, v208, v209
buffer_load_dwordx4 v242, s[4:7], s28 offen offset:2048 lds
v_mfma_f32_32x32x16_bf16 v[112:127], a[156:159], v[144:147], v[112:127]
v_cvt_pk_bf16_f32 v149, v210, v211
v_cvt_pk_bf16_f32 v150, v212, v213
v_cvt_pk_bf16_f32 v151, v214, v215
buffer_load_dwordx4 v243, s[4:7], s28 offen offset:3072 lds
s_add_u32 s28, s28, 262144
s_waitcnt vmcnt(18) lgkmcnt(0)
s_barrier
v_mfma_f32_32x32x16_bf16 v[0:15], a[160:163], v[148:151], v[0:15]
ds_read_b64_tr_b16 a[128:129], v224 offset:16384
ds_read_b64_tr_b16 a[130:131], v224 offset:18432
ds_read_b64_tr_b16 a[132:133], v225 offset:16384
v_fma_mix_f32 v192, v152, v200, v192 op_sel:[0,0,0] op_sel_hi:[1,0,0]
s_add_u32 m0, s30, 81920
v_mfma_f32_32x32x16_bf16 v[16:31], a[164:167], v[148:151], v[16:31]
ds_read_b64_tr_b16 a[134:135], v225 offset:18432
ds_read_b64_tr_b16 a[136:137], v226 offset:16384
ds_read_b64_tr_b16 a[138:139], v226 offset:18432
v_fma_mix_f32 v193, v152, v201, v193 op_sel:[1,0,0] op_sel_hi:[1,0,0]
buffer_load_dwordx4 v[184:187], v248, s[8:11], s29 offen offset:0
v_mfma_f32_32x32x16_bf16 v[32:47], a[168:171], v[148:151], v[32:47]
ds_read_b64_tr_b16 a[140:141], v227 offset:16384
ds_read_b64_tr_b16 a[142:143], v227 offset:18432
ds_read_b64_tr_b16 a[144:145], v224 offset:16640
v_fma_mix_f32 v194, v153, v202, v194 op_sel:[0,0,0] op_sel_hi:[1,0,0]
buffer_load_dwordx4 v240, s[4:7], s28 offen offset:0 lds
v_mfma_f32_32x32x16_bf16 v[48:63], a[172:175], v[148:151], v[48:63]
ds_read_b64_tr_b16 a[146:147], v224 offset:18688
ds_read_b64_tr_b16 a[148:149], v225 offset:16640
ds_read_b64_tr_b16 a[150:151], v225 offset:18688
v_fma_mix_f32 v195, v153, v203, v195 op_sel:[1,0,0] op_sel_hi:[1,0,0]
buffer_load_dwordx4 v241, s[4:7], s28 offen offset:1024 lds
v_mfma_f32_32x32x16_bf16 v[64:79], a[176:179], v[148:151], v[64:79]
ds_read_b64_tr_b16 a[152:153], v226 offset:16640
ds_read_b64_tr_b16 a[154:155], v226 offset:18688
ds_read_b64_tr_b16 a[156:157], v227 offset:16640
v_fma_mix_f32 v196, v154, v204, v196 op_sel:[0,0,0] op_sel_hi:[1,0,0]
v_fma_mix_f32 v197, v154, v205, v197 op_sel:[1,0,0] op_sel_hi:[1,0,0]
buffer_load_dwordx4 v[188:191], v248, s[8:11], s29 offen offset:512
v_mfma_f32_32x32x16_bf16 v[80:95], a[180:183], v[148:151], v[80:95]
ds_read_b64_tr_b16 a[158:159], v227 offset:18688
ds_read_b128 v[208:211], v249 offset:448
ds_read_b128 v[212:215], v249 offset:464
v_fma_mix_f32 v198, v155, v206, v198 op_sel:[0,0,0] op_sel_hi:[1,0,0]
v_fma_mix_f32 v199, v155, v207, v199 op_sel:[1,0,0] op_sel_hi:[1,0,0]
s_add_u32 s29, s29, 1024
v_mfma_f32_32x32x16_bf16 v[96:111], a[184:187], v[148:151], v[96:111]
ds_read_b128 v[216:219], v249 offset:2752
ds_read_b128 v[220:223], v249 offset:2768
v_cvt_pk_bf16_f32 v152, v192, v193
buffer_load_dwordx4 v242, s[4:7], s28 offen offset:2048 lds
v_mfma_f32_32x32x16_bf16 v[112:127], a[188:191], v[148:151], v[112:127]
v_cvt_pk_bf16_f32 v153, v194, v195
v_cvt_pk_bf16_f32 v154, v196, v197
v_cvt_pk_bf16_f32 v155, v198, v199
buffer_load_dwordx4 v243, s[4:7], s28 offen offset:3072 lds
s_add_u32 s28, s28, 262144
s_waitcnt lgkmcnt(0)
v_mfma_f32_32x32x16_bf16 v[0:15], a[128:131], v[152:155], v[0:15]
ds_read_b64_tr_b16 a[160:161], v224 offset:24576
ds_read_b64_tr_b16 a[162:163], v224 offset:26624
ds_read_b64_tr_b16 a[164:165], v225 offset:24576
v_fma_mix_f32 v208, v156, v216, v208 op_sel:[0,0,0] op_sel_hi:[1,0,0]
s_add_u32 m0, s30, 98304
v_mfma_f32_32x32x16_bf16 v[16:31], a[132:135], v[152:155], v[16:31]
ds_read_b64_tr_b16 a[166:167], v225 offset:26624
ds_read_b64_tr_b16 a[168:169], v226 offset:24576
ds_read_b64_tr_b16 a[170:171], v226 offset:26624
v_fma_mix_f32 v209, v156, v217, v209 op_sel:[1,0,0] op_sel_hi:[1,0,0]
buffer_load_dwordx4 v[128:131], v248, s[8:11], s29 offen offset:0
v_mfma_f32_32x32x16_bf16 v[32:47], a[136:139], v[152:155], v[32:47]
ds_read_b64_tr_b16 a[172:173], v227 offset:24576
ds_read_b64_tr_b16 a[174:175], v227 offset:26624
ds_read_b64_tr_b16 a[176:177], v224 offset:24832
v_fma_mix_f32 v210, v157, v218, v210 op_sel:[0,0,0] op_sel_hi:[1,0,0]
buffer_load_dwordx4 v240, s[4:7], s28 offen offset:0 lds
v_mfma_f32_32x32x16_bf16 v[48:63], a[140:143], v[152:155], v[48:63]
ds_read_b64_tr_b16 a[178:179], v224 offset:26880
ds_read_b64_tr_b16 a[180:181], v225 offset:24832
ds_read_b64_tr_b16 a[182:183], v225 offset:26880
v_fma_mix_f32 v211, v157, v219, v211 op_sel:[1,0,0] op_sel_hi:[1,0,0]
buffer_load_dwordx4 v241, s[4:7], s28 offen offset:1024 lds
v_mfma_f32_32x32x16_bf16 v[64:79], a[144:147], v[152:155], v[64:79]
ds_read_b64_tr_b16 a[184:185], v226 offset:24832
ds_read_b64_tr_b16 a[186:187], v226 offset:26880
ds_read_b64_tr_b16 a[188:189], v227 offset:24832
v_fma_mix_f32 v212, v158, v220, v212 op_sel:[0,0,0] op_sel_hi:[1,0,0]
v_fma_mix_f32 v213, v158, v221, v213 op_sel:[1,0,0] op_sel_hi:[1,0,0]
buffer_load_dwordx4 v[132:135], v248, s[8:11], s29 offen offset:512
v_mfma_f32_32x32x16_bf16 v[80:95], a[148:151], v[152:155], v[80:95]
ds_read_b64_tr_b16 a[190:191], v227 offset:26880
ds_read_b128 v[192:195], v249 offset:512
ds_read_b128 v[196:199], v249 offset:528
v_fma_mix_f32 v214, v159, v222, v214 op_sel:[0,0,0] op_sel_hi:[1,0,0]
v_fma_mix_f32 v215, v159, v223, v215 op_sel:[1,0,0] op_sel_hi:[1,0,0]
s_add_u32 s29, s29, 1024
v_mfma_f32_32x32x16_bf16 v[96:111], a[152:155], v[152:155], v[96:111]
ds_read_b128 v[200:203], v249 offset:2816
ds_read_b128 v[204:207], v249 offset:2832
v_cvt_pk_bf16_f32 v156, v208, v209
buffer_load_dwordx4 v242, s[4:7], s28 offen offset:2048 lds
v_mfma_f32_32x32x16_bf16 v[112:127], a[156:159], v[152:155], v[112:127]
v_cvt_pk_bf16_f32 v157, v210, v211
v_cvt_pk_bf16_f32 v158, v212, v213
v_cvt_pk_bf16_f32 v159, v214, v215
buffer_load_dwordx4 v243, s[4:7], s28 offen offset:3072 lds
s_add_u32 s28, s28, 262144
s_waitcnt vmcnt(24) lgkmcnt(0)
s_barrier
v_mfma_f32_32x32x16_bf16 v[0:15], a[160:163], v[156:159], v[0:15]
ds_read_b64_tr_b16 a[128:129], v224 offset:32768
ds_read_b64_tr_b16 a[130:131], v224 offset:34816
ds_read_b64_tr_b16 a[132:133], v225 offset:32768
v_fma_mix_f32 v192, v160, v200, v192 op_sel:[0,0,0] op_sel_hi:[1,0,0]
s_add_u32 m0, s30, 114688
v_mfma_f32_32x32x16_bf16 v[16:31], a[164:167], v[156:159], v[16:31]
ds_read_b64_tr_b16 a[134:135], v225 offset:34816
ds_read_b64_tr_b16 a[136:137], v226 offset:32768
ds_read_b64_tr_b16 a[138:139], v226 offset:34816
v_fma_mix_f32 v193, v160, v201, v193 op_sel:[1,0,0] op_sel_hi:[1,0,0]
buffer_load_dwordx4 v[136:139], v248, s[8:11], s29 offen offset:0
v_mfma_f32_32x32x16_bf16 v[32:47], a[168:171], v[156:159], v[32:47]
ds_read_b64_tr_b16 a[140:141], v227 offset:32768
ds_read_b64_tr_b16 a[142:143], v227 offset:34816
ds_read_b64_tr_b16 a[144:145], v224 offset:33024
v_fma_mix_f32 v194, v161, v202, v194 op_sel:[0,0,0] op_sel_hi:[1,0,0]
buffer_load_dwordx4 v240, s[4:7], s28 offen offset:0 lds
v_mfma_f32_32x32x16_bf16 v[48:63], a[172:175], v[156:159], v[48:63]
ds_read_b64_tr_b16 a[146:147], v224 offset:35072
ds_read_b64_tr_b16 a[148:149], v225 offset:33024
ds_read_b64_tr_b16 a[150:151], v225 offset:35072
v_fma_mix_f32 v195, v161, v203, v195 op_sel:[1,0,0] op_sel_hi:[1,0,0]
buffer_load_dwordx4 v241, s[4:7], s28 offen offset:1024 lds
v_mfma_f32_32x32x16_bf16 v[64:79], a[176:179], v[156:159], v[64:79]
ds_read_b64_tr_b16 a[152:153], v226 offset:33024
ds_read_b64_tr_b16 a[154:155], v226 offset:35072
ds_read_b64_tr_b16 a[156:157], v227 offset:33024
v_fma_mix_f32 v196, v162, v204, v196 op_sel:[0,0,0] op_sel_hi:[1,0,0]
v_fma_mix_f32 v197, v162, v205, v197 op_sel:[1,0,0] op_sel_hi:[1,0,0]
buffer_load_dwordx4 v[140:143], v248, s[8:11], s29 offen offset:512
v_mfma_f32_32x32x16_bf16 v[80:95], a[180:183], v[156:159], v[80:95]
ds_read_b64_tr_b16 a[158:159], v227 offset:35072
ds_read_b128 v[208:211], v249 offset:576
ds_read_b128 v[212:215], v249 offset:592
v_fma_mix_f32 v198, v163, v206, v198 op_sel:[0,0,0] op_sel_hi:[1,0,0]
v_fma_mix_f32 v199, v163, v207, v199 op_sel:[1,0,0] op_sel_hi:[1,0,0]
s_add_u32 s29, s29, 1024
v_mfma_f32_32x32x16_bf16 v[96:111], a[184:187], v[156:159], v[96:111]
ds_read_b128 v[216:219], v249 offset:2880
ds_read_b128 v[220:223], v249 offset:2896
v_cvt_pk_bf16_f32 v160, v192, v193
buffer_load_dwordx4 v242, s[4:7], s28 offen offset:2048 lds
v_mfma_f32_32x32x16_bf16 v[112:127], a[188:191], v[156:159], v[112:127]
v_cvt_pk_bf16_f32 v161, v194, v195
v_cvt_pk_bf16_f32 v162, v196, v197
v_cvt_pk_bf16_f32 v163, v198, v199
buffer_load_dwordx4 v243, s[4:7], s28 offen offset:3072 lds
s_add_u32 s28, s28, 262144
s_waitcnt lgkmcnt(0)
v_mfma_f32_32x32x16_bf16 v[0:15], a[128:131], v[160:163], v[0:15]
ds_read_b64_tr_b16 a[160:161], v224 offset:40960
ds_read_b64_tr_b16 a[162:163], v224 offset:43008
ds_read_b64_tr_b16 a[164:165], v225 offset:40960
v_fma_mix_f32 v208, v164, v216, v208 op_sel:[0,0,0] op_sel_hi:[1,0,0]
s_add_u32 m0, s30, 0
v_mfma_f32_32x32x16_bf16 v[16:31], a[132:135], v[160:163], v[16:31]
ds_read_b64_tr_b16 a[166:167], v225 offset:43008
ds_read_b64_tr_b16 a[168:169], v226 offset:40960
ds_read_b64_tr_b16 a[170:171], v226 offset:43008
v_fma_mix_f32 v209, v164, v217, v209 op_sel:[1,0,0] op_sel_hi:[1,0,0]
buffer_load_dwordx4 v[144:147], v248, s[8:11], s29 offen offset:0
v_mfma_f32_32x32x16_bf16 v[32:47], a[136:139], v[160:163], v[32:47]
ds_read_b64_tr_b16 a[172:173], v227 offset:40960
ds_read_b64_tr_b16 a[174:175], v227 offset:43008
ds_read_b64_tr_b16 a[176:177], v224 offset:41216
v_fma_mix_f32 v210, v165, v218, v210 op_sel:[0,0,0] op_sel_hi:[1,0,0]
buffer_load_dwordx4 v240, s[4:7], s28 offen offset:0 lds
v_mfma_f32_32x32x16_bf16 v[48:63], a[140:143], v[160:163], v[48:63]
ds_read_b64_tr_b16 a[178:179], v224 offset:43264
ds_read_b64_tr_b16 a[180:181], v225 offset:41216
ds_read_b64_tr_b16 a[182:183], v225 offset:43264
v_fma_mix_f32 v211, v165, v219, v211 op_sel:[1,0,0] op_sel_hi:[1,0,0]
buffer_load_dwordx4 v241, s[4:7], s28 offen offset:1024 lds
v_mfma_f32_32x32x16_bf16 v[64:79], a[144:147], v[160:163], v[64:79]
ds_read_b64_tr_b16 a[184:185], v226 offset:41216
ds_read_b64_tr_b16 a[186:187], v226 offset:43264
ds_read_b64_tr_b16 a[188:189], v227 offset:41216
v_fma_mix_f32 v212, v166, v220, v212 op_sel:[0,0,0] op_sel_hi:[1,0,0]
v_fma_mix_f32 v213, v166, v221, v213 op_sel:[1,0,0] op_sel_hi:[1,0,0]
buffer_load_dwordx4 v[148:151], v248, s[8:11], s29 offen offset:512
v_mfma_f32_32x32x16_bf16 v[80:95], a[148:151], v[160:163], v[80:95]
ds_read_b64_tr_b16 a[190:191], v227 offset:43264
ds_read_b128 v[192:195], v249 offset:640
ds_read_b128 v[196:199], v249 offset:656
v_fma_mix_f32 v214, v167, v222, v214 op_sel:[0,0,0] op_sel_hi:[1,0,0]
v_fma_mix_f32 v215, v167, v223, v215 op_sel:[1,0,0] op_sel_hi:[1,0,0]
s_add_u32 s29, s29, 1024
v_mfma_f32_32x32x16_bf16 v[96:111], a[152:155], v[160:163], v[96:111]
ds_read_b128 v[200:203], v249 offset:2944
ds_read_b128 v[204:207], v249 offset:2960
v_cvt_pk_bf16_f32 v164, v208, v209
buffer_load_dwordx4 v242, s[4:7], s28 offen offset:2048 lds
v_mfma_f32_32x32x16_bf16 v[112:127], a[156:159], v[160:163], v[112:127]
v_cvt_pk_bf16_f32 v165, v210, v211
v_cvt_pk_bf16_f32 v166, v212, v213
v_cvt_pk_bf16_f32 v167, v214, v215
buffer_load_dwordx4 v243, s[4:7], s28 offen offset:3072 lds
s_add_u32 s28, s28, 262144
s_waitcnt vmcnt(30) lgkmcnt(0)
s_barrier
v_mfma_f32_32x32x16_bf16 v[0:15], a[160:163], v[164:167], v[0:15]
ds_read_b64_tr_b16 a[128:129], v224 offset:49152
ds_read_b64_tr_b16 a[130:131], v224 offset:51200
ds_read_b64_tr_b16 a[132:133], v225 offset:49152
v_fma_mix_f32 v192, v168, v200, v192 op_sel:[0,0,0] op_sel_hi:[1,0,0]
v_mfma_f32_32x32x16_bf16 v[16:31], a[164:167], v[164:167], v[16:31]
ds_read_b64_tr_b16 a[134:135], v225 offset:51200
ds_read_b64_tr_b16 a[136:137], v226 offset:49152
ds_read_b64_tr_b16 a[138:139], v226 offset:51200
v_fma_mix_f32 v193, v168, v201, v193 op_sel:[1,0,0] op_sel_hi:[1,0,0]
s_add_u32 m0, s30, 16384
v_mfma_f32_32x32x16_bf16 v[32:47], a[168:171], v[164:167], v[32:47]
ds_read_b64_tr_b16 a[140:141], v227 offset:49152
ds_read_b64_tr_b16 a[142:143], v227 offset:51200
ds_read_b64_tr_b16 a[144:145], v224 offset:49408
v_fma_mix_f32 v194, v169, v202, v194 op_sel:[0,0,0] op_sel_hi:[1,0,0]
v_mfma_f32_32x32x16_bf16 v[48:63], a[172:175], v[164:167], v[48:63]
ds_read_b64_tr_b16 a[146:147], v224 offset:51456
ds_read_b64_tr_b16 a[148:149], v225 offset:49408
ds_read_b64_tr_b16 a[150:151], v225 offset:51456
v_fma_mix_f32 v195, v169, v203, v195 op_sel:[1,0,0] op_sel_hi:[1,0,0]
buffer_load_dwordx4 v[152:155], v248, s[8:11], s29 offen offset:0
v_mfma_f32_32x32x16_bf16 v[64:79], a[176:179], v[164:167], v[64:79]
ds_read_b64_tr_b16 a[152:153], v226 offset:49408
ds_read_b64_tr_b16 a[154:155], v226 offset:51456
ds_read_b64_tr_b16 a[156:157], v227 offset:49408
v_fma_mix_f32 v196, v170, v204, v196 op_sel:[0,0,0] op_sel_hi:[1,0,0]
v_fma_mix_f32 v197, v170, v205, v197 op_sel:[1,0,0] op_sel_hi:[1,0,0]
buffer_load_dwordx4 v240, s[4:7], s28 offen offset:0 lds
v_mfma_f32_32x32x16_bf16 v[80:95], a[180:183], v[164:167], v[80:95]
ds_read_b64_tr_b16 a[158:159], v227 offset:51456
ds_read_b128 v[208:211], v249 offset:704
ds_read_b128 v[212:215], v249 offset:720
v_fma_mix_f32 v198, v171, v206, v198 op_sel:[0,0,0] op_sel_hi:[1,0,0]
v_fma_mix_f32 v199, v171, v207, v199 op_sel:[1,0,0] op_sel_hi:[1,0,0]
v_mfma_f32_32x32x16_bf16 v[96:111], a[184:187], v[164:167], v[96:111]
ds_read_b128 v[216:219], v249 offset:3008
ds_read_b128 v[220:223], v249 offset:3024
v_cvt_pk_bf16_f32 v168, v192, v193
buffer_load_dwordx4 v241, s[4:7], s28 offen offset:1024 lds
v_mfma_f32_32x32x16_bf16 v[112:127], a[188:191], v[164:167], v[112:127]
v_cvt_pk_bf16_f32 v169, v194, v195
v_cvt_pk_bf16_f32 v170, v196, v197
v_cvt_pk_bf16_f32 v171, v198, v199
buffer_load_dwordx4 v[156:159], v248, s[8:11], s29 offen offset:512
s_waitcnt lgkmcnt(0)
v_mfma_f32_32x32x16_bf16 v[0:15], a[128:131], v[168:171], v[0:15]
ds_read_b64_tr_b16 a[160:161], v224 offset:57344
ds_read_b64_tr_b16 a[162:163], v224 offset:59392
ds_read_b64_tr_b16 a[164:165], v225 offset:57344
v_fma_mix_f32 v208, v172, v216, v208 op_sel:[0,0,0] op_sel_hi:[1,0,0]
v_mfma_f32_32x32x16_bf16 v[16:31], a[132:135], v[168:171], v[16:31]
ds_read_b64_tr_b16 a[166:167], v225 offset:59392
ds_read_b64_tr_b16 a[168:169], v226 offset:57344
ds_read_b64_tr_b16 a[170:171], v226 offset:59392
v_fma_mix_f32 v209, v172, v217, v209 op_sel:[1,0,0] op_sel_hi:[1,0,0]
s_add_u32 s29, s29, 1024
v_mfma_f32_32x32x16_bf16 v[32:47], a[136:139], v[168:171], v[32:47]
ds_read_b64_tr_b16 a[172:173], v227 offset:57344
ds_read_b64_tr_b16 a[174:175], v227 offset:59392
ds_read_b64_tr_b16 a[176:177], v224 offset:57600
v_fma_mix_f32 v210, v173, v218, v210 op_sel:[0,0,0] op_sel_hi:[1,0,0]
v_mfma_f32_32x32x16_bf16 v[48:63], a[140:143], v[168:171], v[48:63]
ds_read_b64_tr_b16 a[178:179], v224 offset:59648
ds_read_b64_tr_b16 a[180:181], v225 offset:57600
ds_read_b64_tr_b16 a[182:183], v225 offset:59648
v_fma_mix_f32 v211, v173, v219, v211 op_sel:[1,0,0] op_sel_hi:[1,0,0]
buffer_load_dwordx4 v242, s[4:7], s28 offen offset:2048 lds
v_mfma_f32_32x32x16_bf16 v[64:79], a[144:147], v[168:171], v[64:79]
ds_read_b64_tr_b16 a[184:185], v226 offset:57600
ds_read_b64_tr_b16 a[186:187], v226 offset:59648
ds_read_b64_tr_b16 a[188:189], v227 offset:57600
v_fma_mix_f32 v212, v174, v220, v212 op_sel:[0,0,0] op_sel_hi:[1,0,0]
v_fma_mix_f32 v213, v174, v221, v213 op_sel:[1,0,0] op_sel_hi:[1,0,0]
v_mfma_f32_32x32x16_bf16 v[80:95], a[148:151], v[168:171], v[80:95]
ds_read_b64_tr_b16 a[190:191], v227 offset:59648
ds_read_b128 v[192:195], v249 offset:768
ds_read_b128 v[196:199], v249 offset:784
v_fma_mix_f32 v214, v175, v222, v214 op_sel:[0,0,0] op_sel_hi:[1,0,0]
v_fma_mix_f32 v215, v175, v223, v215 op_sel:[1,0,0] op_sel_hi:[1,0,0]
buffer_load_dwordx4 v243, s[4:7], s28 offen offset:3072 lds
v_mfma_f32_32x32x16_bf16 v[96:111], a[152:155], v[168:171], v[96:111]
ds_read_b128 v[200:203], v249 offset:3072
ds_read_b128 v[204:207], v249 offset:3088
v_cvt_pk_bf16_f32 v172, v208, v209
v_mfma_f32_32x32x16_bf16 v[112:127], a[156:159], v[168:171], v[112:127]
v_cvt_pk_bf16_f32 v173, v210, v211
v_cvt_pk_bf16_f32 v174, v212, v213
v_cvt_pk_bf16_f32 v175, v214, v215
s_add_u32 s28, s28, 262144
s_waitcnt vmcnt(30) lgkmcnt(0)
s_barrier
v_mfma_f32_32x32x16_bf16 v[0:15], a[160:163], v[172:175], v[0:15]
v_xor_b32 v224, 0x10000, v224
v_xor_b32 v225, 0x10000, v225
v_xor_b32 v226, 0x10000, v226
v_xor_b32 v227, 0x10000, v227
ds_read_b64_tr_b16 a[128:129], v224 offset:0
ds_read_b64_tr_b16 a[130:131], v224 offset:2048
ds_read_b64_tr_b16 a[132:133], v225 offset:0
v_fma_mix_f32 v192, v176, v200, v192 op_sel:[0,0,0] op_sel_hi:[1,0,0]
v_mfma_f32_32x32x16_bf16 v[16:31], a[164:167], v[172:175], v[16:31]
ds_read_b64_tr_b16 a[134:135], v225 offset:2048
ds_read_b64_tr_b16 a[136:137], v226 offset:0
ds_read_b64_tr_b16 a[138:139], v226 offset:2048
v_fma_mix_f32 v193, v176, v201, v193 op_sel:[1,0,0] op_sel_hi:[1,0,0]
s_add_u32 m0, s30, 32768
v_mfma_f32_32x32x16_bf16 v[32:47], a[168:171], v[172:175], v[32:47]
ds_read_b64_tr_b16 a[140:141], v227 offset:0
ds_read_b64_tr_b16 a[142:143], v227 offset:2048
ds_read_b64_tr_b16 a[144:145], v224 offset:256
v_fma_mix_f32 v194, v177, v202, v194 op_sel:[0,0,0] op_sel_hi:[1,0,0]
v_mfma_f32_32x32x16_bf16 v[48:63], a[172:175], v[172:175], v[48:63]
ds_read_b64_tr_b16 a[146:147], v224 offset:2304
ds_read_b64_tr_b16 a[148:149], v225 offset:256
ds_read_b64_tr_b16 a[150:151], v225 offset:2304
v_fma_mix_f32 v195, v177, v203, v195 op_sel:[1,0,0] op_sel_hi:[1,0,0]
buffer_load_dwordx4 v[160:163], v248, s[8:11], s29 offen offset:0
v_mfma_f32_32x32x16_bf16 v[64:79], a[176:179], v[172:175], v[64:79]
ds_read_b64_tr_b16 a[152:153], v226 offset:256
ds_read_b64_tr_b16 a[154:155], v226 offset:2304
ds_read_b64_tr_b16 a[156:157], v227 offset:256
v_fma_mix_f32 v196, v178, v204, v196 op_sel:[0,0,0] op_sel_hi:[1,0,0]
v_fma_mix_f32 v197, v178, v205, v197 op_sel:[1,0,0] op_sel_hi:[1,0,0]
buffer_load_dwordx4 v240, s[4:7], s28 offen offset:0 lds
v_mfma_f32_32x32x16_bf16 v[80:95], a[180:183], v[172:175], v[80:95]
ds_read_b64_tr_b16 a[158:159], v227 offset:2304
ds_read_b128 v[208:211], v249 offset:832
ds_read_b128 v[212:215], v249 offset:848
v_fma_mix_f32 v198, v179, v206, v198 op_sel:[0,0,0] op_sel_hi:[1,0,0]
v_fma_mix_f32 v199, v179, v207, v199 op_sel:[1,0,0] op_sel_hi:[1,0,0]
v_mfma_f32_32x32x16_bf16 v[96:111], a[184:187], v[172:175], v[96:111]
ds_read_b128 v[216:219], v249 offset:3136
ds_read_b128 v[220:223], v249 offset:3152
v_cvt_pk_bf16_f32 v176, v192, v193
buffer_load_dwordx4 v241, s[4:7], s28 offen offset:1024 lds
v_mfma_f32_32x32x16_bf16 v[112:127], a[188:191], v[172:175], v[112:127]
v_cvt_pk_bf16_f32 v177, v194, v195
v_cvt_pk_bf16_f32 v178, v196, v197
v_cvt_pk_bf16_f32 v179, v198, v199
buffer_load_dwordx4 v[164:167], v248, s[8:11], s29 offen offset:512
s_waitcnt lgkmcnt(0)
v_mfma_f32_32x32x16_bf16 v[0:15], a[128:131], v[176:179], v[0:15]
ds_read_b64_tr_b16 a[160:161], v224 offset:8192
ds_read_b64_tr_b16 a[162:163], v224 offset:10240
ds_read_b64_tr_b16 a[164:165], v225 offset:8192
v_fma_mix_f32 v208, v180, v216, v208 op_sel:[0,0,0] op_sel_hi:[1,0,0]
v_mfma_f32_32x32x16_bf16 v[16:31], a[132:135], v[176:179], v[16:31]
ds_read_b64_tr_b16 a[166:167], v225 offset:10240
ds_read_b64_tr_b16 a[168:169], v226 offset:8192
ds_read_b64_tr_b16 a[170:171], v226 offset:10240
v_fma_mix_f32 v209, v180, v217, v209 op_sel:[1,0,0] op_sel_hi:[1,0,0]
s_add_u32 s29, s29, 1024
v_mfma_f32_32x32x16_bf16 v[32:47], a[136:139], v[176:179], v[32:47]
ds_read_b64_tr_b16 a[172:173], v227 offset:8192
ds_read_b64_tr_b16 a[174:175], v227 offset:10240
ds_read_b64_tr_b16 a[176:177], v224 offset:8448
v_fma_mix_f32 v210, v181, v218, v210 op_sel:[0,0,0] op_sel_hi:[1,0,0]
v_mfma_f32_32x32x16_bf16 v[48:63], a[140:143], v[176:179], v[48:63]
ds_read_b64_tr_b16 a[178:179], v224 offset:10496
ds_read_b64_tr_b16 a[180:181], v225 offset:8448
ds_read_b64_tr_b16 a[182:183], v225 offset:10496
v_fma_mix_f32 v211, v181, v219, v211 op_sel:[1,0,0] op_sel_hi:[1,0,0]
buffer_load_dwordx4 v242, s[4:7], s28 offen offset:2048 lds
v_mfma_f32_32x32x16_bf16 v[64:79], a[144:147], v[176:179], v[64:79]
ds_read_b64_tr_b16 a[184:185], v226 offset:8448
ds_read_b64_tr_b16 a[186:187], v226 offset:10496
ds_read_b64_tr_b16 a[188:189], v227 offset:8448
v_fma_mix_f32 v212, v182, v220, v212 op_sel:[0,0,0] op_sel_hi:[1,0,0]
v_fma_mix_f32 v213, v182, v221, v213 op_sel:[1,0,0] op_sel_hi:[1,0,0]
v_mfma_f32_32x32x16_bf16 v[80:95], a[148:151], v[176:179], v[80:95]
ds_read_b64_tr_b16 a[190:191], v227 offset:10496
ds_read_b128 v[192:195], v249 offset:896
ds_read_b128 v[196:199], v249 offset:912
v_fma_mix_f32 v214, v183, v222, v214 op_sel:[0,0,0] op_sel_hi:[1,0,0]
v_fma_mix_f32 v215, v183, v223, v215 op_sel:[1,0,0] op_sel_hi:[1,0,0]
buffer_load_dwordx4 v243, s[4:7], s28 offen offset:3072 lds
v_mfma_f32_32x32x16_bf16 v[96:111], a[152:155], v[176:179], v[96:111]
ds_read_b128 v[200:203], v249 offset:3200
ds_read_b128 v[204:207], v249 offset:3216
v_cvt_pk_bf16_f32 v180, v208, v209
v_mfma_f32_32x32x16_bf16 v[112:127], a[156:159], v[176:179], v[112:127]
v_cvt_pk_bf16_f32 v181, v210, v211
v_cvt_pk_bf16_f32 v182, v212, v213
v_cvt_pk_bf16_f32 v183, v214, v215
s_add_u32 s28, s28, 262144
s_waitcnt vmcnt(30) lgkmcnt(0)
s_barrier
v_mfma_f32_32x32x16_bf16 v[0:15], a[160:163], v[180:183], v[0:15]
ds_read_b64_tr_b16 a[128:129], v224 offset:16384
ds_read_b64_tr_b16 a[130:131], v224 offset:18432
ds_read_b64_tr_b16 a[132:133], v225 offset:16384
v_fma_mix_f32 v192, v184, v200, v192 op_sel:[0,0,0] op_sel_hi:[1,0,0]
v_mfma_f32_32x32x16_bf16 v[16:31], a[164:167], v[180:183], v[16:31]
ds_read_b64_tr_b16 a[134:135], v225 offset:18432
ds_read_b64_tr_b16 a[136:137], v226 offset:16384
ds_read_b64_tr_b16 a[138:139], v226 offset:18432
v_fma_mix_f32 v193, v184, v201, v193 op_sel:[1,0,0] op_sel_hi:[1,0,0]
s_add_u32 m0, s30, 49152
v_mfma_f32_32x32x16_bf16 v[32:47], a[168:171], v[180:183], v[32:47]
ds_read_b64_tr_b16 a[140:141], v227 offset:16384
ds_read_b64_tr_b16 a[142:143], v227 offset:18432
ds_read_b64_tr_b16 a[144:145], v224 offset:16640
v_fma_mix_f32 v194, v185, v202, v194 op_sel:[0,0,0] op_sel_hi:[1,0,0]
v_mfma_f32_32x32x16_bf16 v[48:63], a[172:175], v[180:183], v[48:63]
ds_read_b64_tr_b16 a[146:147], v224 offset:18688
ds_read_b64_tr_b16 a[148:149], v225 offset:16640
ds_read_b64_tr_b16 a[150:151], v225 offset:18688
v_fma_mix_f32 v195, v185, v203, v195 op_sel:[1,0,0] op_sel_hi:[1,0,0]
buffer_load_dwordx4 v[168:171], v248, s[8:11], s29 offen offset:0
v_mfma_f32_32x32x16_bf16 v[64:79], a[176:179], v[180:183], v[64:79]
ds_read_b64_tr_b16 a[152:153], v226 offset:16640
ds_read_b64_tr_b16 a[154:155], v226 offset:18688
ds_read_b64_tr_b16 a[156:157], v227 offset:16640
v_fma_mix_f32 v196, v186, v204, v196 op_sel:[0,0,0] op_sel_hi:[1,0,0]
v_fma_mix_f32 v197, v186, v205, v197 op_sel:[1,0,0] op_sel_hi:[1,0,0]
buffer_load_dwordx4 v240, s[4:7], s28 offen offset:0 lds
v_mfma_f32_32x32x16_bf16 v[80:95], a[180:183], v[180:183], v[80:95]
ds_read_b64_tr_b16 a[158:159], v227 offset:18688
ds_read_b128 v[208:211], v249 offset:960
ds_read_b128 v[212:215], v249 offset:976
v_fma_mix_f32 v198, v187, v206, v198 op_sel:[0,0,0] op_sel_hi:[1,0,0]
v_fma_mix_f32 v199, v187, v207, v199 op_sel:[1,0,0] op_sel_hi:[1,0,0]
v_mfma_f32_32x32x16_bf16 v[96:111], a[184:187], v[180:183], v[96:111]
ds_read_b128 v[216:219], v249 offset:3264
ds_read_b128 v[220:223], v249 offset:3280
v_cvt_pk_bf16_f32 v184, v192, v193
buffer_load_dwordx4 v241, s[4:7], s28 offen offset:1024 lds
v_mfma_f32_32x32x16_bf16 v[112:127], a[188:191], v[180:183], v[112:127]
v_cvt_pk_bf16_f32 v185, v194, v195
v_cvt_pk_bf16_f32 v186, v196, v197
v_cvt_pk_bf16_f32 v187, v198, v199
buffer_load_dwordx4 v[172:175], v248, s[8:11], s29 offen offset:512
s_waitcnt lgkmcnt(0)
v_mfma_f32_32x32x16_bf16 v[0:15], a[128:131], v[184:187], v[0:15]
ds_read_b64_tr_b16 a[160:161], v224 offset:24576
ds_read_b64_tr_b16 a[162:163], v224 offset:26624
ds_read_b64_tr_b16 a[164:165], v225 offset:24576
v_fma_mix_f32 v208, v188, v216, v208 op_sel:[0,0,0] op_sel_hi:[1,0,0]
v_mfma_f32_32x32x16_bf16 v[16:31], a[132:135], v[184:187], v[16:31]
ds_read_b64_tr_b16 a[166:167], v225 offset:26624
ds_read_b64_tr_b16 a[168:169], v226 offset:24576
ds_read_b64_tr_b16 a[170:171], v226 offset:26624
v_fma_mix_f32 v209, v188, v217, v209 op_sel:[1,0,0] op_sel_hi:[1,0,0]
s_add_u32 s29, s29, 1024
v_mfma_f32_32x32x16_bf16 v[32:47], a[136:139], v[184:187], v[32:47]
ds_read_b64_tr_b16 a[172:173], v227 offset:24576
ds_read_b64_tr_b16 a[174:175], v227 offset:26624
ds_read_b64_tr_b16 a[176:177], v224 offset:24832
v_fma_mix_f32 v210, v189, v218, v210 op_sel:[0,0,0] op_sel_hi:[1,0,0]
v_mfma_f32_32x32x16_bf16 v[48:63], a[140:143], v[184:187], v[48:63]
ds_read_b64_tr_b16 a[178:179], v224 offset:26880
ds_read_b64_tr_b16 a[180:181], v225 offset:24832
ds_read_b64_tr_b16 a[182:183], v225 offset:26880
v_fma_mix_f32 v211, v189, v219, v211 op_sel:[1,0,0] op_sel_hi:[1,0,0]
buffer_load_dwordx4 v242, s[4:7], s28 offen offset:2048 lds
v_mfma_f32_32x32x16_bf16 v[64:79], a[144:147], v[184:187], v[64:79]
ds_read_b64_tr_b16 a[184:185], v226 offset:24832
ds_read_b64_tr_b16 a[186:187], v226 offset:26880
ds_read_b64_tr_b16 a[188:189], v227 offset:24832
v_fma_mix_f32 v212, v190, v220, v212 op_sel:[0,0,0] op_sel_hi:[1,0,0]
v_fma_mix_f32 v213, v190, v221, v213 op_sel:[1,0,0] op_sel_hi:[1,0,0]
v_mfma_f32_32x32x16_bf16 v[80:95], a[148:151], v[184:187], v[80:95]
ds_read_b64_tr_b16 a[190:191], v227 offset:26880
ds_read_b128 v[192:195], v249 offset:1024
ds_read_b128 v[196:199], v249 offset:1040
v_fma_mix_f32 v214, v191, v222, v214 op_sel:[0,0,0] op_sel_hi:[1,0,0]
v_fma_mix_f32 v215, v191, v223, v215 op_sel:[1,0,0] op_sel_hi:[1,0,0]
buffer_load_dwordx4 v243, s[4:7], s28 offen offset:3072 lds
v_mfma_f32_32x32x16_bf16 v[96:111], a[152:155], v[184:187], v[96:111]
ds_read_b128 v[200:203], v249 offset:3328
ds_read_b128 v[204:207], v249 offset:3344
v_cvt_pk_bf16_f32 v188, v208, v209
v_mfma_f32_32x32x16_bf16 v[112:127], a[156:159], v[184:187], v[112:127]
v_cvt_pk_bf16_f32 v189, v210, v211
v_cvt_pk_bf16_f32 v190, v212, v213
v_cvt_pk_bf16_f32 v191, v214, v215
s_add_u32 s28, s28, 262144
s_waitcnt vmcnt(30) lgkmcnt(0)
s_barrier
v_mfma_f32_32x32x16_bf16 v[0:15], a[160:163], v[188:191], v[0:15]
ds_read_b64_tr_b16 a[128:129], v224 offset:32768
ds_read_b64_tr_b16 a[130:131], v224 offset:34816
ds_read_b64_tr_b16 a[132:133], v225 offset:32768
v_fma_mix_f32 v192, v128, v200, v192 op_sel:[0,0,0] op_sel_hi:[1,0,0]
v_mfma_f32_32x32x16_bf16 v[16:31], a[164:167], v[188:191], v[16:31]
ds_read_b64_tr_b16 a[134:135], v225 offset:34816
ds_read_b64_tr_b16 a[136:137], v226 offset:32768
ds_read_b64_tr_b16 a[138:139], v226 offset:34816
v_fma_mix_f32 v193, v128, v201, v193 op_sel:[1,0,0] op_sel_hi:[1,0,0]
s_add_u32 m0, s30, 65536
v_mfma_f32_32x32x16_bf16 v[32:47], a[168:171], v[188:191], v[32:47]
ds_read_b64_tr_b16 a[140:141], v227 offset:32768
ds_read_b64_tr_b16 a[142:143], v227 offset:34816
ds_read_b64_tr_b16 a[144:145], v224 offset:33024
v_fma_mix_f32 v194, v129, v202, v194 op_sel:[0,0,0] op_sel_hi:[1,0,0]
v_mfma_f32_32x32x16_bf16 v[48:63], a[172:175], v[188:191], v[48:63]
ds_read_b64_tr_b16 a[146:147], v224 offset:35072
ds_read_b64_tr_b16 a[148:149], v225 offset:33024
ds_read_b64_tr_b16 a[150:151], v225 offset:35072
v_fma_mix_f32 v195, v129, v203, v195 op_sel:[1,0,0] op_sel_hi:[1,0,0]
buffer_load_dwordx4 v[176:179], v248, s[8:11], s29 offen offset:0
v_mfma_f32_32x32x16_bf16 v[64:79], a[176:179], v[188:191], v[64:79]
ds_read_b64_tr_b16 a[152:153], v226 offset:33024
ds_read_b64_tr_b16 a[154:155], v226 offset:35072
ds_read_b64_tr_b16 a[156:157], v227 offset:33024
v_fma_mix_f32 v196, v130, v204, v196 op_sel:[0,0,0] op_sel_hi:[1,0,0]
v_fma_mix_f32 v197, v130, v205, v197 op_sel:[1,0,0] op_sel_hi:[1,0,0]
buffer_load_dwordx4 v240, s[4:7], s28 offen offset:0 lds
v_mfma_f32_32x32x16_bf16 v[80:95], a[180:183], v[188:191], v[80:95]
ds_read_b64_tr_b16 a[158:159], v227 offset:35072
ds_read_b128 v[208:211], v249 offset:1088
ds_read_b128 v[212:215], v249 offset:1104
v_fma_mix_f32 v198, v131, v206, v198 op_sel:[0,0,0] op_sel_hi:[1,0,0]
v_fma_mix_f32 v199, v131, v207, v199 op_sel:[1,0,0] op_sel_hi:[1,0,0]
v_mfma_f32_32x32x16_bf16 v[96:111], a[184:187], v[188:191], v[96:111]
ds_read_b128 v[216:219], v249 offset:3392
ds_read_b128 v[220:223], v249 offset:3408
v_cvt_pk_bf16_f32 v128, v192, v193
buffer_load_dwordx4 v241, s[4:7], s28 offen offset:1024 lds
v_mfma_f32_32x32x16_bf16 v[112:127], a[188:191], v[188:191], v[112:127]
v_cvt_pk_bf16_f32 v129, v194, v195
v_cvt_pk_bf16_f32 v130, v196, v197
v_cvt_pk_bf16_f32 v131, v198, v199
buffer_load_dwordx4 v[180:183], v248, s[8:11], s29 offen offset:512
s_waitcnt lgkmcnt(0)
v_mfma_f32_32x32x16_bf16 v[0:15], a[128:131], v[128:131], v[0:15]
ds_read_b64_tr_b16 a[160:161], v224 offset:40960
ds_read_b64_tr_b16 a[162:163], v224 offset:43008
ds_read_b64_tr_b16 a[164:165], v225 offset:40960
v_fma_mix_f32 v208, v132, v216, v208 op_sel:[0,0,0] op_sel_hi:[1,0,0]
v_mfma_f32_32x32x16_bf16 v[16:31], a[132:135], v[128:131], v[16:31]
ds_read_b64_tr_b16 a[166:167], v225 offset:43008
ds_read_b64_tr_b16 a[168:169], v226 offset:40960
ds_read_b64_tr_b16 a[170:171], v226 offset:43008
v_fma_mix_f32 v209, v132, v217, v209 op_sel:[1,0,0] op_sel_hi:[1,0,0]
s_add_u32 s29, s29, 1024
v_mfma_f32_32x32x16_bf16 v[32:47], a[136:139], v[128:131], v[32:47]
ds_read_b64_tr_b16 a[172:173], v227 offset:40960
ds_read_b64_tr_b16 a[174:175], v227 offset:43008
ds_read_b64_tr_b16 a[176:177], v224 offset:41216
v_fma_mix_f32 v210, v133, v218, v210 op_sel:[0,0,0] op_sel_hi:[1,0,0]
v_mfma_f32_32x32x16_bf16 v[48:63], a[140:143], v[128:131], v[48:63]
ds_read_b64_tr_b16 a[178:179], v224 offset:43264
ds_read_b64_tr_b16 a[180:181], v225 offset:41216
ds_read_b64_tr_b16 a[182:183], v225 offset:43264
v_fma_mix_f32 v211, v133, v219, v211 op_sel:[1,0,0] op_sel_hi:[1,0,0]
buffer_load_dwordx4 v242, s[4:7], s28 offen offset:2048 lds
v_mfma_f32_32x32x16_bf16 v[64:79], a[144:147], v[128:131], v[64:79]
ds_read_b64_tr_b16 a[184:185], v226 offset:41216
ds_read_b64_tr_b16 a[186:187], v226 offset:43264
ds_read_b64_tr_b16 a[188:189], v227 offset:41216
v_fma_mix_f32 v212, v134, v220, v212 op_sel:[0,0,0] op_sel_hi:[1,0,0]
v_fma_mix_f32 v213, v134, v221, v213 op_sel:[1,0,0] op_sel_hi:[1,0,0]
v_mfma_f32_32x32x16_bf16 v[80:95], a[148:151], v[128:131], v[80:95]
ds_read_b64_tr_b16 a[190:191], v227 offset:43264
ds_read_b128 v[192:195], v249 offset:1152
ds_read_b128 v[196:199], v249 offset:1168
v_fma_mix_f32 v214, v135, v222, v214 op_sel:[0,0,0] op_sel_hi:[1,0,0]
v_fma_mix_f32 v215, v135, v223, v215 op_sel:[1,0,0] op_sel_hi:[1,0,0]
buffer_load_dwordx4 v243, s[4:7], s28 offen offset:3072 lds
v_mfma_f32_32x32x16_bf16 v[96:111], a[152:155], v[128:131], v[96:111]
ds_read_b128 v[200:203], v249 offset:3456
ds_read_b128 v[204:207], v249 offset:3472
v_cvt_pk_bf16_f32 v132, v208, v209
v_mfma_f32_32x32x16_bf16 v[112:127], a[156:159], v[128:131], v[112:127]
v_cvt_pk_bf16_f32 v133, v210, v211
v_cvt_pk_bf16_f32 v134, v212, v213
v_cvt_pk_bf16_f32 v135, v214, v215
s_add_u32 s28, s28, 262144
s_waitcnt vmcnt(30) lgkmcnt(0)
s_barrier
v_mfma_f32_32x32x16_bf16 v[0:15], a[160:163], v[132:135], v[0:15]
ds_read_b64_tr_b16 a[128:129], v224 offset:49152
ds_read_b64_tr_b16 a[130:131], v224 offset:51200
ds_read_b64_tr_b16 a[132:133], v225 offset:49152
v_fma_mix_f32 v192, v136, v200, v192 op_sel:[0,0,0] op_sel_hi:[1,0,0]
v_mfma_f32_32x32x16_bf16 v[16:31], a[164:167], v[132:135], v[16:31]
ds_read_b64_tr_b16 a[134:135], v225 offset:51200
ds_read_b64_tr_b16 a[136:137], v226 offset:49152
ds_read_b64_tr_b16 a[138:139], v226 offset:51200
v_fma_mix_f32 v193, v136, v201, v193 op_sel:[1,0,0] op_sel_hi:[1,0,0]
s_add_u32 m0, s30, 81920
v_mfma_f32_32x32x16_bf16 v[32:47], a[168:171], v[132:135], v[32:47]
ds_read_b64_tr_b16 a[140:141], v227 offset:49152
ds_read_b64_tr_b16 a[142:143], v227 offset:51200
ds_read_b64_tr_b16 a[144:145], v224 offset:49408
v_fma_mix_f32 v194, v137, v202, v194 op_sel:[0,0,0] op_sel_hi:[1,0,0]
v_mfma_f32_32x32x16_bf16 v[48:63], a[172:175], v[132:135], v[48:63]
ds_read_b64_tr_b16 a[146:147], v224 offset:51456
ds_read_b64_tr_b16 a[148:149], v225 offset:49408
ds_read_b64_tr_b16 a[150:151], v225 offset:51456
v_fma_mix_f32 v195, v137, v203, v195 op_sel:[1,0,0] op_sel_hi:[1,0,0]
buffer_load_dwordx4 v[184:187], v248, s[8:11], s29 offen offset:0
v_mfma_f32_32x32x16_bf16 v[64:79], a[176:179], v[132:135], v[64:79]
ds_read_b64_tr_b16 a[152:153], v226 offset:49408
ds_read_b64_tr_b16 a[154:155], v226 offset:51456
ds_read_b64_tr_b16 a[156:157], v227 offset:49408
v_fma_mix_f32 v196, v138, v204, v196 op_sel:[0,0,0] op_sel_hi:[1,0,0]
v_fma_mix_f32 v197, v138, v205, v197 op_sel:[1,0,0] op_sel_hi:[1,0,0]
buffer_load_dwordx4 v240, s[4:7], s28 offen offset:0 lds
v_mfma_f32_32x32x16_bf16 v[80:95], a[180:183], v[132:135], v[80:95]
ds_read_b64_tr_b16 a[158:159], v227 offset:51456
ds_read_b128 v[208:211], v249 offset:1216
ds_read_b128 v[212:215], v249 offset:1232
v_fma_mix_f32 v198, v139, v206, v198 op_sel:[0,0,0] op_sel_hi:[1,0,0]
v_fma_mix_f32 v199, v139, v207, v199 op_sel:[1,0,0] op_sel_hi:[1,0,0]
v_mfma_f32_32x32x16_bf16 v[96:111], a[184:187], v[132:135], v[96:111]
ds_read_b128 v[216:219], v249 offset:3520
ds_read_b128 v[220:223], v249 offset:3536
v_cvt_pk_bf16_f32 v136, v192, v193
buffer_load_dwordx4 v241, s[4:7], s28 offen offset:1024 lds
v_mfma_f32_32x32x16_bf16 v[112:127], a[188:191], v[132:135], v[112:127]
v_cvt_pk_bf16_f32 v137, v194, v195
v_cvt_pk_bf16_f32 v138, v196, v197
v_cvt_pk_bf16_f32 v139, v198, v199
buffer_load_dwordx4 v[188:191], v248, s[8:11], s29 offen offset:512
s_waitcnt lgkmcnt(0)
v_mfma_f32_32x32x16_bf16 v[0:15], a[128:131], v[136:139], v[0:15]
ds_read_b64_tr_b16 a[160:161], v224 offset:57344
ds_read_b64_tr_b16 a[162:163], v224 offset:59392
ds_read_b64_tr_b16 a[164:165], v225 offset:57344
v_fma_mix_f32 v208, v140, v216, v208 op_sel:[0,0,0] op_sel_hi:[1,0,0]
v_mfma_f32_32x32x16_bf16 v[16:31], a[132:135], v[136:139], v[16:31]
ds_read_b64_tr_b16 a[166:167], v225 offset:59392
ds_read_b64_tr_b16 a[168:169], v226 offset:57344
ds_read_b64_tr_b16 a[170:171], v226 offset:59392
v_fma_mix_f32 v209, v140, v217, v209 op_sel:[1,0,0] op_sel_hi:[1,0,0]
s_add_u32 s29, s29, 1024
v_mfma_f32_32x32x16_bf16 v[32:47], a[136:139], v[136:139], v[32:47]
ds_read_b64_tr_b16 a[172:173], v227 offset:57344
ds_read_b64_tr_b16 a[174:175], v227 offset:59392
ds_read_b64_tr_b16 a[176:177], v224 offset:57600
v_fma_mix_f32 v210, v141, v218, v210 op_sel:[0,0,0] op_sel_hi:[1,0,0]
v_mfma_f32_32x32x16_bf16 v[48:63], a[140:143], v[136:139], v[48:63]
ds_read_b64_tr_b16 a[178:179], v224 offset:59648
ds_read_b64_tr_b16 a[180:181], v225 offset:57600
ds_read_b64_tr_b16 a[182:183], v225 offset:59648
v_fma_mix_f32 v211, v141, v219, v211 op_sel:[1,0,0] op_sel_hi:[1,0,0]
buffer_load_dwordx4 v242, s[4:7], s28 offen offset:2048 lds
v_mfma_f32_32x32x16_bf16 v[64:79], a[144:147], v[136:139], v[64:79]
ds_read_b64_tr_b16 a[184:185], v226 offset:57600
ds_read_b64_tr_b16 a[186:187], v226 offset:59648
ds_read_b64_tr_b16 a[188:189], v227 offset:57600
v_fma_mix_f32 v212, v142, v220, v212 op_sel:[0,0,0] op_sel_hi:[1,0,0]
v_fma_mix_f32 v213, v142, v221, v213 op_sel:[1,0,0] op_sel_hi:[1,0,0]
v_mfma_f32_32x32x16_bf16 v[80:95], a[148:151], v[136:139], v[80:95]
ds_read_b64_tr_b16 a[190:191], v227 offset:59648
ds_read_b128 v[192:195], v249 offset:1280
ds_read_b128 v[196:199], v249 offset:1296
v_fma_mix_f32 v214, v143, v222, v214 op_sel:[0,0,0] op_sel_hi:[1,0,0]
v_fma_mix_f32 v215, v143, v223, v215 op_sel:[1,0,0] op_sel_hi:[1,0,0]
buffer_load_dwordx4 v243, s[4:7], s28 offen offset:3072 lds
v_mfma_f32_32x32x16_bf16 v[96:111], a[152:155], v[136:139], v[96:111]
ds_read_b128 v[200:203], v249 offset:3584
ds_read_b128 v[204:207], v249 offset:3600
v_cvt_pk_bf16_f32 v140, v208, v209
v_mfma_f32_32x32x16_bf16 v[112:127], a[156:159], v[136:139], v[112:127]
v_cvt_pk_bf16_f32 v141, v210, v211
v_cvt_pk_bf16_f32 v142, v212, v213
v_cvt_pk_bf16_f32 v143, v214, v215
s_add_u32 s28, s28, 262144
s_waitcnt vmcnt(30) lgkmcnt(0)
s_barrier
v_mfma_f32_32x32x16_bf16 v[0:15], a[160:163], v[140:143], v[0:15]
v_xor_b32 v224, 0x10000, v224
v_xor_b32 v225, 0x10000, v225
v_xor_b32 v226, 0x10000, v226
v_xor_b32 v227, 0x10000, v227
ds_read_b64_tr_b16 a[128:129], v224 offset:0
ds_read_b64_tr_b16 a[130:131], v224 offset:2048
ds_read_b64_tr_b16 a[132:133], v225 offset:0
v_fma_mix_f32 v192, v144, v200, v192 op_sel:[0,0,0] op_sel_hi:[1,0,0]
v_mfma_f32_32x32x16_bf16 v[16:31], a[164:167], v[140:143], v[16:31]
ds_read_b64_tr_b16 a[134:135], v225 offset:2048
ds_read_b64_tr_b16 a[136:137], v226 offset:0
ds_read_b64_tr_b16 a[138:139], v226 offset:2048
v_fma_mix_f32 v193, v144, v201, v193 op_sel:[1,0,0] op_sel_hi:[1,0,0]
s_add_u32 m0, s30, 98304
v_mfma_f32_32x32x16_bf16 v[32:47], a[168:171], v[140:143], v[32:47]
ds_read_b64_tr_b16 a[140:141], v227 offset:0
ds_read_b64_tr_b16 a[142:143], v227 offset:2048
ds_read_b64_tr_b16 a[144:145], v224 offset:256
v_fma_mix_f32 v194, v145, v202, v194 op_sel:[0,0,0] op_sel_hi:[1,0,0]
v_mfma_f32_32x32x16_bf16 v[48:63], a[172:175], v[140:143], v[48:63]
ds_read_b64_tr_b16 a[146:147], v224 offset:2304
ds_read_b64_tr_b16 a[148:149], v225 offset:256
ds_read_b64_tr_b16 a[150:151], v225 offset:2304
v_fma_mix_f32 v195, v145, v203, v195 op_sel:[1,0,0] op_sel_hi:[1,0,0]
buffer_load_dwordx4 v[128:131], v248, s[8:11], s29 offen offset:0
v_mfma_f32_32x32x16_bf16 v[64:79], a[176:179], v[140:143], v[64:79]
ds_read_b64_tr_b16 a[152:153], v226 offset:256
ds_read_b64_tr_b16 a[154:155], v226 offset:2304
ds_read_b64_tr_b16 a[156:157], v227 offset:256
v_fma_mix_f32 v196, v146, v204, v196 op_sel:[0,0,0] op_sel_hi:[1,0,0]
v_fma_mix_f32 v197, v146, v205, v197 op_sel:[1,0,0] op_sel_hi:[1,0,0]
buffer_load_dwordx4 v240, s[4:7], s28 offen offset:0 lds
v_mfma_f32_32x32x16_bf16 v[80:95], a[180:183], v[140:143], v[80:95]
ds_read_b64_tr_b16 a[158:159], v227 offset:2304
ds_read_b128 v[208:211], v249 offset:1344
ds_read_b128 v[212:215], v249 offset:1360
v_fma_mix_f32 v198, v147, v206, v198 op_sel:[0,0,0] op_sel_hi:[1,0,0]
v_fma_mix_f32 v199, v147, v207, v199 op_sel:[1,0,0] op_sel_hi:[1,0,0]
v_mfma_f32_32x32x16_bf16 v[96:111], a[184:187], v[140:143], v[96:111]
ds_read_b128 v[216:219], v249 offset:3648
ds_read_b128 v[220:223], v249 offset:3664
v_cvt_pk_bf16_f32 v144, v192, v193
buffer_load_dwordx4 v241, s[4:7], s28 offen offset:1024 lds
v_mfma_f32_32x32x16_bf16 v[112:127], a[188:191], v[140:143], v[112:127]
v_cvt_pk_bf16_f32 v145, v194, v195
v_cvt_pk_bf16_f32 v146, v196, v197
v_cvt_pk_bf16_f32 v147, v198, v199
buffer_load_dwordx4 v[132:135], v248, s[8:11], s29 offen offset:512
s_waitcnt lgkmcnt(0)
v_mfma_f32_32x32x16_bf16 v[0:15], a[128:131], v[144:147], v[0:15]
ds_read_b64_tr_b16 a[160:161], v224 offset:8192
ds_read_b64_tr_b16 a[162:163], v224 offset:10240
ds_read_b64_tr_b16 a[164:165], v225 offset:8192
v_fma_mix_f32 v208, v148, v216, v208 op_sel:[0,0,0] op_sel_hi:[1,0,0]
v_mfma_f32_32x32x16_bf16 v[16:31], a[132:135], v[144:147], v[16:31]
ds_read_b64_tr_b16 a[166:167], v225 offset:10240
ds_read_b64_tr_b16 a[168:169], v226 offset:8192
ds_read_b64_tr_b16 a[170:171], v226 offset:10240
v_fma_mix_f32 v209, v148, v217, v209 op_sel:[1,0,0] op_sel_hi:[1,0,0]
s_add_u32 s29, s29, 1024
v_mfma_f32_32x32x16_bf16 v[32:47], a[136:139], v[144:147], v[32:47]
ds_read_b64_tr_b16 a[172:173], v227 offset:8192
ds_read_b64_tr_b16 a[174:175], v227 offset:10240
ds_read_b64_tr_b16 a[176:177], v224 offset:8448
v_fma_mix_f32 v210, v149, v218, v210 op_sel:[0,0,0] op_sel_hi:[1,0,0]
v_mfma_f32_32x32x16_bf16 v[48:63], a[140:143], v[144:147], v[48:63]
ds_read_b64_tr_b16 a[178:179], v224 offset:10496
ds_read_b64_tr_b16 a[180:181], v225 offset:8448
ds_read_b64_tr_b16 a[182:183], v225 offset:10496
v_fma_mix_f32 v211, v149, v219, v211 op_sel:[1,0,0] op_sel_hi:[1,0,0]
buffer_load_dwordx4 v242, s[4:7], s28 offen offset:2048 lds
v_mfma_f32_32x32x16_bf16 v[64:79], a[144:147], v[144:147], v[64:79]
ds_read_b64_tr_b16 a[184:185], v226 offset:8448
ds_read_b64_tr_b16 a[186:187], v226 offset:10496
ds_read_b64_tr_b16 a[188:189], v227 offset:8448
v_fma_mix_f32 v212, v150, v220, v212 op_sel:[0,0,0] op_sel_hi:[1,0,0]
v_fma_mix_f32 v213, v150, v221, v213 op_sel:[1,0,0] op_sel_hi:[1,0,0]
v_mfma_f32_32x32x16_bf16 v[80:95], a[148:151], v[144:147], v[80:95]
ds_read_b64_tr_b16 a[190:191], v227 offset:10496
ds_read_b128 v[192:195], v249 offset:1408
ds_read_b128 v[196:199], v249 offset:1424
v_fma_mix_f32 v214, v151, v222, v214 op_sel:[0,0,0] op_sel_hi:[1,0,0]
v_fma_mix_f32 v215, v151, v223, v215 op_sel:[1,0,0] op_sel_hi:[1,0,0]
buffer_load_dwordx4 v243, s[4:7], s28 offen offset:3072 lds
v_mfma_f32_32x32x16_bf16 v[96:111], a[152:155], v[144:147], v[96:111]
ds_read_b128 v[200:203], v249 offset:3712
ds_read_b128 v[204:207], v249 offset:3728
v_cvt_pk_bf16_f32 v148, v208, v209
v_mfma_f32_32x32x16_bf16 v[112:127], a[156:159], v[144:147], v[112:127]
v_cvt_pk_bf16_f32 v149, v210, v211
v_cvt_pk_bf16_f32 v150, v212, v213
v_cvt_pk_bf16_f32 v151, v214, v215
s_add_u32 s28, s28, 262144
s_waitcnt vmcnt(30) lgkmcnt(0)
s_barrier
v_mfma_f32_32x32x16_bf16 v[0:15], a[160:163], v[148:151], v[0:15]
ds_read_b64_tr_b16 a[128:129], v224 offset:16384
ds_read_b64_tr_b16 a[130:131], v224 offset:18432
ds_read_b64_tr_b16 a[132:133], v225 offset:16384
v_fma_mix_f32 v192, v152, v200, v192 op_sel:[0,0,0] op_sel_hi:[1,0,0]
s_add_u32 m0, s30, 114688
v_mfma_f32_32x32x16_bf16 v[16:31], a[164:167], v[148:151], v[16:31]
ds_read_b64_tr_b16 a[134:135], v225 offset:18432
ds_read_b64_tr_b16 a[136:137], v226 offset:16384
ds_read_b64_tr_b16 a[138:139], v226 offset:18432
v_fma_mix_f32 v193, v152, v201, v193 op_sel:[1,0,0] op_sel_hi:[1,0,0]
buffer_load_dwordx4 v[136:139], v248, s[8:11], s29 offen offset:0
v_mfma_f32_32x32x16_bf16 v[32:47], a[168:171], v[148:151], v[32:47]
ds_read_b64_tr_b16 a[140:141], v227 offset:16384
ds_read_b64_tr_b16 a[142:143], v227 offset:18432
ds_read_b64_tr_b16 a[144:145], v224 offset:16640
v_fma_mix_f32 v194, v153, v202, v194 op_sel:[0,0,0] op_sel_hi:[1,0,0]
buffer_load_dwordx4 v240, s[4:7], s28 offen offset:0 lds
v_mfma_f32_32x32x16_bf16 v[48:63], a[172:175], v[148:151], v[48:63]
ds_read_b64_tr_b16 a[146:147], v224 offset:18688
ds_read_b64_tr_b16 a[148:149], v225 offset:16640
ds_read_b64_tr_b16 a[150:151], v225 offset:18688
v_fma_mix_f32 v195, v153, v203, v195 op_sel:[1,0,0] op_sel_hi:[1,0,0]
buffer_load_dwordx4 v241, s[4:7], s28 offen offset:1024 lds
v_mfma_f32_32x32x16_bf16 v[64:79], a[176:179], v[148:151], v[64:79]
ds_read_b64_tr_b16 a[152:153], v226 offset:16640
ds_read_b64_tr_b16 a[154:155], v226 offset:18688
ds_read_b64_tr_b16 a[156:157], v227 offset:16640
v_fma_mix_f32 v196, v154, v204, v196 op_sel:[0,0,0] op_sel_hi:[1,0,0]
v_fma_mix_f32 v197, v154, v205, v197 op_sel:[1,0,0] op_sel_hi:[1,0,0]
buffer_load_dwordx4 v[140:143], v248, s[8:11], s29 offen offset:512
v_mfma_f32_32x32x16_bf16 v[80:95], a[180:183], v[148:151], v[80:95]
ds_read_b64_tr_b16 a[158:159], v227 offset:18688
ds_read_b128 v[208:211], v249 offset:1472
ds_read_b128 v[212:215], v249 offset:1488
v_fma_mix_f32 v198, v155, v206, v198 op_sel:[0,0,0] op_sel_hi:[1,0,0]
v_fma_mix_f32 v199, v155, v207, v199 op_sel:[1,0,0] op_sel_hi:[1,0,0]
s_add_u32 s29, s29, 1024
v_mfma_f32_32x32x16_bf16 v[96:111], a[184:187], v[148:151], v[96:111]
ds_read_b128 v[216:219], v249 offset:3776
ds_read_b128 v[220:223], v249 offset:3792
v_cvt_pk_bf16_f32 v152, v192, v193
buffer_load_dwordx4 v242, s[4:7], s28 offen offset:2048 lds
v_mfma_f32_32x32x16_bf16 v[112:127], a[188:191], v[148:151], v[112:127]
v_cvt_pk_bf16_f32 v153, v194, v195
v_cvt_pk_bf16_f32 v154, v196, v197
v_cvt_pk_bf16_f32 v155, v198, v199
buffer_load_dwordx4 v243, s[4:7], s28 offen offset:3072 lds
s_add_u32 s28, s28, 262144
s_waitcnt lgkmcnt(0)
v_mfma_f32_32x32x16_bf16 v[0:15], a[128:131], v[152:155], v[0:15]
ds_read_b64_tr_b16 a[160:161], v224 offset:24576
ds_read_b64_tr_b16 a[162:163], v224 offset:26624
ds_read_b64_tr_b16 a[164:165], v225 offset:24576
v_fma_mix_f32 v208, v156, v216, v208 op_sel:[0,0,0] op_sel_hi:[1,0,0]
s_add_u32 m0, s33, 0
v_mfma_f32_32x32x16_bf16 v[16:31], a[132:135], v[152:155], v[16:31]
ds_read_b64_tr_b16 a[166:167], v225 offset:26624
ds_read_b64_tr_b16 a[168:169], v226 offset:24576
ds_read_b64_tr_b16 a[170:171], v226 offset:26624
v_fma_mix_f32 v209, v156, v217, v209 op_sel:[1,0,0] op_sel_hi:[1,0,0]
buffer_load_dwordx4 v244, s[16:19], s37 offen offset:0 lds
v_mfma_f32_32x32x16_bf16 v[32:47], a[136:139], v[152:155], v[32:47]
ds_read_b64_tr_b16 a[172:173], v227 offset:24576
ds_read_b64_tr_b16 a[174:175], v227 offset:26624
ds_read_b64_tr_b16 a[176:177], v224 offset:24832
v_fma_mix_f32 v210, v157, v218, v210 op_sel:[0,0,0] op_sel_hi:[1,0,0]
buffer_load_dwordx4 v245, s[16:19], s37 offen offset:1024 lds
v_mfma_f32_32x32x16_bf16 v[48:63], a[140:143], v[152:155], v[48:63]
ds_read_b64_tr_b16 a[178:179], v224 offset:26880
ds_read_b64_tr_b16 a[180:181], v225 offset:24832
ds_read_b64_tr_b16 a[182:183], v225 offset:26880
v_fma_mix_f32 v211, v157, v219, v211 op_sel:[1,0,0] op_sel_hi:[1,0,0]
s_add_u32 s37, s37, 8192
v_mfma_f32_32x32x16_bf16 v[64:79], a[144:147], v[152:155], v[64:79]
ds_read_b64_tr_b16 a[184:185], v226 offset:24832
ds_read_b64_tr_b16 a[186:187], v226 offset:26880
ds_read_b64_tr_b16 a[188:189], v227 offset:24832
v_fma_mix_f32 v212, v158, v220, v212 op_sel:[0,0,0] op_sel_hi:[1,0,0]
v_fma_mix_f32 v213, v158, v221, v213 op_sel:[1,0,0] op_sel_hi:[1,0,0]
s_add_u32 m0, s33, 8192
v_mfma_f32_32x32x16_bf16 v[80:95], a[148:151], v[152:155], v[80:95]
ds_read_b64_tr_b16 a[190:191], v227 offset:26880
ds_read_b128 v[192:195], v249 offset:1536
ds_read_b128 v[196:199], v249 offset:1552
v_fma_mix_f32 v214, v159, v222, v214 op_sel:[0,0,0] op_sel_hi:[1,0,0]
v_fma_mix_f32 v215, v159, v223, v215 op_sel:[1,0,0] op_sel_hi:[1,0,0]
buffer_load_dwordx4 v246, s[20:23], s38 offen offset:0 lds
v_mfma_f32_32x32x16_bf16 v[96:111], a[152:155], v[152:155], v[96:111]
ds_read_b128 v[200:203], v249 offset:3840
ds_read_b128 v[204:207], v249 offset:3856
v_cvt_pk_bf16_f32 v156, v208, v209
buffer_load_dwordx4 v247, s[20:23], s38 offen offset:1024 lds
v_mfma_f32_32x32x16_bf16 v[112:127], a[156:159], v[152:155], v[112:127]
v_cvt_pk_bf16_f32 v157, v210, v211
v_cvt_pk_bf16_f32 v158, v212, v213
v_cvt_pk_bf16_f32 v159, v214, v215
s_add_u32 s38, s38, 8192
s_waitcnt vmcnt(34) lgkmcnt(0)
s_barrier
v_mfma_f32_32x32x16_bf16 v[0:15], a[160:163], v[156:159], v[0:15]
ds_read_b64_tr_b16 a[128:129], v224 offset:32768
ds_read_b64_tr_b16 a[130:131], v224 offset:34816
ds_read_b64_tr_b16 a[132:133], v225 offset:32768
v_fma_mix_f32 v192, v160, v200, v192 op_sel:[0,0,0] op_sel_hi:[1,0,0]
v_mfma_f32_32x32x16_bf16 v[16:31], a[164:167], v[156:159], v[16:31]
ds_read_b64_tr_b16 a[134:135], v225 offset:34816
ds_read_b64_tr_b16 a[136:137], v226 offset:32768
ds_read_b64_tr_b16 a[138:139], v226 offset:34816
v_fma_mix_f32 v193, v160, v201, v193 op_sel:[1,0,0] op_sel_hi:[1,0,0]
s_add_u32 m0, s33, 16384
v_mfma_f32_32x32x16_bf16 v[32:47], a[168:171], v[156:159], v[32:47]
ds_read_b64_tr_b16 a[140:141], v227 offset:32768
ds_read_b64_tr_b16 a[142:143], v227 offset:34816
ds_read_b64_tr_b16 a[144:145], v224 offset:33024
v_fma_mix_f32 v194, v161, v202, v194 op_sel:[0,0,0] op_sel_hi:[1,0,0]
v_mfma_f32_32x32x16_bf16 v[48:63], a[172:175], v[156:159], v[48:63]
ds_read_b64_tr_b16 a[146:147], v224 offset:35072
ds_read_b64_tr_b16 a[148:149], v225 offset:33024
ds_read_b64_tr_b16 a[150:151], v225 offset:35072
v_fma_mix_f32 v195, v161, v203, v195 op_sel:[1,0,0] op_sel_hi:[1,0,0]
buffer_load_dwordx4 v244, s[16:19], s37 offen offset:0 lds
v_mfma_f32_32x32x16_bf16 v[64:79], a[176:179], v[156:159], v[64:79]
ds_read_b64_tr_b16 a[152:153], v226 offset:33024
ds_read_b64_tr_b16 a[154:155], v226 offset:35072
ds_read_b64_tr_b16 a[156:157], v227 offset:33024
v_fma_mix_f32 v196, v162, v204, v196 op_sel:[0,0,0] op_sel_hi:[1,0,0]
v_fma_mix_f32 v197, v162, v205, v197 op_sel:[1,0,0] op_sel_hi:[1,0,0]
v_mfma_f32_32x32x16_bf16 v[80:95], a[180:183], v[156:159], v[80:95]
ds_read_b64_tr_b16 a[158:159], v227 offset:35072
ds_read_b128 v[208:211], v249 offset:1600
ds_read_b128 v[212:215], v249 offset:1616
v_fma_mix_f32 v198, v163, v206, v198 op_sel:[0,0,0] op_sel_hi:[1,0,0]
v_fma_mix_f32 v199, v163, v207, v199 op_sel:[1,0,0] op_sel_hi:[1,0,0]
buffer_load_dwordx4 v245, s[16:19], s37 offen offset:1024 lds
v_mfma_f32_32x32x16_bf16 v[96:111], a[184:187], v[156:159], v[96:111]
ds_read_b128 v[216:219], v249 offset:3904
ds_read_b128 v[220:223], v249 offset:3920
v_cvt_pk_bf16_f32 v160, v192, v193
v_mfma_f32_32x32x16_bf16 v[112:127], a[188:191], v[156:159], v[112:127]
v_cvt_pk_bf16_f32 v161, v194, v195
v_cvt_pk_bf16_f32 v162, v196, v197
v_cvt_pk_bf16_f32 v163, v198, v199
s_add_u32 s37, s37, 8192
s_waitcnt lgkmcnt(0)
v_mfma_f32_32x32x16_bf16 v[0:15], a[128:131], v[160:163], v[0:15]
ds_read_b64_tr_b16 a[160:161], v224 offset:40960
ds_read_b64_tr_b16 a[162:163], v224 offset:43008
ds_read_b64_tr_b16 a[164:165], v225 offset:40960
v_fma_mix_f32 v208, v164, v216, v208 op_sel:[0,0,0] op_sel_hi:[1,0,0]
v_mfma_f32_32x32x16_bf16 v[16:31], a[132:135], v[160:163], v[16:31]
ds_read_b64_tr_b16 a[166:167], v225 offset:43008
ds_read_b64_tr_b16 a[168:169], v226 offset:40960
ds_read_b64_tr_b16 a[170:171], v226 offset:43008
v_fma_mix_f32 v209, v164, v217, v209 op_sel:[1,0,0] op_sel_hi:[1,0,0]
s_add_u32 m0, s33, 24576
v_mfma_f32_32x32x16_bf16 v[32:47], a[136:139], v[160:163], v[32:47]
ds_read_b64_tr_b16 a[172:173], v227 offset:40960
ds_read_b64_tr_b16 a[174:175], v227 offset:43008
ds_read_b64_tr_b16 a[176:177], v224 offset:41216
v_fma_mix_f32 v210, v165, v218, v210 op_sel:[0,0,0] op_sel_hi:[1,0,0]
v_mfma_f32_32x32x16_bf16 v[48:63], a[140:143], v[160:163], v[48:63]
ds_read_b64_tr_b16 a[178:179], v224 offset:43264
ds_read_b64_tr_b16 a[180:181], v225 offset:41216
ds_read_b64_tr_b16 a[182:183], v225 offset:43264
v_fma_mix_f32 v211, v165, v219, v211 op_sel:[1,0,0] op_sel_hi:[1,0,0]
buffer_load_dwordx4 v246, s[20:23], s38 offen offset:0 lds
v_mfma_f32_32x32x16_bf16 v[64:79], a[144:147], v[160:163], v[64:79]
ds_read_b64_tr_b16 a[184:185], v226 offset:41216
ds_read_b64_tr_b16 a[186:187], v226 offset:43264
ds_read_b64_tr_b16 a[188:189], v227 offset:41216
v_fma_mix_f32 v212, v166, v220, v212 op_sel:[0,0,0] op_sel_hi:[1,0,0]
v_fma_mix_f32 v213, v166, v221, v213 op_sel:[1,0,0] op_sel_hi:[1,0,0]
v_mfma_f32_32x32x16_bf16 v[80:95], a[148:151], v[160:163], v[80:95]
ds_read_b64_tr_b16 a[190:191], v227 offset:43264
ds_read_b128 v[192:195], v249 offset:1664
ds_read_b128 v[196:199], v249 offset:1680
v_fma_mix_f32 v214, v167, v222, v214 op_sel:[0,0,0] op_sel_hi:[1,0,0]
v_fma_mix_f32 v215, v167, v223, v215 op_sel:[1,0,0] op_sel_hi:[1,0,0]
buffer_load_dwordx4 v247, s[20:23], s38 offen offset:1024 lds
v_mfma_f32_32x32x16_bf16 v[96:111], a[152:155], v[160:163], v[96:111]
ds_read_b128 v[200:203], v249 offset:3968
ds_read_b128 v[204:207], v249 offset:3984
v_cvt_pk_bf16_f32 v164, v208, v209
v_mfma_f32_32x32x16_bf16 v[112:127], a[156:159], v[160:163], v[112:127]
v_cvt_pk_bf16_f32 v165, v210, v211
v_cvt_pk_bf16_f32 v166, v212, v213
v_cvt_pk_bf16_f32 v167, v214, v215
s_add_u32 s38, s38, 8192
s_waitcnt vmcnt(32) lgkmcnt(0)
s_barrier
v_mfma_f32_32x32x16_bf16 v[0:15], a[160:163], v[164:167], v[0:15]
ds_read_b64_tr_b16 a[128:129], v224 offset:49152
ds_read_b64_tr_b16 a[130:131], v224 offset:51200
ds_read_b64_tr_b16 a[132:133], v225 offset:49152
v_fma_mix_f32 v192, v168, v200, v192 op_sel:[0,0,0] op_sel_hi:[1,0,0]
v_mfma_f32_32x32x16_bf16 v[16:31], a[164:167], v[164:167], v[16:31]
ds_read_b64_tr_b16 a[134:135], v225 offset:51200
ds_read_b64_tr_b16 a[136:137], v226 offset:49152
ds_read_b64_tr_b16 a[138:139], v226 offset:51200
v_fma_mix_f32 v193, v168, v201, v193 op_sel:[1,0,0] op_sel_hi:[1,0,0]
s_add_u32 m0, s33, 32768
v_mfma_f32_32x32x16_bf16 v[32:47], a[168:171], v[164:167], v[32:47]
ds_read_b64_tr_b16 a[140:141], v227 offset:49152
ds_read_b64_tr_b16 a[142:143], v227 offset:51200
ds_read_b64_tr_b16 a[144:145], v224 offset:49408
v_fma_mix_f32 v194, v169, v202, v194 op_sel:[0,0,0] op_sel_hi:[1,0,0]
v_mfma_f32_32x32x16_bf16 v[48:63], a[172:175], v[164:167], v[48:63]
ds_read_b64_tr_b16 a[146:147], v224 offset:51456
ds_read_b64_tr_b16 a[148:149], v225 offset:49408
ds_read_b64_tr_b16 a[150:151], v225 offset:51456
v_fma_mix_f32 v195, v169, v203, v195 op_sel:[1,0,0] op_sel_hi:[1,0,0]
buffer_load_dwordx4 v244, s[16:19], s37 offen offset:0 lds
v_mfma_f32_32x32x16_bf16 v[64:79], a[176:179], v[164:167], v[64:79]
ds_read_b64_tr_b16 a[152:153], v226 offset:49408
ds_read_b64_tr_b16 a[154:155], v226 offset:51456
ds_read_b64_tr_b16 a[156:157], v227 offset:49408
v_fma_mix_f32 v196, v170, v204, v196 op_sel:[0,0,0] op_sel_hi:[1,0,0]
v_fma_mix_f32 v197, v170, v205, v197 op_sel:[1,0,0] op_sel_hi:[1,0,0]
v_mfma_f32_32x32x16_bf16 v[80:95], a[180:183], v[164:167], v[80:95]
ds_read_b64_tr_b16 a[158:159], v227 offset:51456
ds_read_b128 v[208:211], v249 offset:1728
ds_read_b128 v[212:215], v249 offset:1744
v_fma_mix_f32 v198, v171, v206, v198 op_sel:[0,0,0] op_sel_hi:[1,0,0]
v_fma_mix_f32 v199, v171, v207, v199 op_sel:[1,0,0] op_sel_hi:[1,0,0]
buffer_load_dwordx4 v245, s[16:19], s37 offen offset:1024 lds
v_mfma_f32_32x32x16_bf16 v[96:111], a[184:187], v[164:167], v[96:111]
ds_read_b128 v[216:219], v249 offset:4032
ds_read_b128 v[220:223], v249 offset:4048
v_cvt_pk_bf16_f32 v168, v192, v193
v_mfma_f32_32x32x16_bf16 v[112:127], a[188:191], v[164:167], v[112:127]
v_cvt_pk_bf16_f32 v169, v194, v195
v_cvt_pk_bf16_f32 v170, v196, v197
v_cvt_pk_bf16_f32 v171, v198, v199
s_add_u32 s37, s37, 8192
s_waitcnt lgkmcnt(0)
v_mfma_f32_32x32x16_bf16 v[0:15], a[128:131], v[168:171], v[0:15]
ds_read_b64_tr_b16 a[160:161], v224 offset:57344
ds_read_b64_tr_b16 a[162:163], v224 offset:59392
ds_read_b64_tr_b16 a[164:165], v225 offset:57344
v_fma_mix_f32 v208, v172, v216, v208 op_sel:[0,0,0] op_sel_hi:[1,0,0]
v_mfma_f32_32x32x16_bf16 v[16:31], a[132:135], v[168:171], v[16:31]
ds_read_b64_tr_b16 a[166:167], v225 offset:59392
ds_read_b64_tr_b16 a[168:169], v226 offset:57344
ds_read_b64_tr_b16 a[170:171], v226 offset:59392
v_fma_mix_f32 v209, v172, v217, v209 op_sel:[1,0,0] op_sel_hi:[1,0,0]
s_add_u32 m0, s33, 40960
v_mfma_f32_32x32x16_bf16 v[32:47], a[136:139], v[168:171], v[32:47]
ds_read_b64_tr_b16 a[172:173], v227 offset:57344
ds_read_b64_tr_b16 a[174:175], v227 offset:59392
ds_read_b64_tr_b16 a[176:177], v224 offset:57600
v_fma_mix_f32 v210, v173, v218, v210 op_sel:[0,0,0] op_sel_hi:[1,0,0]
v_mfma_f32_32x32x16_bf16 v[48:63], a[140:143], v[168:171], v[48:63]
ds_read_b64_tr_b16 a[178:179], v224 offset:59648
ds_read_b64_tr_b16 a[180:181], v225 offset:57600
ds_read_b64_tr_b16 a[182:183], v225 offset:59648
v_fma_mix_f32 v211, v173, v219, v211 op_sel:[1,0,0] op_sel_hi:[1,0,0]
buffer_load_dwordx4 v246, s[20:23], s38 offen offset:0 lds
v_mfma_f32_32x32x16_bf16 v[64:79], a[144:147], v[168:171], v[64:79]
ds_read_b64_tr_b16 a[184:185], v226 offset:57600
ds_read_b64_tr_b16 a[186:187], v226 offset:59648
ds_read_b64_tr_b16 a[188:189], v227 offset:57600
v_fma_mix_f32 v212, v174, v220, v212 op_sel:[0,0,0] op_sel_hi:[1,0,0]
v_fma_mix_f32 v213, v174, v221, v213 op_sel:[1,0,0] op_sel_hi:[1,0,0]
v_mfma_f32_32x32x16_bf16 v[80:95], a[148:151], v[168:171], v[80:95]
ds_read_b64_tr_b16 a[190:191], v227 offset:59648
ds_read_b128 v[192:195], v249 offset:1792
ds_read_b128 v[196:199], v249 offset:1808
v_fma_mix_f32 v214, v175, v222, v214 op_sel:[0,0,0] op_sel_hi:[1,0,0]
v_fma_mix_f32 v215, v175, v223, v215 op_sel:[1,0,0] op_sel_hi:[1,0,0]
buffer_load_dwordx4 v247, s[20:23], s38 offen offset:1024 lds
v_mfma_f32_32x32x16_bf16 v[96:111], a[152:155], v[168:171], v[96:111]
ds_read_b128 v[200:203], v249 offset:4096
ds_read_b128 v[204:207], v249 offset:4112
v_cvt_pk_bf16_f32 v172, v208, v209
v_mfma_f32_32x32x16_bf16 v[112:127], a[156:159], v[168:171], v[112:127]
v_cvt_pk_bf16_f32 v173, v210, v211
v_cvt_pk_bf16_f32 v174, v212, v213
v_cvt_pk_bf16_f32 v175, v214, v215
s_add_u32 s38, s38, 8192
s_waitcnt vmcnt(30) lgkmcnt(0)
s_barrier
v_mfma_f32_32x32x16_bf16 v[0:15], a[160:163], v[172:175], v[0:15]
v_xor_b32 v224, 0x10000, v224
v_xor_b32 v225, 0x10000, v225
v_xor_b32 v226, 0x10000, v226
v_xor_b32 v227, 0x10000, v227
ds_read_b64_tr_b16 a[128:129], v224 offset:0
ds_read_b64_tr_b16 a[130:131], v224 offset:2048
ds_read_b64_tr_b16 a[132:133], v225 offset:0
v_fma_mix_f32 v192, v176, v200, v192 op_sel:[0,0,0] op_sel_hi:[1,0,0]
v_mfma_f32_32x32x16_bf16 v[16:31], a[164:167], v[172:175], v[16:31]
ds_read_b64_tr_b16 a[134:135], v225 offset:2048
ds_read_b64_tr_b16 a[136:137], v226 offset:0
ds_read_b64_tr_b16 a[138:139], v226 offset:2048
v_fma_mix_f32 v193, v176, v201, v193 op_sel:[1,0,0] op_sel_hi:[1,0,0]
v_mfma_f32_32x32x16_bf16 v[32:47], a[168:171], v[172:175], v[32:47]
ds_read_b64_tr_b16 a[140:141], v227 offset:0
ds_read_b64_tr_b16 a[142:143], v227 offset:2048
ds_read_b64_tr_b16 a[144:145], v224 offset:256
v_fma_mix_f32 v194, v177, v202, v194 op_sel:[0,0,0] op_sel_hi:[1,0,0]
v_mfma_f32_32x32x16_bf16 v[48:63], a[172:175], v[172:175], v[48:63]
ds_read_b64_tr_b16 a[146:147], v224 offset:2304
ds_read_b64_tr_b16 a[148:149], v225 offset:256
ds_read_b64_tr_b16 a[150:151], v225 offset:2304
v_fma_mix_f32 v195, v177, v203, v195 op_sel:[1,0,0] op_sel_hi:[1,0,0]
s_add_u32 m0, s33, 49152
v_mfma_f32_32x32x16_bf16 v[64:79], a[176:179], v[172:175], v[64:79]
ds_read_b64_tr_b16 a[152:153], v226 offset:256
ds_read_b64_tr_b16 a[154:155], v226 offset:2304
ds_read_b64_tr_b16 a[156:157], v227 offset:256
v_fma_mix_f32 v196, v178, v204, v196 op_sel:[0,0,0] op_sel_hi:[1,0,0]
v_fma_mix_f32 v197, v178, v205, v197 op_sel:[1,0,0] op_sel_hi:[1,0,0]
v_mfma_f32_32x32x16_bf16 v[80:95], a[180:183], v[172:175], v[80:95]
ds_read_b64_tr_b16 a[158:159], v227 offset:2304
ds_read_b128 v[208:211], v249 offset:1856
ds_read_b128 v[212:215], v249 offset:1872
v_fma_mix_f32 v198, v179, v206, v198 op_sel:[0,0,0] op_sel_hi:[1,0,0]
v_fma_mix_f32 v199, v179, v207, v199 op_sel:[1,0,0] op_sel_hi:[1,0,0]
v_mfma_f32_32x32x16_bf16 v[96:111], a[184:187], v[172:175], v[96:111]
ds_read_b128 v[216:219], v249 offset:4160
ds_read_b128 v[220:223], v249 offset:4176
v_cvt_pk_bf16_f32 v176, v192, v193
v_mfma_f32_32x32x16_bf16 v[112:127], a[188:191], v[172:175], v[112:127]
v_cvt_pk_bf16_f32 v177, v194, v195
v_cvt_pk_bf16_f32 v178, v196, v197
v_cvt_pk_bf16_f32 v179, v198, v199
buffer_load_dwordx4 v244, s[16:19], s36 offen offset:0 lds
s_waitcnt lgkmcnt(0)
v_mfma_f32_32x32x16_bf16 v[0:15], a[128:131], v[176:179], v[0:15]
ds_read_b64_tr_b16 a[160:161], v224 offset:8192
ds_read_b64_tr_b16 a[162:163], v224 offset:10240
ds_read_b64_tr_b16 a[164:165], v225 offset:8192
v_fma_mix_f32 v208, v180, v216, v208 op_sel:[0,0,0] op_sel_hi:[1,0,0]
v_mfma_f32_32x32x16_bf16 v[16:31], a[132:135], v[176:179], v[16:31]
ds_read_b64_tr_b16 a[166:167], v225 offset:10240
ds_read_b64_tr_b16 a[168:169], v226 offset:8192
ds_read_b64_tr_b16 a[170:171], v226 offset:10240
v_fma_mix_f32 v209, v180, v217, v209 op_sel:[1,0,0] op_sel_hi:[1,0,0]
v_mfma_f32_32x32x16_bf16 v[32:47], a[136:139], v[176:179], v[32:47]
ds_read_b64_tr_b16 a[172:173], v227 offset:8192
ds_read_b64_tr_b16 a[174:175], v227 offset:10240
ds_read_b64_tr_b16 a[176:177], v224 offset:8448
v_fma_mix_f32 v210, v181, v218, v210 op_sel:[0,0,0] op_sel_hi:[1,0,0]
v_mfma_f32_32x32x16_bf16 v[48:63], a[140:143], v[176:179], v[48:63]
ds_read_b64_tr_b16 a[178:179], v224 offset:10496
ds_read_b64_tr_b16 a[180:181], v225 offset:8448
ds_read_b64_tr_b16 a[182:183], v225 offset:10496
v_fma_mix_f32 v211, v181, v219, v211 op_sel:[1,0,0] op_sel_hi:[1,0,0]
v_mfma_f32_32x32x16_bf16 v[64:79], a[144:147], v[176:179], v[64:79]
ds_read_b64_tr_b16 a[184:185], v226 offset:8448
ds_read_b64_tr_b16 a[186:187], v226 offset:10496
ds_read_b64_tr_b16 a[188:189], v227 offset:8448
v_fma_mix_f32 v212, v182, v220, v212 op_sel:[0,0,0] op_sel_hi:[1,0,0]
v_fma_mix_f32 v213, v182, v221, v213 op_sel:[1,0,0] op_sel_hi:[1,0,0]
v_mfma_f32_32x32x16_bf16 v[80:95], a[148:151], v[176:179], v[80:95]
ds_read_b64_tr_b16 a[190:191], v227 offset:10496
ds_read_b128 v[192:195], v249 offset:1920
ds_read_b128 v[196:199], v249 offset:1936
v_fma_mix_f32 v214, v183, v222, v214 op_sel:[0,0,0] op_sel_hi:[1,0,0]
v_fma_mix_f32 v215, v183, v223, v215 op_sel:[1,0,0] op_sel_hi:[1,0,0]
v_mfma_f32_32x32x16_bf16 v[96:111], a[152:155], v[176:179], v[96:111]
ds_read_b128 v[200:203], v249 offset:4224
ds_read_b128 v[204:207], v249 offset:4240
v_cvt_pk_bf16_f32 v180, v208, v209
v_mfma_f32_32x32x16_bf16 v[112:127], a[156:159], v[176:179], v[112:127]
v_cvt_pk_bf16_f32 v181, v210, v211
v_cvt_pk_bf16_f32 v182, v212, v213
v_cvt_pk_bf16_f32 v183, v214, v215
buffer_load_dwordx4 v245, s[16:19], s36 offen offset:1024 lds
s_waitcnt vmcnt(26) lgkmcnt(0)
s_barrier
v_mfma_f32_32x32x16_bf16 v[0:15], a[160:163], v[180:183], v[0:15]
ds_read_b64_tr_b16 a[128:129], v224 offset:16384
ds_read_b64_tr_b16 a[130:131], v224 offset:18432
ds_read_b64_tr_b16 a[132:133], v225 offset:16384
v_fma_mix_f32 v192, v184, v200, v192 op_sel:[0,0,0] op_sel_hi:[1,0,0]
v_mfma_f32_32x32x16_bf16 v[16:31], a[164:167], v[180:183], v[16:31]
ds_read_b64_tr_b16 a[134:135], v225 offset:18432
ds_read_b64_tr_b16 a[136:137], v226 offset:16384
ds_read_b64_tr_b16 a[138:139], v226 offset:18432
v_fma_mix_f32 v193, v184, v201, v193 op_sel:[1,0,0] op_sel_hi:[1,0,0]
v_mfma_f32_32x32x16_bf16 v[32:47], a[168:171], v[180:183], v[32:47]
ds_read_b64_tr_b16 a[140:141], v227 offset:16384
ds_read_b64_tr_b16 a[142:143], v227 offset:18432
ds_read_b64_tr_b16 a[144:145], v224 offset:16640
v_fma_mix_f32 v194, v185, v202, v194 op_sel:[0,0,0] op_sel_hi:[1,0,0]
v_mfma_f32_32x32x16_bf16 v[48:63], a[172:175], v[180:183], v[48:63]
ds_read_b64_tr_b16 a[146:147], v224 offset:18688
ds_read_b64_tr_b16 a[148:149], v225 offset:16640
ds_read_b64_tr_b16 a[150:151], v225 offset:18688
v_fma_mix_f32 v195, v185, v203, v195 op_sel:[1,0,0] op_sel_hi:[1,0,0]
v_mfma_f32_32x32x16_bf16 v[64:79], a[176:179], v[180:183], v[64:79]
ds_read_b64_tr_b16 a[152:153], v226 offset:16640
ds_read_b64_tr_b16 a[154:155], v226 offset:18688
ds_read_b64_tr_b16 a[156:157], v227 offset:16640
v_fma_mix_f32 v196, v186, v204, v196 op_sel:[0,0,0] op_sel_hi:[1,0,0]
v_fma_mix_f32 v197, v186, v205, v197 op_sel:[1,0,0] op_sel_hi:[1,0,0]
v_mfma_f32_32x32x16_bf16 v[80:95], a[180:183], v[180:183], v[80:95]
ds_read_b64_tr_b16 a[158:159], v227 offset:18688
ds_read_b128 v[208:211], v249 offset:1984
ds_read_b128 v[212:215], v249 offset:2000
v_fma_mix_f32 v198, v187, v206, v198 op_sel:[0,0,0] op_sel_hi:[1,0,0]
v_fma_mix_f32 v199, v187, v207, v199 op_sel:[1,0,0] op_sel_hi:[1,0,0]
v_mfma_f32_32x32x16_bf16 v[96:111], a[184:187], v[180:183], v[96:111]
ds_read_b128 v[216:219], v249 offset:4288
ds_read_b128 v[220:223], v249 offset:4304
v_cvt_pk_bf16_f32 v184, v192, v193
v_mfma_f32_32x32x16_bf16 v[112:127], a[188:191], v[180:183], v[112:127]
v_cvt_pk_bf16_f32 v185, v194, v195
v_cvt_pk_bf16_f32 v186, v196, v197
v_cvt_pk_bf16_f32 v187, v198, v199
s_waitcnt lgkmcnt(0)
s_nop 0
v_mfma_f32_32x32x16_bf16 v[0:15], a[128:131], v[184:187], v[0:15]
ds_read_b64_tr_b16 a[160:161], v224 offset:24576
ds_read_b64_tr_b16 a[162:163], v224 offset:26624
ds_read_b64_tr_b16 a[164:165], v225 offset:24576
v_fma_mix_f32 v208, v188, v216, v208 op_sel:[0,0,0] op_sel_hi:[1,0,0]
v_mfma_f32_32x32x16_bf16 v[16:31], a[132:135], v[184:187], v[16:31]
ds_read_b64_tr_b16 a[166:167], v225 offset:26624
ds_read_b64_tr_b16 a[168:169], v226 offset:24576
ds_read_b64_tr_b16 a[170:171], v226 offset:26624
v_fma_mix_f32 v209, v188, v217, v209 op_sel:[1,0,0] op_sel_hi:[1,0,0]
v_mfma_f32_32x32x16_bf16 v[32:47], a[136:139], v[184:187], v[32:47]
ds_read_b64_tr_b16 a[172:173], v227 offset:24576
ds_read_b64_tr_b16 a[174:175], v227 offset:26624
ds_read_b64_tr_b16 a[176:177], v224 offset:24832
v_fma_mix_f32 v210, v189, v218, v210 op_sel:[0,0,0] op_sel_hi:[1,0,0]
v_mfma_f32_32x32x16_bf16 v[48:63], a[140:143], v[184:187], v[48:63]
ds_read_b64_tr_b16 a[178:179], v224 offset:26880
ds_read_b64_tr_b16 a[180:181], v225 offset:24832
ds_read_b64_tr_b16 a[182:183], v225 offset:26880
v_fma_mix_f32 v211, v189, v219, v211 op_sel:[1,0,0] op_sel_hi:[1,0,0]
v_mfma_f32_32x32x16_bf16 v[64:79], a[144:147], v[184:187], v[64:79]
ds_read_b64_tr_b16 a[184:185], v226 offset:24832
ds_read_b64_tr_b16 a[186:187], v226 offset:26880
ds_read_b64_tr_b16 a[188:189], v227 offset:24832
v_fma_mix_f32 v212, v190, v220, v212 op_sel:[0,0,0] op_sel_hi:[1,0,0]
v_fma_mix_f32 v213, v190, v221, v213 op_sel:[1,0,0] op_sel_hi:[1,0,0]
v_mfma_f32_32x32x16_bf16 v[80:95], a[148:151], v[184:187], v[80:95]
ds_read_b64_tr_b16 a[190:191], v227 offset:26880
ds_read_b128 v[192:195], v249 offset:2048
ds_read_b128 v[196:199], v249 offset:2064
v_fma_mix_f32 v214, v191, v222, v214 op_sel:[0,0,0] op_sel_hi:[1,0,0]
v_fma_mix_f32 v215, v191, v223, v215 op_sel:[1,0,0] op_sel_hi:[1,0,0]
v_mfma_f32_32x32x16_bf16 v[96:111], a[152:155], v[184:187], v[96:111]
ds_read_b128 v[200:203], v249 offset:4352
ds_read_b128 v[204:207], v249 offset:4368
v_cvt_pk_bf16_f32 v188, v208, v209
v_mfma_f32_32x32x16_bf16 v[112:127], a[156:159], v[184:187], v[112:127]
v_cvt_pk_bf16_f32 v189, v210, v211
v_cvt_pk_bf16_f32 v190, v212, v213
v_cvt_pk_bf16_f32 v191, v214, v215
s_waitcnt vmcnt(20) lgkmcnt(0)
s_barrier
v_mfma_f32_32x32x16_bf16 v[0:15], a[160:163], v[188:191], v[0:15]
ds_read_b64_tr_b16 a[128:129], v224 offset:32768
ds_read_b64_tr_b16 a[130:131], v224 offset:34816
ds_read_b64_tr_b16 a[132:133], v225 offset:32768
v_fma_mix_f32 v192, v128, v200, v192 op_sel:[0,0,0] op_sel_hi:[1,0,0]
v_mfma_f32_32x32x16_bf16 v[16:31], a[164:167], v[188:191], v[16:31]
ds_read_b64_tr_b16 a[134:135], v225 offset:34816
ds_read_b64_tr_b16 a[136:137], v226 offset:32768
ds_read_b64_tr_b16 a[138:139], v226 offset:34816
v_fma_mix_f32 v193, v128, v201, v193 op_sel:[1,0,0] op_sel_hi:[1,0,0]
v_mfma_f32_32x32x16_bf16 v[32:47], a[168:171], v[188:191], v[32:47]
ds_read_b64_tr_b16 a[140:141], v227 offset:32768
ds_read_b64_tr_b16 a[142:143], v227 offset:34816
ds_read_b64_tr_b16 a[144:145], v224 offset:33024
v_fma_mix_f32 v194, v129, v202, v194 op_sel:[0,0,0] op_sel_hi:[1,0,0]
v_mfma_f32_32x32x16_bf16 v[48:63], a[172:175], v[188:191], v[48:63]
ds_read_b64_tr_b16 a[146:147], v224 offset:35072
ds_read_b64_tr_b16 a[148:149], v225 offset:33024
ds_read_b64_tr_b16 a[150:151], v225 offset:35072
v_fma_mix_f32 v195, v129, v203, v195 op_sel:[1,0,0] op_sel_hi:[1,0,0]
v_mfma_f32_32x32x16_bf16 v[64:79], a[176:179], v[188:191], v[64:79]
ds_read_b64_tr_b16 a[152:153], v226 offset:33024
ds_read_b64_tr_b16 a[154:155], v226 offset:35072
ds_read_b64_tr_b16 a[156:157], v227 offset:33024
v_fma_mix_f32 v196, v130, v204, v196 op_sel:[0,0,0] op_sel_hi:[1,0,0]
v_fma_mix_f32 v197, v130, v205, v197 op_sel:[1,0,0] op_sel_hi:[1,0,0]
v_mfma_f32_32x32x16_bf16 v[80:95], a[180:183], v[188:191], v[80:95]
ds_read_b64_tr_b16 a[158:159], v227 offset:35072
ds_read_b128 v[208:211], v249 offset:2112
ds_read_b128 v[212:215], v249 offset:2128
v_fma_mix_f32 v198, v131, v206, v198 op_sel:[0,0,0] op_sel_hi:[1,0,0]
v_fma_mix_f32 v199, v131, v207, v199 op_sel:[1,0,0] op_sel_hi:[1,0,0]
v_mfma_f32_32x32x16_bf16 v[96:111], a[184:187], v[188:191], v[96:111]
ds_read_b128 v[216:219], v249 offset:4416
ds_read_b128 v[220:223], v249 offset:4432
v_cvt_pk_bf16_f32 v128, v192, v193
v_mfma_f32_32x32x16_bf16 v[112:127], a[188:191], v[188:191], v[112:127]
v_cvt_pk_bf16_f32 v129, v194, v195
v_cvt_pk_bf16_f32 v130, v196, v197
v_cvt_pk_bf16_f32 v131, v198, v199
s_waitcnt lgkmcnt(0)
s_nop 0
v_mfma_f32_32x32x16_bf16 v[0:15], a[128:131], v[128:131], v[0:15]
ds_read_b64_tr_b16 a[160:161], v224 offset:40960
ds_read_b64_tr_b16 a[162:163], v224 offset:43008
ds_read_b64_tr_b16 a[164:165], v225 offset:40960
v_fma_mix_f32 v208, v132, v216, v208 op_sel:[0,0,0] op_sel_hi:[1,0,0]
v_mfma_f32_32x32x16_bf16 v[16:31], a[132:135], v[128:131], v[16:31]
ds_read_b64_tr_b16 a[166:167], v225 offset:43008
ds_read_b64_tr_b16 a[168:169], v226 offset:40960
ds_read_b64_tr_b16 a[170:171], v226 offset:43008
v_fma_mix_f32 v209, v132, v217, v209 op_sel:[1,0,0] op_sel_hi:[1,0,0]
v_mfma_f32_32x32x16_bf16 v[32:47], a[136:139], v[128:131], v[32:47]
ds_read_b64_tr_b16 a[172:173], v227 offset:40960
ds_read_b64_tr_b16 a[174:175], v227 offset:43008
ds_read_b64_tr_b16 a[176:177], v224 offset:41216
v_fma_mix_f32 v210, v133, v218, v210 op_sel:[0,0,0] op_sel_hi:[1,0,0]
v_mfma_f32_32x32x16_bf16 v[48:63], a[140:143], v[128:131], v[48:63]
ds_read_b64_tr_b16 a[178:179], v224 offset:43264
ds_read_b64_tr_b16 a[180:181], v225 offset:41216
ds_read_b64_tr_b16 a[182:183], v225 offset:43264
v_fma_mix_f32 v211, v133, v219, v211 op_sel:[1,0,0] op_sel_hi:[1,0,0]
v_mfma_f32_32x32x16_bf16 v[64:79], a[144:147], v[128:131], v[64:79]
ds_read_b64_tr_b16 a[184:185], v226 offset:41216
ds_read_b64_tr_b16 a[186:187], v226 offset:43264
ds_read_b64_tr_b16 a[188:189], v227 offset:41216
v_fma_mix_f32 v212, v134, v220, v212 op_sel:[0,0,0] op_sel_hi:[1,0,0]
v_fma_mix_f32 v213, v134, v221, v213 op_sel:[1,0,0] op_sel_hi:[1,0,0]
v_mfma_f32_32x32x16_bf16 v[80:95], a[148:151], v[128:131], v[80:95]
ds_read_b64_tr_b16 a[190:191], v227 offset:43264
ds_read_b128 v[192:195], v249 offset:2176
ds_read_b128 v[196:199], v249 offset:2192
v_fma_mix_f32 v214, v135, v222, v214 op_sel:[0,0,0] op_sel_hi:[1,0,0]
v_fma_mix_f32 v215, v135, v223, v215 op_sel:[1,0,0] op_sel_hi:[1,0,0]
v_mfma_f32_32x32x16_bf16 v[96:111], a[152:155], v[128:131], v[96:111]
ds_read_b128 v[200:203], v249 offset:4480
ds_read_b128 v[204:207], v249 offset:4496
v_cvt_pk_bf16_f32 v132, v208, v209
v_mfma_f32_32x32x16_bf16 v[112:127], a[156:159], v[128:131], v[112:127]
v_cvt_pk_bf16_f32 v133, v210, v211
v_cvt_pk_bf16_f32 v134, v212, v213
v_cvt_pk_bf16_f32 v135, v214, v215
s_waitcnt vmcnt(14) lgkmcnt(0)
s_barrier
v_mfma_f32_32x32x16_bf16 v[0:15], a[160:163], v[132:135], v[0:15]
ds_read_b64_tr_b16 a[128:129], v224 offset:49152
ds_read_b64_tr_b16 a[130:131], v224 offset:51200
ds_read_b64_tr_b16 a[132:133], v225 offset:49152
v_fma_mix_f32 v192, v136, v200, v192 op_sel:[0,0,0] op_sel_hi:[1,0,0]
v_mfma_f32_32x32x16_bf16 v[16:31], a[164:167], v[132:135], v[16:31]
ds_read_b64_tr_b16 a[134:135], v225 offset:51200
ds_read_b64_tr_b16 a[136:137], v226 offset:49152
ds_read_b64_tr_b16 a[138:139], v226 offset:51200
v_fma_mix_f32 v193, v136, v201, v193 op_sel:[1,0,0] op_sel_hi:[1,0,0]
v_mfma_f32_32x32x16_bf16 v[32:47], a[168:171], v[132:135], v[32:47]
ds_read_b64_tr_b16 a[140:141], v227 offset:49152
ds_read_b64_tr_b16 a[142:143], v227 offset:51200
ds_read_b64_tr_b16 a[144:145], v224 offset:49408
v_fma_mix_f32 v194, v137, v202, v194 op_sel:[0,0,0] op_sel_hi:[1,0,0]
v_mfma_f32_32x32x16_bf16 v[48:63], a[172:175], v[132:135], v[48:63]
ds_read_b64_tr_b16 a[146:147], v224 offset:51456
ds_read_b64_tr_b16 a[148:149], v225 offset:49408
ds_read_b64_tr_b16 a[150:151], v225 offset:51456
v_fma_mix_f32 v195, v137, v203, v195 op_sel:[1,0,0] op_sel_hi:[1,0,0]
v_mfma_f32_32x32x16_bf16 v[64:79], a[176:179], v[132:135], v[64:79]
ds_read_b64_tr_b16 a[152:153], v226 offset:49408
ds_read_b64_tr_b16 a[154:155], v226 offset:51456
ds_read_b64_tr_b16 a[156:157], v227 offset:49408
v_fma_mix_f32 v196, v138, v204, v196 op_sel:[0,0,0] op_sel_hi:[1,0,0]
v_fma_mix_f32 v197, v138, v205, v197 op_sel:[1,0,0] op_sel_hi:[1,0,0]
v_mfma_f32_32x32x16_bf16 v[80:95], a[180:183], v[132:135], v[80:95]
ds_read_b64_tr_b16 a[158:159], v227 offset:51456
ds_read_b128 v[208:211], v249 offset:2240
ds_read_b128 v[212:215], v249 offset:2256
v_fma_mix_f32 v198, v139, v206, v198 op_sel:[0,0,0] op_sel_hi:[1,0,0]
v_fma_mix_f32 v199, v139, v207, v199 op_sel:[1,0,0] op_sel_hi:[1,0,0]
v_mfma_f32_32x32x16_bf16 v[96:111], a[184:187], v[132:135], v[96:111]
ds_read_b128 v[216:219], v249 offset:4544
ds_read_b128 v[220:223], v249 offset:4560
v_cvt_pk_bf16_f32 v136, v192, v193
v_mfma_f32_32x32x16_bf16 v[112:127], a[188:191], v[132:135], v[112:127]
v_cvt_pk_bf16_f32 v137, v194, v195
v_cvt_pk_bf16_f32 v138, v196, v197
v_cvt_pk_bf16_f32 v139, v198, v199
s_waitcnt lgkmcnt(0)
s_nop 0
v_mfma_f32_32x32x16_bf16 v[0:15], a[128:131], v[136:139], v[0:15]
ds_read_b64_tr_b16 a[160:161], v224 offset:57344
ds_read_b64_tr_b16 a[162:163], v224 offset:59392
ds_read_b64_tr_b16 a[164:165], v225 offset:57344
v_fma_mix_f32 v208, v140, v216, v208 op_sel:[0,0,0] op_sel_hi:[1,0,0]
v_mfma_f32_32x32x16_bf16 v[16:31], a[132:135], v[136:139], v[16:31]
ds_read_b64_tr_b16 a[166:167], v225 offset:59392
ds_read_b64_tr_b16 a[168:169], v226 offset:57344
ds_read_b64_tr_b16 a[170:171], v226 offset:59392
v_fma_mix_f32 v209, v140, v217, v209 op_sel:[1,0,0] op_sel_hi:[1,0,0]
v_mfma_f32_32x32x16_bf16 v[32:47], a[136:139], v[136:139], v[32:47]
ds_read_b64_tr_b16 a[172:173], v227 offset:57344
ds_read_b64_tr_b16 a[174:175], v227 offset:59392
ds_read_b64_tr_b16 a[176:177], v224 offset:57600
v_fma_mix_f32 v210, v141, v218, v210 op_sel:[0,0,0] op_sel_hi:[1,0,0]
v_mfma_f32_32x32x16_bf16 v[48:63], a[140:143], v[136:139], v[48:63]
ds_read_b64_tr_b16 a[178:179], v224 offset:59648
ds_read_b64_tr_b16 a[180:181], v225 offset:57600
ds_read_b64_tr_b16 a[182:183], v225 offset:59648
v_fma_mix_f32 v211, v141, v219, v211 op_sel:[1,0,0] op_sel_hi:[1,0,0]
v_mfma_f32_32x32x16_bf16 v[64:79], a[144:147], v[136:139], v[64:79]
ds_read_b64_tr_b16 a[184:185], v226 offset:57600
ds_read_b64_tr_b16 a[186:187], v226 offset:59648
ds_read_b64_tr_b16 a[188:189], v227 offset:57600
v_fma_mix_f32 v212, v142, v220, v212 op_sel:[0,0,0] op_sel_hi:[1,0,0]
v_fma_mix_f32 v213, v142, v221, v213 op_sel:[1,0,0] op_sel_hi:[1,0,0]
v_mfma_f32_32x32x16_bf16 v[80:95], a[148:151], v[136:139], v[80:95]
ds_read_b64_tr_b16 a[190:191], v227 offset:59648
v_fma_mix_f32 v214, v143, v222, v214 op_sel:[0,0,0] op_sel_hi:[1,0,0]
v_fma_mix_f32 v215, v143, v223, v215 op_sel:[1,0,0] op_sel_hi:[1,0,0]
v_mfma_f32_32x32x16_bf16 v[96:111], a[152:155], v[136:139], v[96:111]
v_cvt_pk_bf16_f32 v140, v208, v209
v_mfma_f32_32x32x16_bf16 v[112:127], a[156:159], v[136:139], v[112:127]
v_cvt_pk_bf16_f32 v141, v210, v211
v_cvt_pk_bf16_f32 v142, v212, v213
v_cvt_pk_bf16_f32 v143, v214, v215
s_waitcnt lgkmcnt(0)
s_nop 0
v_mfma_f32_32x32x16_bf16 v[0:15], a[160:163], v[140:143], v[0:15]
v_mfma_f32_32x32x16_bf16 v[16:31], a[164:167], v[140:143], v[16:31]
v_mfma_f32_32x32x16_bf16 v[32:47], a[168:171], v[140:143], v[32:47]
v_mfma_f32_32x32x16_bf16 v[48:63], a[172:175], v[140:143], v[48:63]
v_mfma_f32_32x32x16_bf16 v[64:79], a[176:179], v[140:143], v[64:79]
v_mfma_f32_32x32x16_bf16 v[80:95], a[180:183], v[140:143], v[80:95]
v_mfma_f32_32x32x16_bf16 v[96:111], a[184:187], v[140:143], v[96:111]
v_mfma_f32_32x32x16_bf16 v[112:127], a[188:191], v[140:143], v[112:127]
s_waitcnt vmcnt(0)
s_barrier
s_nop 1
ds_read_b128 a[128:131], v228 offset:49152
ds_read_b128 a[132:135], v229 offset:49152
ds_read_b128 a[136:139], v230 offset:49152
ds_read_b128 a[140:143], v231 offset:49152
ds_read_b128 a[144:147], v232 offset:49152
ds_read_b128 a[148:151], v233 offset:49152
ds_read_b128 a[152:155], v234 offset:49152
ds_read_b128 a[156:159], v235 offset:49152
v_accvgpr_read_b32 v192, a228
v_accvgpr_read_b32 v193, a229
v_accvgpr_read_b32 v194, a230
v_accvgpr_read_b32 v195, a231
v_accvgpr_read_b32 v196, a232
v_accvgpr_read_b32 v197, a233
v_accvgpr_read_b32 v198, a234
v_accvgpr_read_b32 v199, a235
v_accvgpr_read_b32 v200, a236
v_add_u32 v147, 0, v192
v_lshrrev_b32 v148, 10, v147
v_and_b32 v147, 1023, v147
v_lshl_add_u32 v147, v148, 7, v147
v_subrev_u32 v204, 0, v147
v_add_u32 v147, 1024, v193
v_lshrrev_b32 v148, 10, v147
v_and_b32 v147, 1023, v147
v_lshl_add_u32 v147, v148, 7, v147
v_subrev_u32 v205, 1024, v147
v_add_u32 v147, 2048, v194
v_lshrrev_b32 v148, 10, v147
v_and_b32 v147, 1023, v147
v_lshl_add_u32 v147, v148, 7, v147
v_subrev_u32 v206, 2048, v147
v_add_u32 v147, 3072, v195
v_lshrrev_b32 v148, 10, v147
v_and_b32 v147, 1023, v147
v_lshl_add_u32 v147, v148, 7, v147
v_subrev_u32 v207, 3072, v147
v_add_u32 v147, 0, v196
v_lshrrev_b32 v148, 10, v147
v_and_b32 v147, 1023, v147
v_lshl_add_u32 v147, v148, 7, v147
v_subrev_u32 v208, 0, v147
v_add_u32 v147, 1024, v197
v_lshrrev_b32 v148, 10, v147
v_and_b32 v147, 1023, v147
v_lshl_add_u32 v147, v148, 7, v147
v_subrev_u32 v209, 1024, v147
v_add_u32 v147, 2048, v198
v_lshrrev_b32 v148, 10, v147
v_and_b32 v147, 1023, v147
v_lshl_add_u32 v147, v148, 7, v147
v_subrev_u32 v210, 2048, v147
v_add_u32 v147, 3072, v199
v_lshrrev_b32 v148, 10, v147
v_and_b32 v147, 1023, v147
v_lshl_add_u32 v147, v148, 7, v147
v_subrev_u32 v211, 3072, v147
v_add_u32 v147, 0, v200
v_lshrrev_b32 v148, 10, v147
v_and_b32 v147, 1023, v147
v_lshl_add_u32 v147, v148, 7, v147
v_subrev_u32 v212, 0, v147
s_mul_i32 s30, s24, 9216
s_lshr_b32 s41, s26, 2
s_and_b32 s42, s26, 3
s_mul_i32 s28, s41, 1179648
s_mul_i32 s3, s42, 288
s_add_u32 s28, s28, s3
s_mul_i32 s3, s24, 36864
s_add_u32 s28, s28, s3
s_lshl_b32 s29, s34, 18
s_lshl_b32 s3, s41, 15
s_add_u32 s29, s29, s3
s_mov_b32 s8, s12
s_mov_b32 s9, s13
s_mov_b32 s10, s14
s_add_u32 s4, s12, 16777216
s_addc_u32 s5, s13, 0
s_mov_b32 s6, 9437184
v_cvt_pk_bf16_f32 v0, v0, v1
v_cvt_pk_bf16_f32 v1, v2, v3
v_cvt_pk_bf16_f32 v2, v4, v5
v_cvt_pk_bf16_f32 v3, v6, v7
v_cvt_pk_bf16_f32 v4, v8, v9
v_cvt_pk_bf16_f32 v5, v10, v11
v_cvt_pk_bf16_f32 v6, v12, v13
v_cvt_pk_bf16_f32 v7, v14, v15
v_cvt_pk_bf16_f32 v8, v16, v17
v_cvt_pk_bf16_f32 v9, v18, v19
v_cvt_pk_bf16_f32 v10, v20, v21
v_cvt_pk_bf16_f32 v11, v22, v23
v_cvt_pk_bf16_f32 v12, v24, v25
v_cvt_pk_bf16_f32 v13, v26, v27
v_cvt_pk_bf16_f32 v14, v28, v29
v_cvt_pk_bf16_f32 v15, v30, v31
v_cvt_pk_bf16_f32 v16, v32, v33
v_cvt_pk_bf16_f32 v17, v34, v35
v_cvt_pk_bf16_f32 v18, v36, v37
v_cvt_pk_bf16_f32 v19, v38, v39
v_cvt_pk_bf16_f32 v20, v40, v41
v_cvt_pk_bf16_f32 v21, v42, v43
v_cvt_pk_bf16_f32 v22, v44, v45
v_cvt_pk_bf16_f32 v23, v46, v47
v_cvt_pk_bf16_f32 v24, v48, v49
v_cvt_pk_bf16_f32 v25, v50, v51
v_cvt_pk_bf16_f32 v26, v52, v53
v_cvt_pk_bf16_f32 v27, v54, v55
v_cvt_pk_bf16_f32 v28, v56, v57
v_cvt_pk_bf16_f32 v29, v58, v59
v_cvt_pk_bf16_f32 v30, v60, v61
v_cvt_pk_bf16_f32 v31, v62, v63
v_cvt_pk_bf16_f32 v32, v64, v65
v_cvt_pk_bf16_f32 v33, v66, v67
v_cvt_pk_bf16_f32 v34, v68, v69
v_cvt_pk_bf16_f32 v35, v70, v71
v_cvt_pk_bf16_f32 v36, v72, v73
v_cvt_pk_bf16_f32 v37, v74, v75
v_cvt_pk_bf16_f32 v38, v76, v77
v_cvt_pk_bf16_f32 v39, v78, v79
v_cvt_pk_bf16_f32 v40, v80, v81
v_cvt_pk_bf16_f32 v41, v82, v83
v_cvt_pk_bf16_f32 v42, v84, v85
v_cvt_pk_bf16_f32 v43, v86, v87
v_cvt_pk_bf16_f32 v44, v88, v89
v_cvt_pk_bf16_f32 v45, v90, v91
v_cvt_pk_bf16_f32 v46, v92, v93
v_cvt_pk_bf16_f32 v47, v94, v95
v_cvt_pk_bf16_f32 v48, v96, v97
v_cvt_pk_bf16_f32 v49, v98, v99
v_cvt_pk_bf16_f32 v50, v100, v101
v_cvt_pk_bf16_f32 v51, v102, v103
v_cvt_pk_bf16_f32 v52, v104, v105
v_cvt_pk_bf16_f32 v53, v106, v107
v_cvt_pk_bf16_f32 v54, v108, v109
v_cvt_pk_bf16_f32 v55, v110, v111
v_cvt_pk_bf16_f32 v56, v112, v113
v_cvt_pk_bf16_f32 v57, v114, v115
v_cvt_pk_bf16_f32 v58, v116, v117
v_cvt_pk_bf16_f32 v59, v118, v119
v_cvt_pk_bf16_f32 v60, v120, v121
v_cvt_pk_bf16_f32 v61, v122, v123
v_cvt_pk_bf16_f32 v62, v124, v125
v_cvt_pk_bf16_f32 v63, v126, v127
s_waitcnt lgkmcnt(0)
v_mfma_f32_32x32x16_bf16 v[64:79], a[128:131], v[0:3], 0
v_mfma_f32_32x32x16_bf16 v[64:79], a[132:135], v[4:7], v[64:79]
v_mfma_f32_32x32x16_bf16 v[64:79], a[136:139], v[8:11], v[64:79]
v_mfma_f32_32x32x16_bf16 v[64:79], a[140:143], v[12:15], v[64:79]
v_mfma_f32_32x32x16_bf16 v[64:79], a[144:147], v[16:19], v[64:79]
v_mfma_f32_32x32x16_bf16 v[64:79], a[148:151], v[20:23], v[64:79]
v_mfma_f32_32x32x16_bf16 v[64:79], a[152:155], v[24:27], v[64:79]
v_mfma_f32_32x32x16_bf16 v[64:79], a[156:159], v[28:31], v[64:79]
s_nop 11
v_max3_f32 v144, v64, v65, v66
v_max3_f32 v144, v144, v67, v68
v_max3_f32 v144, v144, v69, v70
v_max3_f32 v144, v144, v71, v72
v_max3_f32 v144, v144, v73, v74
v_max3_f32 v144, v144, v75, v76
v_max3_f32 v144, v144, v77, v78
v_max_f32 v144, v144, v79
v_mov_b32 v145, v144
s_nop 1
v_permlane32_swap_b32 v144, v145
v_max_f32 v144, v144, v145
v_add_f32 v144, s45, v144
v_sub_f32 v64, v64, v144
v_sub_f32 v112, 0, v144
v_sub_f32 v65, v65, v144
v_sub_f32 v113, 0, v144
v_sub_f32 v66, v66, v144
v_sub_f32 v114, 0, v144
v_sub_f32 v67, v67, v144
v_sub_f32 v115, 0, v144
v_sub_f32 v68, v68, v144
v_sub_f32 v116, 0, v144
v_sub_f32 v69, v69, v144
v_sub_f32 v117, 0, v144
v_sub_f32 v70, v70, v144
v_sub_f32 v118, 0, v144
v_sub_f32 v71, v71, v144
v_sub_f32 v119, 0, v144
v_sub_f32 v72, v72, v144
v_sub_f32 v120, 0, v144
v_sub_f32 v73, v73, v144
v_sub_f32 v121, 0, v144
v_sub_f32 v74, v74, v144
v_sub_f32 v122, 0, v144
v_sub_f32 v75, v75, v144
v_sub_f32 v123, 0, v144
v_sub_f32 v76, v76, v144
v_sub_f32 v124, 0, v144
v_sub_f32 v77, v77, v144
v_sub_f32 v125, 0, v144
v_sub_f32 v78, v78, v144
v_sub_f32 v126, 0, v144
v_sub_f32 v79, v79, v144
v_sub_f32 v127, 0, v144
s_barrier
v_mfma_f32_32x32x16_bf16 v[80:95], a[128:131], v[32:35], 0
v_exp_f32 v64, v64
v_exp_f32 v65, v65
v_add_f32 v250, v250, v64
ds_read_b128 a[128:131], v228 offset:0
v_mfma_f32_32x32x16_bf16 v[80:95], a[132:135], v[36:39], v[80:95]
v_exp_f32 v66, v66
v_add_f32 v250, v250, v65
s_add_u32 m0, s33, 49152
ds_read_b128 a[132:135], v229 offset:0
v_mfma_f32_32x32x16_bf16 v[80:95], a[136:139], v[40:43], v[80:95]
v_cvt_pk_bf16_f32 v96, v64, v65
v_exp_f32 v67, v67
v_add_f32 v250, v250, v66
ds_read_b128 a[136:139], v230 offset:0
v_mfma_f32_32x32x16_bf16 v[80:95], a[140:143], v[44:47], v[80:95]
v_exp_f32 v68, v68
v_add_f32 v250, v250, v67
buffer_load_dwordx4 v244, s[16:19], s37 offen offset:0 lds
ds_read_b128 a[140:143], v231 offset:0
v_mfma_f32_32x32x16_bf16 v[80:95], a[144:147], v[48:51], v[80:95]
v_cvt_pk_bf16_f32 v97, v66, v67
v_exp_f32 v69, v69
v_add_f32 v250, v250, v68
ds_read_b128 a[144:147], v232 offset:0
v_mfma_f32_32x32x16_bf16 v[80:95], a[148:151], v[52:55], v[80:95]
v_exp_f32 v70, v70
v_add_f32 v250, v250, v69
buffer_load_dwordx4 v245, s[16:19], s37 offen offset:1024 lds
ds_read_b128 a[148:151], v233 offset:0
v_mfma_f32_32x32x16_bf16 v[80:95], a[152:155], v[56:59], v[80:95]
v_exp_f32 v71, v71
v_add_f32 v250, v250, v70
v_cvt_pk_bf16_f32 v98, v68, v69
ds_read_b128 a[152:155], v234 offset:0
v_mfma_f32_32x32x16_bf16 v[80:95], a[156:159], v[60:63], v[80:95]
v_add_f32 v250, v250, v71
v_cvt_pk_bf16_f32 v99, v70, v71
s_add_u32 s37, s37, 8192
ds_read_b128 a[156:159], v235 offset:0
ds_read_b64_tr_b16 a[160:161], v236 offset:8192
ds_read_b64_tr_b16 a[162:163], v236 offset:10240
ds_read_b64_tr_b16 a[164:165], v237 offset:8192
ds_read_b64_tr_b16 a[166:167], v237 offset:10240
ds_read_b64_tr_b16 a[168:169], v238 offset:8192
ds_read_b64_tr_b16 a[170:171], v238 offset:10240
ds_read_b64_tr_b16 a[172:173], v239 offset:8192
ds_read_b64_tr_b16 a[174:175], v239 offset:10240
v_exp_f32 v72, v72
v_exp_f32 v73, v73
v_add_f32 v250, v250, v72
v_exp_f32 v74, v74
v_add_f32 v250, v250, v73
v_cvt_pk_bf16_f32 v100, v72, v73
v_exp_f32 v75, v75
v_add_f32 v250, v250, v74
v_exp_f32 v76, v76
v_add_f32 v250, v250, v75
v_cvt_pk_bf16_f32 v101, v74, v75
v_exp_f32 v77, v77
v_add_f32 v250, v250, v76
v_exp_f32 v78, v78
v_add_f32 v250, v250, v77
v_exp_f32 v79, v79
v_add_f32 v250, v250, v78
v_cvt_pk_bf16_f32 v102, v76, v77
v_add_f32 v250, v250, v79
v_cvt_pk_bf16_f32 v103, v78, v79
v_max3_f32 v144, v80, v81, v82
v_max3_f32 v144, v144, v83, v84
v_max3_f32 v144, v144, v85, v86
v_max3_f32 v144, v144, v87, v88
v_max3_f32 v144, v144, v89, v90
v_max3_f32 v144, v144, v91, v92
v_max3_f32 v144, v144, v93, v94
v_max_f32 v144, v144, v95
v_mov_b32 v145, v144
s_nop 1
v_permlane32_swap_b32 v144, v145
v_max_f32 v144, v144, v145
v_add_f32 v144, s45, v144
v_sub_f32 v80, v80, v144
v_sub_f32 v128, 0, v144
v_sub_f32 v81, v81, v144
v_sub_f32 v129, 0, v144
v_sub_f32 v82, v82, v144
v_sub_f32 v130, 0, v144
v_sub_f32 v83, v83, v144
v_sub_f32 v131, 0, v144
v_sub_f32 v84, v84, v144
v_sub_f32 v132, 0, v144
v_sub_f32 v85, v85, v144
v_sub_f32 v133, 0, v144
v_sub_f32 v86, v86, v144
v_sub_f32 v134, 0, v144
v_sub_f32 v87, v87, v144
v_sub_f32 v135, 0, v144
v_sub_f32 v88, v88, v144
v_sub_f32 v136, 0, v144
v_sub_f32 v89, v89, v144
v_sub_f32 v137, 0, v144
v_sub_f32 v90, v90, v144
v_sub_f32 v138, 0, v144
v_sub_f32 v91, v91, v144
v_sub_f32 v139, 0, v144
v_sub_f32 v92, v92, v144
v_sub_f32 v140, 0, v144
v_sub_f32 v93, v93, v144
v_sub_f32 v141, 0, v144
v_sub_f32 v94, v94, v144
v_sub_f32 v142, 0, v144
v_sub_f32 v95, v95, v144
v_sub_f32 v143, 0, v144
s_waitcnt lgkmcnt(8)
v_mfma_f32_32x32x16_bf16 v[64:79], a[128:131], v[0:3], v[112:127]
v_exp_f32 v80, v80
ds_read_b64_tr_b16 a[176:177], v236 offset:12288
v_exp_f32 v81, v81
v_mfma_f32_32x32x16_bf16 v[64:79], a[132:135], v[4:7], v[64:79]
ds_read_b64_tr_b16 a[178:179], v236 offset:14336
v_add_f32 v251, v251, v80
v_exp_f32 v82, v82
ds_read_b64_tr_b16 a[180:181], v237 offset:12288
v_mfma_f32_32x32x16_bf16 v[64:79], a[136:139], v[8:11], v[64:79]
v_add_f32 v251, v251, v81
ds_read_b64_tr_b16 a[182:183], v237 offset:14336
v_cvt_pk_bf16_f32 v104, v80, v81
v_mfma_f32_32x32x16_bf16 v[64:79], a[140:143], v[12:15], v[64:79]
v_exp_f32 v83, v83
ds_read_b64_tr_b16 a[184:185], v238 offset:12288
v_add_f32 v251, v251, v82
ds_read_b64_tr_b16 a[186:187], v238 offset:14336
v_mfma_f32_32x32x16_bf16 v[64:79], a[144:147], v[16:19], v[64:79]
v_exp_f32 v84, v84
v_add_f32 v251, v251, v83
ds_read_b64_tr_b16 a[188:189], v239 offset:12288
v_mfma_f32_32x32x16_bf16 v[64:79], a[148:151], v[20:23], v[64:79]
v_cvt_pk_bf16_f32 v105, v82, v83
ds_read_b64_tr_b16 a[190:191], v239 offset:14336
v_exp_f32 v85, v85
v_add_f32 v251, v251, v84
v_mfma_f32_32x32x16_bf16 v[64:79], a[152:155], v[24:27], v[64:79]
v_exp_f32 v86, v86
v_add_f32 v251, v251, v85
v_exp_f32 v87, v87
v_mfma_f32_32x32x16_bf16 v[64:79], a[156:159], v[28:31], v[64:79]
v_add_f32 v251, v251, v86
v_cvt_pk_bf16_f32 v106, v84, v85
v_add_f32 v251, v251, v87
v_cvt_pk_bf16_f32 v107, v86, v87
s_waitcnt lgkmcnt(0)
v_mfma_f32_32x32x16_bf16 a[0:15], a[160:163], v[96:99], a[0:15]
v_exp_f32 v88, v88
v_exp_f32 v89, v89
v_add_f32 v251, v251, v88
v_exp_f32 v90, v90
v_mfma_f32_32x32x16_bf16 a[16:31], a[164:167], v[96:99], a[16:31]
v_add_f32 v251, v251, v89
v_cvt_pk_bf16_f32 v108, v88, v89
v_exp_f32 v91, v91
v_add_f32 v251, v251, v90
v_mfma_f32_32x32x16_bf16 a[32:47], a[168:171], v[96:99], a[32:47]
v_exp_f32 v92, v92
v_add_f32 v251, v251, v91
v_cvt_pk_bf16_f32 v109, v90, v91
s_add_u32 m0, s33, 57344
v_mfma_f32_32x32x16_bf16 a[48:63], a[172:175], v[96:99], a[48:63]
v_exp_f32 v93, v93
v_add_f32 v251, v251, v92
v_exp_f32 v94, v94
buffer_load_dwordx4 v246, s[20:23], s38 offen offset:0 lds
v_add_f32 v251, v251, v93
v_mfma_f32_32x32x16_bf16 a[0:15], a[176:179], v[100:103], a[0:15]
v_exp_f32 v95, v95
v_add_f32 v251, v251, v94
buffer_load_dwordx4 v247, s[20:23], s38 offen offset:1024 lds
v_cvt_pk_bf16_f32 v110, v92, v93
v_mfma_f32_32x32x16_bf16 a[16:31], a[180:183], v[100:103], a[16:31]
v_add_f32 v251, v251, v95
v_cvt_pk_bf16_f32 v111, v94, v95
s_add_u32 s38, s38, 8192
v_max3_f32 v144, v64, v65, v66
v_mfma_f32_32x32x16_bf16 a[32:47], a[184:187], v[100:103], a[32:47]
v_max3_f32 v144, v144, v67, v68
v_max3_f32 v144, v144, v69, v70
v_max3_f32 v144, v144, v71, v72
v_max3_f32 v144, v144, v73, v74
v_mfma_f32_32x32x16_bf16 a[48:63], a[188:191], v[100:103], a[48:63]
v_max3_f32 v144, v144, v75, v76
v_max3_f32 v144, v144, v77, v78
v_max_f32 v144, v144, v79
v_cmp_lt_f32 vcc, s44, v144
s_mov_b32 s46, 0
s_cbranch_vccnz k1_fix0
k1_r0:
s_barrier
v_mfma_f32_32x32x16_bf16 v[80:95], a[128:131], v[32:35], v[128:143]
v_exp_f32 v64, v64
v_exp_f32 v65, v65
v_add_f32 v250, v250, v64
ds_read_b128 a[128:131], v228 offset:16384
v_mfma_f32_32x32x16_bf16 v[80:95], a[132:135], v[36:39], v[80:95]
s_add_u32 m0, s33, 0
v_exp_f32 v66, v66
v_add_f32 v250, v250, v65
buffer_load_dwordx4 v244, s[16:19], s37 offen offset:0 lds
ds_read_b128 a[132:135], v229 offset:16384
v_mfma_f32_32x32x16_bf16 v[80:95], a[136:139], v[40:43], v[80:95]
v_cvt_pk_bf16_f32 v96, v64, v65
v_exp_f32 v67, v67
buffer_load_dwordx4 v245, s[16:19], s37 offen offset:1024 lds
ds_read_b128 a[136:139], v230 offset:16384
v_mfma_f32_32x32x16_bf16 v[80:95], a[140:143], v[44:47], v[80:95]
v_add_f32 v250, v250, v66
v_exp_f32 v68, v68
s_add_u32 s37, s37, 8192
v_add_f32 v250, v250, v67
ds_read_b128 a[140:143], v231 offset:16384
v_mfma_f32_32x32x16_bf16 v[80:95], a[144:147], v[48:51], v[80:95]
v_cvt_pk_bf16_f32 v97, v66, v67
v_exp_f32 v69, v69
v_accvgpr_mov_b32 a208, a192
v_add_f32 v250, v250, v68
ds_read_b128 a[144:147], v232 offset:16384
v_mfma_f32_32x32x16_bf16 v[80:95], a[148:151], v[52:55], v[80:95]
v_exp_f32 v70, v70
v_accvgpr_mov_b32 a209, a193
v_add_f32 v250, v250, v69
ds_read_b128 a[148:151], v233 offset:16384
v_mfma_f32_32x32x16_bf16 v[80:95], a[152:155], v[56:59], v[80:95]
v_exp_f32 v71, v71
v_accvgpr_mov_b32 a210, a194
v_add_f32 v250, v250, v70
v_cvt_pk_bf16_f32 v98, v68, v69
ds_read_b128 a[152:155], v234 offset:16384
v_mfma_f32_32x32x16_bf16 v[80:95], a[156:159], v[60:63], v[80:95]
v_accvgpr_mov_b32 a211, a195
v_add_f32 v250, v250, v71
v_cvt_pk_bf16_f32 v99, v70, v71
buffer_load_dwordx4 a[192:195], v254, s[48:51], s47 offen offset:0
ds_read_b128 a[156:159], v235 offset:16384
v_mfma_f32_32x32x16_bf16 a[64:79], a[160:163], v[104:107], a[64:79]
v_exp_f32 v72, v72
v_exp_f32 v73, v73
v_add_f32 v250, v250, v72
v_mfma_f32_32x32x16_bf16 a[80:95], a[164:167], v[104:107], a[80:95]
v_exp_f32 v74, v74
v_add_f32 v250, v250, v73
v_cvt_pk_bf16_f32 v100, v72, v73
v_exp_f32 v75, v75
v_mfma_f32_32x32x16_bf16 a[96:111], a[168:171], v[104:107], a[96:111]
v_add_f32 v250, v250, v74
v_exp_f32 v76, v76
v_add_f32 v250, v250, v75
v_cvt_pk_bf16_f32 v101, v74, v75
v_mfma_f32_32x32x16_bf16 a[112:127], a[172:175], v[104:107], a[112:127]
v_exp_f32 v77, v77
v_add_f32 v250, v250, v76
v_exp_f32 v78, v78
v_add_f32 v250, v250, v77
v_mfma_f32_32x32x16_bf16 a[64:79], a[176:179], v[108:111], a[64:79]
v_exp_f32 v79, v79
v_add_f32 v250, v250, v78
v_cvt_pk_bf16_f32 v102, v76, v77
ds_read_b64_tr_b16 a[160:161], v236 offset:24576
ds_read_b64_tr_b16 a[162:163], v236 offset:26624
v_mfma_f32_32x32x16_bf16 a[80:95], a[180:183], v[108:111], a[80:95]
v_add_f32 v250, v250, v79
v_cvt_pk_bf16_f32 v103, v78, v79
v_max3_f32 v144, v80, v81, v82
v_max3_f32 v144, v144, v83, v84
ds_read_b64_tr_b16 a[164:165], v237 offset:24576
ds_read_b64_tr_b16 a[166:167], v237 offset:26624
v_mfma_f32_32x32x16_bf16 a[96:111], a[184:187], v[108:111], a[96:111]
v_max3_f32 v144, v144, v85, v86
v_max3_f32 v144, v144, v87, v88
v_max3_f32 v144, v144, v89, v90
v_max3_f32 v144, v144, v91, v92
ds_read_b64_tr_b16 a[168:169], v238 offset:24576
ds_read_b64_tr_b16 a[170:171], v238 offset:26624
v_mfma_f32_32x32x16_bf16 a[112:127], a[188:191], v[108:111], a[112:127]
v_max3_f32 v144, v144, v93, v94
v_max_f32 v144, v144, v95
v_cmp_lt_f32 vcc, s44, v144
s_mov_b32 s46, 1
ds_read_b64_tr_b16 a[172:173], v239 offset:24576
ds_read_b64_tr_b16 a[174:175], v239 offset:26624
s_cbranch_vccnz k1_fix1
k1_r1:
s_waitcnt lgkmcnt(8)
v_mfma_f32_32x32x16_bf16 v[64:79], a[128:131], v[0:3], v[112:127]
v_exp_f32 v80, v80
ds_read_b64_tr_b16 a[176:177], v236 offset:28672
v_exp_f32 v81, v81
v_mfma_f32_32x32x16_bf16 v[64:79], a[132:135], v[4:7], v[64:79]
ds_read_b64_tr_b16 a[178:179], v236 offset:30720
v_add_f32 v251, v251, v80
v_exp_f32 v82, v82
ds_read_b64_tr_b16 a[180:181], v237 offset:28672
v_mfma_f32_32x32x16_bf16 v[64:79], a[136:139], v[8:11], v[64:79]
v_add_f32 v251, v251, v81
ds_read_b64_tr_b16 a[182:183], v237 offset:30720
v_cvt_pk_bf16_f32 v104, v80, v81
v_mfma_f32_32x32x16_bf16 v[64:79], a[140:143], v[12:15], v[64:79]
v_exp_f32 v83, v83
ds_read_b64_tr_b16 a[184:185], v238 offset:28672
v_add_f32 v251, v251, v82
ds_read_b64_tr_b16 a[186:187], v238 offset:30720
v_mfma_f32_32x32x16_bf16 v[64:79], a[144:147], v[16:19], v[64:79]
v_exp_f32 v84, v84
v_add_f32 v251, v251, v83
ds_read_b64_tr_b16 a[188:189], v239 offset:28672
v_mfma_f32_32x32x16_bf16 v[64:79], a[148:151], v[20:23], v[64:79]
v_cvt_pk_bf16_f32 v105, v82, v83
ds_read_b64_tr_b16 a[190:191], v239 offset:30720
v_exp_f32 v85, v85
v_add_f32 v251, v251, v84
v_mfma_f32_32x32x16_bf16 v[64:79], a[152:155], v[24:27], v[64:79]
v_exp_f32 v86, v86
v_add_f32 v251, v251, v85
v_exp_f32 v87, v87
v_mfma_f32_32x32x16_bf16 v[64:79], a[156:159], v[28:31], v[64:79]
v_add_f32 v251, v251, v86
v_cvt_pk_bf16_f32 v106, v84, v85
v_add_f32 v251, v251, v87
v_cvt_pk_bf16_f32 v107, v86, v87
s_waitcnt lgkmcnt(0)
v_mfma_f32_32x32x16_bf16 a[0:15], a[160:163], v[96:99], a[0:15]
v_exp_f32 v88, v88
v_exp_f32 v89, v89
v_add_f32 v251, v251, v88
v_exp_f32 v90, v90
v_mfma_f32_32x32x16_bf16 a[16:31], a[164:167], v[96:99], a[16:31]
v_add_f32 v251, v251, v89
v_cvt_pk_bf16_f32 v108, v88, v89
v_exp_f32 v91, v91
v_add_f32 v251, v251, v90
v_mfma_f32_32x32x16_bf16 a[32:47], a[168:171], v[96:99], a[32:47]
v_exp_f32 v92, v92
v_add_f32 v251, v251, v91
v_cvt_pk_bf16_f32 v109, v90, v91
s_add_u32 m0, s33, 8192
v_mfma_f32_32x32x16_bf16 a[48:63], a[172:175], v[96:99], a[48:63]
v_exp_f32 v93, v93
v_add_f32 v251, v251, v92
v_exp_f32 v94, v94
buffer_load_dwordx4 v246, s[20:23], s38 offen offset:0 lds
v_add_f32 v251, v251, v93
v_mfma_f32_32x32x16_bf16 a[0:15], a[176:179], v[100:103], a[0:15]
v_exp_f32 v95, v95
v_add_f32 v251, v251, v94
buffer_load_dwordx4 v247, s[20:23], s38 offen offset:1024 lds
v_cvt_pk_bf16_f32 v110, v92, v93
v_mfma_f32_32x32x16_bf16 a[16:31], a[180:183], v[100:103], a[16:31]
v_add_f32 v251, v251, v95
v_cvt_pk_bf16_f32 v111, v94, v95
s_add_u32 s38, s38, 8192
v_max3_f32 v144, v64, v65, v66
v_mfma_f32_32x32x16_bf16 a[32:47], a[184:187], v[100:103], a[32:47]
v_max3_f32 v144, v144, v67, v68
v_max3_f32 v144, v144, v69, v70
v_max3_f32 v144, v144, v71, v72
v_max3_f32 v144, v144, v73, v74
v_mfma_f32_32x32x16_bf16 a[48:63], a[188:191], v[100:103], a[48:63]
v_max3_f32 v144, v144, v75, v76
v_max3_f32 v144, v144, v77, v78
v_max_f32 v144, v144, v79
v_cmp_lt_f32 vcc, s44, v144
s_mov_b32 s46, 2
s_cbranch_vccnz k1_fix0
k1_r2:
s_barrier
v_mfma_f32_32x32x16_bf16 v[80:95], a[128:131], v[32:35], v[128:143]
v_exp_f32 v64, v64
v_exp_f32 v65, v65
v_add_f32 v250, v250, v64
ds_read_b128 a[128:131], v228 offset:32768
v_mfma_f32_32x32x16_bf16 v[80:95], a[132:135], v[36:39], v[80:95]
s_add_u32 m0, s33, 16384
v_exp_f32 v66, v66
v_add_f32 v250, v250, v65
buffer_load_dwordx4 v244, s[16:19], s37 offen offset:0 lds
ds_read_b128 a[132:135], v229 offset:32768
v_mfma_f32_32x32x16_bf16 v[80:95], a[136:139], v[40:43], v[80:95]
v_cvt_pk_bf16_f32 v96, v64, v65
v_exp_f32 v67, v67
buffer_load_dwordx4 v245, s[16:19], s37 offen offset:1024 lds
ds_read_b128 a[136:139], v230 offset:32768
v_mfma_f32_32x32x16_bf16 v[80:95], a[140:143], v[44:47], v[80:95]
v_add_f32 v250, v250, v66
v_exp_f32 v68, v68
s_add_u32 s37, s37, 8192
v_add_f32 v250, v250, v67
ds_read_b128 a[140:143], v231 offset:32768
v_mfma_f32_32x32x16_bf16 v[80:95], a[144:147], v[48:51], v[80:95]
v_cvt_pk_bf16_f32 v97, v66, v67
v_exp_f32 v69, v69
v_accvgpr_mov_b32 a212, a196
v_add_f32 v250, v250, v68
ds_read_b128 a[144:147], v232 offset:32768
v_mfma_f32_32x32x16_bf16 v[80:95], a[148:151], v[52:55], v[80:95]
v_exp_f32 v70, v70
v_accvgpr_mov_b32 a213, a197
v_add_f32 v250, v250, v69
ds_read_b128 a[148:151], v233 offset:32768
v_mfma_f32_32x32x16_bf16 v[80:95], a[152:155], v[56:59], v[80:95]
v_exp_f32 v71, v71
v_accvgpr_mov_b32 a214, a198
v_add_f32 v250, v250, v70
v_cvt_pk_bf16_f32 v98, v68, v69
ds_read_b128 a[152:155], v234 offset:32768
v_mfma_f32_32x32x16_bf16 v[80:95], a[156:159], v[60:63], v[80:95]
v_accvgpr_mov_b32 a215, a199
v_add_f32 v250, v250, v71
v_cvt_pk_bf16_f32 v99, v70, v71
buffer_load_dwordx4 a[196:199], v254, s[48:51], s47 offen offset:64
ds_read_b128 a[156:159], v235 offset:32768
v_mfma_f32_32x32x16_bf16 a[64:79], a[160:163], v[104:107], a[64:79]
v_exp_f32 v72, v72
v_exp_f32 v73, v73
v_add_f32 v250, v250, v72
v_mfma_f32_32x32x16_bf16 a[80:95], a[164:167], v[104:107], a[80:95]
v_exp_f32 v74, v74
v_add_f32 v250, v250, v73
v_cvt_pk_bf16_f32 v100, v72, v73
v_exp_f32 v75, v75
v_mfma_f32_32x32x16_bf16 a[96:111], a[168:171], v[104:107], a[96:111]
v_add_f32 v250, v250, v74
v_exp_f32 v76, v76
v_add_f32 v250, v250, v75
v_cvt_pk_bf16_f32 v101, v74, v75
v_mfma_f32_32x32x16_bf16 a[112:127], a[172:175], v[104:107], a[112:127]
v_exp_f32 v77, v77
v_add_f32 v250, v250, v76
v_exp_f32 v78, v78
v_add_f32 v250, v250, v77
v_mfma_f32_32x32x16_bf16 a[64:79], a[176:179], v[108:111], a[64:79]
v_exp_f32 v79, v79
v_add_f32 v250, v250, v78
v_cvt_pk_bf16_f32 v102, v76, v77
ds_read_b64_tr_b16 a[160:161], v236 offset:40960
ds_read_b64_tr_b16 a[162:163], v236 offset:43008
v_mfma_f32_32x32x16_bf16 a[80:95], a[180:183], v[108:111], a[80:95]
v_add_f32 v250, v250, v79
v_cvt_pk_bf16_f32 v103, v78, v79
v_max3_f32 v144, v80, v81, v82
v_max3_f32 v144, v144, v83, v84
ds_read_b64_tr_b16 a[164:165], v237 offset:40960
ds_read_b64_tr_b16 a[166:167], v237 offset:43008
v_mfma_f32_32x32x16_bf16 a[96:111], a[184:187], v[108:111], a[96:111]
v_max3_f32 v144, v144, v85, v86
v_max3_f32 v144, v144, v87, v88
v_max3_f32 v144, v144, v89, v90
v_max3_f32 v144, v144, v91, v92
ds_read_b64_tr_b16 a[168:169], v238 offset:40960
ds_read_b64_tr_b16 a[170:171], v238 offset:43008
v_mfma_f32_32x32x16_bf16 a[112:127], a[188:191], v[108:111], a[112:127]
v_max3_f32 v144, v144, v93, v94
v_max_f32 v144, v144, v95
v_cmp_lt_f32 vcc, s44, v144
s_mov_b32 s46, 3
ds_read_b64_tr_b16 a[172:173], v239 offset:40960
ds_read_b64_tr_b16 a[174:175], v239 offset:43008
s_cbranch_vccnz k1_fix1
k1_r3:
s_mov_b32 s31, 2
k1_lp:
s_waitcnt lgkmcnt(8)
v_mfma_f32_32x32x16_bf16 v[64:79], a[128:131], v[0:3], v[112:127]
v_exp_f32 v80, v80
ds_read_b64_tr_b16 a[176:177], v236 offset:45056
v_exp_f32 v81, v81
v_mfma_f32_32x32x16_bf16 v[64:79], a[132:135], v[4:7], v[64:79]
ds_read_b64_tr_b16 a[178:179], v236 offset:47104
v_add_f32 v251, v251, v80
v_exp_f32 v82, v82
ds_read_b64_tr_b16 a[180:181], v237 offset:45056
v_mfma_f32_32x32x16_bf16 v[64:79], a[136:139], v[8:11], v[64:79]
v_add_f32 v251, v251, v81
ds_read_b64_tr_b16 a[182:183], v237 offset:47104
v_cvt_pk_bf16_f32 v104, v80, v81
v_mfma_f32_32x32x16_bf16 v[64:79], a[140:143], v[12:15], v[64:79]
v_exp_f32 v83, v83
ds_read_b64_tr_b16 a[184:185], v238 offset:45056
v_add_f32 v251, v251, v82
ds_read_b64_tr_b16 a[186:187], v238 offset:47104
v_mfma_f32_32x32x16_bf16 v[64:79], a[144:147], v[16:19], v[64:79]
v_exp_f32 v84, v84
v_add_f32 v251, v251, v83
ds_read_b64_tr_b16 a[188:189], v239 offset:45056
v_mfma_f32_32x32x16_bf16 v[64:79], a[148:151], v[20:23], v[64:79]
v_cvt_pk_bf16_f32 v105, v82, v83
ds_read_b64_tr_b16 a[190:191], v239 offset:47104
v_exp_f32 v85, v85
v_add_f32 v251, v251, v84
v_mfma_f32_32x32x16_bf16 v[64:79], a[152:155], v[24:27], v[64:79]
v_exp_f32 v86, v86
v_add_f32 v251, v251, v85
v_exp_f32 v87, v87
v_mfma_f32_32x32x16_bf16 v[64:79], a[156:159], v[28:31], v[64:79]
v_add_f32 v251, v251, v86
v_cvt_pk_bf16_f32 v106, v84, v85
v_add_f32 v251, v251, v87
v_cvt_pk_bf16_f32 v107, v86, v87
s_waitcnt lgkmcnt(0)
v_mfma_f32_32x32x16_bf16 a[0:15], a[160:163], v[96:99], a[0:15]
v_exp_f32 v88, v88
v_exp_f32 v89, v89
v_add_f32 v251, v251, v88
v_exp_f32 v90, v90
v_mfma_f32_32x32x16_bf16 a[16:31], a[164:167], v[96:99], a[16:31]
v_add_f32 v251, v251, v89
v_cvt_pk_bf16_f32 v108, v88, v89
v_exp_f32 v91, v91
v_add_f32 v251, v251, v90
v_mfma_f32_32x32x16_bf16 a[32:47], a[168:171], v[96:99], a[32:47]
v_exp_f32 v92, v92
v_add_f32 v251, v251, v91
v_cvt_pk_bf16_f32 v109, v90, v91
s_add_u32 m0, s33, 24576
v_mfma_f32_32x32x16_bf16 a[48:63], a[172:175], v[96:99], a[48:63]
v_exp_f32 v93, v93
v_add_f32 v251, v251, v92
v_exp_f32 v94, v94
buffer_load_dwordx4 v246, s[20:23], s38 offen offset:0 lds
v_add_f32 v251, v251, v93
v_mfma_f32_32x32x16_bf16 a[0:15], a[176:179], v[100:103], a[0:15]
v_exp_f32 v95, v95
v_add_f32 v251, v251, v94
buffer_load_dwordx4 v247, s[20:23], s38 offen offset:1024 lds
v_cvt_pk_bf16_f32 v110, v92, v93
v_mfma_f32_32x32x16_bf16 a[16:31], a[180:183], v[100:103], a[16:31]
v_add_f32 v251, v251, v95
v_cvt_pk_bf16_f32 v111, v94, v95
s_add_u32 s38, s38, 8192
v_max3_f32 v144, v64, v65, v66
v_mfma_f32_32x32x16_bf16 a[32:47], a[184:187], v[100:103], a[32:47]
v_max3_f32 v144, v144, v67, v68
v_max3_f32 v144, v144, v69, v70
v_max3_f32 v144, v144, v71, v72
v_max3_f32 v144, v144, v73, v74
v_mfma_f32_32x32x16_bf16 a[48:63], a[188:191], v[100:103], a[48:63]
v_max3_f32 v144, v144, v75, v76
v_max3_f32 v144, v144, v77, v78
v_max_f32 v144, v144, v79
v_cmp_lt_f32 vcc, s44, v144
s_mov_b32 s46, 4
s_cbranch_vccnz k1_fix0
k1_r4:
s_waitcnt vmcnt(10)
s_barrier
v_mfma_f32_32x32x16_bf16 v[80:95], a[128:131], v[32:35], v[128:143]
v_exp_f32 v64, v64
v_exp_f32 v65, v65
v_add_f32 v250, v250, v64
ds_read_b128 a[128:131], v228 offset:49152
v_mfma_f32_32x32x16_bf16 v[80:95], a[132:135], v[36:39], v[80:95]
s_add_u32 m0, s33, 32768
v_exp_f32 v66, v66
v_add_f32 v250, v250, v65
buffer_load_dwordx4 v244, s[16:19], s37 offen offset:0 lds
ds_read_b128 a[132:135], v229 offset:49152
v_mfma_f32_32x32x16_bf16 v[80:95], a[136:139], v[40:43], v[80:95]
v_cvt_pk_bf16_f32 v96, v64, v65
v_exp_f32 v67, v67
buffer_load_dwordx4 v245, s[16:19], s37 offen offset:1024 lds
ds_read_b128 a[136:139], v230 offset:49152
v_mfma_f32_32x32x16_bf16 v[80:95], a[140:143], v[44:47], v[80:95]
v_add_f32 v250, v250, v66
v_exp_f32 v68, v68
s_add_u32 s37, s37, 8192
v_add_f32 v250, v250, v67
ds_read_b128 a[140:143], v231 offset:49152
v_mfma_f32_32x32x16_bf16 v[80:95], a[144:147], v[48:51], v[80:95]
v_cvt_pk_bf16_f32 v97, v66, v67
v_exp_f32 v69, v69
v_accvgpr_mov_b32 a216, a200
v_add_f32 v250, v250, v68
ds_read_b128 a[144:147], v232 offset:49152
v_mfma_f32_32x32x16_bf16 v[80:95], a[148:151], v[52:55], v[80:95]
v_exp_f32 v70, v70
v_accvgpr_mov_b32 a217, a201
v_add_f32 v250, v250, v69
ds_read_b128 a[148:151], v233 offset:49152
v_mfma_f32_32x32x16_bf16 v[80:95], a[152:155], v[56:59], v[80:95]
v_exp_f32 v71, v71
v_accvgpr_mov_b32 a218, a202
v_add_f32 v250, v250, v70
v_cvt_pk_bf16_f32 v98, v68, v69
ds_read_b128 a[152:155], v234 offset:49152
v_mfma_f32_32x32x16_bf16 v[80:95], a[156:159], v[60:63], v[80:95]
v_accvgpr_mov_b32 a219, a203
v_add_f32 v250, v250, v71
v_cvt_pk_bf16_f32 v99, v70, v71
buffer_load_dwordx4 a[200:203], v254, s[48:51], s47 offen offset:128
ds_read_b128 a[156:159], v235 offset:49152
v_mfma_f32_32x32x16_bf16 a[64:79], a[160:163], v[104:107], a[64:79]
v_exp_f32 v72, v72
v_exp_f32 v73, v73
v_add_f32 v250, v250, v72
v_mfma_f32_32x32x16_bf16 a[80:95], a[164:167], v[104:107], a[80:95]
v_exp_f32 v74, v74
v_add_f32 v250, v250, v73
v_cvt_pk_bf16_f32 v100, v72, v73
v_exp_f32 v75, v75
v_mfma_f32_32x32x16_bf16 a[96:111], a[168:171], v[104:107], a[96:111]
v_add_f32 v250, v250, v74
v_exp_f32 v76, v76
v_add_f32 v250, v250, v75
v_cvt_pk_bf16_f32 v101, v74, v75
v_mfma_f32_32x32x16_bf16 a[112:127], a[172:175], v[104:107], a[112:127]
v_exp_f32 v77, v77
v_add_f32 v250, v250, v76
v_exp_f32 v78, v78
v_add_f32 v250, v250, v77
v_mfma_f32_32x32x16_bf16 a[64:79], a[176:179], v[108:111], a[64:79]
v_exp_f32 v79, v79
v_add_f32 v250, v250, v78
v_cvt_pk_bf16_f32 v102, v76, v77
ds_read_b64_tr_b16 a[160:161], v236 offset:57344
ds_read_b64_tr_b16 a[162:163], v236 offset:59392
v_mfma_f32_32x32x16_bf16 a[80:95], a[180:183], v[108:111], a[80:95]
v_add_f32 v250, v250, v79
v_cvt_pk_bf16_f32 v103, v78, v79
v_max3_f32 v144, v80, v81, v82
v_max3_f32 v144, v144, v83, v84
ds_read_b64_tr_b16 a[164:165], v237 offset:57344
ds_read_b64_tr_b16 a[166:167], v237 offset:59392
v_mfma_f32_32x32x16_bf16 a[96:111], a[184:187], v[108:111], a[96:111]
v_max3_f32 v144, v144, v85, v86
v_max3_f32 v144, v144, v87, v88
v_max3_f32 v144, v144, v89, v90
v_max3_f32 v144, v144, v91, v92
ds_read_b64_tr_b16 a[168:169], v238 offset:57344
ds_read_b64_tr_b16 a[170:171], v238 offset:59392
v_mfma_f32_32x32x16_bf16 a[112:127], a[188:191], v[108:111], a[112:127]
v_max3_f32 v144, v144, v93, v94
v_max_f32 v144, v144, v95
v_cmp_lt_f32 vcc, s44, v144
s_mov_b32 s46, 5
ds_read_b64_tr_b16 a[172:173], v239 offset:57344
ds_read_b64_tr_b16 a[174:175], v239 offset:59392
s_cbranch_vccnz k1_fix1
k1_r5:
s_waitcnt lgkmcnt(8)
v_mfma_f32_32x32x16_bf16 v[64:79], a[128:131], v[0:3], v[112:127]
v_exp_f32 v80, v80
ds_read_b64_tr_b16 a[176:177], v236 offset:61440
v_exp_f32 v81, v81
v_mfma_f32_32x32x16_bf16 v[64:79], a[132:135], v[4:7], v[64:79]
ds_read_b64_tr_b16 a[178:179], v236 offset:63488
v_add_f32 v251, v251, v80
v_exp_f32 v82, v82
ds_read_b64_tr_b16 a[180:181], v237 offset:61440
v_mfma_f32_32x32x16_bf16 v[64:79], a[136:139], v[8:11], v[64:79]
v_add_f32 v251, v251, v81
ds_read_b64_tr_b16 a[182:183], v237 offset:63488
v_cvt_pk_bf16_f32 v104, v80, v81
v_mfma_f32_32x32x16_bf16 v[64:79], a[140:143], v[12:15], v[64:79]
v_exp_f32 v83, v83
ds_read_b64_tr_b16 a[184:185], v238 offset:61440
v_add_f32 v251, v251, v82
ds_read_b64_tr_b16 a[186:187], v238 offset:63488
v_mfma_f32_32x32x16_bf16 v[64:79], a[144:147], v[16:19], v[64:79]
v_exp_f32 v84, v84
v_add_f32 v251, v251, v83
ds_read_b64_tr_b16 a[188:189], v239 offset:61440
v_mfma_f32_32x32x16_bf16 v[64:79], a[148:151], v[20:23], v[64:79]
v_cvt_pk_bf16_f32 v105, v82, v83
ds_read_b64_tr_b16 a[190:191], v239 offset:63488
v_exp_f32 v85, v85
v_add_f32 v251, v251, v84
v_mfma_f32_32x32x16_bf16 v[64:79], a[152:155], v[24:27], v[64:79]
v_exp_f32 v86, v86
v_add_f32 v251, v251, v85
v_exp_f32 v87, v87
v_mfma_f32_32x32x16_bf16 v[64:79], a[156:159], v[28:31], v[64:79]
v_add_f32 v251, v251, v86
v_cvt_pk_bf16_f32 v106, v84, v85
v_add_f32 v251, v251, v87
v_cvt_pk_bf16_f32 v107, v86, v87
s_waitcnt lgkmcnt(0)
v_mfma_f32_32x32x16_bf16 a[0:15], a[160:163], v[96:99], a[0:15]
v_exp_f32 v88, v88
v_exp_f32 v89, v89
v_add_f32 v251, v251, v88
v_exp_f32 v90, v90
v_mfma_f32_32x32x16_bf16 a[16:31], a[164:167], v[96:99], a[16:31]
v_add_f32 v251, v251, v89
v_cvt_pk_bf16_f32 v108, v88, v89
v_exp_f32 v91, v91
v_add_f32 v251, v251, v90
v_mfma_f32_32x32x16_bf16 a[32:47], a[168:171], v[96:99], a[32:47]
v_exp_f32 v92, v92
v_add_f32 v251, v251, v91
v_cvt_pk_bf16_f32 v109, v90, v91
s_add_u32 m0, s33, 40960
v_mfma_f32_32x32x16_bf16 a[48:63], a[172:175], v[96:99], a[48:63]
v_exp_f32 v93, v93
v_add_f32 v251, v251, v92
v_exp_f32 v94, v94
buffer_load_dwordx4 v246, s[20:23], s38 offen offset:0 lds
v_add_f32 v251, v251, v93
v_mfma_f32_32x32x16_bf16 a[0:15], a[176:179], v[100:103], a[0:15]
v_exp_f32 v95, v95
v_add_f32 v251, v251, v94
buffer_load_dwordx4 v247, s[20:23], s38 offen offset:1024 lds
v_cvt_pk_bf16_f32 v110, v92, v93
v_mfma_f32_32x32x16_bf16 a[16:31], a[180:183], v[100:103], a[16:31]
v_add_f32 v251, v251, v95
v_cvt_pk_bf16_f32 v111, v94, v95
s_add_u32 s38, s38, 8192
v_max3_f32 v144, v64, v65, v66
v_mfma_f32_32x32x16_bf16 a[32:47], a[184:187], v[100:103], a[32:47]
v_max3_f32 v144, v144, v67, v68
v_max3_f32 v144, v144, v69, v70
v_max3_f32 v144, v144, v71, v72
v_max3_f32 v144, v144, v73, v74
v_mfma_f32_32x32x16_bf16 a[48:63], a[188:191], v[100:103], a[48:63]
v_max3_f32 v144, v144, v75, v76
v_max3_f32 v144, v144, v77, v78
v_max_f32 v144, v144, v79
v_cmp_lt_f32 vcc, s44, v144
s_mov_b32 s46, 6
s_cbranch_vccnz k1_fix0
k1_r6:
s_waitcnt vmcnt(10)
s_barrier
v_mfma_f32_32x32x16_bf16 v[80:95], a[128:131], v[32:35], v[128:143]
v_exp_f32 v64, v64
v_exp_f32 v65, v65
s_add_u32 m0, s33, 49152
ds_read_b128 a[128:131], v228 offset:0
v_mfma_f32_32x32x16_bf16 v[80:95], a[132:135], v[36:39], v[80:95]
v_add_f32 v250, v250, v64
v_exp_f32 v66, v66
buffer_load_dwordx4 v244, s[16:19], s37 offen offset:0 lds
v_add_f32 v250, v250, v65
ds_read_b128 a[132:135], v229 offset:0
v_mfma_f32_32x32x16_bf16 v[80:95], a[136:139], v[40:43], v[80:95]
v_cvt_pk_bf16_f32 v96, v64, v65
buffer_load_dwordx4 v245, s[16:19], s37 offen offset:1024 lds
v_exp_f32 v67, v67
v_add_f32 v250, v250, v66
ds_read_b128 a[136:139], v230 offset:0
v_mfma_f32_32x32x16_bf16 v[80:95], a[140:143], v[44:47], v[80:95]
s_add_u32 s37, s37, 8192
v_exp_f32 v68, v68
v_add_f32 v250, v250, v67
v_accvgpr_mov_b32 a220, a204
ds_read_b128 a[140:143], v231 offset:0
v_mfma_f32_32x32x16_bf16 v[80:95], a[144:147], v[48:51], v[80:95]
v_cvt_pk_bf16_f32 v97, v66, v67
v_exp_f32 v69, v69
v_accvgpr_mov_b32 a221, a205
ds_read_b128 a[144:147], v232 offset:0
v_mfma_f32_32x32x16_bf16 v[80:95], a[148:151], v[52:55], v[80:95]
v_add_f32 v250, v250, v68
v_exp_f32 v70, v70
v_accvgpr_mov_b32 a222, a206
v_add_f32 v250, v250, v69
ds_read_b128 a[148:151], v233 offset:0
v_mfma_f32_32x32x16_bf16 v[80:95], a[152:155], v[56:59], v[80:95]
v_exp_f32 v71, v71
v_accvgpr_mov_b32 a223, a207
v_add_f32 v250, v250, v70
v_cvt_pk_bf16_f32 v98, v68, v69
ds_read_b128 a[152:155], v234 offset:0
v_mfma_f32_32x32x16_bf16 v[80:95], a[156:159], v[60:63], v[80:95]
buffer_load_dwordx4 a[204:207], v254, s[48:51], s47 offen offset:192
v_add_f32 v250, v250, v71
v_cvt_pk_bf16_f32 v99, v70, v71
s_xor_b32 s47, s47, 256
ds_read_b128 a[156:159], v235 offset:0
v_mfma_f32_32x32x16_bf16 a[64:79], a[160:163], v[104:107], a[64:79]
v_exp_f32 v72, v72
v_exp_f32 v73, v73
v_add_f32 v250, v250, v72
v_mfma_f32_32x32x16_bf16 a[80:95], a[164:167], v[104:107], a[80:95]
v_exp_f32 v74, v74
v_add_f32 v250, v250, v73
v_cvt_pk_bf16_f32 v100, v72, v73
v_exp_f32 v75, v75
v_mfma_f32_32x32x16_bf16 a[96:111], a[168:171], v[104:107], a[96:111]
v_add_f32 v250, v250, v74
v_exp_f32 v76, v76
v_add_f32 v250, v250, v75
v_cvt_pk_bf16_f32 v101, v74, v75
v_mfma_f32_32x32x16_bf16 a[112:127], a[172:175], v[104:107], a[112:127]
v_exp_f32 v77, v77
v_add_f32 v250, v250, v76
v_exp_f32 v78, v78
v_add_f32 v250, v250, v77
v_mfma_f32_32x32x16_bf16 a[64:79], a[176:179], v[108:111], a[64:79]
v_exp_f32 v79, v79
v_add_f32 v250, v250, v78
v_cvt_pk_bf16_f32 v102, v76, v77
ds_read_b64_tr_b16 a[160:161], v236 offset:8192
ds_read_b64_tr_b16 a[162:163], v236 offset:10240
v_mfma_f32_32x32x16_bf16 a[80:95], a[180:183], v[108:111], a[80:95]
v_add_f32 v250, v250, v79
v_cvt_pk_bf16_f32 v103, v78, v79
v_max3_f32 v144, v80, v81, v82
v_max3_f32 v144, v144, v83, v84
ds_read_b64_tr_b16 a[164:165], v237 offset:8192
ds_read_b64_tr_b16 a[166:167], v237 offset:10240
v_mfma_f32_32x32x16_bf16 a[96:111], a[184:187], v[108:111], a[96:111]
v_max3_f32 v144, v144, v85, v86
v_max3_f32 v144, v144, v87, v88
v_max3_f32 v144, v144, v89, v90
v_max3_f32 v144, v144, v91, v92
ds_read_b64_tr_b16 a[168:169], v238 offset:8192
ds_read_b64_tr_b16 a[170:171], v238 offset:10240
v_mfma_f32_32x32x16_bf16 a[112:127], a[188:191], v[108:111], a[112:127]
v_max3_f32 v144, v144, v93, v94
v_max_f32 v144, v144, v95
v_cmp_lt_f32 vcc, s44, v144
s_mov_b32 s46, 7
ds_read_b64_tr_b16 a[172:173], v239 offset:8192
ds_read_b64_tr_b16 a[174:175], v239 offset:10240
s_cbranch_vccnz k1_fix1
k1_r7:
s_waitcnt lgkmcnt(8)
v_mfma_f32_32x32x16_bf16 v[64:79], a[128:131], v[0:3], v[112:127]
v_exp_f32 v80, v80
ds_read_b64_tr_b16 a[176:177], v236 offset:12288
v_exp_f32 v81, v81
v_mfma_f32_32x32x16_bf16 v[64:79], a[132:135], v[4:7], v[64:79]
ds_read_b64_tr_b16 a[178:179], v236 offset:14336
v_add_f32 v251, v251, v80
v_exp_f32 v82, v82
ds_read_b64_tr_b16 a[180:181], v237 offset:12288
v_mfma_f32_32x32x16_bf16 v[64:79], a[136:139], v[8:11], v[64:79]
v_add_f32 v251, v251, v81
ds_read_b64_tr_b16 a[182:183], v237 offset:14336
v_cvt_pk_bf16_f32 v104, v80, v81
v_mfma_f32_32x32x16_bf16 v[64:79], a[140:143], v[12:15], v[64:79]
v_exp_f32 v83, v83
ds_read_b64_tr_b16 a[184:185], v238 offset:12288
v_add_f32 v251, v251, v82
ds_read_b64_tr_b16 a[186:187], v238 offset:14336
v_mfma_f32_32x32x16_bf16 v[64:79], a[144:147], v[16:19], v[64:79]
v_exp_f32 v84, v84
v_add_f32 v251, v251, v83
ds_read_b64_tr_b16 a[188:189], v239 offset:12288
v_mfma_f32_32x32x16_bf16 v[64:79], a[148:151], v[20:23], v[64:79]
v_cvt_pk_bf16_f32 v105, v82, v83
ds_read_b64_tr_b16 a[190:191], v239 offset:14336
v_exp_f32 v85, v85
v_add_f32 v251, v251, v84
v_mfma_f32_32x32x16_bf16 v[64:79], a[152:155], v[24:27], v[64:79]
v_exp_f32 v86, v86
v_add_f32 v251, v251, v85
v_exp_f32 v87, v87
v_mfma_f32_32x32x16_bf16 v[64:79], a[156:159], v[28:31], v[64:79]
v_add_f32 v251, v251, v86
v_cvt_pk_bf16_f32 v106, v84, v85
v_add_f32 v251, v251, v87
v_cvt_pk_bf16_f32 v107, v86, v87
s_waitcnt lgkmcnt(0)
v_mfma_f32_32x32x16_bf16 a[0:15], a[160:163], v[96:99], a[0:15]
v_exp_f32 v88, v88
v_exp_f32 v89, v89
v_add_f32 v251, v251, v88
v_exp_f32 v90, v90
v_mfma_f32_32x32x16_bf16 a[16:31], a[164:167], v[96:99], a[16:31]
v_add_f32 v251, v251, v89
v_cvt_pk_bf16_f32 v108, v88, v89
v_exp_f32 v91, v91
v_add_f32 v251, v251, v90
v_mfma_f32_32x32x16_bf16 a[32:47], a[168:171], v[96:99], a[32:47]
v_exp_f32 v92, v92
v_add_f32 v251, v251, v91
v_cvt_pk_bf16_f32 v109, v90, v91
s_add_u32 m0, s33, 57344
v_mfma_f32_32x32x16_bf16 a[48:63], a[172:175], v[96:99], a[48:63]
v_exp_f32 v93, v93
v_add_f32 v251, v251, v92
v_exp_f32 v94, v94
buffer_load_dwordx4 v246, s[20:23], s38 offen offset:0 lds
v_add_f32 v251, v251, v93
v_mfma_f32_32x32x16_bf16 a[0:15], a[176:179], v[100:103], a[0:15]
v_exp_f32 v95, v95
v_add_f32 v251, v251, v94
buffer_load_dwordx4 v247, s[20:23], s38 offen offset:1024 lds
v_cvt_pk_bf16_f32 v110, v92, v93
v_mfma_f32_32x32x16_bf16 a[16:31], a[180:183], v[100:103], a[16:31]
v_add_f32 v251, v251, v95
v_cvt_pk_bf16_f32 v111, v94, v95
s_add_u32 s38, s38, 8192
v_max3_f32 v144, v64, v65, v66
v_mfma_f32_32x32x16_bf16 a[32:47], a[184:187], v[100:103], a[32:47]
v_max3_f32 v144, v144, v67, v68
v_max3_f32 v144, v144, v69, v70
v_max3_f32 v144, v144, v71, v72
v_max3_f32 v144, v144, v73, v74
v_mfma_f32_32x32x16_bf16 a[48:63], a[188:191], v[100:103], a[48:63]
v_max3_f32 v144, v144, v75, v76
v_max3_f32 v144, v144, v77, v78
v_max_f32 v144, v144, v79
v_cmp_lt_f32 vcc, s44, v144
s_mov_b32 s46, 8
s_cbranch_vccnz k1_fix0
k1_r8:
s_waitcnt vmcnt(10)
s_barrier
v_mfma_f32_32x32x16_bf16 v[80:95], a[128:131], v[32:35], v[128:143]
v_exp_f32 v64, v64
v_exp_f32 v65, v65
v_add_f32 v250, v250, v64
ds_read_b128 a[128:131], v228 offset:16384
v_mfma_f32_32x32x16_bf16 v[80:95], a[132:135], v[36:39], v[80:95]
s_add_u32 m0, s33, 0
v_exp_f32 v66, v66
v_add_f32 v250, v250, v65
buffer_load_dwordx4 v244, s[16:19], s37 offen offset:0 lds
ds_read_b128 a[132:135], v229 offset:16384
v_mfma_f32_32x32x16_bf16 v[80:95], a[136:139], v[40:43], v[80:95]
v_cvt_pk_bf16_f32 v96, v64, v65
v_exp_f32 v67, v67
buffer_load_dwordx4 v245, s[16:19], s37 offen offset:1024 lds
ds_read_b128 a[136:139], v230 offset:16384
v_mfma_f32_32x32x16_bf16 v[80:95], a[140:143], v[44:47], v[80:95]
v_add_f32 v250, v250, v66
v_exp_f32 v68, v68
s_add_u32 s37, s37, 8192
v_add_f32 v250, v250, v67
ds_read_b128 a[140:143], v231 offset:16384
v_mfma_f32_32x32x16_bf16 v[80:95], a[144:147], v[48:51], v[80:95]
v_cvt_pk_bf16_f32 v97, v66, v67
v_exp_f32 v69, v69
v_accvgpr_mov_b32 a208, a192
v_add_f32 v250, v250, v68
ds_read_b128 a[144:147], v232 offset:16384
v_mfma_f32_32x32x16_bf16 v[80:95], a[148:151], v[52:55], v[80:95]
v_exp_f32 v70, v70
v_accvgpr_mov_b32 a209, a193
v_add_f32 v250, v250, v69
ds_read_b128 a[148:151], v233 offset:16384
v_mfma_f32_32x32x16_bf16 v[80:95], a[152:155], v[56:59], v[80:95]
v_exp_f32 v71, v71
v_accvgpr_mov_b32 a210, a194
v_add_f32 v250, v250, v70
v_cvt_pk_bf16_f32 v98, v68, v69
ds_read_b128 a[152:155], v234 offset:16384
v_mfma_f32_32x32x16_bf16 v[80:95], a[156:159], v[60:63], v[80:95]
v_accvgpr_mov_b32 a211, a195
v_add_f32 v250, v250, v71
v_cvt_pk_bf16_f32 v99, v70, v71
buffer_load_dwordx4 a[192:195], v254, s[48:51], s47 offen offset:0
ds_read_b128 a[156:159], v235 offset:16384
v_mfma_f32_32x32x16_bf16 a[64:79], a[160:163], v[104:107], a[64:79]
v_exp_f32 v72, v72
v_exp_f32 v73, v73
v_add_f32 v250, v250, v72
v_mfma_f32_32x32x16_bf16 a[80:95], a[164:167], v[104:107], a[80:95]
v_exp_f32 v74, v74
v_add_f32 v250, v250, v73
v_cvt_pk_bf16_f32 v100, v72, v73
v_exp_f32 v75, v75
v_mfma_f32_32x32x16_bf16 a[96:111], a[168:171], v[104:107], a[96:111]
v_add_f32 v250, v250, v74
v_exp_f32 v76, v76
v_add_f32 v250, v250, v75
v_cvt_pk_bf16_f32 v101, v74, v75
v_mfma_f32_32x32x16_bf16 a[112:127], a[172:175], v[104:107], a[112:127]
v_exp_f32 v77, v77
v_add_f32 v250, v250, v76
v_exp_f32 v78, v78
v_add_f32 v250, v250, v77
v_mfma_f32_32x32x16_bf16 a[64:79], a[176:179], v[108:111], a[64:79]
v_exp_f32 v79, v79
v_add_f32 v250, v250, v78
v_cvt_pk_bf16_f32 v102, v76, v77
ds_read_b64_tr_b16 a[160:161], v236 offset:24576
ds_read_b64_tr_b16 a[162:163], v236 offset:26624
v_mfma_f32_32x32x16_bf16 a[80:95], a[180:183], v[108:111], a[80:95]
v_add_f32 v250, v250, v79
v_cvt_pk_bf16_f32 v103, v78, v79
v_max3_f32 v144, v80, v81, v82
v_max3_f32 v144, v144, v83, v84
ds_read_b64_tr_b16 a[164:165], v237 offset:24576
ds_read_b64_tr_b16 a[166:167], v237 offset:26624
v_mfma_f32_32x32x16_bf16 a[96:111], a[184:187], v[108:111], a[96:111]
v_max3_f32 v144, v144, v85, v86
v_max3_f32 v144, v144, v87, v88
v_max3_f32 v144, v144, v89, v90
v_max3_f32 v144, v144, v91, v92
ds_read_b64_tr_b16 a[168:169], v238 offset:24576
ds_read_b64_tr_b16 a[170:171], v238 offset:26624
v_mfma_f32_32x32x16_bf16 a[112:127], a[188:191], v[108:111], a[112:127]
v_max3_f32 v144, v144, v93, v94
v_max_f32 v144, v144, v95
v_cmp_lt_f32 vcc, s44, v144
s_mov_b32 s46, 9
ds_read_b64_tr_b16 a[172:173], v239 offset:24576
ds_read_b64_tr_b16 a[174:175], v239 offset:26624
s_cbranch_vccnz k1_fix1
k1_r9:
s_waitcnt lgkmcnt(8)
v_mfma_f32_32x32x16_bf16 v[64:79], a[128:131], v[0:3], v[112:127]
v_exp_f32 v80, v80
ds_read_b64_tr_b16 a[176:177], v236 offset:28672
v_exp_f32 v81, v81
v_mfma_f32_32x32x16_bf16 v[64:79], a[132:135], v[4:7], v[64:79]
ds_read_b64_tr_b16 a[178:179], v236 offset:30720
v_add_f32 v251, v251, v80
v_exp_f32 v82, v82
ds_read_b64_tr_b16 a[180:181], v237 offset:28672
v_mfma_f32_32x32x16_bf16 v[64:79], a[136:139], v[8:11], v[64:79]
v_add_f32 v251, v251, v81
ds_read_b64_tr_b16 a[182:183], v237 offset:30720
v_cvt_pk_bf16_f32 v104, v80, v81
v_mfma_f32_32x32x16_bf16 v[64:79], a[140:143], v[12:15], v[64:79]
v_exp_f32 v83, v83
ds_read_b64_tr_b16 a[184:185], v238 offset:28672
v_add_f32 v251, v251, v82
ds_read_b64_tr_b16 a[186:187], v238 offset:30720
v_mfma_f32_32x32x16_bf16 v[64:79], a[144:147], v[16:19], v[64:79]
v_exp_f32 v84, v84
v_add_f32 v251, v251, v83
ds_read_b64_tr_b16 a[188:189], v239 offset:28672
v_mfma_f32_32x32x16_bf16 v[64:79], a[148:151], v[20:23], v[64:79]
v_cvt_pk_bf16_f32 v105, v82, v83
ds_read_b64_tr_b16 a[190:191], v239 offset:30720
v_exp_f32 v85, v85
v_add_f32 v251, v251, v84
v_mfma_f32_32x32x16_bf16 v[64:79], a[152:155], v[24:27], v[64:79]
v_exp_f32 v86, v86
v_add_f32 v251, v251, v85
v_exp_f32 v87, v87
v_mfma_f32_32x32x16_bf16 v[64:79], a[156:159], v[28:31], v[64:79]
v_add_f32 v251, v251, v86
v_cvt_pk_bf16_f32 v106, v84, v85
v_add_f32 v251, v251, v87
v_cvt_pk_bf16_f32 v107, v86, v87
s_waitcnt lgkmcnt(0)
v_mfma_f32_32x32x16_bf16 a[0:15], a[160:163], v[96:99], a[0:15]
v_exp_f32 v88, v88
v_exp_f32 v89, v89
v_add_f32 v251, v251, v88
v_exp_f32 v90, v90
v_mfma_f32_32x32x16_bf16 a[16:31], a[164:167], v[96:99], a[16:31]
v_add_f32 v251, v251, v89
v_cvt_pk_bf16_f32 v108, v88, v89
v_exp_f32 v91, v91
v_add_f32 v251, v251, v90
v_mfma_f32_32x32x16_bf16 a[32:47], a[168:171], v[96:99], a[32:47]
v_exp_f32 v92, v92
v_add_f32 v251, v251, v91
v_cvt_pk_bf16_f32 v109, v90, v91
s_add_u32 m0, s33, 8192
v_mfma_f32_32x32x16_bf16 a[48:63], a[172:175], v[96:99], a[48:63]
v_exp_f32 v93, v93
v_add_f32 v251, v251, v92
v_exp_f32 v94, v94
buffer_load_dwordx4 v246, s[20:23], s38 offen offset:0 lds
v_add_f32 v251, v251, v93
v_mfma_f32_32x32x16_bf16 a[0:15], a[176:179], v[100:103], a[0:15]
v_exp_f32 v95, v95
v_add_f32 v251, v251, v94
buffer_load_dwordx4 v247, s[20:23], s38 offen offset:1024 lds
v_cvt_pk_bf16_f32 v110, v92, v93
v_mfma_f32_32x32x16_bf16 a[16:31], a[180:183], v[100:103], a[16:31]
v_add_f32 v251, v251, v95
v_cvt_pk_bf16_f32 v111, v94, v95
s_add_u32 s38, s38, 8192
v_max3_f32 v144, v64, v65, v66
v_mfma_f32_32x32x16_bf16 a[32:47], a[184:187], v[100:103], a[32:47]
v_max3_f32 v144, v144, v67, v68
v_max3_f32 v144, v144, v69, v70
v_max3_f32 v144, v144, v71, v72
v_max3_f32 v144, v144, v73, v74
v_mfma_f32_32x32x16_bf16 a[48:63], a[188:191], v[100:103], a[48:63]
v_max3_f32 v144, v144, v75, v76
v_max3_f32 v144, v144, v77, v78
v_max_f32 v144, v144, v79
v_cmp_lt_f32 vcc, s44, v144
s_mov_b32 s46, 10
s_cbranch_vccnz k1_fix0
k1_r10:
s_waitcnt vmcnt(10)
s_barrier
v_mfma_f32_32x32x16_bf16 v[80:95], a[128:131], v[32:35], v[128:143]
v_exp_f32 v64, v64
v_exp_f32 v65, v65
v_add_f32 v250, v250, v64
ds_read_b128 a[128:131], v228 offset:32768
v_mfma_f32_32x32x16_bf16 v[80:95], a[132:135], v[36:39], v[80:95]
s_add_u32 m0, s33, 16384
v_exp_f32 v66, v66
v_add_f32 v250, v250, v65
buffer_load_dwordx4 v244, s[16:19], s37 offen offset:0 lds
ds_read_b128 a[132:135], v229 offset:32768
v_mfma_f32_32x32x16_bf16 v[80:95], a[136:139], v[40:43], v[80:95]
v_cvt_pk_bf16_f32 v96, v64, v65
v_exp_f32 v67, v67
buffer_load_dwordx4 v245, s[16:19], s37 offen offset:1024 lds
ds_read_b128 a[136:139], v230 offset:32768
v_mfma_f32_32x32x16_bf16 v[80:95], a[140:143], v[44:47], v[80:95]
v_add_f32 v250, v250, v66
v_exp_f32 v68, v68
s_add_u32 s37, s37, 8192
v_add_f32 v250, v250, v67
ds_read_b128 a[140:143], v231 offset:32768
v_mfma_f32_32x32x16_bf16 v[80:95], a[144:147], v[48:51], v[80:95]
v_cvt_pk_bf16_f32 v97, v66, v67
v_exp_f32 v69, v69
v_accvgpr_mov_b32 a212, a196
v_add_f32 v250, v250, v68
ds_read_b128 a[144:147], v232 offset:32768
v_mfma_f32_32x32x16_bf16 v[80:95], a[148:151], v[52:55], v[80:95]
v_exp_f32 v70, v70
v_accvgpr_mov_b32 a213, a197
v_add_f32 v250, v250, v69
ds_read_b128 a[148:151], v233 offset:32768
v_mfma_f32_32x32x16_bf16 v[80:95], a[152:155], v[56:59], v[80:95]
v_exp_f32 v71, v71
v_accvgpr_mov_b32 a214, a198
v_add_f32 v250, v250, v70
v_cvt_pk_bf16_f32 v98, v68, v69
ds_read_b128 a[152:155], v234 offset:32768
v_mfma_f32_32x32x16_bf16 v[80:95], a[156:159], v[60:63], v[80:95]
v_accvgpr_mov_b32 a215, a199
v_add_f32 v250, v250, v71
v_cvt_pk_bf16_f32 v99, v70, v71
buffer_load_dwordx4 a[196:199], v254, s[48:51], s47 offen offset:64
ds_read_b128 a[156:159], v235 offset:32768
v_mfma_f32_32x32x16_bf16 a[64:79], a[160:163], v[104:107], a[64:79]
v_exp_f32 v72, v72
v_exp_f32 v73, v73
v_add_f32 v250, v250, v72
v_mfma_f32_32x32x16_bf16 a[80:95], a[164:167], v[104:107], a[80:95]
v_exp_f32 v74, v74
v_add_f32 v250, v250, v73
v_cvt_pk_bf16_f32 v100, v72, v73
v_exp_f32 v75, v75
v_mfma_f32_32x32x16_bf16 a[96:111], a[168:171], v[104:107], a[96:111]
v_add_f32 v250, v250, v74
v_exp_f32 v76, v76
v_add_f32 v250, v250, v75
v_cvt_pk_bf16_f32 v101, v74, v75
v_mfma_f32_32x32x16_bf16 a[112:127], a[172:175], v[104:107], a[112:127]
v_exp_f32 v77, v77
v_add_f32 v250, v250, v76
v_exp_f32 v78, v78
v_add_f32 v250, v250, v77
v_mfma_f32_32x32x16_bf16 a[64:79], a[176:179], v[108:111], a[64:79]
v_exp_f32 v79, v79
v_add_f32 v250, v250, v78
v_cvt_pk_bf16_f32 v102, v76, v77
ds_read_b64_tr_b16 a[160:161], v236 offset:40960
ds_read_b64_tr_b16 a[162:163], v236 offset:43008
v_mfma_f32_32x32x16_bf16 a[80:95], a[180:183], v[108:111], a[80:95]
v_add_f32 v250, v250, v79
v_cvt_pk_bf16_f32 v103, v78, v79
v_max3_f32 v144, v80, v81, v82
v_max3_f32 v144, v144, v83, v84
ds_read_b64_tr_b16 a[164:165], v237 offset:40960
ds_read_b64_tr_b16 a[166:167], v237 offset:43008
v_mfma_f32_32x32x16_bf16 a[96:111], a[184:187], v[108:111], a[96:111]
v_max3_f32 v144, v144, v85, v86
v_max3_f32 v144, v144, v87, v88
v_max3_f32 v144, v144, v89, v90
v_max3_f32 v144, v144, v91, v92
ds_read_b64_tr_b16 a[168:169], v238 offset:40960
ds_read_b64_tr_b16 a[170:171], v238 offset:43008
v_mfma_f32_32x32x16_bf16 a[112:127], a[188:191], v[108:111], a[112:127]
v_max3_f32 v144, v144, v93, v94
v_max_f32 v144, v144, v95
v_cmp_lt_f32 vcc, s44, v144
s_mov_b32 s46, 11
ds_read_b64_tr_b16 a[172:173], v239 offset:40960
ds_read_b64_tr_b16 a[174:175], v239 offset:43008
s_cbranch_vccnz k1_fix1
k1_r11:
s_sub_u32 s31, s31, 1
s_cmp_lg_u32 s31, 0
s_cbranch_scc1 k1_lp
s_waitcnt lgkmcnt(8)
v_mfma_f32_32x32x16_bf16 v[64:79], a[128:131], v[0:3], v[112:127]
v_exp_f32 v80, v80
ds_read_b64_tr_b16 a[176:177], v236 offset:45056
v_exp_f32 v81, v81
v_mfma_f32_32x32x16_bf16 v[64:79], a[132:135], v[4:7], v[64:79]
ds_read_b64_tr_b16 a[178:179], v236 offset:47104
v_add_f32 v251, v251, v80
v_exp_f32 v82, v82
ds_read_b64_tr_b16 a[180:181], v237 offset:45056
v_mfma_f32_32x32x16_bf16 v[64:79], a[136:139], v[8:11], v[64:79]
v_add_f32 v251, v251, v81
ds_read_b64_tr_b16 a[182:183], v237 offset:47104
v_cvt_pk_bf16_f32 v104, v80, v81
v_mfma_f32_32x32x16_bf16 v[64:79], a[140:143], v[12:15], v[64:79]
v_exp_f32 v83, v83
ds_read_b64_tr_b16 a[184:185], v238 offset:45056
v_add_f32 v251, v251, v82
ds_read_b64_tr_b16 a[186:187], v238 offset:47104
v_mfma_f32_32x32x16_bf16 v[64:79], a[144:147], v[16:19], v[64:79]
v_exp_f32 v84, v84
v_add_f32 v251, v251, v83
ds_read_b64_tr_b16 a[188:189], v239 offset:45056
v_mfma_f32_32x32x16_bf16 v[64:79], a[148:151], v[20:23], v[64:79]
v_cvt_pk_bf16_f32 v105, v82, v83
ds_read_b64_tr_b16 a[190:191], v239 offset:47104
v_exp_f32 v85, v85
v_add_f32 v251, v251, v84
v_mfma_f32_32x32x16_bf16 v[64:79], a[152:155], v[24:27], v[64:79]
v_exp_f32 v86, v86
v_add_f32 v251, v251, v85
v_exp_f32 v87, v87
v_mfma_f32_32x32x16_bf16 v[64:79], a[156:159], v[28:31], v[64:79]
v_add_f32 v251, v251, v86
v_cvt_pk_bf16_f32 v106, v84, v85
v_add_f32 v251, v251, v87
v_cvt_pk_bf16_f32 v107, v86, v87
s_waitcnt lgkmcnt(0)
v_mfma_f32_32x32x16_bf16 a[0:15], a[160:163], v[96:99], a[0:15]
v_exp_f32 v88, v88
v_exp_f32 v89, v89
v_add_f32 v251, v251, v88
v_exp_f32 v90, v90
v_mfma_f32_32x32x16_bf16 a[16:31], a[164:167], v[96:99], a[16:31]
v_add_f32 v251, v251, v89
v_cvt_pk_bf16_f32 v108, v88, v89
v_exp_f32 v91, v91
v_add_f32 v251, v251, v90
v_mfma_f32_32x32x16_bf16 a[32:47], a[168:171], v[96:99], a[32:47]
v_exp_f32 v92, v92
v_add_f32 v251, v251, v91
v_cvt_pk_bf16_f32 v109, v90, v91
s_add_u32 m0, s33, 24576
v_mfma_f32_32x32x16_bf16 a[48:63], a[172:175], v[96:99], a[48:63]
v_exp_f32 v93, v93
v_add_f32 v251, v251, v92
v_exp_f32 v94, v94
buffer_load_dwordx4 v246, s[20:23], s38 offen offset:0 lds
v_add_f32 v251, v251, v93
v_mfma_f32_32x32x16_bf16 a[0:15], a[176:179], v[100:103], a[0:15]
v_exp_f32 v95, v95
v_add_f32 v251, v251, v94
buffer_load_dwordx4 v247, s[20:23], s38 offen offset:1024 lds
v_cvt_pk_bf16_f32 v110, v92, v93
v_mfma_f32_32x32x16_bf16 a[16:31], a[180:183], v[100:103], a[16:31]
v_add_f32 v251, v251, v95
v_cvt_pk_bf16_f32 v111, v94, v95
s_add_u32 s38, s38, 8192
v_max3_f32 v144, v64, v65, v66
v_mfma_f32_32x32x16_bf16 a[32:47], a[184:187], v[100:103], a[32:47]
v_max3_f32 v144, v144, v67, v68
v_max3_f32 v144, v144, v69, v70
v_max3_f32 v144, v144, v71, v72
v_max3_f32 v144, v144, v73, v74
v_mfma_f32_32x32x16_bf16 a[48:63], a[188:191], v[100:103], a[48:63]
v_max3_f32 v144, v144, v75, v76
v_max3_f32 v144, v144, v77, v78
v_max_f32 v144, v144, v79
v_cmp_lt_f32 vcc, s44, v144
s_mov_b32 s46, 12
s_cbranch_vccnz k1_fix0
k1_r12:
s_waitcnt vmcnt(10)
s_barrier
v_mfma_f32_32x32x16_bf16 v[80:95], a[128:131], v[32:35], v[128:143]
v_exp_f32 v64, v64
v_exp_f32 v65, v65
v_add_f32 v250, v250, v64
ds_read_b128 a[128:131], v228 offset:49152
v_mfma_f32_32x32x16_bf16 v[80:95], a[132:135], v[36:39], v[80:95]
v_exp_f32 v66, v66
s_add_u32 m0, s33, 32768
v_add_f32 v250, v250, v65
ds_read_b128 a[132:135], v229 offset:49152
v_mfma_f32_32x32x16_bf16 v[80:95], a[136:139], v[40:43], v[80:95]
v_cvt_pk_bf16_f32 v96, v64, v65
v_exp_f32 v67, v67
v_add_f32 v250, v250, v66
ds_read_b128 a[136:139], v230 offset:49152
v_mfma_f32_32x32x16_bf16 v[80:95], a[140:143], v[44:47], v[80:95]
buffer_load_dwordx4 v244, s[16:19], s37 offen offset:0 lds
v_exp_f32 v68, v68
v_add_f32 v250, v250, v67
ds_read_b128 a[140:143], v231 offset:49152
v_mfma_f32_32x32x16_bf16 v[80:95], a[144:147], v[48:51], v[80:95]
v_cvt_pk_bf16_f32 v97, v66, v67
v_exp_f32 v69, v69
buffer_load_dwordx4 v245, s[16:19], s37 offen offset:1024 lds
ds_read_b128 a[144:147], v232 offset:49152
v_mfma_f32_32x32x16_bf16 v[80:95], a[148:151], v[52:55], v[80:95]
v_add_f32 v250, v250, v68
v_exp_f32 v70, v70
v_add_f32 v250, v250, v69
ds_read_b128 a[148:151], v233 offset:49152
v_mfma_f32_32x32x16_bf16 v[80:95], a[152:155], v[56:59], v[80:95]
v_exp_f32 v71, v71
s_add_u32 s37, s37, 8192
v_add_f32 v250, v250, v70
ds_read_b128 a[152:155], v234 offset:49152
v_mfma_f32_32x32x16_bf16 v[80:95], a[156:159], v[60:63], v[80:95]
v_cvt_pk_bf16_f32 v98, v68, v69
v_add_f32 v250, v250, v71
v_cvt_pk_bf16_f32 v99, v70, v71
buffer_load_dword a224, v255, s[80:83], 0 offen
ds_read_b128 a[156:159], v235 offset:49152
v_mfma_f32_32x32x16_bf16 a[64:79], a[160:163], v[104:107], a[64:79]
v_exp_f32 v72, v72
v_exp_f32 v73, v73
v_add_f32 v250, v250, v72
v_mfma_f32_32x32x16_bf16 a[80:95], a[164:167], v[104:107], a[80:95]
v_exp_f32 v74, v74
v_add_f32 v250, v250, v73
v_cvt_pk_bf16_f32 v100, v72, v73
v_exp_f32 v75, v75
v_mfma_f32_32x32x16_bf16 a[96:111], a[168:171], v[104:107], a[96:111]
v_add_f32 v250, v250, v74
v_exp_f32 v76, v76
v_add_f32 v250, v250, v75
v_cvt_pk_bf16_f32 v101, v74, v75
v_mfma_f32_32x32x16_bf16 a[112:127], a[172:175], v[104:107], a[112:127]
v_exp_f32 v77, v77
v_add_f32 v250, v250, v76
v_exp_f32 v78, v78
v_add_f32 v250, v250, v77
v_mfma_f32_32x32x16_bf16 a[64:79], a[176:179], v[108:111], a[64:79]
v_exp_f32 v79, v79
v_add_f32 v250, v250, v78
v_cvt_pk_bf16_f32 v102, v76, v77
ds_read_b64_tr_b16 a[160:161], v236 offset:57344
ds_read_b64_tr_b16 a[162:163], v236 offset:59392
v_mfma_f32_32x32x16_bf16 a[80:95], a[180:183], v[108:111], a[80:95]
v_add_f32 v250, v250, v79
v_cvt_pk_bf16_f32 v103, v78, v79
v_max3_f32 v144, v80, v81, v82
v_max3_f32 v144, v144, v83, v84
ds_read_b64_tr_b16 a[164:165], v237 offset:57344
ds_read_b64_tr_b16 a[166:167], v237 offset:59392
v_mfma_f32_32x32x16_bf16 a[96:111], a[184:187], v[108:111], a[96:111]
v_max3_f32 v144, v144, v85, v86
v_max3_f32 v144, v144, v87, v88
v_max3_f32 v144, v144, v89, v90
v_max3_f32 v144, v144, v91, v92
ds_read_b64_tr_b16 a[168:169], v238 offset:57344
ds_read_b64_tr_b16 a[170:171], v238 offset:59392
v_mfma_f32_32x32x16_bf16 a[112:127], a[188:191], v[108:111], a[112:127]
v_max3_f32 v144, v144, v93, v94
v_max_f32 v144, v144, v95
v_cmp_lt_f32 vcc, s44, v144
s_mov_b32 s46, 13
ds_read_b64_tr_b16 a[172:173], v239 offset:57344
ds_read_b64_tr_b16 a[174:175], v239 offset:59392
s_cbranch_vccnz k1_fix1
k1_r13:
s_waitcnt lgkmcnt(8)
v_mfma_f32_32x32x16_bf16 v[64:79], a[128:131], v[0:3], v[112:127]
v_exp_f32 v80, v80
ds_read_b64_tr_b16 a[176:177], v236 offset:61440
v_exp_f32 v81, v81
v_mfma_f32_32x32x16_bf16 v[64:79], a[132:135], v[4:7], v[64:79]
ds_read_b64_tr_b16 a[178:179], v236 offset:63488
v_add_f32 v251, v251, v80
v_exp_f32 v82, v82
ds_read_b64_tr_b16 a[180:181], v237 offset:61440
v_mfma_f32_32x32x16_bf16 v[64:79], a[136:139], v[8:11], v[64:79]
v_add_f32 v251, v251, v81
ds_read_b64_tr_b16 a[182:183], v237 offset:63488
v_cvt_pk_bf16_f32 v104, v80, v81
v_mfma_f32_32x32x16_bf16 v[64:79], a[140:143], v[12:15], v[64:79]
v_exp_f32 v83, v83
ds_read_b64_tr_b16 a[184:185], v238 offset:61440
v_add_f32 v251, v251, v82
ds_read_b64_tr_b16 a[186:187], v238 offset:63488
v_mfma_f32_32x32x16_bf16 v[64:79], a[144:147], v[16:19], v[64:79]
v_exp_f32 v84, v84
v_add_f32 v251, v251, v83
ds_read_b64_tr_b16 a[188:189], v239 offset:61440
v_mfma_f32_32x32x16_bf16 v[64:79], a[148:151], v[20:23], v[64:79]
v_cvt_pk_bf16_f32 v105, v82, v83
ds_read_b64_tr_b16 a[190:191], v239 offset:63488
v_exp_f32 v85, v85
v_add_f32 v251, v251, v84
v_mfma_f32_32x32x16_bf16 v[64:79], a[152:155], v[24:27], v[64:79]
v_exp_f32 v86, v86
v_add_f32 v251, v251, v85
v_exp_f32 v87, v87
v_mfma_f32_32x32x16_bf16 v[64:79], a[156:159], v[28:31], v[64:79]
v_add_f32 v251, v251, v86
v_cvt_pk_bf16_f32 v106, v84, v85
v_add_f32 v251, v251, v87
v_cvt_pk_bf16_f32 v107, v86, v87
s_waitcnt lgkmcnt(0)
v_mfma_f32_32x32x16_bf16 a[0:15], a[160:163], v[96:99], a[0:15]
v_exp_f32 v88, v88
v_exp_f32 v89, v89
v_add_f32 v251, v251, v88
v_exp_f32 v90, v90
v_mfma_f32_32x32x16_bf16 a[16:31], a[164:167], v[96:99], a[16:31]
v_add_f32 v251, v251, v89
v_cvt_pk_bf16_f32 v108, v88, v89
v_exp_f32 v91, v91
v_add_f32 v251, v251, v90
v_mfma_f32_32x32x16_bf16 a[32:47], a[168:171], v[96:99], a[32:47]
v_exp_f32 v92, v92
v_add_f32 v251, v251, v91
v_cvt_pk_bf16_f32 v109, v90, v91
s_add_u32 m0, s33, 40960
v_mfma_f32_32x32x16_bf16 a[48:63], a[172:175], v[96:99], a[48:63]
v_exp_f32 v93, v93
v_add_f32 v251, v251, v92
v_exp_f32 v94, v94
buffer_load_dwordx4 v246, s[20:23], s38 offen offset:0 lds
v_add_f32 v251, v251, v93
v_mfma_f32_32x32x16_bf16 a[0:15], a[176:179], v[100:103], a[0:15]
v_exp_f32 v95, v95
v_add_f32 v251, v251, v94
buffer_load_dwordx4 v247, s[20:23], s38 offen offset:1024 lds
v_cvt_pk_bf16_f32 v110, v92, v93
v_mfma_f32_32x32x16_bf16 a[16:31], a[180:183], v[100:103], a[16:31]
v_add_f32 v251, v251, v95
v_cvt_pk_bf16_f32 v111, v94, v95
s_add_u32 s38, s38, 8192
v_max3_f32 v144, v64, v65, v66
v_mfma_f32_32x32x16_bf16 a[32:47], a[184:187], v[100:103], a[32:47]
v_max3_f32 v144, v144, v67, v68
v_max3_f32 v144, v144, v69, v70
v_max3_f32 v144, v144, v71, v72
v_max3_f32 v144, v144, v73, v74
v_mfma_f32_32x32x16_bf16 a[48:63], a[188:191], v[100:103], a[48:63]
v_max3_f32 v144, v144, v75, v76
v_max3_f32 v144, v144, v77, v78
v_max_f32 v144, v144, v79
v_cmp_lt_f32 vcc, s44, v144
s_mov_b32 s46, 14
s_cbranch_vccnz k1_fix0
k1_r14:
s_waitcnt vmcnt(10)
s_barrier
v_mfma_f32_32x32x16_bf16 v[80:95], a[128:131], v[32:35], v[128:143]
v_exp_f32 v64, v64
v_exp_f32 v65, v65
v_add_f32 v250, v250, v64
ds_read_b128 a[128:131], v228 offset:0
v_mfma_f32_32x32x16_bf16 v[80:95], a[132:135], v[36:39], v[80:95]
v_exp_f32 v66, v66
v_add_f32 v250, v250, v65
s_add_u32 m0, s33, 57344
ds_read_b128 a[132:135], v229 offset:0
v_mfma_f32_32x32x16_bf16 v[80:95], a[136:139], v[40:43], v[80:95]
v_cvt_pk_bf16_f32 v96, v64, v65
v_exp_f32 v67, v67
v_add_f32 v250, v250, v66
ds_read_b128 a[136:139], v230 offset:0
v_mfma_f32_32x32x16_bf16 v[80:95], a[140:143], v[44:47], v[80:95]
v_exp_f32 v68, v68
v_add_f32 v250, v250, v67
buffer_load_dwordx4 v246, s[20:23], s38 offen offset:0 lds
ds_read_b128 a[140:143], v231 offset:0
v_mfma_f32_32x32x16_bf16 v[80:95], a[144:147], v[48:51], v[80:95]
v_cvt_pk_bf16_f32 v97, v66, v67
v_exp_f32 v69, v69
v_add_f32 v250, v250, v68
ds_read_b128 a[144:147], v232 offset:0
v_mfma_f32_32x32x16_bf16 v[80:95], a[148:151], v[52:55], v[80:95]
v_exp_f32 v70, v70
v_add_f32 v250, v250, v69
buffer_load_dwordx4 v247, s[20:23], s38 offen offset:1024 lds
ds_read_b128 a[148:151], v233 offset:0
v_mfma_f32_32x32x16_bf16 v[80:95], a[152:155], v[56:59], v[80:95]
v_exp_f32 v71, v71
v_add_f32 v250, v250, v70
v_cvt_pk_bf16_f32 v98, v68, v69
ds_read_b128 a[152:155], v234 offset:0
v_mfma_f32_32x32x16_bf16 v[80:95], a[156:159], v[60:63], v[80:95]
v_add_f32 v250, v250, v71
v_cvt_pk_bf16_f32 v99, v70, v71
s_add_u32 s38, s38, 8192
ds_read_b128 a[156:159], v235 offset:0
v_mfma_f32_32x32x16_bf16 a[64:79], a[160:163], v[104:107], a[64:79]
v_exp_f32 v72, v72
v_exp_f32 v73, v73
v_add_f32 v250, v250, v72
v_mfma_f32_32x32x16_bf16 a[80:95], a[164:167], v[104:107], a[80:95]
v_exp_f32 v74, v74
v_add_f32 v250, v250, v73
v_cvt_pk_bf16_f32 v100, v72, v73
v_exp_f32 v75, v75
v_mfma_f32_32x32x16_bf16 a[96:111], a[168:171], v[104:107], a[96:111]
v_add_f32 v250, v250, v74
v_exp_f32 v76, v76
v_add_f32 v250, v250, v75
v_cvt_pk_bf16_f32 v101, v74, v75
v_mfma_f32_32x32x16_bf16 a[112:127], a[172:175], v[104:107], a[112:127]
v_exp_f32 v77, v77
v_add_f32 v250, v250, v76
v_exp_f32 v78, v78
v_add_f32 v250, v250, v77
v_mfma_f32_32x32x16_bf16 a[64:79], a[176:179], v[108:111], a[64:79]
v_exp_f32 v79, v79
v_add_f32 v250, v250, v78
v_cvt_pk_bf16_f32 v102, v76, v77
ds_read_b64_tr_b16 a[160:161], v236 offset:8192
ds_read_b64_tr_b16 a[162:163], v236 offset:10240
v_mfma_f32_32x32x16_bf16 a[80:95], a[180:183], v[108:111], a[80:95]
v_add_f32 v250, v250, v79
v_cvt_pk_bf16_f32 v103, v78, v79
v_max3_f32 v144, v80, v81, v82
v_max3_f32 v144, v144, v83, v84
ds_read_b64_tr_b16 a[164:165], v237 offset:8192
ds_read_b64_tr_b16 a[166:167], v237 offset:10240
v_mfma_f32_32x32x16_bf16 a[96:111], a[184:187], v[108:111], a[96:111]
v_max3_f32 v144, v144, v85, v86
v_max3_f32 v144, v144, v87, v88
v_max3_f32 v144, v144, v89, v90
v_max3_f32 v144, v144, v91, v92
ds_read_b64_tr_b16 a[168:169], v238 offset:8192
ds_read_b64_tr_b16 a[170:171], v238 offset:10240
v_mfma_f32_32x32x16_bf16 a[112:127], a[188:191], v[108:111], a[112:127]
v_max3_f32 v144, v144, v93, v94
v_max_f32 v144, v144, v95
v_cmp_lt_f32 vcc, s44, v144
s_mov_b32 s46, 15
ds_read_b64_tr_b16 a[172:173], v239 offset:8192
ds_read_b64_tr_b16 a[174:175], v239 offset:10240
s_cbranch_vccnz k1_fix1
k1_r15:
s_waitcnt lgkmcnt(8)
v_mfma_f32_32x32x16_bf16 v[64:79], a[128:131], v[0:3], v[112:127]
v_exp_f32 v80, v80
ds_read_b64_tr_b16 a[176:177], v236 offset:12288
v_exp_f32 v81, v81
v_mfma_f32_32x32x16_bf16 v[64:79], a[132:135], v[4:7], v[64:79]
ds_read_b64_tr_b16 a[178:179], v236 offset:14336
v_add_f32 v251, v251, v80
v_exp_f32 v82, v82
ds_read_b64_tr_b16 a[180:181], v237 offset:12288
v_mfma_f32_32x32x16_bf16 v[64:79], a[136:139], v[8:11], v[64:79]
v_add_f32 v251, v251, v81
ds_read_b64_tr_b16 a[182:183], v237 offset:14336
v_cvt_pk_bf16_f32 v104, v80, v81
v_mfma_f32_32x32x16_bf16 v[64:79], a[140:143], v[12:15], v[64:79]
v_exp_f32 v83, v83
ds_read_b64_tr_b16 a[184:185], v238 offset:12288
v_add_f32 v251, v251, v82
ds_read_b64_tr_b16 a[186:187], v238 offset:14336
v_mfma_f32_32x32x16_bf16 v[64:79], a[144:147], v[16:19], v[64:79]
v_exp_f32 v84, v84
v_add_f32 v251, v251, v83
ds_read_b64_tr_b16 a[188:189], v239 offset:12288
v_mfma_f32_32x32x16_bf16 v[64:79], a[148:151], v[20:23], v[64:79]
v_cvt_pk_bf16_f32 v105, v82, v83
ds_read_b64_tr_b16 a[190:191], v239 offset:14336
v_exp_f32 v85, v85
v_add_f32 v251, v251, v84
v_mfma_f32_32x32x16_bf16 v[64:79], a[152:155], v[24:27], v[64:79]
v_exp_f32 v86, v86
v_add_f32 v251, v251, v85
v_exp_f32 v87, v87
v_mfma_f32_32x32x16_bf16 v[64:79], a[156:159], v[28:31], v[64:79]
v_add_f32 v251, v251, v86
v_cvt_pk_bf16_f32 v106, v84, v85
v_add_f32 v251, v251, v87
v_cvt_pk_bf16_f32 v107, v86, v87
s_waitcnt lgkmcnt(0)
v_mfma_f32_32x32x16_bf16 a[0:15], a[160:163], v[96:99], a[0:15]
v_exp_f32 v88, v88
v_exp_f32 v89, v89
v_add_f32 v251, v251, v88
v_mfma_f32_32x32x16_bf16 a[16:31], a[164:167], v[96:99], a[16:31]
v_exp_f32 v90, v90
v_add_f32 v251, v251, v89
v_cvt_pk_bf16_f32 v108, v88, v89
v_exp_f32 v91, v91
v_mfma_f32_32x32x16_bf16 a[32:47], a[168:171], v[96:99], a[32:47]
v_add_f32 v251, v251, v90
v_exp_f32 v92, v92
v_add_f32 v251, v251, v91
v_cvt_pk_bf16_f32 v109, v90, v91
v_mfma_f32_32x32x16_bf16 a[48:63], a[172:175], v[96:99], a[48:63]
v_exp_f32 v93, v93
v_add_f32 v251, v251, v92
v_exp_f32 v94, v94
v_add_f32 v251, v251, v93
v_mfma_f32_32x32x16_bf16 a[0:15], a[176:179], v[100:103], a[0:15]
v_exp_f32 v95, v95
v_add_f32 v251, v251, v94
v_cvt_pk_bf16_f32 v110, v92, v93
v_mfma_f32_32x32x16_bf16 a[16:31], a[180:183], v[100:103], a[16:31]
v_add_f32 v251, v251, v95
v_cvt_pk_bf16_f32 v111, v94, v95
v_max3_f32 v144, v64, v65, v66
v_max3_f32 v144, v144, v67, v68
v_mfma_f32_32x32x16_bf16 a[32:47], a[184:187], v[100:103], a[32:47]
v_max3_f32 v144, v144, v69, v70
v_max3_f32 v144, v144, v71, v72
v_max3_f32 v144, v144, v73, v74
v_max3_f32 v144, v144, v75, v76
v_mfma_f32_32x32x16_bf16 a[48:63], a[188:191], v[100:103], a[48:63]
v_max3_f32 v144, v144, v77, v78
v_max_f32 v144, v144, v79
v_cmp_lt_f32 vcc, s44, v144
s_mov_b32 s46, 16
s_cbranch_vccnz k1_fix0
k1_r16:
s_waitcnt vmcnt(7)
s_barrier
v_mfma_f32_32x32x16_bf16 v[80:95], a[128:131], v[32:35], v[128:143]
v_exp_f32 v64, v64
v_exp_f32 v65, v65
ds_read_b128 a[128:131], v228 offset:16384
v_mfma_f32_32x32x16_bf16 v[80:95], a[132:135], v[36:39], v[80:95]
v_add_f32 v250, v250, v64
v_exp_f32 v66, v66
v_add_f32 v250, v250, v65
ds_read_b128 a[132:135], v229 offset:16384
v_mfma_f32_32x32x16_bf16 v[80:95], a[136:139], v[40:43], v[80:95]
v_cvt_pk_bf16_f32 v96, v64, v65
v_exp_f32 v67, v67
ds_read_b128 a[136:139], v230 offset:16384
v_mfma_f32_32x32x16_bf16 v[80:95], a[140:143], v[44:47], v[80:95]
v_add_f32 v250, v250, v66
v_exp_f32 v68, v68
v_add_f32 v250, v250, v67
ds_read_b128 a[140:143], v231 offset:16384
v_mfma_f32_32x32x16_bf16 v[80:95], a[144:147], v[48:51], v[80:95]
v_cvt_pk_bf16_f32 v97, v66, v67
v_exp_f32 v69, v69
v_add_f32 v250, v250, v68
ds_read_b128 a[144:147], v232 offset:16384
v_mfma_f32_32x32x16_bf16 v[80:95], a[148:151], v[52:55], v[80:95]
v_exp_f32 v70, v70
v_add_f32 v250, v250, v69
ds_read_b128 a[148:151], v233 offset:16384
v_mfma_f32_32x32x16_bf16 v[80:95], a[152:155], v[56:59], v[80:95]
v_exp_f32 v71, v71
v_add_f32 v250, v250, v70
v_cvt_pk_bf16_f32 v98, v68, v69
ds_read_b128 a[152:155], v234 offset:16384
v_mfma_f32_32x32x16_bf16 v[80:95], a[156:159], v[60:63], v[80:95]
v_add_f32 v250, v250, v71
v_cvt_pk_bf16_f32 v99, v70, v71
buffer_load_dword a224, v255, s[84:87], 0 offen
ds_read_b128 a[156:159], v235 offset:16384
v_mfma_f32_32x32x16_bf16 a[64:79], a[160:163], v[104:107], a[64:79]
v_exp_f32 v72, v72
v_exp_f32 v73, v73
v_add_f32 v250, v250, v72
v_mfma_f32_32x32x16_bf16 a[80:95], a[164:167], v[104:107], a[80:95]
v_exp_f32 v74, v74
v_add_f32 v250, v250, v73
v_cvt_pk_bf16_f32 v100, v72, v73
v_exp_f32 v75, v75
v_mfma_f32_32x32x16_bf16 a[96:111], a[168:171], v[104:107], a[96:111]
v_add_f32 v250, v250, v74
v_exp_f32 v76, v76
v_add_f32 v250, v250, v75
v_cvt_pk_bf16_f32 v101, v74, v75
v_mfma_f32_32x32x16_bf16 a[112:127], a[172:175], v[104:107], a[112:127]
v_exp_f32 v77, v77
v_add_f32 v250, v250, v76
v_exp_f32 v78, v78
v_add_f32 v250, v250, v77
v_mfma_f32_32x32x16_bf16 a[64:79], a[176:179], v[108:111], a[64:79]
v_exp_f32 v79, v79
v_add_f32 v250, v250, v78
v_cvt_pk_bf16_f32 v102, v76, v77
ds_read_b64_tr_b16 a[160:161], v236 offset:24576
ds_read_b64_tr_b16 a[162:163], v236 offset:26624
v_mfma_f32_32x32x16_bf16 a[80:95], a[180:183], v[108:111], a[80:95]
v_add_f32 v250, v250, v79
v_cvt_pk_bf16_f32 v103, v78, v79
v_max3_f32 v144, v80, v81, v82
v_max3_f32 v144, v144, v83, v84
ds_read_b64_tr_b16 a[164:165], v237 offset:24576
ds_read_b64_tr_b16 a[166:167], v237 offset:26624
v_mfma_f32_32x32x16_bf16 a[96:111], a[184:187], v[108:111], a[96:111]
v_max3_f32 v144, v144, v85, v86
v_max3_f32 v144, v144, v87, v88
v_max3_f32 v144, v144, v89, v90
v_max3_f32 v144, v144, v91, v92
ds_read_b64_tr_b16 a[168:169], v238 offset:24576
ds_read_b64_tr_b16 a[170:171], v238 offset:26624
v_mfma_f32_32x32x16_bf16 a[112:127], a[188:191], v[108:111], a[112:127]
v_max3_f32 v144, v144, v93, v94
v_max_f32 v144, v144, v95
v_cmp_lt_f32 vcc, s44, v144
s_mov_b32 s46, 17
ds_read_b64_tr_b16 a[172:173], v239 offset:24576
ds_read_b64_tr_b16 a[174:175], v239 offset:26624
s_cbranch_vccnz k1_fix1
k1_r17:
s_waitcnt lgkmcnt(8)
v_mfma_f32_32x32x16_bf16 v[64:79], a[128:131], v[0:3], v[112:127]
v_exp_f32 v80, v80
ds_read_b64_tr_b16 a[176:177], v236 offset:28672
v_exp_f32 v81, v81
v_mfma_f32_32x32x16_bf16 v[64:79], a[132:135], v[4:7], v[64:79]
ds_read_b64_tr_b16 a[178:179], v236 offset:30720
v_add_f32 v251, v251, v80
v_exp_f32 v82, v82
ds_read_b64_tr_b16 a[180:181], v237 offset:28672
v_mfma_f32_32x32x16_bf16 v[64:79], a[136:139], v[8:11], v[64:79]
v_add_f32 v251, v251, v81
ds_read_b64_tr_b16 a[182:183], v237 offset:30720
v_cvt_pk_bf16_f32 v104, v80, v81
v_mfma_f32_32x32x16_bf16 v[64:79], a[140:143], v[12:15], v[64:79]
v_exp_f32 v83, v83
ds_read_b64_tr_b16 a[184:185], v238 offset:28672
v_add_f32 v251, v251, v82
ds_read_b64_tr_b16 a[186:187], v238 offset:30720
v_mfma_f32_32x32x16_bf16 v[64:79], a[144:147], v[16:19], v[64:79]
v_exp_f32 v84, v84
v_add_f32 v251, v251, v83
ds_read_b64_tr_b16 a[188:189], v239 offset:28672
v_mfma_f32_32x32x16_bf16 v[64:79], a[148:151], v[20:23], v[64:79]
v_cvt_pk_bf16_f32 v105, v82, v83
ds_read_b64_tr_b16 a[190:191], v239 offset:30720
v_exp_f32 v85, v85
v_add_f32 v251, v251, v84
v_mfma_f32_32x32x16_bf16 v[64:79], a[152:155], v[24:27], v[64:79]
v_exp_f32 v86, v86
v_add_f32 v251, v251, v85
v_exp_f32 v87, v87
v_mfma_f32_32x32x16_bf16 v[64:79], a[156:159], v[28:31], v[64:79]
v_add_f32 v251, v251, v86
v_cvt_pk_bf16_f32 v106, v84, v85
v_add_f32 v251, v251, v87
v_cvt_pk_bf16_f32 v107, v86, v87
s_waitcnt lgkmcnt(0)
v_mfma_f32_32x32x16_bf16 a[0:15], a[160:163], v[96:99], a[0:15]
v_exp_f32 v88, v88
v_exp_f32 v89, v89
v_add_f32 v251, v251, v88
v_mfma_f32_32x32x16_bf16 a[16:31], a[164:167], v[96:99], a[16:31]
v_exp_f32 v90, v90
v_add_f32 v251, v251, v89
v_cvt_pk_bf16_f32 v108, v88, v89
v_exp_f32 v91, v91
v_mfma_f32_32x32x16_bf16 a[32:47], a[168:171], v[96:99], a[32:47]
v_add_f32 v251, v251, v90
v_exp_f32 v92, v92
v_add_f32 v251, v251, v91
v_cvt_pk_bf16_f32 v109, v90, v91
v_mfma_f32_32x32x16_bf16 a[48:63], a[172:175], v[96:99], a[48:63]
v_exp_f32 v93, v93
v_add_f32 v251, v251, v92
v_exp_f32 v94, v94
v_add_f32 v251, v251, v93
v_mfma_f32_32x32x16_bf16 a[0:15], a[176:179], v[100:103], a[0:15]
v_exp_f32 v95, v95
v_add_f32 v251, v251, v94
v_cvt_pk_bf16_f32 v110, v92, v93
v_mfma_f32_32x32x16_bf16 a[16:31], a[180:183], v[100:103], a[16:31]
v_add_f32 v251, v251, v95
v_cvt_pk_bf16_f32 v111, v94, v95
v_max3_f32 v144, v64, v65, v66
v_max3_f32 v144, v144, v67, v68
v_mfma_f32_32x32x16_bf16 a[32:47], a[184:187], v[100:103], a[32:47]
v_max3_f32 v144, v144, v69, v70
v_max3_f32 v144, v144, v71, v72
v_max3_f32 v144, v144, v73, v74
v_max3_f32 v144, v144, v75, v76
v_mfma_f32_32x32x16_bf16 a[48:63], a[188:191], v[100:103], a[48:63]
v_max3_f32 v144, v144, v77, v78
v_max_f32 v144, v144, v79
v_cmp_lt_f32 vcc, s44, v144
s_mov_b32 s46, 18
s_cbranch_vccnz k1_fix0
k1_r18:
s_waitcnt vmcnt(3)
s_barrier
v_mfma_f32_32x32x16_bf16 v[80:95], a[128:131], v[32:35], v[128:143]
v_exp_f32 v64, v64
v_exp_f32 v65, v65
ds_read_b128 a[128:131], v228 offset:32768
v_mfma_f32_32x32x16_bf16 v[80:95], a[132:135], v[36:39], v[80:95]
v_add_f32 v250, v250, v64
v_exp_f32 v66, v66
v_add_f32 v250, v250, v65
ds_read_b128 a[132:135], v229 offset:32768
v_mfma_f32_32x32x16_bf16 v[80:95], a[136:139], v[40:43], v[80:95]
v_cvt_pk_bf16_f32 v96, v64, v65
v_exp_f32 v67, v67
ds_read_b128 a[136:139], v230 offset:32768
v_mfma_f32_32x32x16_bf16 v[80:95], a[140:143], v[44:47], v[80:95]
v_add_f32 v250, v250, v66
v_exp_f32 v68, v68
v_add_f32 v250, v250, v67
ds_read_b128 a[140:143], v231 offset:32768
v_mfma_f32_32x32x16_bf16 v[80:95], a[144:147], v[48:51], v[80:95]
v_cvt_pk_bf16_f32 v97, v66, v67
v_exp_f32 v69, v69
ds_read_b128 a[144:147], v232 offset:32768
v_mfma_f32_32x32x16_bf16 v[80:95], a[148:151], v[52:55], v[80:95]
v_add_f32 v250, v250, v68
v_exp_f32 v70, v70
v_add_f32 v250, v250, v69
ds_read_b128 a[148:151], v233 offset:32768
v_mfma_f32_32x32x16_bf16 v[80:95], a[152:155], v[56:59], v[80:95]
v_exp_f32 v71, v71
v_add_f32 v250, v250, v70
ds_read_b128 a[152:155], v234 offset:32768
v_mfma_f32_32x32x16_bf16 v[80:95], a[156:159], v[60:63], v[80:95]
v_cvt_pk_bf16_f32 v98, v68, v69
v_add_f32 v250, v250, v71
v_cvt_pk_bf16_f32 v99, v70, v71
ds_read_b128 a[156:159], v235 offset:32768
v_mfma_f32_32x32x16_bf16 a[64:79], a[160:163], v[104:107], a[64:79]
v_exp_f32 v72, v72
v_exp_f32 v73, v73
v_add_f32 v250, v250, v72
v_mfma_f32_32x32x16_bf16 a[80:95], a[164:167], v[104:107], a[80:95]
v_exp_f32 v74, v74
v_add_f32 v250, v250, v73
v_cvt_pk_bf16_f32 v100, v72, v73
v_exp_f32 v75, v75
v_mfma_f32_32x32x16_bf16 a[96:111], a[168:171], v[104:107], a[96:111]
v_add_f32 v250, v250, v74
v_exp_f32 v76, v76
v_add_f32 v250, v250, v75
v_cvt_pk_bf16_f32 v101, v74, v75
v_mfma_f32_32x32x16_bf16 a[112:127], a[172:175], v[104:107], a[112:127]
v_exp_f32 v77, v77
v_add_f32 v250, v250, v76
v_exp_f32 v78, v78
v_add_f32 v250, v250, v77
v_mfma_f32_32x32x16_bf16 a[64:79], a[176:179], v[108:111], a[64:79]
v_exp_f32 v79, v79
v_add_f32 v250, v250, v78
v_cvt_pk_bf16_f32 v102, v76, v77
ds_read_b64_tr_b16 a[160:161], v236 offset:40960
ds_read_b64_tr_b16 a[162:163], v236 offset:43008
v_mfma_f32_32x32x16_bf16 a[80:95], a[180:183], v[108:111], a[80:95]
v_add_f32 v250, v250, v79
v_cvt_pk_bf16_f32 v103, v78, v79
v_max3_f32 v144, v80, v81, v82
v_max3_f32 v144, v144, v83, v84
ds_read_b64_tr_b16 a[164:165], v237 offset:40960
ds_read_b64_tr_b16 a[166:167], v237 offset:43008
v_mfma_f32_32x32x16_bf16 a[96:111], a[184:187], v[108:111], a[96:111]
v_max3_f32 v144, v144, v85, v86
v_max3_f32 v144, v144, v87, v88
v_max3_f32 v144, v144, v89, v90
v_max3_f32 v144, v144, v91, v92
ds_read_b64_tr_b16 a[168:169], v238 offset:40960
ds_read_b64_tr_b16 a[170:171], v238 offset:43008
v_mfma_f32_32x32x16_bf16 a[112:127], a[188:191], v[108:111], a[112:127]
v_max3_f32 v144, v144, v93, v94
v_max_f32 v144, v144, v95
v_cmp_lt_f32 vcc, s44, v144
s_mov_b32 s46, 19
ds_read_b64_tr_b16 a[172:173], v239 offset:40960
ds_read_b64_tr_b16 a[174:175], v239 offset:43008
s_cbranch_vccnz k1_fix1
k1_r19:
s_waitcnt lgkmcnt(8)
v_mfma_f32_32x32x16_bf16 v[64:79], a[128:131], v[0:3], v[112:127]
v_exp_f32 v80, v80
ds_read_b64_tr_b16 a[176:177], v236 offset:45056
v_exp_f32 v81, v81
v_mfma_f32_32x32x16_bf16 v[64:79], a[132:135], v[4:7], v[64:79]
ds_read_b64_tr_b16 a[178:179], v236 offset:47104
v_add_f32 v251, v251, v80
v_exp_f32 v82, v82
ds_read_b64_tr_b16 a[180:181], v237 offset:45056
v_mfma_f32_32x32x16_bf16 v[64:79], a[136:139], v[8:11], v[64:79]
v_add_f32 v251, v251, v81
ds_read_b64_tr_b16 a[182:183], v237 offset:47104
v_cvt_pk_bf16_f32 v104, v80, v81
v_mfma_f32_32x32x16_bf16 v[64:79], a[140:143], v[12:15], v[64:79]
v_exp_f32 v83, v83
ds_read_b64_tr_b16 a[184:185], v238 offset:45056
v_add_f32 v251, v251, v82
ds_read_b64_tr_b16 a[186:187], v238 offset:47104
v_mfma_f32_32x32x16_bf16 v[64:79], a[144:147], v[16:19], v[64:79]
v_exp_f32 v84, v84
v_add_f32 v251, v251, v83
ds_read_b64_tr_b16 a[188:189], v239 offset:45056
v_mfma_f32_32x32x16_bf16 v[64:79], a[148:151], v[20:23], v[64:79]
v_cvt_pk_bf16_f32 v105, v82, v83
ds_read_b64_tr_b16 a[190:191], v239 offset:47104
v_exp_f32 v85, v85
v_add_f32 v251, v251, v84
v_mfma_f32_32x32x16_bf16 v[64:79], a[152:155], v[24:27], v[64:79]
v_exp_f32 v86, v86
v_add_f32 v251, v251, v85
v_exp_f32 v87, v87
v_mfma_f32_32x32x16_bf16 v[64:79], a[156:159], v[28:31], v[64:79]
v_add_f32 v251, v251, v86
v_cvt_pk_bf16_f32 v106, v84, v85
v_add_f32 v251, v251, v87
v_cvt_pk_bf16_f32 v107, v86, v87
s_waitcnt lgkmcnt(0)
v_mfma_f32_32x32x16_bf16 a[0:15], a[160:163], v[96:99], a[0:15]
v_exp_f32 v88, v88
v_exp_f32 v89, v89
v_add_f32 v251, v251, v88
v_mfma_f32_32x32x16_bf16 a[16:31], a[164:167], v[96:99], a[16:31]
v_exp_f32 v90, v90
v_add_f32 v251, v251, v89
v_cvt_pk_bf16_f32 v108, v88, v89
v_exp_f32 v91, v91
v_mfma_f32_32x32x16_bf16 a[32:47], a[168:171], v[96:99], a[32:47]
v_add_f32 v251, v251, v90
v_exp_f32 v92, v92
v_add_f32 v251, v251, v91
v_cvt_pk_bf16_f32 v109, v90, v91
v_mfma_f32_32x32x16_bf16 a[48:63], a[172:175], v[96:99], a[48:63]
v_exp_f32 v93, v93
v_add_f32 v251, v251, v92
v_exp_f32 v94, v94
v_add_f32 v251, v251, v93
v_mfma_f32_32x32x16_bf16 a[0:15], a[176:179], v[100:103], a[0:15]
v_exp_f32 v95, v95
v_add_f32 v251, v251, v94
v_cvt_pk_bf16_f32 v110, v92, v93
v_mfma_f32_32x32x16_bf16 a[16:31], a[180:183], v[100:103], a[16:31]
v_add_f32 v251, v251, v95
v_cvt_pk_bf16_f32 v111, v94, v95
v_max3_f32 v144, v64, v65, v66
v_max3_f32 v144, v144, v67, v68
v_mfma_f32_32x32x16_bf16 a[32:47], a[184:187], v[100:103], a[32:47]
v_max3_f32 v144, v144, v69, v70
v_max3_f32 v144, v144, v71, v72
v_max3_f32 v144, v144, v73, v74
v_max3_f32 v144, v144, v75, v76
v_mfma_f32_32x32x16_bf16 a[48:63], a[188:191], v[100:103], a[48:63]
v_max3_f32 v144, v144, v77, v78
v_max_f32 v144, v144, v79
v_cmp_lt_f32 vcc, s44, v144
s_mov_b32 s46, 20
s_cbranch_vccnz k1_fix0
k1_r20:
s_waitcnt vmcnt(1)
s_barrier
v_mfma_f32_32x32x16_bf16 v[80:95], a[128:131], v[32:35], v[128:143]
v_exp_f32 v64, v64
v_exp_f32 v65, v65
v_mfma_f32_32x32x16_bf16 v[80:95], a[132:135], v[36:39], v[80:95]
v_add_f32 v250, v250, v64
v_exp_f32 v66, v66
v_add_f32 v250, v250, v65
v_mfma_f32_32x32x16_bf16 v[80:95], a[136:139], v[40:43], v[80:95]
v_cvt_pk_bf16_f32 v96, v64, v65
v_exp_f32 v67, v67
v_mfma_f32_32x32x16_bf16 v[80:95], a[140:143], v[44:47], v[80:95]
v_add_f32 v250, v250, v66
v_exp_f32 v68, v68
v_add_f32 v250, v250, v67
v_mfma_f32_32x32x16_bf16 v[80:95], a[144:147], v[48:51], v[80:95]
v_cvt_pk_bf16_f32 v97, v66, v67
v_exp_f32 v69, v69
v_mfma_f32_32x32x16_bf16 v[80:95], a[148:151], v[52:55], v[80:95]
v_add_f32 v250, v250, v68
v_exp_f32 v70, v70
v_add_f32 v250, v250, v69
v_mfma_f32_32x32x16_bf16 v[80:95], a[152:155], v[56:59], v[80:95]
v_exp_f32 v71, v71
v_add_f32 v250, v250, v70
v_mfma_f32_32x32x16_bf16 v[80:95], a[156:159], v[60:63], v[80:95]
v_cvt_pk_bf16_f32 v98, v68, v69
v_add_f32 v250, v250, v71
v_cvt_pk_bf16_f32 v99, v70, v71
v_mfma_f32_32x32x16_bf16 a[64:79], a[160:163], v[104:107], a[64:79]
v_exp_f32 v72, v72
v_exp_f32 v73, v73
v_add_f32 v250, v250, v72
v_mfma_f32_32x32x16_bf16 a[80:95], a[164:167], v[104:107], a[80:95]
v_exp_f32 v74, v74
v_add_f32 v250, v250, v73
v_cvt_pk_bf16_f32 v100, v72, v73
v_exp_f32 v75, v75
v_mfma_f32_32x32x16_bf16 a[96:111], a[168:171], v[104:107], a[96:111]
v_add_f32 v250, v250, v74
v_exp_f32 v76, v76
v_add_f32 v250, v250, v75
v_cvt_pk_bf16_f32 v101, v74, v75
v_mfma_f32_32x32x16_bf16 a[112:127], a[172:175], v[104:107], a[112:127]
v_exp_f32 v77, v77
v_add_f32 v250, v250, v76
v_exp_f32 v78, v78
v_add_f32 v250, v250, v77
v_mfma_f32_32x32x16_bf16 a[64:79], a[176:179], v[108:111], a[64:79]
v_exp_f32 v79, v79
v_add_f32 v250, v250, v78
v_cvt_pk_bf16_f32 v102, v76, v77
ds_read_b64_tr_b16 a[160:161], v236 offset:57344
ds_read_b64_tr_b16 a[162:163], v236 offset:59392
v_mfma_f32_32x32x16_bf16 a[80:95], a[180:183], v[108:111], a[80:95]
v_add_f32 v250, v250, v79
v_cvt_pk_bf16_f32 v103, v78, v79
v_max3_f32 v144, v80, v81, v82
v_max3_f32 v144, v144, v83, v84
ds_read_b64_tr_b16 a[164:165], v237 offset:57344
ds_read_b64_tr_b16 a[166:167], v237 offset:59392
v_mfma_f32_32x32x16_bf16 a[96:111], a[184:187], v[108:111], a[96:111]
v_max3_f32 v144, v144, v85, v86
v_max3_f32 v144, v144, v87, v88
v_max3_f32 v144, v144, v89, v90
v_max3_f32 v144, v144, v91, v92
ds_read_b64_tr_b16 a[168:169], v238 offset:57344
ds_read_b64_tr_b16 a[170:171], v238 offset:59392
v_mfma_f32_32x32x16_bf16 a[112:127], a[188:191], v[108:111], a[112:127]
v_max3_f32 v144, v144, v93, v94
v_max_f32 v144, v144, v95
v_cmp_lt_f32 vcc, s44, v144
s_mov_b32 s46, 21
ds_read_b64_tr_b16 a[172:173], v239 offset:57344
ds_read_b64_tr_b16 a[174:175], v239 offset:59392
s_cbranch_vccnz k1_fix1
k1_r21:
s_waitcnt lgkmcnt(8)
v_exp_f32 v80, v80
ds_read_b64_tr_b16 a[176:177], v236 offset:61440
v_exp_f32 v81, v81
ds_read_b64_tr_b16 a[178:179], v236 offset:63488
v_add_f32 v251, v251, v80
v_exp_f32 v82, v82
ds_read_b64_tr_b16 a[180:181], v237 offset:61440
v_add_f32 v251, v251, v81
ds_read_b64_tr_b16 a[182:183], v237 offset:63488
v_cvt_pk_bf16_f32 v104, v80, v81
v_exp_f32 v83, v83
ds_read_b64_tr_b16 a[184:185], v238 offset:61440
v_add_f32 v251, v251, v82
ds_read_b64_tr_b16 a[186:187], v238 offset:63488
v_exp_f32 v84, v84
v_add_f32 v251, v251, v83
ds_read_b64_tr_b16 a[188:189], v239 offset:61440
v_cvt_pk_bf16_f32 v105, v82, v83
ds_read_b64_tr_b16 a[190:191], v239 offset:63488
v_exp_f32 v85, v85
v_add_f32 v251, v251, v84
v_exp_f32 v86, v86
v_add_f32 v251, v251, v85
v_exp_f32 v87, v87
v_add_f32 v251, v251, v86
v_cvt_pk_bf16_f32 v106, v84, v85
v_add_f32 v251, v251, v87
v_cvt_pk_bf16_f32 v107, v86, v87
s_waitcnt lgkmcnt(0)
v_mfma_f32_32x32x16_bf16 a[0:15], a[160:163], v[96:99], a[0:15]
v_exp_f32 v88, v88
v_exp_f32 v89, v89
v_mfma_f32_32x32x16_bf16 a[16:31], a[164:167], v[96:99], a[16:31]
v_add_f32 v251, v251, v88
v_exp_f32 v90, v90
v_add_f32 v251, v251, v89
v_mfma_f32_32x32x16_bf16 a[32:47], a[168:171], v[96:99], a[32:47]
v_cvt_pk_bf16_f32 v108, v88, v89
v_exp_f32 v91, v91
v_mfma_f32_32x32x16_bf16 a[48:63], a[172:175], v[96:99], a[48:63]
v_add_f32 v251, v251, v90
v_exp_f32 v92, v92
v_add_f32 v251, v251, v91
v_mfma_f32_32x32x16_bf16 a[0:15], a[176:179], v[100:103], a[0:15]
v_cvt_pk_bf16_f32 v109, v90, v91
v_exp_f32 v93, v93
v_mfma_f32_32x32x16_bf16 a[16:31], a[180:183], v[100:103], a[16:31]
v_add_f32 v251, v251, v92
v_exp_f32 v94, v94
v_add_f32 v251, v251, v93
v_mfma_f32_32x32x16_bf16 a[32:47], a[184:187], v[100:103], a[32:47]
v_exp_f32 v95, v95
v_add_f32 v251, v251, v94
v_mfma_f32_32x32x16_bf16 a[48:63], a[188:191], v[100:103], a[48:63]
v_cvt_pk_bf16_f32 v110, v92, v93
v_add_f32 v251, v251, v95
v_cvt_pk_bf16_f32 v111, v94, v95
v_mfma_f32_32x32x16_bf16 a[64:79], a[160:163], v[104:107], a[64:79]
v_mfma_f32_32x32x16_bf16 a[80:95], a[164:167], v[104:107], a[80:95]
v_mfma_f32_32x32x16_bf16 a[96:111], a[168:171], v[104:107], a[96:111]
v_mfma_f32_32x32x16_bf16 a[112:127], a[172:175], v[104:107], a[112:127]
v_mfma_f32_32x32x16_bf16 a[64:79], a[176:179], v[108:111], a[64:79]
v_mfma_f32_32x32x16_bf16 a[80:95], a[180:183], v[108:111], a[80:95]
v_mfma_f32_32x32x16_bf16 a[96:111], a[184:187], v[108:111], a[96:111]
v_mfma_f32_32x32x16_bf16 a[112:127], a[188:191], v[108:111], a[112:127]
v_mov_b32 v145, v250
s_nop 1
v_permlane32_swap_b32 v250, v145
v_add_f32 v145, v145, v250
v_rcp_f32 v145, v145
v_accvgpr_read_b32 v64, a0
v_accvgpr_read_b32 v65, a1
v_accvgpr_read_b32 v66, a2
v_accvgpr_read_b32 v67, a3
v_accvgpr_read_b32 v68, a4
v_accvgpr_read_b32 v69, a5
v_accvgpr_read_b32 v70, a6
v_accvgpr_read_b32 v71, a7
v_mul_f32 v64, v64, v145
v_mul_f32 v65, v65, v145
v_mul_f32 v66, v66, v145
v_mul_f32 v67, v67, v145
v_mul_f32 v68, v68, v145
v_mul_f32 v69, v69, v145
v_mul_f32 v70, v70, v145
v_mul_f32 v71, v71, v145
v_cvt_pk_bf16_f32 v80, v64, v65
v_cvt_pk_bf16_f32 v81, v66, v67
v_cvt_pk_bf16_f32 v82, v68, v69
v_cvt_pk_bf16_f32 v83, v70, v71
buffer_store_dwordx4 v[80:83], v252, s[12:15], s35 offen offset:0 sc0 sc1
v_accvgpr_read_b32 v72, a8
v_accvgpr_read_b32 v73, a9
v_accvgpr_read_b32 v74, a10
v_accvgpr_read_b32 v75, a11
v_accvgpr_read_b32 v76, a12
v_accvgpr_read_b32 v77, a13
v_accvgpr_read_b32 v78, a14
v_accvgpr_read_b32 v79, a15
v_mul_f32 v72, v72, v145
v_mul_f32 v73, v73, v145
v_mul_f32 v74, v74, v145
v_mul_f32 v75, v75, v145
v_mul_f32 v76, v76, v145
v_mul_f32 v77, v77, v145
v_mul_f32 v78, v78, v145
v_mul_f32 v79, v79, v145
v_cvt_pk_bf16_f32 v84, v72, v73
v_cvt_pk_bf16_f32 v85, v74, v75
v_cvt_pk_bf16_f32 v86, v76, v77
v_cvt_pk_bf16_f32 v87, v78, v79
buffer_store_dwordx4 v[84:87], v252, s[12:15], s35 offen offset:512 sc0 sc1
v_accvgpr_read_b32 v64, a16
v_accvgpr_read_b32 v65, a17
v_accvgpr_read_b32 v66, a18
v_accvgpr_read_b32 v67, a19
v_accvgpr_read_b32 v68, a20
v_accvgpr_read_b32 v69, a21
v_accvgpr_read_b32 v70, a22
v_accvgpr_read_b32 v71, a23
v_mul_f32 v64, v64, v145
v_mul_f32 v65, v65, v145
v_mul_f32 v66, v66, v145
v_mul_f32 v67, v67, v145
v_mul_f32 v68, v68, v145
v_mul_f32 v69, v69, v145
v_mul_f32 v70, v70, v145
v_mul_f32 v71, v71, v145
v_cvt_pk_bf16_f32 v88, v64, v65
v_cvt_pk_bf16_f32 v89, v66, v67
v_cvt_pk_bf16_f32 v90, v68, v69
v_cvt_pk_bf16_f32 v91, v70, v71
buffer_store_dwordx4 v[88:91], v252, s[12:15], s35 offen offset:1024 sc0 sc1
v_accvgpr_read_b32 v72, a24
v_accvgpr_read_b32 v73, a25
v_accvgpr_read_b32 v74, a26
v_accvgpr_read_b32 v75, a27
v_accvgpr_read_b32 v76, a28
v_accvgpr_read_b32 v77, a29
v_accvgpr_read_b32 v78, a30
v_accvgpr_read_b32 v79, a31
v_mul_f32 v72, v72, v145
v_mul_f32 v73, v73, v145
v_mul_f32 v74, v74, v145
v_mul_f32 v75, v75, v145
v_mul_f32 v76, v76, v145
v_mul_f32 v77, v77, v145
v_mul_f32 v78, v78, v145
v_mul_f32 v79, v79, v145
v_cvt_pk_bf16_f32 v92, v72, v73
v_cvt_pk_bf16_f32 v93, v74, v75
v_cvt_pk_bf16_f32 v94, v76, v77
v_cvt_pk_bf16_f32 v95, v78, v79
buffer_store_dwordx4 v[92:95], v252, s[12:15], s35 offen offset:1536 sc0 sc1
v_accvgpr_read_b32 v64, a32
v_accvgpr_read_b32 v65, a33
v_accvgpr_read_b32 v66, a34
v_accvgpr_read_b32 v67, a35
v_accvgpr_read_b32 v68, a36
v_accvgpr_read_b32 v69, a37
v_accvgpr_read_b32 v70, a38
v_accvgpr_read_b32 v71, a39
v_mul_f32 v64, v64, v145
v_mul_f32 v65, v65, v145
v_mul_f32 v66, v66, v145
v_mul_f32 v67, v67, v145
v_mul_f32 v68, v68, v145
v_mul_f32 v69, v69, v145
v_mul_f32 v70, v70, v145
v_mul_f32 v71, v71, v145
v_cvt_pk_bf16_f32 v80, v64, v65
v_cvt_pk_bf16_f32 v81, v66, v67
v_cvt_pk_bf16_f32 v82, v68, v69
v_cvt_pk_bf16_f32 v83, v70, v71
buffer_store_dwordx4 v[80:83], v252, s[12:15], s35 offen offset:2048 sc0 sc1
v_accvgpr_read_b32 v72, a40
v_accvgpr_read_b32 v73, a41
v_accvgpr_read_b32 v74, a42
v_accvgpr_read_b32 v75, a43
v_accvgpr_read_b32 v76, a44
v_accvgpr_read_b32 v77, a45
v_accvgpr_read_b32 v78, a46
v_accvgpr_read_b32 v79, a47
v_mul_f32 v72, v72, v145
v_mul_f32 v73, v73, v145
v_mul_f32 v74, v74, v145
v_mul_f32 v75, v75, v145
v_mul_f32 v76, v76, v145
v_mul_f32 v77, v77, v145
v_mul_f32 v78, v78, v145
v_mul_f32 v79, v79, v145
v_cvt_pk_bf16_f32 v84, v72, v73
v_cvt_pk_bf16_f32 v85, v74, v75
v_cvt_pk_bf16_f32 v86, v76, v77
v_cvt_pk_bf16_f32 v87, v78, v79
buffer_store_dwordx4 v[84:87], v252, s[12:15], s35 offen offset:2560 sc0 sc1
v_accvgpr_read_b32 v64, a48
v_accvgpr_read_b32 v65, a49
v_accvgpr_read_b32 v66, a50
v_accvgpr_read_b32 v67, a51
v_accvgpr_read_b32 v68, a52
v_accvgpr_read_b32 v69, a53
v_accvgpr_read_b32 v70, a54
v_accvgpr_read_b32 v71, a55
v_mul_f32 v64, v64, v145
v_mul_f32 v65, v65, v145
v_mul_f32 v66, v66, v145
v_mul_f32 v67, v67, v145
v_mul_f32 v68, v68, v145
v_mul_f32 v69, v69, v145
v_mul_f32 v70, v70, v145
v_mul_f32 v71, v71, v145
v_cvt_pk_bf16_f32 v88, v64, v65
v_cvt_pk_bf16_f32 v89, v66, v67
v_cvt_pk_bf16_f32 v90, v68, v69
v_cvt_pk_bf16_f32 v91, v70, v71
buffer_store_dwordx4 v[88:91], v252, s[12:15], s35 offen offset:3072 sc0 sc1
v_accvgpr_read_b32 v72, a56
v_accvgpr_read_b32 v73, a57
v_accvgpr_read_b32 v74, a58
v_accvgpr_read_b32 v75, a59
v_accvgpr_read_b32 v76, a60
v_accvgpr_read_b32 v77, a61
v_accvgpr_read_b32 v78, a62
v_accvgpr_read_b32 v79, a63
v_mul_f32 v72, v72, v145
v_mul_f32 v73, v73, v145
v_mul_f32 v74, v74, v145
v_mul_f32 v75, v75, v145
v_mul_f32 v76, v76, v145
v_mul_f32 v77, v77, v145
v_mul_f32 v78, v78, v145
v_mul_f32 v79, v79, v145
v_cvt_pk_bf16_f32 v92, v72, v73
v_cvt_pk_bf16_f32 v93, v74, v75
v_cvt_pk_bf16_f32 v94, v76, v77
v_cvt_pk_bf16_f32 v95, v78, v79
buffer_store_dwordx4 v[92:95], v252, s[12:15], s35 offen offset:3584 sc0 sc1
s_add_u32 s35, s35, 4096
v_mov_b32 v145, v251
s_nop 1
v_permlane32_swap_b32 v251, v145
v_add_f32 v145, v145, v251
v_rcp_f32 v145, v145
v_accvgpr_read_b32 v64, a64
v_accvgpr_read_b32 v65, a65
v_accvgpr_read_b32 v66, a66
v_accvgpr_read_b32 v67, a67
v_accvgpr_read_b32 v68, a68
v_accvgpr_read_b32 v69, a69
v_accvgpr_read_b32 v70, a70
v_accvgpr_read_b32 v71, a71
v_mul_f32 v64, v64, v145
v_mul_f32 v65, v65, v145
v_mul_f32 v66, v66, v145
v_mul_f32 v67, v67, v145
v_mul_f32 v68, v68, v145
v_mul_f32 v69, v69, v145
v_mul_f32 v70, v70, v145
v_mul_f32 v71, v71, v145
v_cvt_pk_bf16_f32 v80, v64, v65
v_cvt_pk_bf16_f32 v81, v66, v67
v_cvt_pk_bf16_f32 v82, v68, v69
v_cvt_pk_bf16_f32 v83, v70, v71
buffer_store_dwordx4 v[80:83], v252, s[12:15], s35 offen offset:0 sc0 sc1
v_accvgpr_read_b32 v72, a72
v_accvgpr_read_b32 v73, a73
v_accvgpr_read_b32 v74, a74
v_accvgpr_read_b32 v75, a75
v_accvgpr_read_b32 v76, a76
v_accvgpr_read_b32 v77, a77
v_accvgpr_read_b32 v78, a78
v_accvgpr_read_b32 v79, a79
v_mul_f32 v72, v72, v145
v_mul_f32 v73, v73, v145
v_mul_f32 v74, v74, v145
v_mul_f32 v75, v75, v145
v_mul_f32 v76, v76, v145
v_mul_f32 v77, v77, v145
v_mul_f32 v78, v78, v145
v_mul_f32 v79, v79, v145
v_cvt_pk_bf16_f32 v84, v72, v73
v_cvt_pk_bf16_f32 v85, v74, v75
v_cvt_pk_bf16_f32 v86, v76, v77
v_cvt_pk_bf16_f32 v87, v78, v79
buffer_store_dwordx4 v[84:87], v252, s[12:15], s35 offen offset:512 sc0 sc1
v_accvgpr_read_b32 v64, a80
v_accvgpr_read_b32 v65, a81
v_accvgpr_read_b32 v66, a82
v_accvgpr_read_b32 v67, a83
v_accvgpr_read_b32 v68, a84
v_accvgpr_read_b32 v69, a85
v_accvgpr_read_b32 v70, a86
v_accvgpr_read_b32 v71, a87
v_mul_f32 v64, v64, v145
v_mul_f32 v65, v65, v145
v_mul_f32 v66, v66, v145
v_mul_f32 v67, v67, v145
v_mul_f32 v68, v68, v145
v_mul_f32 v69, v69, v145
v_mul_f32 v70, v70, v145
v_mul_f32 v71, v71, v145
v_cvt_pk_bf16_f32 v88, v64, v65
v_cvt_pk_bf16_f32 v89, v66, v67
v_cvt_pk_bf16_f32 v90, v68, v69
v_cvt_pk_bf16_f32 v91, v70, v71
buffer_store_dwordx4 v[88:91], v252, s[12:15], s35 offen offset:1024 sc0 sc1
v_accvgpr_read_b32 v72, a88
v_accvgpr_read_b32 v73, a89
v_accvgpr_read_b32 v74, a90
v_accvgpr_read_b32 v75, a91
v_accvgpr_read_b32 v76, a92
v_accvgpr_read_b32 v77, a93
v_accvgpr_read_b32 v78, a94
v_accvgpr_read_b32 v79, a95
v_mul_f32 v72, v72, v145
v_mul_f32 v73, v73, v145
v_mul_f32 v74, v74, v145
v_mul_f32 v75, v75, v145
v_mul_f32 v76, v76, v145
v_mul_f32 v77, v77, v145
v_mul_f32 v78, v78, v145
v_mul_f32 v79, v79, v145
v_cvt_pk_bf16_f32 v92, v72, v73
v_cvt_pk_bf16_f32 v93, v74, v75
v_cvt_pk_bf16_f32 v94, v76, v77
v_cvt_pk_bf16_f32 v95, v78, v79
buffer_store_dwordx4 v[92:95], v252, s[12:15], s35 offen offset:1536 sc0 sc1
v_accvgpr_read_b32 v64, a96
v_accvgpr_read_b32 v65, a97
v_accvgpr_read_b32 v66, a98
v_accvgpr_read_b32 v67, a99
v_accvgpr_read_b32 v68, a100
v_accvgpr_read_b32 v69, a101
v_accvgpr_read_b32 v70, a102
v_accvgpr_read_b32 v71, a103
v_mul_f32 v64, v64, v145
v_mul_f32 v65, v65, v145
v_mul_f32 v66, v66, v145
v_mul_f32 v67, v67, v145
v_mul_f32 v68, v68, v145
v_mul_f32 v69, v69, v145
v_mul_f32 v70, v70, v145
v_mul_f32 v71, v71, v145
v_cvt_pk_bf16_f32 v80, v64, v65
v_cvt_pk_bf16_f32 v81, v66, v67
v_cvt_pk_bf16_f32 v82, v68, v69
v_cvt_pk_bf16_f32 v83, v70, v71
buffer_store_dwordx4 v[80:83], v252, s[12:15], s35 offen offset:2048 sc0 sc1
v_accvgpr_read_b32 v72, a104
v_accvgpr_read_b32 v73, a105
v_accvgpr_read_b32 v74, a106
v_accvgpr_read_b32 v75, a107
v_accvgpr_read_b32 v76, a108
v_accvgpr_read_b32 v77, a109
v_accvgpr_read_b32 v78, a110
v_accvgpr_read_b32 v79, a111
v_mul_f32 v72, v72, v145
v_mul_f32 v73, v73, v145
v_mul_f32 v74, v74, v145
v_mul_f32 v75, v75, v145
v_mul_f32 v76, v76, v145
v_mul_f32 v77, v77, v145
v_mul_f32 v78, v78, v145
v_mul_f32 v79, v79, v145
v_cvt_pk_bf16_f32 v84, v72, v73
v_cvt_pk_bf16_f32 v85, v74, v75
v_cvt_pk_bf16_f32 v86, v76, v77
v_cvt_pk_bf16_f32 v87, v78, v79
buffer_store_dwordx4 v[84:87], v252, s[12:15], s35 offen offset:2560 sc0 sc1
v_accvgpr_read_b32 v64, a112
v_accvgpr_read_b32 v65, a113
v_accvgpr_read_b32 v66, a114
v_accvgpr_read_b32 v67, a115
v_accvgpr_read_b32 v68, a116
v_accvgpr_read_b32 v69, a117
v_accvgpr_read_b32 v70, a118
v_accvgpr_read_b32 v71, a119
v_mul_f32 v64, v64, v145
v_mul_f32 v65, v65, v145
v_mul_f32 v66, v66, v145
v_mul_f32 v67, v67, v145
v_mul_f32 v68, v68, v145
v_mul_f32 v69, v69, v145
v_mul_f32 v70, v70, v145
v_mul_f32 v71, v71, v145
v_cvt_pk_bf16_f32 v88, v64, v65
v_cvt_pk_bf16_f32 v89, v66, v67
v_cvt_pk_bf16_f32 v90, v68, v69
v_cvt_pk_bf16_f32 v91, v70, v71
buffer_store_dwordx4 v[88:91], v252, s[12:15], s35 offen offset:3072 sc0 sc1
v_accvgpr_read_b32 v72, a120
v_accvgpr_read_b32 v73, a121
v_accvgpr_read_b32 v74, a122
v_accvgpr_read_b32 v75, a123
v_accvgpr_read_b32 v76, a124
v_accvgpr_read_b32 v77, a125
v_accvgpr_read_b32 v78, a126
v_accvgpr_read_b32 v79, a127
v_mul_f32 v72, v72, v145
v_mul_f32 v73, v73, v145
v_mul_f32 v74, v74, v145
v_mul_f32 v75, v75, v145
v_mul_f32 v76, v76, v145
v_mul_f32 v77, v77, v145
v_mul_f32 v78, v78, v145
v_mul_f32 v79, v79, v145
v_cvt_pk_bf16_f32 v92, v72, v73
v_cvt_pk_bf16_f32 v93, v74, v75
v_cvt_pk_bf16_f32 v94, v76, v77
v_cvt_pk_bf16_f32 v95, v78, v79
buffer_store_dwordx4 v[92:95], v252, s[12:15], s35 offen offset:3584 sc0 sc1
s_add_u32 s35, s35, 4096
v_lshrrev_b32 v1, 4, v253
v_mov_b32 v7, v253
v_add_u32 v8, 131072, v7
v_lshrrev_b32 v12, 4, v1
v_and_b32 v13, 15, v1
v_lshrrev_b32 v14, 5, v1
v_lshlrev_b32 v14, 4, v14
v_bfe_u32 v15, v1, 2, 3
v_add_u32 v14, v14, v15
v_mul_u32_u24 v14, 288, v14
v_and_b32 v15, 3, v1
v_lshl_add_u32 v2, v15, 3, v14
v_add_u32 v3, 36864, v2
v_add_u32 v4, 36864, v3
v_add_u32 v5, 36864, v4
v_and_b32 v17, 1, v12
v_lshrrev_b32 v18, 1, v12
v_lshl_add_u32 v14, v17, 1, v18
v_mul_u32_u24 v14, 256, v14
v_mul_u32_u24 v19, 16, v13
v_add_u32 v14, v14, v19
v_add_u32 v15, 18432, v14
v_add_u32 v18, 16, v18
v_mul_u32_u24 v18, 256, v18
v_mul_u32_u24 v17, 18432, v17
v_add3_u32 v16, v17, v18, v19
s_mul_i32 s35, s34, 36864
s_mul_i32 s3, s41, 2359296
s_add_u32 s35, s35, s3
s_mul_i32 s3, s42, 4608
s_add_u32 s35, s35, s3
s_lshl_b32 s36, s34, 4
s_add_u32 s36, s36, s26
s_and_b32 s27, s36, -4
s_mul_i32 s93, s25, 288
s_mul_i32 s3, s24, 294912
s_add_u32 s93, s93, s3
s_add_u32 s93, s93, 4608
v_mov_b32 v216, v192
v_mov_b32 v217, v193
v_mov_b32 v218, v194
v_mov_b32 v219, v195
v_mov_b32 v220, v196
v_mov_b32 v221, v197
v_mov_b32 v222, v198
v_mov_b32 v223, v199
v_mov_b32 v224, v200
s_mul_i32 s3, s42, 294912
s_add_u32 s28, s28, s3
s_lshl_b32 s3, s42, 13
s_add_u32 s29, s29, s3
s_mov_b32 s16, 147456
s_mov_b32 s19, 4096
s_cmp_eq_u32 s42, 3
s_cselect_b32 s16, 4293935104, s16
s_cselect_b32 s19, 4294938624, s19
s_mov_b32 s17, 147456
s_mov_b32 s20, 4096
s_cmp_eq_u32 s42, 2
s_cselect_b32 s17, 4293935104, s17
s_cselect_b32 s20, 4294938624, s20
s_mov_b32 s18, 147456
s_mov_b32 s21, 4096
s_cmp_eq_u32 s42, 1
s_cselect_b32 s18, 4293935104, s18
s_cselect_b32 s21, 4294938624, s21
s_lshl_b32 s3, s36, 7
s_add_u32 s3, s3, 524288
s_lshl_b32 s38, s27, 7
s_add_u32 s38, s38, 524288
v_and_b32 v21, 3, v1
v_lshlrev_b32 v21, 7, v21
v_mov_b32 v9, 0
s_waitcnt vmcnt(0)
buffer_store_dword v9, v9, s[88:91], s3 offen sc0 sc1
s_add_u32 m0, s30, 73728
s_nop 0
buffer_load_dwordx4 v204, s[80:83], s28 offen offset:0 lds
buffer_load_dwordx4 a[36:39], v7, s[8:11], s29 offen offset:0
buffer_load_dwordx4 v205, s[80:83], s28 offen offset:1024 lds
buffer_load_dwordx4 a[40:43], v8, s[8:11], s29 offen offset:0
buffer_load_dwordx4 v206, s[80:83], s28 offen offset:2048 lds
buffer_load_dwordx4 v207, s[80:83], s28 offen offset:3072 lds
buffer_load_dwordx4 a[44:47], v7, s[8:11], s29 offen offset:1024
s_add_u32 m0, s30, 77824
buffer_load_dwordx4 a[48:51], v8, s[8:11], s29 offen offset:1024
buffer_load_dwordx4 v208, s[80:83], s28 offen offset:0 lds
buffer_load_dwordx4 v209, s[80:83], s28 offen offset:1024 lds
buffer_load_dwordx4 a[52:55], v7, s[8:11], s29 offen offset:2048
buffer_load_dwordx4 v210, s[80:83], s28 offen offset:2048 lds
buffer_load_dwordx4 a[56:59], v8, s[8:11], s29 offen offset:2048
buffer_load_dwordx4 v211, s[80:83], s28 offen offset:3072 lds
s_add_u32 m0, s30, 81920
buffer_load_dwordx4 a[60:63], v7, s[8:11], s29 offen offset:3072
buffer_load_dwordx4 v212, s[80:83], s28 offen offset:0 lds
buffer_load_dwordx4 a[64:67], v8, s[8:11], s29 offen offset:3072
s_add_u32 s28, s28, 147456
s_add_u32 s29, s29, 4096
s_add_u32 m0, s30, 110592
s_nop 0
buffer_load_dwordx4 v204, s[80:83], s28 offen offset:0 lds
buffer_load_dwordx4 a[68:71], v7, s[8:11], s29 offen offset:0
buffer_load_dwordx4 v205, s[80:83], s28 offen offset:1024 lds
buffer_load_dwordx4 a[72:75], v8, s[8:11], s29 offen offset:0
buffer_load_dwordx4 v206, s[80:83], s28 offen offset:2048 lds
buffer_load_dwordx4 v207, s[80:83], s28 offen offset:3072 lds
buffer_load_dwordx4 a[76:79], v7, s[8:11], s29 offen offset:1024
s_add_u32 m0, s30, 114688
buffer_load_dwordx4 a[80:83], v8, s[8:11], s29 offen offset:1024
buffer_load_dwordx4 v208, s[80:83], s28 offen offset:0 lds
buffer_load_dwordx4 v209, s[80:83], s28 offen offset:1024 lds
buffer_load_dwordx4 a[84:87], v7, s[8:11], s29 offen offset:2048
buffer_load_dwordx4 v210, s[80:83], s28 offen offset:2048 lds
buffer_load_dwordx4 a[88:91], v8, s[8:11], s29 offen offset:2048
buffer_load_dwordx4 v211, s[80:83], s28 offen offset:3072 lds
s_add_u32 m0, s30, 118784
buffer_load_dwordx4 a[92:95], v7, s[8:11], s29 offen offset:3072
buffer_load_dwordx4 v212, s[80:83], s28 offen offset:0 lds
buffer_load_dwordx4 a[96:99], v8, s[8:11], s29 offen offset:3072
s_add_u32 s28, s28, s16
s_add_u32 s29, s29, s19
s_waitcnt vmcnt(17)
s_barrier
ds_read_b64_tr_b16 a[0:1], v4 offset:0
ds_read_b64_tr_b16 a[2:3], v4 offset:2304
ds_read_b64_tr_b16 a[4:5], v4 offset:32
ds_read_b64_tr_b16 a[6:7], v4 offset:2336
ds_read_b64_tr_b16 a[8:9], v4 offset:64
ds_read_b64_tr_b16 a[10:11], v4 offset:2368
ds_read_b64_tr_b16 a[12:13], v4 offset:96
ds_read_b64_tr_b16 a[14:15], v4 offset:2400
ds_read_b64_tr_b16 a[16:17], v4 offset:128
ds_read_b64_tr_b16 a[18:19], v4 offset:2432
ds_read_b64_tr_b16 a[20:21], v4 offset:160
ds_read_b64_tr_b16 a[22:23], v4 offset:2464
s_waitcnt lgkmcnt(6)
v_mfma_f32_16x16x32_bf16 v[24:27], a[0:3], a[36:39], 0
ds_read_b64_tr_b16 a[24:25], v4 offset:192
v_mfma_f32_16x16x32_bf16 v[28:31], a[0:3], a[40:43], 0
ds_read_b64_tr_b16 a[26:27], v4 offset:2496
v_mfma_f32_16x16x32_bf16 v[32:35], a[4:7], a[36:39], 0
ds_read_b64_tr_b16 a[28:29], v4 offset:224
v_mfma_f32_16x16x32_bf16 v[36:39], a[4:7], a[40:43], 0
ds_read_b64_tr_b16 a[30:31], v4 offset:2528
v_mfma_f32_16x16x32_bf16 v[40:43], a[8:11], a[36:39], 0
ds_read_b64_tr_b16 a[32:33], v4 offset:256
v_mfma_f32_16x16x32_bf16 v[44:47], a[8:11], a[40:43], 0
ds_read_b64_tr_b16 a[34:35], v4 offset:2560
s_add_u32 m0, s30, 0
s_waitcnt lgkmcnt(6)
v_mfma_f32_16x16x32_bf16 v[48:51], a[12:15], a[36:39], 0
ds_read_b64_tr_b16 a[0:1], v4 offset:9216
v_mfma_f32_16x16x32_bf16 v[52:55], a[12:15], a[40:43], 0
ds_read_b64_tr_b16 a[2:3], v4 offset:11520
v_mfma_f32_16x16x32_bf16 v[56:59], a[16:19], a[36:39], 0
ds_read_b64_tr_b16 a[4:5], v4 offset:9248
v_mfma_f32_16x16x32_bf16 v[60:63], a[16:19], a[40:43], 0
ds_read_b64_tr_b16 a[6:7], v4 offset:11552
v_mfma_f32_16x16x32_bf16 v[64:67], a[20:23], a[36:39], 0
ds_read_b64_tr_b16 a[8:9], v4 offset:9280
v_mfma_f32_16x16x32_bf16 v[68:71], a[20:23], a[40:43], 0
ds_read_b64_tr_b16 a[10:11], v4 offset:11584
buffer_load_dwordx4 v204, s[80:83], s28 offen offset:0 lds
s_waitcnt lgkmcnt(6)
v_mfma_f32_16x16x32_bf16 v[72:75], a[24:27], a[36:39], 0
ds_read_b64_tr_b16 a[12:13], v4 offset:9312
v_mfma_f32_16x16x32_bf16 v[76:79], a[24:27], a[40:43], 0
ds_read_b64_tr_b16 a[14:15], v4 offset:11616
v_mfma_f32_16x16x32_bf16 v[80:83], a[28:31], a[36:39], 0
ds_read_b64_tr_b16 a[16:17], v4 offset:9344
v_mfma_f32_16x16x32_bf16 v[84:87], a[28:31], a[40:43], 0
ds_read_b64_tr_b16 a[18:19], v4 offset:11648
v_mfma_f32_16x16x32_bf16 v[88:91], a[32:35], a[36:39], 0
ds_read_b64_tr_b16 a[20:21], v4 offset:9376
buffer_load_dwordx4 v205, s[80:83], s28 offen offset:1024 lds
v_mfma_f32_16x16x32_bf16 v[92:95], a[32:35], a[40:43], 0
ds_read_b64_tr_b16 a[22:23], v4 offset:11680
s_waitcnt lgkmcnt(6)
v_mfma_f32_16x16x32_bf16 v[24:27], a[0:3], a[44:47], v[24:27]
ds_read_b64_tr_b16 a[24:25], v4 offset:9408
v_mfma_f32_16x16x32_bf16 v[28:31], a[0:3], a[48:51], v[28:31]
ds_read_b64_tr_b16 a[26:27], v4 offset:11712
v_mfma_f32_16x16x32_bf16 v[32:35], a[4:7], a[44:47], v[32:35]
ds_read_b64_tr_b16 a[28:29], v4 offset:9440
v_mfma_f32_16x16x32_bf16 v[36:39], a[4:7], a[48:51], v[36:39]
ds_read_b64_tr_b16 a[30:31], v4 offset:11744
v_mfma_f32_16x16x32_bf16 v[40:43], a[8:11], a[44:47], v[40:43]
ds_read_b64_tr_b16 a[32:33], v4 offset:9472
buffer_load_dwordx4 v206, s[80:83], s28 offen offset:2048 lds
v_mfma_f32_16x16x32_bf16 v[44:47], a[8:11], a[48:51], v[44:47]
ds_read_b64_tr_b16 a[34:35], v4 offset:11776
s_waitcnt lgkmcnt(6)
v_mfma_f32_16x16x32_bf16 v[48:51], a[12:15], a[44:47], v[48:51]
ds_read_b64_tr_b16 a[0:1], v4 offset:18432
v_mfma_f32_16x16x32_bf16 v[52:55], a[12:15], a[48:51], v[52:55]
ds_read_b64_tr_b16 a[2:3], v4 offset:20736
v_mfma_f32_16x16x32_bf16 v[56:59], a[16:19], a[44:47], v[56:59]
ds_read_b64_tr_b16 a[4:5], v4 offset:18464
v_mfma_f32_16x16x32_bf16 v[60:63], a[16:19], a[48:51], v[60:63]
ds_read_b64_tr_b16 a[6:7], v4 offset:20768
buffer_load_dwordx4 v207, s[80:83], s28 offen offset:3072 lds
v_mfma_f32_16x16x32_bf16 v[64:67], a[20:23], a[44:47], v[64:67]
ds_read_b64_tr_b16 a[8:9], v4 offset:18496
v_mfma_f32_16x16x32_bf16 v[68:71], a[20:23], a[48:51], v[68:71]
ds_read_b64_tr_b16 a[10:11], v4 offset:20800
s_waitcnt lgkmcnt(6)
v_mfma_f32_16x16x32_bf16 v[72:75], a[24:27], a[44:47], v[72:75]
ds_read_b64_tr_b16 a[12:13], v4 offset:18528
v_mfma_f32_16x16x32_bf16 v[76:79], a[24:27], a[48:51], v[76:79]
ds_read_b64_tr_b16 a[14:15], v4 offset:20832
v_mfma_f32_16x16x32_bf16 v[80:83], a[28:31], a[44:47], v[80:83]
ds_read_b64_tr_b16 a[16:17], v4 offset:18560
v_mfma_f32_16x16x32_bf16 v[84:87], a[28:31], a[48:51], v[84:87]
ds_read_b64_tr_b16 a[18:19], v4 offset:20864
s_add_u32 m0, s30, 4096
v_mfma_f32_16x16x32_bf16 v[88:91], a[32:35], a[44:47], v[88:91]
ds_read_b64_tr_b16 a[20:21], v4 offset:18592
v_mfma_f32_16x16x32_bf16 v[92:95], a[32:35], a[48:51], v[92:95]
ds_read_b64_tr_b16 a[22:23], v4 offset:20896
buffer_load_dword v6, v21, s[88:91], s38 offen sc0 sc1
s_waitcnt lgkmcnt(6)
v_mfma_f32_16x16x32_bf16 v[24:27], a[0:3], a[52:55], v[24:27]
ds_read_b64_tr_b16 a[24:25], v4 offset:18624
v_mfma_f32_16x16x32_bf16 v[28:31], a[0:3], a[56:59], v[28:31]
ds_read_b64_tr_b16 a[26:27], v4 offset:20928
v_mfma_f32_16x16x32_bf16 v[32:35], a[4:7], a[52:55], v[32:35]
ds_read_b64_tr_b16 a[28:29], v4 offset:18656
buffer_load_dwordx4 v208, s[80:83], s28 offen offset:0 lds
v_mfma_f32_16x16x32_bf16 v[36:39], a[4:7], a[56:59], v[36:39]
ds_read_b64_tr_b16 a[30:31], v4 offset:20960
v_mfma_f32_16x16x32_bf16 v[40:43], a[8:11], a[52:55], v[40:43]
ds_read_b64_tr_b16 a[32:33], v4 offset:18688
v_mfma_f32_16x16x32_bf16 v[44:47], a[8:11], a[56:59], v[44:47]
ds_read_b64_tr_b16 a[34:35], v4 offset:20992
s_waitcnt lgkmcnt(6)
v_mfma_f32_16x16x32_bf16 v[48:51], a[12:15], a[52:55], v[48:51]
ds_read_b64_tr_b16 a[0:1], v4 offset:27648
v_mfma_f32_16x16x32_bf16 v[52:55], a[12:15], a[56:59], v[52:55]
ds_read_b64_tr_b16 a[2:3], v4 offset:29952
v_mfma_f32_16x16x32_bf16 v[56:59], a[16:19], a[52:55], v[56:59]
ds_read_b64_tr_b16 a[4:5], v4 offset:27680
buffer_load_dwordx4 v209, s[80:83], s28 offen offset:1024 lds
v_mfma_f32_16x16x32_bf16 v[60:63], a[16:19], a[56:59], v[60:63]
ds_read_b64_tr_b16 a[6:7], v4 offset:29984
v_mfma_f32_16x16x32_bf16 v[64:67], a[20:23], a[52:55], v[64:67]
ds_read_b64_tr_b16 a[8:9], v4 offset:27712
v_mfma_f32_16x16x32_bf16 v[68:71], a[20:23], a[56:59], v[68:71]
ds_read_b64_tr_b16 a[10:11], v4 offset:30016
s_waitcnt lgkmcnt(6)
v_mfma_f32_16x16x32_bf16 v[72:75], a[24:27], a[52:55], v[72:75]
ds_read_b64_tr_b16 a[12:13], v4 offset:27744
v_mfma_f32_16x16x32_bf16 v[76:79], a[24:27], a[56:59], v[76:79]
ds_read_b64_tr_b16 a[14:15], v4 offset:30048
buffer_load_dwordx4 v210, s[80:83], s28 offen offset:2048 lds
v_mfma_f32_16x16x32_bf16 v[80:83], a[28:31], a[52:55], v[80:83]
ds_read_b64_tr_b16 a[16:17], v4 offset:27776
v_mfma_f32_16x16x32_bf16 v[84:87], a[28:31], a[56:59], v[84:87]
ds_read_b64_tr_b16 a[18:19], v4 offset:30080
v_mfma_f32_16x16x32_bf16 v[88:91], a[32:35], a[52:55], v[88:91]
ds_read_b64_tr_b16 a[20:21], v4 offset:27808
v_mfma_f32_16x16x32_bf16 v[92:95], a[32:35], a[56:59], v[92:95]
ds_read_b64_tr_b16 a[22:23], v4 offset:30112
s_waitcnt lgkmcnt(6)
v_mfma_f32_16x16x32_bf16 v[24:27], a[0:3], a[60:63], v[24:27]
ds_read_b64_tr_b16 a[24:25], v4 offset:27840
v_mfma_f32_16x16x32_bf16 v[28:31], a[0:3], a[64:67], v[28:31]
ds_read_b64_tr_b16 a[26:27], v4 offset:30144
buffer_load_dwordx4 v211, s[80:83], s28 offen offset:3072 lds
v_mfma_f32_16x16x32_bf16 v[32:35], a[4:7], a[60:63], v[32:35]
ds_read_b64_tr_b16 a[28:29], v4 offset:27872
v_mfma_f32_16x16x32_bf16 v[36:39], a[4:7], a[64:67], v[36:39]
ds_read_b64_tr_b16 a[30:31], v4 offset:30176
v_mfma_f32_16x16x32_bf16 v[40:43], a[8:11], a[60:63], v[40:43]
ds_read_b64_tr_b16 a[32:33], v4 offset:27904
v_mfma_f32_16x16x32_bf16 v[44:47], a[8:11], a[64:67], v[44:47]
ds_read_b64_tr_b16 a[34:35], v4 offset:30208
s_waitcnt vmcnt(9) lgkmcnt(6)
s_barrier
v_mfma_f32_16x16x32_bf16 v[48:51], a[12:15], a[60:63], v[48:51]
ds_read_b64_tr_b16 a[0:1], v5 offset:0
s_add_u32 m0, s30, 8192
v_mfma_f32_16x16x32_bf16 v[52:55], a[12:15], a[64:67], v[52:55]
ds_read_b64_tr_b16 a[2:3], v5 offset:2304
v_mfma_f32_16x16x32_bf16 v[56:59], a[16:19], a[60:63], v[56:59]
ds_read_b64_tr_b16 a[4:5], v5 offset:32
v_mfma_f32_16x16x32_bf16 v[60:63], a[16:19], a[64:67], v[60:63]
ds_read_b64_tr_b16 a[6:7], v5 offset:2336
v_mfma_f32_16x16x32_bf16 v[64:67], a[20:23], a[60:63], v[64:67]
ds_read_b64_tr_b16 a[8:9], v5 offset:64
v_mfma_f32_16x16x32_bf16 v[68:71], a[20:23], a[64:67], v[68:71]
ds_read_b64_tr_b16 a[10:11], v5 offset:2368
s_waitcnt lgkmcnt(6)
v_mfma_f32_16x16x32_bf16 v[72:75], a[24:27], a[60:63], v[72:75]
ds_read_b64_tr_b16 a[12:13], v5 offset:96
buffer_load_dwordx4 v212, s[80:83], s28 offen offset:0 lds
v_mfma_f32_16x16x32_bf16 v[76:79], a[24:27], a[64:67], v[76:79]
ds_read_b64_tr_b16 a[14:15], v5 offset:2400
v_mfma_f32_16x16x32_bf16 v[80:83], a[28:31], a[60:63], v[80:83]
ds_read_b64_tr_b16 a[16:17], v5 offset:128
v_mfma_f32_16x16x32_bf16 v[84:87], a[28:31], a[64:67], v[84:87]
ds_read_b64_tr_b16 a[18:19], v5 offset:2432
v_mfma_f32_16x16x32_bf16 v[88:91], a[32:35], a[60:63], v[88:91]
ds_read_b64_tr_b16 a[20:21], v5 offset:160
v_mfma_f32_16x16x32_bf16 v[92:95], a[32:35], a[64:67], v[92:95]
ds_read_b64_tr_b16 a[22:23], v5 offset:2464
s_add_u32 s28, s28, 147456
s_waitcnt vmcnt(5)
k1_p:
v_cmp_eq_u32 vcc, -1, v6
s_nop 0
s_cbranch_vccz k1_g
buffer_load_dword v6, v21, s[88:91], s38 offen sc0 sc1
s_waitcnt vmcnt(0)
s_branch k1_p
k1_g:
buffer_load_dwordx4 a[100:103], v7, s[8:11], s29 offen offset:0
buffer_load_dwordx4 a[104:107], v8, s[8:11], s29 offen offset:0
buffer_load_dwordx4 a[108:111], v7, s[8:11], s29 offen offset:1024
buffer_load_dwordx4 a[112:115], v8, s[8:11], s29 offen offset:1024
buffer_load_dwordx4 a[116:119], v7, s[8:11], s29 offen offset:2048
buffer_load_dwordx4 a[120:123], v8, s[8:11], s29 offen offset:2048
buffer_load_dwordx4 a[124:127], v7, s[8:11], s29 offen offset:3072
buffer_load_dwordx4 a[128:131], v8, s[8:11], s29 offen offset:3072
s_add_u32 s29, s29, 4096
s_waitcnt lgkmcnt(6)
v_mfma_f32_16x16x32_bf16 v[24:27], a[0:3], a[68:71], v[24:27]
ds_read_b64_tr_b16 a[24:25], v5 offset:192
v_mfma_f32_16x16x32_bf16 v[28:31], a[0:3], a[72:75], v[28:31]
ds_read_b64_tr_b16 a[26:27], v5 offset:2496
v_mfma_f32_16x16x32_bf16 v[32:35], a[4:7], a[68:71], v[32:35]
ds_read_b64_tr_b16 a[28:29], v5 offset:224
v_mfma_f32_16x16x32_bf16 v[36:39], a[4:7], a[72:75], v[36:39]
ds_read_b64_tr_b16 a[30:31], v5 offset:2528
s_add_u32 m0, s30, 36864
v_mfma_f32_16x16x32_bf16 v[40:43], a[8:11], a[68:71], v[40:43]
ds_read_b64_tr_b16 a[32:33], v5 offset:256
v_mfma_f32_16x16x32_bf16 v[44:47], a[8:11], a[72:75], v[44:47]
ds_read_b64_tr_b16 a[34:35], v5 offset:2560
s_waitcnt lgkmcnt(6)
v_mfma_f32_16x16x32_bf16 v[48:51], a[12:15], a[68:71], v[48:51]
ds_read_b64_tr_b16 a[0:1], v5 offset:9216
buffer_load_dwordx4 v204, s[80:83], s28 offen offset:0 lds
v_mfma_f32_16x16x32_bf16 v[52:55], a[12:15], a[72:75], v[52:55]
ds_read_b64_tr_b16 a[2:3], v5 offset:11520
v_mfma_f32_16x16x32_bf16 v[56:59], a[16:19], a[68:71], v[56:59]
ds_read_b64_tr_b16 a[4:5], v5 offset:9248
v_mfma_f32_16x16x32_bf16 v[60:63], a[16:19], a[72:75], v[60:63]
ds_read_b64_tr_b16 a[6:7], v5 offset:11552
buffer_load_dwordx4 a[132:135], v7, s[8:11], s29 offen offset:0
v_mfma_f32_16x16x32_bf16 v[64:67], a[20:23], a[68:71], v[64:67]
ds_read_b64_tr_b16 a[8:9], v5 offset:9280
v_mfma_f32_16x16x32_bf16 v[68:71], a[20:23], a[72:75], v[68:71]
ds_read_b64_tr_b16 a[10:11], v5 offset:11584
s_waitcnt lgkmcnt(6)
v_mfma_f32_16x16x32_bf16 v[72:75], a[24:27], a[68:71], v[72:75]
ds_read_b64_tr_b16 a[12:13], v5 offset:9312
v_mfma_f32_16x16x32_bf16 v[76:79], a[24:27], a[72:75], v[76:79]
ds_read_b64_tr_b16 a[14:15], v5 offset:11616
buffer_load_dwordx4 v205, s[80:83], s28 offen offset:1024 lds
v_mfma_f32_16x16x32_bf16 v[80:83], a[28:31], a[68:71], v[80:83]
ds_read_b64_tr_b16 a[16:17], v5 offset:9344
v_mfma_f32_16x16x32_bf16 v[84:87], a[28:31], a[72:75], v[84:87]
ds_read_b64_tr_b16 a[18:19], v5 offset:11648
v_mfma_f32_16x16x32_bf16 v[88:91], a[32:35], a[68:71], v[88:91]
ds_read_b64_tr_b16 a[20:21], v5 offset:9376
buffer_load_dwordx4 a[136:139], v8, s[8:11], s29 offen offset:0
v_mfma_f32_16x16x32_bf16 v[92:95], a[32:35], a[72:75], v[92:95]
ds_read_b64_tr_b16 a[22:23], v5 offset:11680
s_waitcnt lgkmcnt(6)
v_mfma_f32_16x16x32_bf16 v[24:27], a[0:3], a[76:79], v[24:27]
ds_read_b64_tr_b16 a[24:25], v5 offset:9408
v_mfma_f32_16x16x32_bf16 v[28:31], a[0:3], a[80:83], v[28:31]
ds_read_b64_tr_b16 a[26:27], v5 offset:11712
buffer_load_dwordx4 v206, s[80:83], s28 offen offset:2048 lds
v_mfma_f32_16x16x32_bf16 v[32:35], a[4:7], a[76:79], v[32:35]
ds_read_b64_tr_b16 a[28:29], v5 offset:9440
v_mfma_f32_16x16x32_bf16 v[36:39], a[4:7], a[80:83], v[36:39]
ds_read_b64_tr_b16 a[30:31], v5 offset:11744
v_mfma_f32_16x16x32_bf16 v[40:43], a[8:11], a[76:79], v[40:43]
ds_read_b64_tr_b16 a[32:33], v5 offset:9472
buffer_load_dwordx4 v207, s[80:83], s28 offen offset:3072 lds
v_mfma_f32_16x16x32_bf16 v[44:47], a[8:11], a[80:83], v[44:47]
ds_read_b64_tr_b16 a[34:35], v5 offset:11776
s_waitcnt lgkmcnt(6)
v_mfma_f32_16x16x32_bf16 v[48:51], a[12:15], a[76:79], v[48:51]
ds_read_b64_tr_b16 a[0:1], v5 offset:18432
v_mfma_f32_16x16x32_bf16 v[52:55], a[12:15], a[80:83], v[52:55]
ds_read_b64_tr_b16 a[2:3], v5 offset:20736
v_mfma_f32_16x16x32_bf16 v[56:59], a[16:19], a[76:79], v[56:59]
ds_read_b64_tr_b16 a[4:5], v5 offset:18464
buffer_load_dwordx4 a[140:143], v7, s[8:11], s29 offen offset:1024
v_mfma_f32_16x16x32_bf16 v[60:63], a[16:19], a[80:83], v[60:63]
ds_read_b64_tr_b16 a[6:7], v5 offset:20768
v_mfma_f32_16x16x32_bf16 v[64:67], a[20:23], a[76:79], v[64:67]
ds_read_b64_tr_b16 a[8:9], v5 offset:18496
v_mfma_f32_16x16x32_bf16 v[68:71], a[20:23], a[80:83], v[68:71]
ds_read_b64_tr_b16 a[10:11], v5 offset:20800
s_add_u32 m0, s30, 40960
s_waitcnt lgkmcnt(6)
v_mfma_f32_16x16x32_bf16 v[72:75], a[24:27], a[76:79], v[72:75]
ds_read_b64_tr_b16 a[12:13], v5 offset:18528
v_mfma_f32_16x16x32_bf16 v[76:79], a[24:27], a[80:83], v[76:79]
ds_read_b64_tr_b16 a[14:15], v5 offset:20832
v_mfma_f32_16x16x32_bf16 v[80:83], a[28:31], a[76:79], v[80:83]
ds_read_b64_tr_b16 a[16:17], v5 offset:18560
buffer_load_dwordx4 a[144:147], v8, s[8:11], s29 offen offset:1024
v_mfma_f32_16x16x32_bf16 v[84:87], a[28:31], a[80:83], v[84:87]
ds_read_b64_tr_b16 a[18:19], v5 offset:20864
v_mfma_f32_16x16x32_bf16 v[88:91], a[32:35], a[76:79], v[88:91]
ds_read_b64_tr_b16 a[20:21], v5 offset:18592
v_mfma_f32_16x16x32_bf16 v[92:95], a[32:35], a[80:83], v[92:95]
ds_read_b64_tr_b16 a[22:23], v5 offset:20896
buffer_load_dwordx4 v208, s[80:83], s28 offen offset:0 lds
s_waitcnt lgkmcnt(6)
v_mfma_f32_16x16x32_bf16 v[24:27], a[0:3], a[84:87], v[24:27]
ds_read_b64_tr_b16 a[24:25], v5 offset:18624
v_mfma_f32_16x16x32_bf16 v[28:31], a[0:3], a[88:91], v[28:31]
ds_read_b64_tr_b16 a[26:27], v5 offset:20928
v_mfma_f32_16x16x32_bf16 v[32:35], a[4:7], a[84:87], v[32:35]
ds_read_b64_tr_b16 a[28:29], v5 offset:18656
v_mfma_f32_16x16x32_bf16 v[36:39], a[4:7], a[88:91], v[36:39]
ds_read_b64_tr_b16 a[30:31], v5 offset:20960
buffer_load_dwordx4 v209, s[80:83], s28 offen offset:1024 lds
v_mfma_f32_16x16x32_bf16 v[40:43], a[8:11], a[84:87], v[40:43]
ds_read_b64_tr_b16 a[32:33], v5 offset:18688
v_mfma_f32_16x16x32_bf16 v[44:47], a[8:11], a[88:91], v[44:47]
ds_read_b64_tr_b16 a[34:35], v5 offset:20992
s_waitcnt lgkmcnt(6)
v_mfma_f32_16x16x32_bf16 v[48:51], a[12:15], a[84:87], v[48:51]
ds_read_b64_tr_b16 a[0:1], v5 offset:27648
buffer_load_dwordx4 a[148:151], v7, s[8:11], s29 offen offset:2048
v_mfma_f32_16x16x32_bf16 v[52:55], a[12:15], a[88:91], v[52:55]
ds_read_b64_tr_b16 a[2:3], v5 offset:29952
v_mfma_f32_16x16x32_bf16 v[56:59], a[16:19], a[84:87], v[56:59]
ds_read_b64_tr_b16 a[4:5], v5 offset:27680
v_mfma_f32_16x16x32_bf16 v[60:63], a[16:19], a[88:91], v[60:63]
ds_read_b64_tr_b16 a[6:7], v5 offset:29984
buffer_load_dwordx4 v210, s[80:83], s28 offen offset:2048 lds
v_mfma_f32_16x16x32_bf16 v[64:67], a[20:23], a[84:87], v[64:67]
ds_read_b64_tr_b16 a[8:9], v5 offset:27712
v_mfma_f32_16x16x32_bf16 v[68:71], a[20:23], a[88:91], v[68:71]
ds_read_b64_tr_b16 a[10:11], v5 offset:30016
s_waitcnt lgkmcnt(6)
v_mfma_f32_16x16x32_bf16 v[72:75], a[24:27], a[84:87], v[72:75]
ds_read_b64_tr_b16 a[12:13], v5 offset:27744
v_mfma_f32_16x16x32_bf16 v[76:79], a[24:27], a[88:91], v[76:79]
ds_read_b64_tr_b16 a[14:15], v5 offset:30048
buffer_load_dwordx4 a[152:155], v8, s[8:11], s29 offen offset:2048
v_mfma_f32_16x16x32_bf16 v[80:83], a[28:31], a[84:87], v[80:83]
ds_read_b64_tr_b16 a[16:17], v5 offset:27776
v_mfma_f32_16x16x32_bf16 v[84:87], a[28:31], a[88:91], v[84:87]
ds_read_b64_tr_b16 a[18:19], v5 offset:30080
v_mfma_f32_16x16x32_bf16 v[88:91], a[32:35], a[84:87], v[88:91]
ds_read_b64_tr_b16 a[20:21], v5 offset:27808
buffer_load_dwordx4 v211, s[80:83], s28 offen offset:3072 lds
v_mfma_f32_16x16x32_bf16 v[92:95], a[32:35], a[88:91], v[92:95]
ds_read_b64_tr_b16 a[22:23], v5 offset:30112
s_waitcnt lgkmcnt(6)
v_mfma_f32_16x16x32_bf16 v[24:27], a[0:3], a[92:95], v[24:27]
ds_read_b64_tr_b16 a[24:25], v5 offset:27840
v_mfma_f32_16x16x32_bf16 v[28:31], a[0:3], a[96:99], v[28:31]
ds_read_b64_tr_b16 a[26:27], v5 offset:30144
s_add_u32 m0, s30, 45056
v_mfma_f32_16x16x32_bf16 v[32:35], a[4:7], a[92:95], v[32:35]
ds_read_b64_tr_b16 a[28:29], v5 offset:27872
v_mfma_f32_16x16x32_bf16 v[36:39], a[4:7], a[96:99], v[36:39]
ds_read_b64_tr_b16 a[30:31], v5 offset:30176
v_mfma_f32_16x16x32_bf16 v[40:43], a[8:11], a[92:95], v[40:43]
ds_read_b64_tr_b16 a[32:33], v5 offset:27904
buffer_load_dwordx4 a[156:159], v7, s[8:11], s29 offen offset:3072
v_mfma_f32_16x16x32_bf16 v[44:47], a[8:11], a[96:99], v[44:47]
ds_read_b64_tr_b16 a[34:35], v5 offset:30208
s_waitcnt vmcnt(15) lgkmcnt(6)
s_barrier
v_mfma_f32_16x16x32_bf16 v[48:51], a[12:15], a[92:95], v[48:51]
ds_read_b64_tr_b16 a[0:1], v2 offset:0
v_mfma_f32_16x16x32_bf16 v[52:55], a[12:15], a[96:99], v[52:55]
ds_read_b64_tr_b16 a[2:3], v2 offset:2304
v_mfma_f32_16x16x32_bf16 v[56:59], a[16:19], a[92:95], v[56:59]
ds_read_b64_tr_b16 a[4:5], v2 offset:32
buffer_load_dwordx4 v212, s[80:83], s28 offen offset:0 lds
v_mfma_f32_16x16x32_bf16 v[60:63], a[16:19], a[96:99], v[60:63]
ds_read_b64_tr_b16 a[6:7], v2 offset:2336
v_mfma_f32_16x16x32_bf16 v[64:67], a[20:23], a[92:95], v[64:67]
ds_read_b64_tr_b16 a[8:9], v2 offset:64
v_mfma_f32_16x16x32_bf16 v[68:71], a[20:23], a[96:99], v[68:71]
ds_read_b64_tr_b16 a[10:11], v2 offset:2368
buffer_load_dwordx4 a[160:163], v8, s[8:11], s29 offen offset:3072
s_waitcnt lgkmcnt(6)
v_mfma_f32_16x16x32_bf16 v[72:75], a[24:27], a[92:95], v[72:75]
ds_read_b64_tr_b16 a[12:13], v2 offset:96
v_mfma_f32_16x16x32_bf16 v[76:79], a[24:27], a[96:99], v[76:79]
ds_read_b64_tr_b16 a[14:15], v2 offset:2400
v_mfma_f32_16x16x32_bf16 v[80:83], a[28:31], a[92:95], v[80:83]
ds_read_b64_tr_b16 a[16:17], v2 offset:128
s_add_u32 s28, s28, s17
v_mfma_f32_16x16x32_bf16 v[84:87], a[28:31], a[96:99], v[84:87]
ds_read_b64_tr_b16 a[18:19], v2 offset:2432
v_mfma_f32_16x16x32_bf16 v[88:91], a[32:35], a[92:95], v[88:91]
ds_read_b64_tr_b16 a[20:21], v2 offset:160
v_mfma_f32_16x16x32_bf16 v[92:95], a[32:35], a[96:99], v[92:95]
ds_read_b64_tr_b16 a[22:23], v2 offset:2464
s_add_u32 s29, s29, s20
s_waitcnt lgkmcnt(6)
v_mfma_f32_16x16x32_bf16 v[24:27], a[0:3], a[100:103], v[24:27]
ds_read_b64_tr_b16 a[24:25], v2 offset:192
v_mfma_f32_16x16x32_bf16 v[28:31], a[0:3], a[104:107], v[28:31]
ds_read_b64_tr_b16 a[26:27], v2 offset:2496
v_mfma_f32_16x16x32_bf16 v[32:35], a[4:7], a[100:103], v[32:35]
ds_read_b64_tr_b16 a[28:29], v2 offset:224
v_mfma_f32_16x16x32_bf16 v[36:39], a[4:7], a[104:107], v[36:39]
ds_read_b64_tr_b16 a[30:31], v2 offset:2528
s_add_u32 m0, s30, 73728
v_mfma_f32_16x16x32_bf16 v[40:43], a[8:11], a[100:103], v[40:43]
ds_read_b64_tr_b16 a[32:33], v2 offset:256
v_mfma_f32_16x16x32_bf16 v[44:47], a[8:11], a[104:107], v[44:47]
ds_read_b64_tr_b16 a[34:35], v2 offset:2560
s_waitcnt lgkmcnt(6)
v_mfma_f32_16x16x32_bf16 v[48:51], a[12:15], a[100:103], v[48:51]
ds_read_b64_tr_b16 a[0:1], v2 offset:9216
buffer_load_dwordx4 v204, s[80:83], s28 offen offset:0 lds
v_mfma_f32_16x16x32_bf16 v[52:55], a[12:15], a[104:107], v[52:55]
ds_read_b64_tr_b16 a[2:3], v2 offset:11520
v_mfma_f32_16x16x32_bf16 v[56:59], a[16:19], a[100:103], v[56:59]
ds_read_b64_tr_b16 a[4:5], v2 offset:9248
v_mfma_f32_16x16x32_bf16 v[60:63], a[16:19], a[104:107], v[60:63]
ds_read_b64_tr_b16 a[6:7], v2 offset:11552
buffer_load_dwordx4 a[36:39], v7, s[8:11], s29 offen offset:0
v_mfma_f32_16x16x32_bf16 v[64:67], a[20:23], a[100:103], v[64:67]
ds_read_b64_tr_b16 a[8:9], v2 offset:9280
v_mfma_f32_16x16x32_bf16 v[68:71], a[20:23], a[104:107], v[68:71]
ds_read_b64_tr_b16 a[10:11], v2 offset:11584
s_waitcnt lgkmcnt(6)
v_mfma_f32_16x16x32_bf16 v[72:75], a[24:27], a[100:103], v[72:75]
ds_read_b64_tr_b16 a[12:13], v2 offset:9312
v_mfma_f32_16x16x32_bf16 v[76:79], a[24:27], a[104:107], v[76:79]
ds_read_b64_tr_b16 a[14:15], v2 offset:11616
buffer_load_dwordx4 v205, s[80:83], s28 offen offset:1024 lds
v_mfma_f32_16x16x32_bf16 v[80:83], a[28:31], a[100:103], v[80:83]
ds_read_b64_tr_b16 a[16:17], v2 offset:9344
v_mfma_f32_16x16x32_bf16 v[84:87], a[28:31], a[104:107], v[84:87]
ds_read_b64_tr_b16 a[18:19], v2 offset:11648
v_mfma_f32_16x16x32_bf16 v[88:91], a[32:35], a[100:103], v[88:91]
ds_read_b64_tr_b16 a[20:21], v2 offset:9376
buffer_load_dwordx4 a[40:43], v8, s[8:11], s29 offen offset:0
v_mfma_f32_16x16x32_bf16 v[92:95], a[32:35], a[104:107], v[92:95]
ds_read_b64_tr_b16 a[22:23], v2 offset:11680
s_waitcnt lgkmcnt(6)
v_mfma_f32_16x16x32_bf16 v[24:27], a[0:3], a[108:111], v[24:27]
ds_read_b64_tr_b16 a[24:25], v2 offset:9408
v_mfma_f32_16x16x32_bf16 v[28:31], a[0:3], a[112:115], v[28:31]
ds_read_b64_tr_b16 a[26:27], v2 offset:11712
buffer_load_dwordx4 v206, s[80:83], s28 offen offset:2048 lds
v_mfma_f32_16x16x32_bf16 v[32:35], a[4:7], a[108:111], v[32:35]
ds_read_b64_tr_b16 a[28:29], v2 offset:9440
v_mfma_f32_16x16x32_bf16 v[36:39], a[4:7], a[112:115], v[36:39]
ds_read_b64_tr_b16 a[30:31], v2 offset:11744
v_mfma_f32_16x16x32_bf16 v[40:43], a[8:11], a[108:111], v[40:43]
ds_read_b64_tr_b16 a[32:33], v2 offset:9472
buffer_load_dwordx4 v207, s[80:83], s28 offen offset:3072 lds
v_mfma_f32_16x16x32_bf16 v[44:47], a[8:11], a[112:115], v[44:47]
ds_read_b64_tr_b16 a[34:35], v2 offset:11776
s_waitcnt lgkmcnt(6)
v_mfma_f32_16x16x32_bf16 v[48:51], a[12:15], a[108:111], v[48:51]
ds_read_b64_tr_b16 a[0:1], v2 offset:18432
v_mfma_f32_16x16x32_bf16 v[52:55], a[12:15], a[112:115], v[52:55]
ds_read_b64_tr_b16 a[2:3], v2 offset:20736
v_mfma_f32_16x16x32_bf16 v[56:59], a[16:19], a[108:111], v[56:59]
ds_read_b64_tr_b16 a[4:5], v2 offset:18464
buffer_load_dwordx4 a[44:47], v7, s[8:11], s29 offen offset:1024
v_mfma_f32_16x16x32_bf16 v[60:63], a[16:19], a[112:115], v[60:63]
ds_read_b64_tr_b16 a[6:7], v2 offset:20768
v_mfma_f32_16x16x32_bf16 v[64:67], a[20:23], a[108:111], v[64:67]
ds_read_b64_tr_b16 a[8:9], v2 offset:18496
v_mfma_f32_16x16x32_bf16 v[68:71], a[20:23], a[112:115], v[68:71]
ds_read_b64_tr_b16 a[10:11], v2 offset:20800
s_add_u32 m0, s30, 77824
s_waitcnt lgkmcnt(6)
v_mfma_f32_16x16x32_bf16 v[72:75], a[24:27], a[108:111], v[72:75]
ds_read_b64_tr_b16 a[12:13], v2 offset:18528
v_mfma_f32_16x16x32_bf16 v[76:79], a[24:27], a[112:115], v[76:79]
ds_read_b64_tr_b16 a[14:15], v2 offset:20832
v_mfma_f32_16x16x32_bf16 v[80:83], a[28:31], a[108:111], v[80:83]
ds_read_b64_tr_b16 a[16:17], v2 offset:18560
buffer_load_dwordx4 a[48:51], v8, s[8:11], s29 offen offset:1024
v_mfma_f32_16x16x32_bf16 v[84:87], a[28:31], a[112:115], v[84:87]
ds_read_b64_tr_b16 a[18:19], v2 offset:20864
v_mfma_f32_16x16x32_bf16 v[88:91], a[32:35], a[108:111], v[88:91]
ds_read_b64_tr_b16 a[20:21], v2 offset:18592
v_mfma_f32_16x16x32_bf16 v[92:95], a[32:35], a[112:115], v[92:95]
ds_read_b64_tr_b16 a[22:23], v2 offset:20896
buffer_load_dwordx4 v208, s[80:83], s28 offen offset:0 lds
s_waitcnt lgkmcnt(6)
v_mfma_f32_16x16x32_bf16 v[24:27], a[0:3], a[116:119], v[24:27]
ds_read_b64_tr_b16 a[24:25], v2 offset:18624
v_mfma_f32_16x16x32_bf16 v[28:31], a[0:3], a[120:123], v[28:31]
ds_read_b64_tr_b16 a[26:27], v2 offset:20928
v_mfma_f32_16x16x32_bf16 v[32:35], a[4:7], a[116:119], v[32:35]
ds_read_b64_tr_b16 a[28:29], v2 offset:18656
v_mfma_f32_16x16x32_bf16 v[36:39], a[4:7], a[120:123], v[36:39]
ds_read_b64_tr_b16 a[30:31], v2 offset:20960
buffer_load_dwordx4 v209, s[80:83], s28 offen offset:1024 lds
v_mfma_f32_16x16x32_bf16 v[40:43], a[8:11], a[116:119], v[40:43]
ds_read_b64_tr_b16 a[32:33], v2 offset:18688
v_mfma_f32_16x16x32_bf16 v[44:47], a[8:11], a[120:123], v[44:47]
ds_read_b64_tr_b16 a[34:35], v2 offset:20992
s_waitcnt lgkmcnt(6)
v_mfma_f32_16x16x32_bf16 v[48:51], a[12:15], a[116:119], v[48:51]
ds_read_b64_tr_b16 a[0:1], v2 offset:27648
buffer_load_dwordx4 a[52:55], v7, s[8:11], s29 offen offset:2048
v_mfma_f32_16x16x32_bf16 v[52:55], a[12:15], a[120:123], v[52:55]
ds_read_b64_tr_b16 a[2:3], v2 offset:29952
v_mfma_f32_16x16x32_bf16 v[56:59], a[16:19], a[116:119], v[56:59]
ds_read_b64_tr_b16 a[4:5], v2 offset:27680
v_mfma_f32_16x16x32_bf16 v[60:63], a[16:19], a[120:123], v[60:63]
ds_read_b64_tr_b16 a[6:7], v2 offset:29984
buffer_load_dwordx4 v210, s[80:83], s28 offen offset:2048 lds
v_mfma_f32_16x16x32_bf16 v[64:67], a[20:23], a[116:119], v[64:67]
ds_read_b64_tr_b16 a[8:9], v2 offset:27712
v_mfma_f32_16x16x32_bf16 v[68:71], a[20:23], a[120:123], v[68:71]
ds_read_b64_tr_b16 a[10:11], v2 offset:30016
s_waitcnt lgkmcnt(6)
v_mfma_f32_16x16x32_bf16 v[72:75], a[24:27], a[116:119], v[72:75]
ds_read_b64_tr_b16 a[12:13], v2 offset:27744
v_mfma_f32_16x16x32_bf16 v[76:79], a[24:27], a[120:123], v[76:79]
ds_read_b64_tr_b16 a[14:15], v2 offset:30048
buffer_load_dwordx4 a[56:59], v8, s[8:11], s29 offen offset:2048
v_mfma_f32_16x16x32_bf16 v[80:83], a[28:31], a[116:119], v[80:83]
ds_read_b64_tr_b16 a[16:17], v2 offset:27776
v_mfma_f32_16x16x32_bf16 v[84:87], a[28:31], a[120:123], v[84:87]
ds_read_b64_tr_b16 a[18:19], v2 offset:30080
v_mfma_f32_16x16x32_bf16 v[88:91], a[32:35], a[116:119], v[88:91]
ds_read_b64_tr_b16 a[20:21], v2 offset:27808
buffer_load_dwordx4 v211, s[80:83], s28 offen offset:3072 lds
v_mfma_f32_16x16x32_bf16 v[92:95], a[32:35], a[120:123], v[92:95]
ds_read_b64_tr_b16 a[22:23], v2 offset:30112
s_waitcnt lgkmcnt(6)
v_mfma_f32_16x16x32_bf16 v[24:27], a[0:3], a[124:127], v[24:27]
ds_read_b64_tr_b16 a[24:25], v2 offset:27840
v_mfma_f32_16x16x32_bf16 v[28:31], a[0:3], a[128:131], v[28:31]
ds_read_b64_tr_b16 a[26:27], v2 offset:30144
s_add_u32 m0, s30, 81920
v_mfma_f32_16x16x32_bf16 v[32:35], a[4:7], a[124:127], v[32:35]
ds_read_b64_tr_b16 a[28:29], v2 offset:27872
v_mfma_f32_16x16x32_bf16 v[36:39], a[4:7], a[128:131], v[36:39]
ds_read_b64_tr_b16 a[30:31], v2 offset:30176
v_mfma_f32_16x16x32_bf16 v[40:43], a[8:11], a[124:127], v[40:43]
ds_read_b64_tr_b16 a[32:33], v2 offset:27904
buffer_load_dwordx4 a[60:63], v7, s[8:11], s29 offen offset:3072
v_mfma_f32_16x16x32_bf16 v[44:47], a[8:11], a[128:131], v[44:47]
ds_read_b64_tr_b16 a[34:35], v2 offset:30208
s_waitcnt vmcnt(15) lgkmcnt(6)
s_barrier
v_mfma_f32_16x16x32_bf16 v[48:51], a[12:15], a[124:127], v[48:51]
ds_read_b64_tr_b16 a[0:1], v3 offset:0
v_mfma_f32_16x16x32_bf16 v[52:55], a[12:15], a[128:131], v[52:55]
ds_read_b64_tr_b16 a[2:3], v3 offset:2304
v_mfma_f32_16x16x32_bf16 v[56:59], a[16:19], a[124:127], v[56:59]
ds_read_b64_tr_b16 a[4:5], v3 offset:32
buffer_load_dwordx4 v212, s[80:83], s28 offen offset:0 lds
v_mfma_f32_16x16x32_bf16 v[60:63], a[16:19], a[128:131], v[60:63]
ds_read_b64_tr_b16 a[6:7], v3 offset:2336
v_mfma_f32_16x16x32_bf16 v[64:67], a[20:23], a[124:127], v[64:67]
ds_read_b64_tr_b16 a[8:9], v3 offset:64
v_mfma_f32_16x16x32_bf16 v[68:71], a[20:23], a[128:131], v[68:71]
ds_read_b64_tr_b16 a[10:11], v3 offset:2368
buffer_load_dwordx4 a[64:67], v8, s[8:11], s29 offen offset:3072
s_waitcnt lgkmcnt(6)
v_mfma_f32_16x16x32_bf16 v[72:75], a[24:27], a[124:127], v[72:75]
ds_read_b64_tr_b16 a[12:13], v3 offset:96
v_mfma_f32_16x16x32_bf16 v[76:79], a[24:27], a[128:131], v[76:79]
ds_read_b64_tr_b16 a[14:15], v3 offset:2400
v_mfma_f32_16x16x32_bf16 v[80:83], a[28:31], a[124:127], v[80:83]
ds_read_b64_tr_b16 a[16:17], v3 offset:128
s_add_u32 s28, s28, 147456
v_mfma_f32_16x16x32_bf16 v[84:87], a[28:31], a[128:131], v[84:87]
ds_read_b64_tr_b16 a[18:19], v3 offset:2432
v_mfma_f32_16x16x32_bf16 v[88:91], a[32:35], a[124:127], v[88:91]
ds_read_b64_tr_b16 a[20:21], v3 offset:160
v_mfma_f32_16x16x32_bf16 v[92:95], a[32:35], a[128:131], v[92:95]
ds_read_b64_tr_b16 a[22:23], v3 offset:2464
s_add_u32 s29, s29, 4096
s_waitcnt lgkmcnt(6)
v_mfma_f32_16x16x32_bf16 v[24:27], a[0:3], a[132:135], v[24:27]
ds_read_b64_tr_b16 a[24:25], v3 offset:192
v_mfma_f32_16x16x32_bf16 v[28:31], a[0:3], a[136:139], v[28:31]
ds_read_b64_tr_b16 a[26:27], v3 offset:2496
v_mfma_f32_16x16x32_bf16 v[32:35], a[4:7], a[132:135], v[32:35]
ds_read_b64_tr_b16 a[28:29], v3 offset:224
v_mfma_f32_16x16x32_bf16 v[36:39], a[4:7], a[136:139], v[36:39]
ds_read_b64_tr_b16 a[30:31], v3 offset:2528
s_add_u32 m0, s30, 110592
v_mfma_f32_16x16x32_bf16 v[40:43], a[8:11], a[132:135], v[40:43]
ds_read_b64_tr_b16 a[32:33], v3 offset:256
v_mfma_f32_16x16x32_bf16 v[44:47], a[8:11], a[136:139], v[44:47]
ds_read_b64_tr_b16 a[34:35], v3 offset:2560
s_waitcnt lgkmcnt(6)
v_mfma_f32_16x16x32_bf16 v[48:51], a[12:15], a[132:135], v[48:51]
ds_read_b64_tr_b16 a[0:1], v3 offset:9216
buffer_load_dwordx4 v204, s[80:83], s28 offen offset:0 lds
v_mfma_f32_16x16x32_bf16 v[52:55], a[12:15], a[136:139], v[52:55]
ds_read_b64_tr_b16 a[2:3], v3 offset:11520
v_mfma_f32_16x16x32_bf16 v[56:59], a[16:19], a[132:135], v[56:59]
ds_read_b64_tr_b16 a[4:5], v3 offset:9248
v_mfma_f32_16x16x32_bf16 v[60:63], a[16:19], a[136:139], v[60:63]
ds_read_b64_tr_b16 a[6:7], v3 offset:11552
buffer_load_dwordx4 a[68:71], v7, s[8:11], s29 offen offset:0
v_mfma_f32_16x16x32_bf16 v[64:67], a[20:23], a[132:135], v[64:67]
ds_read_b64_tr_b16 a[8:9], v3 offset:9280
v_mfma_f32_16x16x32_bf16 v[68:71], a[20:23], a[136:139], v[68:71]
ds_read_b64_tr_b16 a[10:11], v3 offset:11584
s_waitcnt lgkmcnt(6)
v_mfma_f32_16x16x32_bf16 v[72:75], a[24:27], a[132:135], v[72:75]
ds_read_b64_tr_b16 a[12:13], v3 offset:9312
v_mfma_f32_16x16x32_bf16 v[76:79], a[24:27], a[136:139], v[76:79]
ds_read_b64_tr_b16 a[14:15], v3 offset:11616
buffer_load_dwordx4 v205, s[80:83], s28 offen offset:1024 lds
v_mfma_f32_16x16x32_bf16 v[80:83], a[28:31], a[132:135], v[80:83]
ds_read_b64_tr_b16 a[16:17], v3 offset:9344
v_mfma_f32_16x16x32_bf16 v[84:87], a[28:31], a[136:139], v[84:87]
ds_read_b64_tr_b16 a[18:19], v3 offset:11648
v_mfma_f32_16x16x32_bf16 v[88:91], a[32:35], a[132:135], v[88:91]
ds_read_b64_tr_b16 a[20:21], v3 offset:9376
buffer_load_dwordx4 a[72:75], v8, s[8:11], s29 offen offset:0
v_mfma_f32_16x16x32_bf16 v[92:95], a[32:35], a[136:139], v[92:95]
ds_read_b64_tr_b16 a[22:23], v3 offset:11680
s_waitcnt lgkmcnt(6)
v_mfma_f32_16x16x32_bf16 v[24:27], a[0:3], a[140:143], v[24:27]
ds_read_b64_tr_b16 a[24:25], v3 offset:9408
v_mfma_f32_16x16x32_bf16 v[28:31], a[0:3], a[144:147], v[28:31]
ds_read_b64_tr_b16 a[26:27], v3 offset:11712
buffer_load_dwordx4 v206, s[80:83], s28 offen offset:2048 lds
v_mfma_f32_16x16x32_bf16 v[32:35], a[4:7], a[140:143], v[32:35]
ds_read_b64_tr_b16 a[28:29], v3 offset:9440
v_mfma_f32_16x16x32_bf16 v[36:39], a[4:7], a[144:147], v[36:39]
ds_read_b64_tr_b16 a[30:31], v3 offset:11744
v_mfma_f32_16x16x32_bf16 v[40:43], a[8:11], a[140:143], v[40:43]
ds_read_b64_tr_b16 a[32:33], v3 offset:9472
buffer_load_dwordx4 v207, s[80:83], s28 offen offset:3072 lds
v_mfma_f32_16x16x32_bf16 v[44:47], a[8:11], a[144:147], v[44:47]
ds_read_b64_tr_b16 a[34:35], v3 offset:11776
s_waitcnt lgkmcnt(6)
v_mfma_f32_16x16x32_bf16 v[48:51], a[12:15], a[140:143], v[48:51]
ds_read_b64_tr_b16 a[0:1], v3 offset:18432
v_mfma_f32_16x16x32_bf16 v[52:55], a[12:15], a[144:147], v[52:55]
ds_read_b64_tr_b16 a[2:3], v3 offset:20736
v_mfma_f32_16x16x32_bf16 v[56:59], a[16:19], a[140:143], v[56:59]
ds_read_b64_tr_b16 a[4:5], v3 offset:18464
buffer_load_dwordx4 a[76:79], v7, s[8:11], s29 offen offset:1024
v_mfma_f32_16x16x32_bf16 v[60:63], a[16:19], a[144:147], v[60:63]
ds_read_b64_tr_b16 a[6:7], v3 offset:20768
v_mfma_f32_16x16x32_bf16 v[64:67], a[20:23], a[140:143], v[64:67]
ds_read_b64_tr_b16 a[8:9], v3 offset:18496
v_mfma_f32_16x16x32_bf16 v[68:71], a[20:23], a[144:147], v[68:71]
ds_read_b64_tr_b16 a[10:11], v3 offset:20800
s_add_u32 m0, s30, 114688
s_waitcnt lgkmcnt(6)
v_mfma_f32_16x16x32_bf16 v[72:75], a[24:27], a[140:143], v[72:75]
ds_read_b64_tr_b16 a[12:13], v3 offset:18528
v_mfma_f32_16x16x32_bf16 v[76:79], a[24:27], a[144:147], v[76:79]
ds_read_b64_tr_b16 a[14:15], v3 offset:20832
v_mfma_f32_16x16x32_bf16 v[80:83], a[28:31], a[140:143], v[80:83]
ds_read_b64_tr_b16 a[16:17], v3 offset:18560
buffer_load_dwordx4 a[80:83], v8, s[8:11], s29 offen offset:1024
v_mfma_f32_16x16x32_bf16 v[84:87], a[28:31], a[144:147], v[84:87]
ds_read_b64_tr_b16 a[18:19], v3 offset:20864
v_mfma_f32_16x16x32_bf16 v[88:91], a[32:35], a[140:143], v[88:91]
ds_read_b64_tr_b16 a[20:21], v3 offset:18592
v_mfma_f32_16x16x32_bf16 v[92:95], a[32:35], a[144:147], v[92:95]
ds_read_b64_tr_b16 a[22:23], v3 offset:20896
buffer_load_dwordx4 v208, s[80:83], s28 offen offset:0 lds
s_waitcnt lgkmcnt(6)
v_mfma_f32_16x16x32_bf16 v[24:27], a[0:3], a[148:151], v[24:27]
ds_read_b64_tr_b16 a[24:25], v3 offset:18624
v_mfma_f32_16x16x32_bf16 v[28:31], a[0:3], a[152:155], v[28:31]
ds_read_b64_tr_b16 a[26:27], v3 offset:20928
v_mfma_f32_16x16x32_bf16 v[32:35], a[4:7], a[148:151], v[32:35]
ds_read_b64_tr_b16 a[28:29], v3 offset:18656
v_mfma_f32_16x16x32_bf16 v[36:39], a[4:7], a[152:155], v[36:39]
ds_read_b64_tr_b16 a[30:31], v3 offset:20960
buffer_load_dwordx4 v209, s[80:83], s28 offen offset:1024 lds
v_mfma_f32_16x16x32_bf16 v[40:43], a[8:11], a[148:151], v[40:43]
ds_read_b64_tr_b16 a[32:33], v3 offset:18688
v_mfma_f32_16x16x32_bf16 v[44:47], a[8:11], a[152:155], v[44:47]
ds_read_b64_tr_b16 a[34:35], v3 offset:20992
s_waitcnt lgkmcnt(6)
v_mfma_f32_16x16x32_bf16 v[48:51], a[12:15], a[148:151], v[48:51]
ds_read_b64_tr_b16 a[0:1], v3 offset:27648
buffer_load_dwordx4 a[84:87], v7, s[8:11], s29 offen offset:2048
v_mfma_f32_16x16x32_bf16 v[52:55], a[12:15], a[152:155], v[52:55]
ds_read_b64_tr_b16 a[2:3], v3 offset:29952
v_mfma_f32_16x16x32_bf16 v[56:59], a[16:19], a[148:151], v[56:59]
ds_read_b64_tr_b16 a[4:5], v3 offset:27680
v_mfma_f32_16x16x32_bf16 v[60:63], a[16:19], a[152:155], v[60:63]
ds_read_b64_tr_b16 a[6:7], v3 offset:29984
buffer_load_dwordx4 v210, s[80:83], s28 offen offset:2048 lds
v_mfma_f32_16x16x32_bf16 v[64:67], a[20:23], a[148:151], v[64:67]
ds_read_b64_tr_b16 a[8:9], v3 offset:27712
v_mfma_f32_16x16x32_bf16 v[68:71], a[20:23], a[152:155], v[68:71]
ds_read_b64_tr_b16 a[10:11], v3 offset:30016
s_waitcnt lgkmcnt(6)
v_mfma_f32_16x16x32_bf16 v[72:75], a[24:27], a[148:151], v[72:75]
ds_read_b64_tr_b16 a[12:13], v3 offset:27744
v_mfma_f32_16x16x32_bf16 v[76:79], a[24:27], a[152:155], v[76:79]
ds_read_b64_tr_b16 a[14:15], v3 offset:30048
buffer_load_dwordx4 a[88:91], v8, s[8:11], s29 offen offset:2048
v_mfma_f32_16x16x32_bf16 v[80:83], a[28:31], a[148:151], v[80:83]
ds_read_b64_tr_b16 a[16:17], v3 offset:27776
v_mfma_f32_16x16x32_bf16 v[84:87], a[28:31], a[152:155], v[84:87]
ds_read_b64_tr_b16 a[18:19], v3 offset:30080
v_mfma_f32_16x16x32_bf16 v[88:91], a[32:35], a[148:151], v[88:91]
ds_read_b64_tr_b16 a[20:21], v3 offset:27808
buffer_load_dwordx4 v211, s[80:83], s28 offen offset:3072 lds
v_mfma_f32_16x16x32_bf16 v[92:95], a[32:35], a[152:155], v[92:95]
ds_read_b64_tr_b16 a[22:23], v3 offset:30112
s_waitcnt lgkmcnt(6)
v_mfma_f32_16x16x32_bf16 v[24:27], a[0:3], a[156:159], v[24:27]
ds_read_b64_tr_b16 a[24:25], v3 offset:27840
v_mfma_f32_16x16x32_bf16 v[28:31], a[0:3], a[160:163], v[28:31]
ds_read_b64_tr_b16 a[26:27], v3 offset:30144
s_add_u32 m0, s30, 118784
v_mfma_f32_16x16x32_bf16 v[32:35], a[4:7], a[156:159], v[32:35]
ds_read_b64_tr_b16 a[28:29], v3 offset:27872
v_mfma_f32_16x16x32_bf16 v[36:39], a[4:7], a[160:163], v[36:39]
ds_read_b64_tr_b16 a[30:31], v3 offset:30176
v_mfma_f32_16x16x32_bf16 v[40:43], a[8:11], a[156:159], v[40:43]
ds_read_b64_tr_b16 a[32:33], v3 offset:27904
buffer_load_dwordx4 a[92:95], v7, s[8:11], s29 offen offset:3072
v_mfma_f32_16x16x32_bf16 v[44:47], a[8:11], a[160:163], v[44:47]
ds_read_b64_tr_b16 a[34:35], v3 offset:30208
s_waitcnt vmcnt(15) lgkmcnt(6)
s_barrier
v_mfma_f32_16x16x32_bf16 v[48:51], a[12:15], a[156:159], v[48:51]
ds_read_b64_tr_b16 a[0:1], v4 offset:0
v_mfma_f32_16x16x32_bf16 v[52:55], a[12:15], a[160:163], v[52:55]
ds_read_b64_tr_b16 a[2:3], v4 offset:2304
v_mfma_f32_16x16x32_bf16 v[56:59], a[16:19], a[156:159], v[56:59]
ds_read_b64_tr_b16 a[4:5], v4 offset:32
buffer_load_dwordx4 v212, s[80:83], s28 offen offset:0 lds
v_mfma_f32_16x16x32_bf16 v[60:63], a[16:19], a[160:163], v[60:63]
ds_read_b64_tr_b16 a[6:7], v4 offset:2336
v_mfma_f32_16x16x32_bf16 v[64:67], a[20:23], a[156:159], v[64:67]
ds_read_b64_tr_b16 a[8:9], v4 offset:64
v_mfma_f32_16x16x32_bf16 v[68:71], a[20:23], a[160:163], v[68:71]
ds_read_b64_tr_b16 a[10:11], v4 offset:2368
buffer_load_dwordx4 a[96:99], v8, s[8:11], s29 offen offset:3072
s_waitcnt lgkmcnt(6)
v_mfma_f32_16x16x32_bf16 v[72:75], a[24:27], a[156:159], v[72:75]
ds_read_b64_tr_b16 a[12:13], v4 offset:96
v_mfma_f32_16x16x32_bf16 v[76:79], a[24:27], a[160:163], v[76:79]
ds_read_b64_tr_b16 a[14:15], v4 offset:2400
v_mfma_f32_16x16x32_bf16 v[80:83], a[28:31], a[156:159], v[80:83]
ds_read_b64_tr_b16 a[16:17], v4 offset:128
s_add_u32 s28, s28, s18
v_mfma_f32_16x16x32_bf16 v[84:87], a[28:31], a[160:163], v[84:87]
ds_read_b64_tr_b16 a[18:19], v4 offset:2432
v_mfma_f32_16x16x32_bf16 v[88:91], a[32:35], a[156:159], v[88:91]
ds_read_b64_tr_b16 a[20:21], v4 offset:160
v_mfma_f32_16x16x32_bf16 v[92:95], a[32:35], a[160:163], v[92:95]
ds_read_b64_tr_b16 a[22:23], v4 offset:2464
s_add_u32 s29, s29, s21
s_waitcnt lgkmcnt(6)
v_mfma_f32_16x16x32_bf16 v[24:27], a[0:3], a[36:39], v[24:27]
ds_read_b64_tr_b16 a[24:25], v4 offset:192
v_mfma_f32_16x16x32_bf16 v[28:31], a[0:3], a[40:43], v[28:31]
ds_read_b64_tr_b16 a[26:27], v4 offset:2496
v_mfma_f32_16x16x32_bf16 v[32:35], a[4:7], a[36:39], v[32:35]
ds_read_b64_tr_b16 a[28:29], v4 offset:224
v_mfma_f32_16x16x32_bf16 v[36:39], a[4:7], a[40:43], v[36:39]
ds_read_b64_tr_b16 a[30:31], v4 offset:2528
s_add_u32 m0, s30, 0
v_mfma_f32_16x16x32_bf16 v[40:43], a[8:11], a[36:39], v[40:43]
ds_read_b64_tr_b16 a[32:33], v4 offset:256
v_mfma_f32_16x16x32_bf16 v[44:47], a[8:11], a[40:43], v[44:47]
ds_read_b64_tr_b16 a[34:35], v4 offset:2560
s_waitcnt lgkmcnt(6)
v_mfma_f32_16x16x32_bf16 v[48:51], a[12:15], a[36:39], v[48:51]
ds_read_b64_tr_b16 a[0:1], v4 offset:9216
buffer_load_dwordx4 v204, s[80:83], s28 offen offset:0 lds
v_mfma_f32_16x16x32_bf16 v[52:55], a[12:15], a[40:43], v[52:55]
ds_read_b64_tr_b16 a[2:3], v4 offset:11520
v_mfma_f32_16x16x32_bf16 v[56:59], a[16:19], a[36:39], v[56:59]
ds_read_b64_tr_b16 a[4:5], v4 offset:9248
v_mfma_f32_16x16x32_bf16 v[60:63], a[16:19], a[40:43], v[60:63]
ds_read_b64_tr_b16 a[6:7], v4 offset:11552
buffer_load_dwordx4 a[100:103], v7, s[8:11], s29 offen offset:0
v_mfma_f32_16x16x32_bf16 v[64:67], a[20:23], a[36:39], v[64:67]
ds_read_b64_tr_b16 a[8:9], v4 offset:9280
v_mfma_f32_16x16x32_bf16 v[68:71], a[20:23], a[40:43], v[68:71]
ds_read_b64_tr_b16 a[10:11], v4 offset:11584
s_waitcnt lgkmcnt(6)
v_mfma_f32_16x16x32_bf16 v[72:75], a[24:27], a[36:39], v[72:75]
ds_read_b64_tr_b16 a[12:13], v4 offset:9312
v_mfma_f32_16x16x32_bf16 v[76:79], a[24:27], a[40:43], v[76:79]
ds_read_b64_tr_b16 a[14:15], v4 offset:11616
buffer_load_dwordx4 v205, s[80:83], s28 offen offset:1024 lds
v_mfma_f32_16x16x32_bf16 v[80:83], a[28:31], a[36:39], v[80:83]
ds_read_b64_tr_b16 a[16:17], v4 offset:9344
v_mfma_f32_16x16x32_bf16 v[84:87], a[28:31], a[40:43], v[84:87]
ds_read_b64_tr_b16 a[18:19], v4 offset:11648
v_mfma_f32_16x16x32_bf16 v[88:91], a[32:35], a[36:39], v[88:91]
ds_read_b64_tr_b16 a[20:21], v4 offset:9376
buffer_load_dwordx4 a[104:107], v8, s[8:11], s29 offen offset:0
v_mfma_f32_16x16x32_bf16 v[92:95], a[32:35], a[40:43], v[92:95]
ds_read_b64_tr_b16 a[22:23], v4 offset:11680
s_waitcnt lgkmcnt(6)
v_mfma_f32_16x16x32_bf16 v[24:27], a[0:3], a[44:47], v[24:27]
ds_read_b64_tr_b16 a[24:25], v4 offset:9408
v_mfma_f32_16x16x32_bf16 v[28:31], a[0:3], a[48:51], v[28:31]
ds_read_b64_tr_b16 a[26:27], v4 offset:11712
buffer_load_dwordx4 v206, s[80:83], s28 offen offset:2048 lds
v_mfma_f32_16x16x32_bf16 v[32:35], a[4:7], a[44:47], v[32:35]
ds_read_b64_tr_b16 a[28:29], v4 offset:9440
v_mfma_f32_16x16x32_bf16 v[36:39], a[4:7], a[48:51], v[36:39]
ds_read_b64_tr_b16 a[30:31], v4 offset:11744
v_mfma_f32_16x16x32_bf16 v[40:43], a[8:11], a[44:47], v[40:43]
ds_read_b64_tr_b16 a[32:33], v4 offset:9472
buffer_load_dwordx4 v207, s[80:83], s28 offen offset:3072 lds
v_mfma_f32_16x16x32_bf16 v[44:47], a[8:11], a[48:51], v[44:47]
ds_read_b64_tr_b16 a[34:35], v4 offset:11776
s_waitcnt lgkmcnt(6)
v_mfma_f32_16x16x32_bf16 v[48:51], a[12:15], a[44:47], v[48:51]
ds_read_b64_tr_b16 a[0:1], v4 offset:18432
v_mfma_f32_16x16x32_bf16 v[52:55], a[12:15], a[48:51], v[52:55]
ds_read_b64_tr_b16 a[2:3], v4 offset:20736
v_mfma_f32_16x16x32_bf16 v[56:59], a[16:19], a[44:47], v[56:59]
ds_read_b64_tr_b16 a[4:5], v4 offset:18464
buffer_load_dwordx4 a[108:111], v7, s[8:11], s29 offen offset:1024
v_mfma_f32_16x16x32_bf16 v[60:63], a[16:19], a[48:51], v[60:63]
ds_read_b64_tr_b16 a[6:7], v4 offset:20768
v_mfma_f32_16x16x32_bf16 v[64:67], a[20:23], a[44:47], v[64:67]
ds_read_b64_tr_b16 a[8:9], v4 offset:18496
v_mfma_f32_16x16x32_bf16 v[68:71], a[20:23], a[48:51], v[68:71]
ds_read_b64_tr_b16 a[10:11], v4 offset:20800
s_add_u32 m0, s30, 4096
s_waitcnt lgkmcnt(6)
v_mfma_f32_16x16x32_bf16 v[72:75], a[24:27], a[44:47], v[72:75]
ds_read_b64_tr_b16 a[12:13], v4 offset:18528
v_mfma_f32_16x16x32_bf16 v[76:79], a[24:27], a[48:51], v[76:79]
ds_read_b64_tr_b16 a[14:15], v4 offset:20832
v_mfma_f32_16x16x32_bf16 v[80:83], a[28:31], a[44:47], v[80:83]
ds_read_b64_tr_b16 a[16:17], v4 offset:18560
buffer_load_dwordx4 a[112:115], v8, s[8:11], s29 offen offset:1024
v_mfma_f32_16x16x32_bf16 v[84:87], a[28:31], a[48:51], v[84:87]
ds_read_b64_tr_b16 a[18:19], v4 offset:20864
v_mfma_f32_16x16x32_bf16 v[88:91], a[32:35], a[44:47], v[88:91]
ds_read_b64_tr_b16 a[20:21], v4 offset:18592
v_mfma_f32_16x16x32_bf16 v[92:95], a[32:35], a[48:51], v[92:95]
ds_read_b64_tr_b16 a[22:23], v4 offset:20896
buffer_load_dwordx4 v208, s[80:83], s28 offen offset:0 lds
s_waitcnt lgkmcnt(6)
v_mfma_f32_16x16x32_bf16 v[24:27], a[0:3], a[52:55], v[24:27]
ds_read_b64_tr_b16 a[24:25], v4 offset:18624
v_mfma_f32_16x16x32_bf16 v[28:31], a[0:3], a[56:59], v[28:31]
ds_read_b64_tr_b16 a[26:27], v4 offset:20928
v_mfma_f32_16x16x32_bf16 v[32:35], a[4:7], a[52:55], v[32:35]
ds_read_b64_tr_b16 a[28:29], v4 offset:18656
v_mfma_f32_16x16x32_bf16 v[36:39], a[4:7], a[56:59], v[36:39]
ds_read_b64_tr_b16 a[30:31], v4 offset:20960
buffer_load_dwordx4 v209, s[80:83], s28 offen offset:1024 lds
v_mfma_f32_16x16x32_bf16 v[40:43], a[8:11], a[52:55], v[40:43]
ds_read_b64_tr_b16 a[32:33], v4 offset:18688
v_mfma_f32_16x16x32_bf16 v[44:47], a[8:11], a[56:59], v[44:47]
ds_read_b64_tr_b16 a[34:35], v4 offset:20992
s_waitcnt lgkmcnt(6)
v_mfma_f32_16x16x32_bf16 v[48:51], a[12:15], a[52:55], v[48:51]
ds_read_b64_tr_b16 a[0:1], v4 offset:27648
buffer_load_dwordx4 a[116:119], v7, s[8:11], s29 offen offset:2048
v_mfma_f32_16x16x32_bf16 v[52:55], a[12:15], a[56:59], v[52:55]
ds_read_b64_tr_b16 a[2:3], v4 offset:29952
v_mfma_f32_16x16x32_bf16 v[56:59], a[16:19], a[52:55], v[56:59]
ds_read_b64_tr_b16 a[4:5], v4 offset:27680
v_mfma_f32_16x16x32_bf16 v[60:63], a[16:19], a[56:59], v[60:63]
ds_read_b64_tr_b16 a[6:7], v4 offset:29984
buffer_load_dwordx4 v210, s[80:83], s28 offen offset:2048 lds
v_mfma_f32_16x16x32_bf16 v[64:67], a[20:23], a[52:55], v[64:67]
ds_read_b64_tr_b16 a[8:9], v4 offset:27712
v_mfma_f32_16x16x32_bf16 v[68:71], a[20:23], a[56:59], v[68:71]
ds_read_b64_tr_b16 a[10:11], v4 offset:30016
s_waitcnt lgkmcnt(6)
v_mfma_f32_16x16x32_bf16 v[72:75], a[24:27], a[52:55], v[72:75]
ds_read_b64_tr_b16 a[12:13], v4 offset:27744
v_mfma_f32_16x16x32_bf16 v[76:79], a[24:27], a[56:59], v[76:79]
ds_read_b64_tr_b16 a[14:15], v4 offset:30048
buffer_load_dwordx4 a[120:123], v8, s[8:11], s29 offen offset:2048
v_mfma_f32_16x16x32_bf16 v[80:83], a[28:31], a[52:55], v[80:83]
ds_read_b64_tr_b16 a[16:17], v4 offset:27776
v_mfma_f32_16x16x32_bf16 v[84:87], a[28:31], a[56:59], v[84:87]
ds_read_b64_tr_b16 a[18:19], v4 offset:30080
v_mfma_f32_16x16x32_bf16 v[88:91], a[32:35], a[52:55], v[88:91]
ds_read_b64_tr_b16 a[20:21], v4 offset:27808
buffer_load_dwordx4 v211, s[80:83], s28 offen offset:3072 lds
v_mfma_f32_16x16x32_bf16 v[92:95], a[32:35], a[56:59], v[92:95]
ds_read_b64_tr_b16 a[22:23], v4 offset:30112
s_waitcnt lgkmcnt(6)
v_mfma_f32_16x16x32_bf16 v[24:27], a[0:3], a[60:63], v[24:27]
ds_read_b64_tr_b16 a[24:25], v4 offset:27840
v_mfma_f32_16x16x32_bf16 v[28:31], a[0:3], a[64:67], v[28:31]
ds_read_b64_tr_b16 a[26:27], v4 offset:30144
s_add_u32 m0, s30, 8192
v_mfma_f32_16x16x32_bf16 v[32:35], a[4:7], a[60:63], v[32:35]
ds_read_b64_tr_b16 a[28:29], v4 offset:27872
v_mfma_f32_16x16x32_bf16 v[36:39], a[4:7], a[64:67], v[36:39]
ds_read_b64_tr_b16 a[30:31], v4 offset:30176
v_mfma_f32_16x16x32_bf16 v[40:43], a[8:11], a[60:63], v[40:43]
ds_read_b64_tr_b16 a[32:33], v4 offset:27904
buffer_load_dwordx4 a[124:127], v7, s[8:11], s29 offen offset:3072
v_mfma_f32_16x16x32_bf16 v[44:47], a[8:11], a[64:67], v[44:47]
ds_read_b64_tr_b16 a[34:35], v4 offset:30208
s_waitcnt vmcnt(15) lgkmcnt(6)
s_barrier
v_mfma_f32_16x16x32_bf16 v[48:51], a[12:15], a[60:63], v[48:51]
ds_read_b64_tr_b16 a[0:1], v5 offset:0
v_mfma_f32_16x16x32_bf16 v[52:55], a[12:15], a[64:67], v[52:55]
ds_read_b64_tr_b16 a[2:3], v5 offset:2304
v_mfma_f32_16x16x32_bf16 v[56:59], a[16:19], a[60:63], v[56:59]
ds_read_b64_tr_b16 a[4:5], v5 offset:32
buffer_load_dwordx4 v212, s[80:83], s28 offen offset:0 lds
v_mfma_f32_16x16x32_bf16 v[60:63], a[16:19], a[64:67], v[60:63]
ds_read_b64_tr_b16 a[6:7], v5 offset:2336
v_mfma_f32_16x16x32_bf16 v[64:67], a[20:23], a[60:63], v[64:67]
ds_read_b64_tr_b16 a[8:9], v5 offset:64
v_mfma_f32_16x16x32_bf16 v[68:71], a[20:23], a[64:67], v[68:71]
ds_read_b64_tr_b16 a[10:11], v5 offset:2368
buffer_load_dwordx4 a[128:131], v8, s[8:11], s29 offen offset:3072
s_waitcnt lgkmcnt(6)
v_mfma_f32_16x16x32_bf16 v[72:75], a[24:27], a[60:63], v[72:75]
ds_read_b64_tr_b16 a[12:13], v5 offset:96
v_mfma_f32_16x16x32_bf16 v[76:79], a[24:27], a[64:67], v[76:79]
ds_read_b64_tr_b16 a[14:15], v5 offset:2400
v_mfma_f32_16x16x32_bf16 v[80:83], a[28:31], a[60:63], v[80:83]
ds_read_b64_tr_b16 a[16:17], v5 offset:128
s_add_u32 s28, s28, 147456
v_mfma_f32_16x16x32_bf16 v[84:87], a[28:31], a[64:67], v[84:87]
ds_read_b64_tr_b16 a[18:19], v5 offset:2432
v_mfma_f32_16x16x32_bf16 v[88:91], a[32:35], a[60:63], v[88:91]
ds_read_b64_tr_b16 a[20:21], v5 offset:160
v_mfma_f32_16x16x32_bf16 v[92:95], a[32:35], a[64:67], v[92:95]
ds_read_b64_tr_b16 a[22:23], v5 offset:2464
s_add_u32 s29, s29, 4096
s_waitcnt lgkmcnt(6)
v_mfma_f32_16x16x32_bf16 v[24:27], a[0:3], a[68:71], v[24:27]
ds_read_b64_tr_b16 a[24:25], v5 offset:192
v_mfma_f32_16x16x32_bf16 v[28:31], a[0:3], a[72:75], v[28:31]
ds_read_b64_tr_b16 a[26:27], v5 offset:2496
v_mfma_f32_16x16x32_bf16 v[32:35], a[4:7], a[68:71], v[32:35]
ds_read_b64_tr_b16 a[28:29], v5 offset:224
v_mfma_f32_16x16x32_bf16 v[36:39], a[4:7], a[72:75], v[36:39]
ds_read_b64_tr_b16 a[30:31], v5 offset:2528
s_add_u32 m0, s30, 36864
v_mfma_f32_16x16x32_bf16 v[40:43], a[8:11], a[68:71], v[40:43]
ds_read_b64_tr_b16 a[32:33], v5 offset:256
v_mfma_f32_16x16x32_bf16 v[44:47], a[8:11], a[72:75], v[44:47]
ds_read_b64_tr_b16 a[34:35], v5 offset:2560
s_waitcnt lgkmcnt(6)
v_mfma_f32_16x16x32_bf16 v[48:51], a[12:15], a[68:71], v[48:51]
ds_read_b64_tr_b16 a[0:1], v5 offset:9216
buffer_load_dwordx4 v204, s[80:83], s28 offen offset:0 lds
v_mfma_f32_16x16x32_bf16 v[52:55], a[12:15], a[72:75], v[52:55]
ds_read_b64_tr_b16 a[2:3], v5 offset:11520
v_mfma_f32_16x16x32_bf16 v[56:59], a[16:19], a[68:71], v[56:59]
ds_read_b64_tr_b16 a[4:5], v5 offset:9248
v_mfma_f32_16x16x32_bf16 v[60:63], a[16:19], a[72:75], v[60:63]
ds_read_b64_tr_b16 a[6:7], v5 offset:11552
buffer_load_dwordx4 a[132:135], v7, s[8:11], s29 offen offset:0
v_mfma_f32_16x16x32_bf16 v[64:67], a[20:23], a[68:71], v[64:67]
ds_read_b64_tr_b16 a[8:9], v5 offset:9280
v_mfma_f32_16x16x32_bf16 v[68:71], a[20:23], a[72:75], v[68:71]
ds_read_b64_tr_b16 a[10:11], v5 offset:11584
s_waitcnt lgkmcnt(6)
v_mfma_f32_16x16x32_bf16 v[72:75], a[24:27], a[68:71], v[72:75]
ds_read_b64_tr_b16 a[12:13], v5 offset:9312
v_mfma_f32_16x16x32_bf16 v[76:79], a[24:27], a[72:75], v[76:79]
ds_read_b64_tr_b16 a[14:15], v5 offset:11616
buffer_load_dwordx4 v205, s[80:83], s28 offen offset:1024 lds
v_mfma_f32_16x16x32_bf16 v[80:83], a[28:31], a[68:71], v[80:83]
ds_read_b64_tr_b16 a[16:17], v5 offset:9344
v_mfma_f32_16x16x32_bf16 v[84:87], a[28:31], a[72:75], v[84:87]
ds_read_b64_tr_b16 a[18:19], v5 offset:11648
v_mfma_f32_16x16x32_bf16 v[88:91], a[32:35], a[68:71], v[88:91]
ds_read_b64_tr_b16 a[20:21], v5 offset:9376
buffer_load_dwordx4 a[136:139], v8, s[8:11], s29 offen offset:0
v_mfma_f32_16x16x32_bf16 v[92:95], a[32:35], a[72:75], v[92:95]
ds_read_b64_tr_b16 a[22:23], v5 offset:11680
s_waitcnt lgkmcnt(6)
v_mfma_f32_16x16x32_bf16 v[24:27], a[0:3], a[76:79], v[24:27]
ds_read_b64_tr_b16 a[24:25], v5 offset:9408
v_mfma_f32_16x16x32_bf16 v[28:31], a[0:3], a[80:83], v[28:31]
ds_read_b64_tr_b16 a[26:27], v5 offset:11712
buffer_load_dwordx4 v206, s[80:83], s28 offen offset:2048 lds
v_mfma_f32_16x16x32_bf16 v[32:35], a[4:7], a[76:79], v[32:35]
ds_read_b64_tr_b16 a[28:29], v5 offset:9440
v_mfma_f32_16x16x32_bf16 v[36:39], a[4:7], a[80:83], v[36:39]
ds_read_b64_tr_b16 a[30:31], v5 offset:11744
v_mfma_f32_16x16x32_bf16 v[40:43], a[8:11], a[76:79], v[40:43]
ds_read_b64_tr_b16 a[32:33], v5 offset:9472
buffer_load_dwordx4 v207, s[80:83], s28 offen offset:3072 lds
v_mfma_f32_16x16x32_bf16 v[44:47], a[8:11], a[80:83], v[44:47]
ds_read_b64_tr_b16 a[34:35], v5 offset:11776
s_waitcnt lgkmcnt(6)
v_mfma_f32_16x16x32_bf16 v[48:51], a[12:15], a[76:79], v[48:51]
ds_read_b64_tr_b16 a[0:1], v5 offset:18432
v_mfma_f32_16x16x32_bf16 v[52:55], a[12:15], a[80:83], v[52:55]
ds_read_b64_tr_b16 a[2:3], v5 offset:20736
v_mfma_f32_16x16x32_bf16 v[56:59], a[16:19], a[76:79], v[56:59]
ds_read_b64_tr_b16 a[4:5], v5 offset:18464
buffer_load_dwordx4 a[140:143], v7, s[8:11], s29 offen offset:1024
v_mfma_f32_16x16x32_bf16 v[60:63], a[16:19], a[80:83], v[60:63]
ds_read_b64_tr_b16 a[6:7], v5 offset:20768
v_mfma_f32_16x16x32_bf16 v[64:67], a[20:23], a[76:79], v[64:67]
ds_read_b64_tr_b16 a[8:9], v5 offset:18496
v_mfma_f32_16x16x32_bf16 v[68:71], a[20:23], a[80:83], v[68:71]
ds_read_b64_tr_b16 a[10:11], v5 offset:20800
s_add_u32 m0, s30, 40960
s_waitcnt lgkmcnt(6)
v_mfma_f32_16x16x32_bf16 v[72:75], a[24:27], a[76:79], v[72:75]
ds_read_b64_tr_b16 a[12:13], v5 offset:18528
v_mfma_f32_16x16x32_bf16 v[76:79], a[24:27], a[80:83], v[76:79]
ds_read_b64_tr_b16 a[14:15], v5 offset:20832
v_mfma_f32_16x16x32_bf16 v[80:83], a[28:31], a[76:79], v[80:83]
ds_read_b64_tr_b16 a[16:17], v5 offset:18560
buffer_load_dwordx4 a[144:147], v8, s[8:11], s29 offen offset:1024
v_mfma_f32_16x16x32_bf16 v[84:87], a[28:31], a[80:83], v[84:87]
ds_read_b64_tr_b16 a[18:19], v5 offset:20864
v_mfma_f32_16x16x32_bf16 v[88:91], a[32:35], a[76:79], v[88:91]
ds_read_b64_tr_b16 a[20:21], v5 offset:18592
v_mfma_f32_16x16x32_bf16 v[92:95], a[32:35], a[80:83], v[92:95]
ds_read_b64_tr_b16 a[22:23], v5 offset:20896
buffer_load_dwordx4 v208, s[80:83], s28 offen offset:0 lds
s_waitcnt lgkmcnt(6)
v_mfma_f32_16x16x32_bf16 v[24:27], a[0:3], a[84:87], v[24:27]
ds_read_b64_tr_b16 a[24:25], v5 offset:18624
v_mfma_f32_16x16x32_bf16 v[28:31], a[0:3], a[88:91], v[28:31]
ds_read_b64_tr_b16 a[26:27], v5 offset:20928
v_mfma_f32_16x16x32_bf16 v[32:35], a[4:7], a[84:87], v[32:35]
ds_read_b64_tr_b16 a[28:29], v5 offset:18656
v_mfma_f32_16x16x32_bf16 v[36:39], a[4:7], a[88:91], v[36:39]
ds_read_b64_tr_b16 a[30:31], v5 offset:20960
buffer_load_dwordx4 v209, s[80:83], s28 offen offset:1024 lds
v_mfma_f32_16x16x32_bf16 v[40:43], a[8:11], a[84:87], v[40:43]
ds_read_b64_tr_b16 a[32:33], v5 offset:18688
v_mfma_f32_16x16x32_bf16 v[44:47], a[8:11], a[88:91], v[44:47]
ds_read_b64_tr_b16 a[34:35], v5 offset:20992
s_waitcnt lgkmcnt(6)
v_mfma_f32_16x16x32_bf16 v[48:51], a[12:15], a[84:87], v[48:51]
ds_read_b64_tr_b16 a[0:1], v5 offset:27648
buffer_load_dwordx4 a[148:151], v7, s[8:11], s29 offen offset:2048
v_mfma_f32_16x16x32_bf16 v[52:55], a[12:15], a[88:91], v[52:55]
ds_read_b64_tr_b16 a[2:3], v5 offset:29952
v_mfma_f32_16x16x32_bf16 v[56:59], a[16:19], a[84:87], v[56:59]
ds_read_b64_tr_b16 a[4:5], v5 offset:27680
v_mfma_f32_16x16x32_bf16 v[60:63], a[16:19], a[88:91], v[60:63]
ds_read_b64_tr_b16 a[6:7], v5 offset:29984
buffer_load_dwordx4 v210, s[80:83], s28 offen offset:2048 lds
v_mfma_f32_16x16x32_bf16 v[64:67], a[20:23], a[84:87], v[64:67]
ds_read_b64_tr_b16 a[8:9], v5 offset:27712
v_mfma_f32_16x16x32_bf16 v[68:71], a[20:23], a[88:91], v[68:71]
ds_read_b64_tr_b16 a[10:11], v5 offset:30016
s_waitcnt lgkmcnt(6)
v_mfma_f32_16x16x32_bf16 v[72:75], a[24:27], a[84:87], v[72:75]
ds_read_b64_tr_b16 a[12:13], v5 offset:27744
v_mfma_f32_16x16x32_bf16 v[76:79], a[24:27], a[88:91], v[76:79]
ds_read_b64_tr_b16 a[14:15], v5 offset:30048
buffer_load_dwordx4 a[152:155], v8, s[8:11], s29 offen offset:2048
v_mfma_f32_16x16x32_bf16 v[80:83], a[28:31], a[84:87], v[80:83]
ds_read_b64_tr_b16 a[16:17], v5 offset:27776
v_mfma_f32_16x16x32_bf16 v[84:87], a[28:31], a[88:91], v[84:87]
ds_read_b64_tr_b16 a[18:19], v5 offset:30080
v_mfma_f32_16x16x32_bf16 v[88:91], a[32:35], a[84:87], v[88:91]
ds_read_b64_tr_b16 a[20:21], v5 offset:27808
buffer_load_dwordx4 v211, s[80:83], s28 offen offset:3072 lds
v_mfma_f32_16x16x32_bf16 v[92:95], a[32:35], a[88:91], v[92:95]
ds_read_b64_tr_b16 a[22:23], v5 offset:30112
s_waitcnt lgkmcnt(6)
v_mfma_f32_16x16x32_bf16 v[24:27], a[0:3], a[92:95], v[24:27]
ds_read_b64_tr_b16 a[24:25], v5 offset:27840
v_mfma_f32_16x16x32_bf16 v[28:31], a[0:3], a[96:99], v[28:31]
ds_read_b64_tr_b16 a[26:27], v5 offset:30144
s_add_u32 m0, s30, 45056
v_mfma_f32_16x16x32_bf16 v[32:35], a[4:7], a[92:95], v[32:35]
ds_read_b64_tr_b16 a[28:29], v5 offset:27872
v_mfma_f32_16x16x32_bf16 v[36:39], a[4:7], a[96:99], v[36:39]
ds_read_b64_tr_b16 a[30:31], v5 offset:30176
v_mfma_f32_16x16x32_bf16 v[40:43], a[8:11], a[92:95], v[40:43]
ds_read_b64_tr_b16 a[32:33], v5 offset:27904
buffer_load_dwordx4 a[156:159], v7, s[8:11], s29 offen offset:3072
v_mfma_f32_16x16x32_bf16 v[44:47], a[8:11], a[96:99], v[44:47]
ds_read_b64_tr_b16 a[34:35], v5 offset:30208
s_waitcnt vmcnt(15) lgkmcnt(6)
s_barrier
v_mfma_f32_16x16x32_bf16 v[48:51], a[12:15], a[92:95], v[48:51]
ds_read_b64_tr_b16 a[0:1], v2 offset:0
v_mfma_f32_16x16x32_bf16 v[52:55], a[12:15], a[96:99], v[52:55]
ds_read_b64_tr_b16 a[2:3], v2 offset:2304
v_mfma_f32_16x16x32_bf16 v[56:59], a[16:19], a[92:95], v[56:59]
ds_read_b64_tr_b16 a[4:5], v2 offset:32
buffer_load_dwordx4 v212, s[80:83], s28 offen offset:0 lds
v_mfma_f32_16x16x32_bf16 v[60:63], a[16:19], a[96:99], v[60:63]
ds_read_b64_tr_b16 a[6:7], v2 offset:2336
v_mfma_f32_16x16x32_bf16 v[64:67], a[20:23], a[92:95], v[64:67]
ds_read_b64_tr_b16 a[8:9], v2 offset:64
v_mfma_f32_16x16x32_bf16 v[68:71], a[20:23], a[96:99], v[68:71]
ds_read_b64_tr_b16 a[10:11], v2 offset:2368
buffer_load_dwordx4 a[160:163], v8, s[8:11], s29 offen offset:3072
s_waitcnt lgkmcnt(6)
v_mfma_f32_16x16x32_bf16 v[72:75], a[24:27], a[92:95], v[72:75]
ds_read_b64_tr_b16 a[12:13], v2 offset:96
v_mfma_f32_16x16x32_bf16 v[76:79], a[24:27], a[96:99], v[76:79]
ds_read_b64_tr_b16 a[14:15], v2 offset:2400
v_mfma_f32_16x16x32_bf16 v[80:83], a[28:31], a[92:95], v[80:83]
ds_read_b64_tr_b16 a[16:17], v2 offset:128
s_add_u32 s28, s28, 147456
v_mfma_f32_16x16x32_bf16 v[84:87], a[28:31], a[96:99], v[84:87]
ds_read_b64_tr_b16 a[18:19], v2 offset:2432
v_mfma_f32_16x16x32_bf16 v[88:91], a[32:35], a[92:95], v[88:91]
ds_read_b64_tr_b16 a[20:21], v2 offset:160
v_mfma_f32_16x16x32_bf16 v[92:95], a[32:35], a[96:99], v[92:95]
ds_read_b64_tr_b16 a[22:23], v2 offset:2464
s_add_u32 s29, s29, 4096
s_waitcnt lgkmcnt(6)
v_mfma_f32_16x16x32_bf16 v[24:27], a[0:3], a[100:103], v[24:27]
ds_read_b64_tr_b16 a[24:25], v2 offset:192
v_mfma_f32_16x16x32_bf16 v[28:31], a[0:3], a[104:107], v[28:31]
ds_read_b64_tr_b16 a[26:27], v2 offset:2496
v_mfma_f32_16x16x32_bf16 v[32:35], a[4:7], a[100:103], v[32:35]
ds_read_b64_tr_b16 a[28:29], v2 offset:224
v_mfma_f32_16x16x32_bf16 v[36:39], a[4:7], a[104:107], v[36:39]
ds_read_b64_tr_b16 a[30:31], v2 offset:2528
v_mfma_f32_16x16x32_bf16 v[40:43], a[8:11], a[100:103], v[40:43]
ds_read_b64_tr_b16 a[32:33], v2 offset:256
v_mfma_f32_16x16x32_bf16 v[44:47], a[8:11], a[104:107], v[44:47]
ds_read_b64_tr_b16 a[34:35], v2 offset:2560
s_add_u32 m0, s30, 73728
s_waitcnt lgkmcnt(6)
v_mfma_f32_16x16x32_bf16 v[48:51], a[12:15], a[100:103], v[48:51]
ds_read_b64_tr_b16 a[0:1], v2 offset:9216
v_mfma_f32_16x16x32_bf16 v[52:55], a[12:15], a[104:107], v[52:55]
ds_read_b64_tr_b16 a[2:3], v2 offset:11520
v_mfma_f32_16x16x32_bf16 v[56:59], a[16:19], a[100:103], v[56:59]
ds_read_b64_tr_b16 a[4:5], v2 offset:9248
v_mfma_f32_16x16x32_bf16 v[60:63], a[16:19], a[104:107], v[60:63]
ds_read_b64_tr_b16 a[6:7], v2 offset:11552
v_mfma_f32_16x16x32_bf16 v[64:67], a[20:23], a[100:103], v[64:67]
ds_read_b64_tr_b16 a[8:9], v2 offset:9280
v_mfma_f32_16x16x32_bf16 v[68:71], a[20:23], a[104:107], v[68:71]
ds_read_b64_tr_b16 a[10:11], v2 offset:11584
buffer_load_dwordx4 v216, s[84:87], s93 offen offset:0 lds
s_waitcnt lgkmcnt(6)
v_mfma_f32_16x16x32_bf16 v[72:75], a[24:27], a[100:103], v[72:75]
ds_read_b64_tr_b16 a[12:13], v2 offset:9312
v_mfma_f32_16x16x32_bf16 v[76:79], a[24:27], a[104:107], v[76:79]
ds_read_b64_tr_b16 a[14:15], v2 offset:11616
v_mfma_f32_16x16x32_bf16 v[80:83], a[28:31], a[100:103], v[80:83]
ds_read_b64_tr_b16 a[16:17], v2 offset:9344
v_mfma_f32_16x16x32_bf16 v[84:87], a[28:31], a[104:107], v[84:87]
ds_read_b64_tr_b16 a[18:19], v2 offset:11648
v_mfma_f32_16x16x32_bf16 v[88:91], a[32:35], a[100:103], v[88:91]
ds_read_b64_tr_b16 a[20:21], v2 offset:9376
buffer_load_dwordx4 v217, s[84:87], s93 offen offset:1024 lds
v_mfma_f32_16x16x32_bf16 v[92:95], a[32:35], a[104:107], v[92:95]
ds_read_b64_tr_b16 a[22:23], v2 offset:11680
s_waitcnt lgkmcnt(6)
v_mfma_f32_16x16x32_bf16 v[24:27], a[0:3], a[108:111], v[24:27]
ds_read_b64_tr_b16 a[24:25], v2 offset:9408
v_mfma_f32_16x16x32_bf16 v[28:31], a[0:3], a[112:115], v[28:31]
ds_read_b64_tr_b16 a[26:27], v2 offset:11712
v_mfma_f32_16x16x32_bf16 v[32:35], a[4:7], a[108:111], v[32:35]
ds_read_b64_tr_b16 a[28:29], v2 offset:9440
v_mfma_f32_16x16x32_bf16 v[36:39], a[4:7], a[112:115], v[36:39]
ds_read_b64_tr_b16 a[30:31], v2 offset:11744
v_mfma_f32_16x16x32_bf16 v[40:43], a[8:11], a[108:111], v[40:43]
ds_read_b64_tr_b16 a[32:33], v2 offset:9472
buffer_load_dwordx4 v218, s[84:87], s93 offen offset:2048 lds
v_mfma_f32_16x16x32_bf16 v[44:47], a[8:11], a[112:115], v[44:47]
ds_read_b64_tr_b16 a[34:35], v2 offset:11776
s_waitcnt lgkmcnt(6)
v_mfma_f32_16x16x32_bf16 v[48:51], a[12:15], a[108:111], v[48:51]
ds_read_b64_tr_b16 a[0:1], v2 offset:18432
v_mfma_f32_16x16x32_bf16 v[52:55], a[12:15], a[112:115], v[52:55]
ds_read_b64_tr_b16 a[2:3], v2 offset:20736
v_mfma_f32_16x16x32_bf16 v[56:59], a[16:19], a[108:111], v[56:59]
ds_read_b64_tr_b16 a[4:5], v2 offset:18464
v_mfma_f32_16x16x32_bf16 v[60:63], a[16:19], a[112:115], v[60:63]
ds_read_b64_tr_b16 a[6:7], v2 offset:20768
buffer_load_dwordx4 v219, s[84:87], s93 offen offset:3072 lds
v_mfma_f32_16x16x32_bf16 v[64:67], a[20:23], a[108:111], v[64:67]
ds_read_b64_tr_b16 a[8:9], v2 offset:18496
v_mfma_f32_16x16x32_bf16 v[68:71], a[20:23], a[112:115], v[68:71]
ds_read_b64_tr_b16 a[10:11], v2 offset:20800
s_waitcnt lgkmcnt(6)
v_mfma_f32_16x16x32_bf16 v[72:75], a[24:27], a[108:111], v[72:75]
ds_read_b64_tr_b16 a[12:13], v2 offset:18528
v_mfma_f32_16x16x32_bf16 v[76:79], a[24:27], a[112:115], v[76:79]
ds_read_b64_tr_b16 a[14:15], v2 offset:20832
v_mfma_f32_16x16x32_bf16 v[80:83], a[28:31], a[108:111], v[80:83]
ds_read_b64_tr_b16 a[16:17], v2 offset:18560
v_mfma_f32_16x16x32_bf16 v[84:87], a[28:31], a[112:115], v[84:87]
ds_read_b64_tr_b16 a[18:19], v2 offset:20864
s_add_u32 m0, s30, 77824
v_mfma_f32_16x16x32_bf16 v[88:91], a[32:35], a[108:111], v[88:91]
ds_read_b64_tr_b16 a[20:21], v2 offset:18592
v_mfma_f32_16x16x32_bf16 v[92:95], a[32:35], a[112:115], v[92:95]
ds_read_b64_tr_b16 a[22:23], v2 offset:20896
s_waitcnt lgkmcnt(6)
v_mfma_f32_16x16x32_bf16 v[24:27], a[0:3], a[116:119], v[24:27]
ds_read_b64_tr_b16 a[24:25], v2 offset:18624
v_mfma_f32_16x16x32_bf16 v[28:31], a[0:3], a[120:123], v[28:31]
ds_read_b64_tr_b16 a[26:27], v2 offset:20928
v_mfma_f32_16x16x32_bf16 v[32:35], a[4:7], a[116:119], v[32:35]
ds_read_b64_tr_b16 a[28:29], v2 offset:18656
buffer_load_dwordx4 v220, s[84:87], s93 offen offset:0 lds
v_mfma_f32_16x16x32_bf16 v[36:39], a[4:7], a[120:123], v[36:39]
ds_read_b64_tr_b16 a[30:31], v2 offset:20960
v_mfma_f32_16x16x32_bf16 v[40:43], a[8:11], a[116:119], v[40:43]
ds_read_b64_tr_b16 a[32:33], v2 offset:18688
v_mfma_f32_16x16x32_bf16 v[44:47], a[8:11], a[120:123], v[44:47]
ds_read_b64_tr_b16 a[34:35], v2 offset:20992
s_waitcnt lgkmcnt(6)
v_mfma_f32_16x16x32_bf16 v[48:51], a[12:15], a[116:119], v[48:51]
ds_read_b64_tr_b16 a[0:1], v2 offset:27648
v_mfma_f32_16x16x32_bf16 v[52:55], a[12:15], a[120:123], v[52:55]
ds_read_b64_tr_b16 a[2:3], v2 offset:29952
v_mfma_f32_16x16x32_bf16 v[56:59], a[16:19], a[116:119], v[56:59]
ds_read_b64_tr_b16 a[4:5], v2 offset:27680
buffer_load_dwordx4 v221, s[84:87], s93 offen offset:1024 lds
v_mfma_f32_16x16x32_bf16 v[60:63], a[16:19], a[120:123], v[60:63]
ds_read_b64_tr_b16 a[6:7], v2 offset:29984
v_mfma_f32_16x16x32_bf16 v[64:67], a[20:23], a[116:119], v[64:67]
ds_read_b64_tr_b16 a[8:9], v2 offset:27712
v_mfma_f32_16x16x32_bf16 v[68:71], a[20:23], a[120:123], v[68:71]
ds_read_b64_tr_b16 a[10:11], v2 offset:30016
s_waitcnt lgkmcnt(6)
v_mfma_f32_16x16x32_bf16 v[72:75], a[24:27], a[116:119], v[72:75]
ds_read_b64_tr_b16 a[12:13], v2 offset:27744
v_mfma_f32_16x16x32_bf16 v[76:79], a[24:27], a[120:123], v[76:79]
ds_read_b64_tr_b16 a[14:15], v2 offset:30048
buffer_load_dwordx4 v222, s[84:87], s93 offen offset:2048 lds
v_mfma_f32_16x16x32_bf16 v[80:83], a[28:31], a[116:119], v[80:83]
ds_read_b64_tr_b16 a[16:17], v2 offset:27776
v_mfma_f32_16x16x32_bf16 v[84:87], a[28:31], a[120:123], v[84:87]
ds_read_b64_tr_b16 a[18:19], v2 offset:30080
v_mfma_f32_16x16x32_bf16 v[88:91], a[32:35], a[116:119], v[88:91]
ds_read_b64_tr_b16 a[20:21], v2 offset:27808
v_mfma_f32_16x16x32_bf16 v[92:95], a[32:35], a[120:123], v[92:95]
ds_read_b64_tr_b16 a[22:23], v2 offset:30112
s_waitcnt lgkmcnt(6)
v_mfma_f32_16x16x32_bf16 v[24:27], a[0:3], a[124:127], v[24:27]
ds_read_b64_tr_b16 a[24:25], v2 offset:27840
v_mfma_f32_16x16x32_bf16 v[28:31], a[0:3], a[128:131], v[28:31]
ds_read_b64_tr_b16 a[26:27], v2 offset:30144
buffer_load_dwordx4 v223, s[84:87], s93 offen offset:3072 lds
v_mfma_f32_16x16x32_bf16 v[32:35], a[4:7], a[124:127], v[32:35]
ds_read_b64_tr_b16 a[28:29], v2 offset:27872
v_mfma_f32_16x16x32_bf16 v[36:39], a[4:7], a[128:131], v[36:39]
ds_read_b64_tr_b16 a[30:31], v2 offset:30176
v_mfma_f32_16x16x32_bf16 v[40:43], a[8:11], a[124:127], v[40:43]
ds_read_b64_tr_b16 a[32:33], v2 offset:27904
v_mfma_f32_16x16x32_bf16 v[44:47], a[8:11], a[128:131], v[44:47]
ds_read_b64_tr_b16 a[34:35], v2 offset:30208
s_waitcnt vmcnt(8) lgkmcnt(6)
s_barrier
v_mfma_f32_16x16x32_bf16 v[48:51], a[12:15], a[124:127], v[48:51]
ds_read_b64_tr_b16 a[0:1], v3 offset:0
s_add_u32 m0, s30, 81920
v_mfma_f32_16x16x32_bf16 v[52:55], a[12:15], a[128:131], v[52:55]
ds_read_b64_tr_b16 a[2:3], v3 offset:2304
v_mfma_f32_16x16x32_bf16 v[56:59], a[16:19], a[124:127], v[56:59]
ds_read_b64_tr_b16 a[4:5], v3 offset:32
v_mfma_f32_16x16x32_bf16 v[60:63], a[16:19], a[128:131], v[60:63]
ds_read_b64_tr_b16 a[6:7], v3 offset:2336
v_mfma_f32_16x16x32_bf16 v[64:67], a[20:23], a[124:127], v[64:67]
ds_read_b64_tr_b16 a[8:9], v3 offset:64
v_mfma_f32_16x16x32_bf16 v[68:71], a[20:23], a[128:131], v[68:71]
ds_read_b64_tr_b16 a[10:11], v3 offset:2368
s_waitcnt lgkmcnt(6)
v_mfma_f32_16x16x32_bf16 v[72:75], a[24:27], a[124:127], v[72:75]
ds_read_b64_tr_b16 a[12:13], v3 offset:96
buffer_load_dwordx4 v224, s[84:87], s93 offen offset:0 lds
v_mfma_f32_16x16x32_bf16 v[76:79], a[24:27], a[128:131], v[76:79]
ds_read_b64_tr_b16 a[14:15], v3 offset:2400
v_mfma_f32_16x16x32_bf16 v[80:83], a[28:31], a[124:127], v[80:83]
ds_read_b64_tr_b16 a[16:17], v3 offset:128
v_mfma_f32_16x16x32_bf16 v[84:87], a[28:31], a[128:131], v[84:87]
ds_read_b64_tr_b16 a[18:19], v3 offset:2432
v_mfma_f32_16x16x32_bf16 v[88:91], a[32:35], a[124:127], v[88:91]
ds_read_b64_tr_b16 a[20:21], v3 offset:160
v_mfma_f32_16x16x32_bf16 v[92:95], a[32:35], a[128:131], v[92:95]
ds_read_b64_tr_b16 a[22:23], v3 offset:2464
s_add_u32 s93, s93, 1179648
s_waitcnt lgkmcnt(6)
v_mfma_f32_16x16x32_bf16 v[24:27], a[0:3], a[132:135], v[24:27]
ds_read_b64_tr_b16 a[24:25], v3 offset:192
v_mfma_f32_16x16x32_bf16 v[28:31], a[0:3], a[136:139], v[28:31]
ds_read_b64_tr_b16 a[26:27], v3 offset:2496
v_mfma_f32_16x16x32_bf16 v[32:35], a[4:7], a[132:135], v[32:35]
ds_read_b64_tr_b16 a[28:29], v3 offset:224
v_mfma_f32_16x16x32_bf16 v[36:39], a[4:7], a[136:139], v[36:39]
ds_read_b64_tr_b16 a[30:31], v3 offset:2528
v_mfma_f32_16x16x32_bf16 v[40:43], a[8:11], a[132:135], v[40:43]
ds_read_b64_tr_b16 a[32:33], v3 offset:256
v_mfma_f32_16x16x32_bf16 v[44:47], a[8:11], a[136:139], v[44:47]
ds_read_b64_tr_b16 a[34:35], v3 offset:2560
s_add_u32 m0, s30, 110592
s_waitcnt lgkmcnt(6)
v_mfma_f32_16x16x32_bf16 v[48:51], a[12:15], a[132:135], v[48:51]
ds_read_b64_tr_b16 a[0:1], v3 offset:9216
v_mfma_f32_16x16x32_bf16 v[52:55], a[12:15], a[136:139], v[52:55]
ds_read_b64_tr_b16 a[2:3], v3 offset:11520
v_mfma_f32_16x16x32_bf16 v[56:59], a[16:19], a[132:135], v[56:59]
ds_read_b64_tr_b16 a[4:5], v3 offset:9248
v_mfma_f32_16x16x32_bf16 v[60:63], a[16:19], a[136:139], v[60:63]
ds_read_b64_tr_b16 a[6:7], v3 offset:11552
v_mfma_f32_16x16x32_bf16 v[64:67], a[20:23], a[132:135], v[64:67]
ds_read_b64_tr_b16 a[8:9], v3 offset:9280
v_mfma_f32_16x16x32_bf16 v[68:71], a[20:23], a[136:139], v[68:71]
ds_read_b64_tr_b16 a[10:11], v3 offset:11584
buffer_load_dwordx4 v216, s[84:87], s93 offen offset:0 lds
s_waitcnt lgkmcnt(6)
v_mfma_f32_16x16x32_bf16 v[72:75], a[24:27], a[132:135], v[72:75]
ds_read_b64_tr_b16 a[12:13], v3 offset:9312
v_mfma_f32_16x16x32_bf16 v[76:79], a[24:27], a[136:139], v[76:79]
ds_read_b64_tr_b16 a[14:15], v3 offset:11616
v_mfma_f32_16x16x32_bf16 v[80:83], a[28:31], a[132:135], v[80:83]
ds_read_b64_tr_b16 a[16:17], v3 offset:9344
v_mfma_f32_16x16x32_bf16 v[84:87], a[28:31], a[136:139], v[84:87]
ds_read_b64_tr_b16 a[18:19], v3 offset:11648
v_mfma_f32_16x16x32_bf16 v[88:91], a[32:35], a[132:135], v[88:91]
ds_read_b64_tr_b16 a[20:21], v3 offset:9376
buffer_load_dwordx4 v217, s[84:87], s93 offen offset:1024 lds
v_mfma_f32_16x16x32_bf16 v[92:95], a[32:35], a[136:139], v[92:95]
ds_read_b64_tr_b16 a[22:23], v3 offset:11680
s_waitcnt lgkmcnt(6)
v_mfma_f32_16x16x32_bf16 v[24:27], a[0:3], a[140:143], v[24:27]
ds_read_b64_tr_b16 a[24:25], v3 offset:9408
v_mfma_f32_16x16x32_bf16 v[28:31], a[0:3], a[144:147], v[28:31]
ds_read_b64_tr_b16 a[26:27], v3 offset:11712
v_mfma_f32_16x16x32_bf16 v[32:35], a[4:7], a[140:143], v[32:35]
ds_read_b64_tr_b16 a[28:29], v3 offset:9440
v_mfma_f32_16x16x32_bf16 v[36:39], a[4:7], a[144:147], v[36:39]
ds_read_b64_tr_b16 a[30:31], v3 offset:11744
v_mfma_f32_16x16x32_bf16 v[40:43], a[8:11], a[140:143], v[40:43]
ds_read_b64_tr_b16 a[32:33], v3 offset:9472
buffer_load_dwordx4 v218, s[84:87], s93 offen offset:2048 lds
v_mfma_f32_16x16x32_bf16 v[44:47], a[8:11], a[144:147], v[44:47]
ds_read_b64_tr_b16 a[34:35], v3 offset:11776
s_waitcnt lgkmcnt(6)
v_mfma_f32_16x16x32_bf16 v[48:51], a[12:15], a[140:143], v[48:51]
ds_read_b64_tr_b16 a[0:1], v3 offset:18432
v_mfma_f32_16x16x32_bf16 v[52:55], a[12:15], a[144:147], v[52:55]
ds_read_b64_tr_b16 a[2:3], v3 offset:20736
v_mfma_f32_16x16x32_bf16 v[56:59], a[16:19], a[140:143], v[56:59]
ds_read_b64_tr_b16 a[4:5], v3 offset:18464
v_mfma_f32_16x16x32_bf16 v[60:63], a[16:19], a[144:147], v[60:63]
ds_read_b64_tr_b16 a[6:7], v3 offset:20768
buffer_load_dwordx4 v219, s[84:87], s93 offen offset:3072 lds
v_mfma_f32_16x16x32_bf16 v[64:67], a[20:23], a[140:143], v[64:67]
ds_read_b64_tr_b16 a[8:9], v3 offset:18496
v_mfma_f32_16x16x32_bf16 v[68:71], a[20:23], a[144:147], v[68:71]
ds_read_b64_tr_b16 a[10:11], v3 offset:20800
s_waitcnt lgkmcnt(6)
v_mfma_f32_16x16x32_bf16 v[72:75], a[24:27], a[140:143], v[72:75]
ds_read_b64_tr_b16 a[12:13], v3 offset:18528
v_mfma_f32_16x16x32_bf16 v[76:79], a[24:27], a[144:147], v[76:79]
ds_read_b64_tr_b16 a[14:15], v3 offset:20832
v_mfma_f32_16x16x32_bf16 v[80:83], a[28:31], a[140:143], v[80:83]
ds_read_b64_tr_b16 a[16:17], v3 offset:18560
v_mfma_f32_16x16x32_bf16 v[84:87], a[28:31], a[144:147], v[84:87]
ds_read_b64_tr_b16 a[18:19], v3 offset:20864
s_add_u32 m0, s30, 114688
v_mfma_f32_16x16x32_bf16 v[88:91], a[32:35], a[140:143], v[88:91]
ds_read_b64_tr_b16 a[20:21], v3 offset:18592
v_mfma_f32_16x16x32_bf16 v[92:95], a[32:35], a[144:147], v[92:95]
ds_read_b64_tr_b16 a[22:23], v3 offset:20896
s_waitcnt lgkmcnt(6)
v_mfma_f32_16x16x32_bf16 v[24:27], a[0:3], a[148:151], v[24:27]
ds_read_b64_tr_b16 a[24:25], v3 offset:18624
v_mfma_f32_16x16x32_bf16 v[28:31], a[0:3], a[152:155], v[28:31]
ds_read_b64_tr_b16 a[26:27], v3 offset:20928
v_mfma_f32_16x16x32_bf16 v[32:35], a[4:7], a[148:151], v[32:35]
ds_read_b64_tr_b16 a[28:29], v3 offset:18656
buffer_load_dwordx4 v220, s[84:87], s93 offen offset:0 lds
v_mfma_f32_16x16x32_bf16 v[36:39], a[4:7], a[152:155], v[36:39]
ds_read_b64_tr_b16 a[30:31], v3 offset:20960
v_mfma_f32_16x16x32_bf16 v[40:43], a[8:11], a[148:151], v[40:43]
ds_read_b64_tr_b16 a[32:33], v3 offset:18688
v_mfma_f32_16x16x32_bf16 v[44:47], a[8:11], a[152:155], v[44:47]
ds_read_b64_tr_b16 a[34:35], v3 offset:20992
s_waitcnt lgkmcnt(6)
v_mfma_f32_16x16x32_bf16 v[48:51], a[12:15], a[148:151], v[48:51]
ds_read_b64_tr_b16 a[0:1], v3 offset:27648
v_mfma_f32_16x16x32_bf16 v[52:55], a[12:15], a[152:155], v[52:55]
ds_read_b64_tr_b16 a[2:3], v3 offset:29952
v_mfma_f32_16x16x32_bf16 v[56:59], a[16:19], a[148:151], v[56:59]
ds_read_b64_tr_b16 a[4:5], v3 offset:27680
buffer_load_dwordx4 v221, s[84:87], s93 offen offset:1024 lds
v_mfma_f32_16x16x32_bf16 v[60:63], a[16:19], a[152:155], v[60:63]
ds_read_b64_tr_b16 a[6:7], v3 offset:29984
v_mfma_f32_16x16x32_bf16 v[64:67], a[20:23], a[148:151], v[64:67]
ds_read_b64_tr_b16 a[8:9], v3 offset:27712
v_mfma_f32_16x16x32_bf16 v[68:71], a[20:23], a[152:155], v[68:71]
ds_read_b64_tr_b16 a[10:11], v3 offset:30016
s_waitcnt lgkmcnt(6)
v_mfma_f32_16x16x32_bf16 v[72:75], a[24:27], a[148:151], v[72:75]
ds_read_b64_tr_b16 a[12:13], v3 offset:27744
v_mfma_f32_16x16x32_bf16 v[76:79], a[24:27], a[152:155], v[76:79]
ds_read_b64_tr_b16 a[14:15], v3 offset:30048
buffer_load_dwordx4 v222, s[84:87], s93 offen offset:2048 lds
v_mfma_f32_16x16x32_bf16 v[80:83], a[28:31], a[148:151], v[80:83]
ds_read_b64_tr_b16 a[16:17], v3 offset:27776
v_mfma_f32_16x16x32_bf16 v[84:87], a[28:31], a[152:155], v[84:87]
ds_read_b64_tr_b16 a[18:19], v3 offset:30080
v_mfma_f32_16x16x32_bf16 v[88:91], a[32:35], a[148:151], v[88:91]
ds_read_b64_tr_b16 a[20:21], v3 offset:27808
v_mfma_f32_16x16x32_bf16 v[92:95], a[32:35], a[152:155], v[92:95]
ds_read_b64_tr_b16 a[22:23], v3 offset:30112
s_waitcnt lgkmcnt(6)
v_mfma_f32_16x16x32_bf16 v[24:27], a[0:3], a[156:159], v[24:27]
ds_read_b64_tr_b16 a[24:25], v3 offset:27840
v_mfma_f32_16x16x32_bf16 v[28:31], a[0:3], a[160:163], v[28:31]
ds_read_b64_tr_b16 a[26:27], v3 offset:30144
buffer_load_dwordx4 v223, s[84:87], s93 offen offset:3072 lds
v_mfma_f32_16x16x32_bf16 v[32:35], a[4:7], a[156:159], v[32:35]
ds_read_b64_tr_b16 a[28:29], v3 offset:27872
v_mfma_f32_16x16x32_bf16 v[36:39], a[4:7], a[160:163], v[36:39]
ds_read_b64_tr_b16 a[30:31], v3 offset:30176
v_mfma_f32_16x16x32_bf16 v[40:43], a[8:11], a[156:159], v[40:43]
ds_read_b64_tr_b16 a[32:33], v3 offset:27904
v_mfma_f32_16x16x32_bf16 v[44:47], a[8:11], a[160:163], v[44:47]
ds_read_b64_tr_b16 a[34:35], v3 offset:30208
s_waitcnt lgkmcnt(6)
v_mfma_f32_16x16x32_bf16 v[48:51], a[12:15], a[156:159], v[48:51]
s_add_u32 m0, s30, 118784
v_mfma_f32_16x16x32_bf16 v[52:55], a[12:15], a[160:163], v[52:55]
v_mfma_f32_16x16x32_bf16 v[56:59], a[16:19], a[156:159], v[56:59]
v_mfma_f32_16x16x32_bf16 v[60:63], a[16:19], a[160:163], v[60:63]
v_mfma_f32_16x16x32_bf16 v[64:67], a[20:23], a[156:159], v[64:67]
v_mfma_f32_16x16x32_bf16 v[68:71], a[20:23], a[160:163], v[68:71]
s_waitcnt lgkmcnt(0)
v_mfma_f32_16x16x32_bf16 v[72:75], a[24:27], a[156:159], v[72:75]
buffer_load_dwordx4 v224, s[84:87], s93 offen offset:0 lds
v_mfma_f32_16x16x32_bf16 v[76:79], a[24:27], a[160:163], v[76:79]
v_mfma_f32_16x16x32_bf16 v[80:83], a[28:31], a[156:159], v[80:83]
v_mfma_f32_16x16x32_bf16 v[84:87], a[28:31], a[160:163], v[84:87]
v_mfma_f32_16x16x32_bf16 v[88:91], a[32:35], a[156:159], v[88:91]
v_mfma_f32_16x16x32_bf16 v[92:95], a[32:35], a[160:163], v[92:95]
s_add_u32 s93, s93, 1179648
s_load_dwordx2 s[8:9], s[0:1], 112
s_load_dwordx2 s[16:17], s[0:1], 0
s_mov_b32 s10, 2359296
s_mov_b32 s11, 0x20000
s_mov_b32 s18, 2359296
s_mov_b32 s19, 0x20000
v_cvt_pk_bf16_f32 v96, v24, v25
v_cvt_pk_bf16_f32 v97, v26, v27
v_cvt_pk_bf16_f32 v98, v32, v33
v_cvt_pk_bf16_f32 v99, v34, v35
s_nop 0
v_permlane16_swap_b32 v96, v98
v_permlane16_swap_b32 v97, v99
buffer_store_dwordx4 v[96:99], v14, s[4:7], s35 offen offset:0 sc0 sc1
v_cvt_pk_bf16_f32 v100, v28, v29
v_cvt_pk_bf16_f32 v101, v30, v31
v_cvt_pk_bf16_f32 v102, v36, v37
v_cvt_pk_bf16_f32 v103, v38, v39
s_nop 0
v_permlane16_swap_b32 v100, v102
v_permlane16_swap_b32 v101, v103
buffer_store_dwordx4 v[100:103], v15, s[4:7], s35 offen offset:0 sc0 sc1
v_cvt_pk_bf16_f32 v104, v40, v41
v_cvt_pk_bf16_f32 v105, v42, v43
v_cvt_pk_bf16_f32 v106, v48, v49
v_cvt_pk_bf16_f32 v107, v50, v51
s_nop 0
v_permlane16_swap_b32 v104, v106
v_permlane16_swap_b32 v105, v107
buffer_store_dwordx4 v[104:107], v14, s[4:7], s35 offen offset:1024 sc0 sc1
v_cvt_pk_bf16_f32 v96, v44, v45
v_cvt_pk_bf16_f32 v97, v46, v47
v_cvt_pk_bf16_f32 v98, v52, v53
v_cvt_pk_bf16_f32 v99, v54, v55
s_nop 0
v_permlane16_swap_b32 v96, v98
v_permlane16_swap_b32 v97, v99
buffer_store_dwordx4 v[96:99], v15, s[4:7], s35 offen offset:1024 sc0 sc1
v_cvt_pk_bf16_f32 v100, v56, v57
v_cvt_pk_bf16_f32 v101, v58, v59
v_cvt_pk_bf16_f32 v102, v64, v65
v_cvt_pk_bf16_f32 v103, v66, v67
s_nop 0
v_permlane16_swap_b32 v100, v102
v_permlane16_swap_b32 v101, v103
buffer_store_dwordx4 v[100:103], v14, s[4:7], s35 offen offset:2048 sc0 sc1
v_cvt_pk_bf16_f32 v104, v60, v61
v_cvt_pk_bf16_f32 v105, v62, v63
v_cvt_pk_bf16_f32 v106, v68, v69
v_cvt_pk_bf16_f32 v107, v70, v71
s_nop 0
v_permlane16_swap_b32 v104, v106
v_permlane16_swap_b32 v105, v107
buffer_store_dwordx4 v[104:107], v15, s[4:7], s35 offen offset:2048 sc0 sc1
v_cvt_pk_bf16_f32 v96, v72, v73
v_cvt_pk_bf16_f32 v97, v74, v75
v_cvt_pk_bf16_f32 v98, v80, v81
v_cvt_pk_bf16_f32 v99, v82, v83
s_nop 0
v_permlane16_swap_b32 v96, v98
v_permlane16_swap_b32 v97, v99
buffer_store_dwordx4 v[96:99], v14, s[4:7], s35 offen offset:3072 sc0 sc1
v_cvt_pk_bf16_f32 v100, v76, v77
v_cvt_pk_bf16_f32 v101, v78, v79
v_cvt_pk_bf16_f32 v102, v84, v85
v_cvt_pk_bf16_f32 v103, v86, v87
s_nop 0
v_permlane16_swap_b32 v100, v102
v_permlane16_swap_b32 v101, v103
buffer_store_dwordx4 v[100:103], v15, s[4:7], s35 offen offset:3072 sc0 sc1
v_cvt_pk_bf16_f32 v104, v88, v89
v_cvt_pk_bf16_f32 v105, v90, v91
v_cvt_pk_bf16_f32 v106, v92, v93
v_cvt_pk_bf16_f32 v107, v94, v95
s_nop 0
v_permlane16_swap_b32 v104, v106
v_permlane16_swap_b32 v105, v107
buffer_store_dwordx4 v[104:107], v16, s[4:7], s35 offen offset:0 sc0 sc1
v_and_b32 v10, 7, v1
v_lshrrev_b32 v11, 3, v1
s_lshl_b32 s3, s24, 3
v_add_u32 v11, s3, v11
s_lshl_b32 s3, s43, 3
v_add_u32 v17, s3, v10
v_mul_u32_u24 v240, 1152, v17
v_lshl_add_u32 v240, v11, 4, v240
s_lshr_b32 s3, s43, 1
s_mul_i32 s3, s3, 18432
v_and_b32 v17, 15, v17
v_lshlrev_b32 v17, 4, v17
v_lshl_add_u32 v243, v11, 8, v17
v_add_u32 v243, s3, v243
v_lshlrev_b32 v246, 5, v11
v_mul_u32_u24 v18, 12, v11
v_sub_u32 v242, v240, v18
v_add_u32 v242, 1024, v242
v_lshlrev_b32 v248, 3, v11
v_add_u32 v248, 2048, v248
v_lshrrev_b32 v18, 2, v11
v_lshl_add_u32 v17, v18, 8, v17
v_and_b32 v18, 3, v11
v_lshl_add_u32 v17, v18, 2, v17
s_add_u32 s3, s3, 16384
v_add_u32 v245, s3, v17
v_add_u32 v241, 512, v240
v_add_u32 v244, 8192, v243
v_add_u32 v247, 1024, v246
s_waitcnt lgkmcnt(0)
s_add_u32 s8, s8, 6291456
s_addc_u32 s9, s9, 0
s_lshr_b32 s39, s43, 2
s_lshl_b32 s39, s39, 4
s_lshl_b32 s3, s36, 7
s_add_u32 s3, s3, 655360
s_lshl_b32 s38, s39, 7
s_add_u32 s38, s38, 655360
v_and_b32 v21, 15, v1
v_lshlrev_b32 v21, 7, v21
v_mov_b32 v9, 0
s_waitcnt vmcnt(0)
buffer_store_dword v9, v9, s[88:91], s3 offen sc0 sc1
buffer_load_dwordx4 v[108:111], v240, s[16:19], 0 offen
buffer_load_dwordx4 v[112:115], v241, s[16:19], 0 offen
buffer_load_dword v116, v242, s[16:19], 0 offen
s_mov_b32 s27, 4608
buffer_load_dwordx4 v[120:123], v246, s[96:99], s27 offen offset:0
buffer_load_dwordx4 v[124:127], v246, s[96:99], s27 offen offset:16
buffer_load_dwordx4 v[128:131], v247, s[96:99], s27 offen offset:0
buffer_load_dwordx4 v[132:135], v247, s[96:99], s27 offen offset:16
buffer_load_dwordx2 v[136:137], v248, s[96:99], s27 offen
s_mov_b32 s27, 9216
buffer_load_dwordx4 v[144:147], v246, s[96:99], s27 offen offset:0
buffer_load_dwordx4 v[148:151], v246, s[96:99], s27 offen offset:16
buffer_load_dwordx4 v[152:155], v247, s[96:99], s27 offen offset:0
buffer_load_dwordx4 v[156:159], v247, s[96:99], s27 offen offset:16
buffer_load_dwordx2 v[160:161], v248, s[96:99], s27 offen
s_mov_b32 s27, 6912
buffer_load_dwordx4 v[168:171], v246, s[96:99], s27 offen offset:0
buffer_load_dwordx4 v[172:175], v246, s[96:99], s27 offen offset:16
buffer_load_dwordx4 v[176:179], v247, s[96:99], s27 offen offset:0
buffer_load_dwordx4 v[180:183], v247, s[96:99], s27 offen offset:16
buffer_load_dwordx2 v[184:185], v248, s[96:99], s27 offen
k1_p2:
buffer_load_dword v6, v21, s[88:91], s38 offen sc0 sc1
s_waitcnt vmcnt(0)
v_cmp_eq_u32 vcc, -1, v6
s_nop 0
s_cbranch_vccnz k1_p2
s_mov_b32 s27, 0
buffer_load_dwordx4 v[24:27], v243, s[4:7], s27 offen
s_mov_b32 s27, 2359296
buffer_load_dwordx4 v[28:31], v243, s[4:7], s27 offen
s_mov_b32 s27, 4718592
buffer_load_dwordx4 v[32:35], v243, s[4:7], s27 offen
s_mov_b32 s27, 7077888
buffer_load_dwordx4 v[36:39], v243, s[4:7], s27 offen
s_mov_b32 s27, 0
buffer_load_dwordx4 v[40:43], v244, s[4:7], s27 offen
s_mov_b32 s27, 2359296
buffer_load_dwordx4 v[44:47], v244, s[4:7], s27 offen
s_mov_b32 s27, 4718592
buffer_load_dwordx4 v[48:51], v244, s[4:7], s27 offen
s_mov_b32 s27, 7077888
buffer_load_dwordx4 v[52:55], v244, s[4:7], s27 offen
s_mov_b32 s27, 0
buffer_load_dword v56, v245, s[4:7], s27 offen
s_mov_b32 s27, 2359296
buffer_load_dword v60, v245, s[4:7], s27 offen
s_mov_b32 s27, 4718592
buffer_load_dword v64, v245, s[4:7], s27 offen
s_mov_b32 s27, 7077888
buffer_load_dword v68, v245, s[4:7], s27 offen
s_waitcnt vmcnt(8)
v_lshlrev_b32 v96, 16, v24
v_and_b32 v97, 0xffff0000, v24
v_lshlrev_b32 v98, 16, v25
v_and_b32 v99, 0xffff0000, v25
v_lshlrev_b32 v100, 16, v26
v_and_b32 v101, 0xffff0000, v26
v_lshlrev_b32 v102, 16, v27
v_and_b32 v103, 0xffff0000, v27
v_lshlrev_b32 v192, 16, v28
v_and_b32 v193, 0xffff0000, v28
v_lshlrev_b32 v194, 16, v29
v_and_b32 v195, 0xffff0000, v29
v_lshlrev_b32 v196, 16, v30
v_and_b32 v197, 0xffff0000, v30
v_lshlrev_b32 v198, 16, v31
v_and_b32 v199, 0xffff0000, v31
v_pk_add_f32 v[96:97], v[96:97], v[192:193]
v_pk_add_f32 v[98:99], v[98:99], v[194:195]
v_pk_add_f32 v[100:101], v[100:101], v[196:197]
v_pk_add_f32 v[102:103], v[102:103], v[198:199]
v_lshlrev_b32 v192, 16, v32
v_and_b32 v193, 0xffff0000, v32
v_lshlrev_b32 v194, 16, v33
v_and_b32 v195, 0xffff0000, v33
v_lshlrev_b32 v196, 16, v34
v_and_b32 v197, 0xffff0000, v34
v_lshlrev_b32 v198, 16, v35
v_and_b32 v199, 0xffff0000, v35
v_pk_add_f32 v[96:97], v[96:97], v[192:193]
v_pk_add_f32 v[98:99], v[98:99], v[194:195]
v_pk_add_f32 v[100:101], v[100:101], v[196:197]
v_pk_add_f32 v[102:103], v[102:103], v[198:199]
v_lshlrev_b32 v192, 16, v36
v_and_b32 v193, 0xffff0000, v36
v_lshlrev_b32 v194, 16, v37
v_and_b32 v195, 0xffff0000, v37
v_lshlrev_b32 v196, 16, v38
v_and_b32 v197, 0xffff0000, v38
v_lshlrev_b32 v198, 16, v39
v_and_b32 v199, 0xffff0000, v39
v_pk_add_f32 v[96:97], v[96:97], v[192:193]
v_pk_add_f32 v[98:99], v[98:99], v[194:195]
v_pk_add_f32 v[100:101], v[100:101], v[196:197]
v_pk_add_f32 v[102:103], v[102:103], v[198:199]
v_lshlrev_b32 v72, 16, v108
v_and_b32 v73, 0xffff0000, v108
v_lshlrev_b32 v74, 16, v109
v_and_b32 v75, 0xffff0000, v109
v_lshlrev_b32 v76, 16, v110
v_and_b32 v77, 0xffff0000, v110
v_lshlrev_b32 v78, 16, v111
v_and_b32 v79, 0xffff0000, v111
v_fmac_f32 v72, v96, v120
v_fmac_f32 v73, v97, v121
v_fmac_f32 v74, v98, v122
v_fmac_f32 v75, v99, v123
v_fmac_f32 v76, v100, v124
v_fmac_f32 v77, v101, v125
v_fmac_f32 v78, v102, v126
v_fmac_f32 v79, v103, v127
v_cvt_pk_bf16_f32 v108, v72, v73
v_cvt_pk_bf16_f32 v109, v74, v75
v_cvt_pk_bf16_f32 v110, v76, v77
v_cvt_pk_bf16_f32 v111, v78, v79
v_lshlrev_b32 v72, 16, v108
v_and_b32 v73, 0xffff0000, v108
v_lshlrev_b32 v74, 16, v109
v_and_b32 v75, 0xffff0000, v109
v_lshlrev_b32 v76, 16, v110
v_and_b32 v77, 0xffff0000, v110
v_lshlrev_b32 v78, 16, v111
v_and_b32 v79, 0xffff0000, v111
s_waitcnt vmcnt(4)
v_lshlrev_b32 v96, 16, v40
v_and_b32 v97, 0xffff0000, v40
v_lshlrev_b32 v98, 16, v41
v_and_b32 v99, 0xffff0000, v41
v_lshlrev_b32 v100, 16, v42
v_and_b32 v101, 0xffff0000, v42
v_lshlrev_b32 v102, 16, v43
v_and_b32 v103, 0xffff0000, v43
v_lshlrev_b32 v192, 16, v44
v_and_b32 v193, 0xffff0000, v44
v_lshlrev_b32 v194, 16, v45
v_and_b32 v195, 0xffff0000, v45
v_lshlrev_b32 v196, 16, v46
v_and_b32 v197, 0xffff0000, v46
v_lshlrev_b32 v198, 16, v47
v_and_b32 v199, 0xffff0000, v47
v_pk_add_f32 v[96:97], v[96:97], v[192:193]
v_pk_add_f32 v[98:99], v[98:99], v[194:195]
v_pk_add_f32 v[100:101], v[100:101], v[196:197]
v_pk_add_f32 v[102:103], v[102:103], v[198:199]
v_lshlrev_b32 v192, 16, v48
v_and_b32 v193, 0xffff0000, v48
v_lshlrev_b32 v194, 16, v49
v_and_b32 v195, 0xffff0000, v49
v_lshlrev_b32 v196, 16, v50
v_and_b32 v197, 0xffff0000, v50
v_lshlrev_b32 v198, 16, v51
v_and_b32 v199, 0xffff0000, v51
v_pk_add_f32 v[96:97], v[96:97], v[192:193]
v_pk_add_f32 v[98:99], v[98:99], v[194:195]
v_pk_add_f32 v[100:101], v[100:101], v[196:197]
v_pk_add_f32 v[102:103], v[102:103], v[198:199]
v_lshlrev_b32 v192, 16, v52
v_and_b32 v193, 0xffff0000, v52
v_lshlrev_b32 v194, 16, v53
v_and_b32 v195, 0xffff0000, v53
v_lshlrev_b32 v196, 16, v54
v_and_b32 v197, 0xffff0000, v54
v_lshlrev_b32 v198, 16, v55
v_and_b32 v199, 0xffff0000, v55
v_pk_add_f32 v[96:97], v[96:97], v[192:193]
v_pk_add_f32 v[98:99], v[98:99], v[194:195]
v_pk_add_f32 v[100:101], v[100:101], v[196:197]
v_pk_add_f32 v[102:103], v[102:103], v[198:199]
v_lshlrev_b32 v80, 16, v112
v_and_b32 v81, 0xffff0000, v112
v_lshlrev_b32 v82, 16, v113
v_and_b32 v83, 0xffff0000, v113
v_lshlrev_b32 v84, 16, v114
v_and_b32 v85, 0xffff0000, v114
v_lshlrev_b32 v86, 16, v115
v_and_b32 v87, 0xffff0000, v115
v_fmac_f32 v80, v96, v128
v_fmac_f32 v81, v97, v129
v_fmac_f32 v82, v98, v130
v_fmac_f32 v83, v99, v131
v_fmac_f32 v84, v100, v132
v_fmac_f32 v85, v101, v133
v_fmac_f32 v86, v102, v134
v_fmac_f32 v87, v103, v135
v_cvt_pk_bf16_f32 v112, v80, v81
v_cvt_pk_bf16_f32 v113, v82, v83
v_cvt_pk_bf16_f32 v114, v84, v85
v_cvt_pk_bf16_f32 v115, v86, v87
v_lshlrev_b32 v80, 16, v112
v_and_b32 v81, 0xffff0000, v112
v_lshlrev_b32 v82, 16, v113
v_and_b32 v83, 0xffff0000, v113
v_lshlrev_b32 v84, 16, v114
v_and_b32 v85, 0xffff0000, v114
v_lshlrev_b32 v86, 16, v115
v_and_b32 v87, 0xffff0000, v115
s_waitcnt vmcnt(0)
v_lshlrev_b32 v96, 16, v56
v_and_b32 v97, 0xffff0000, v56
v_lshlrev_b32 v192, 16, v60
v_and_b32 v193, 0xffff0000, v60
v_pk_add_f32 v[96:97], v[96:97], v[192:193]
v_lshlrev_b32 v192, 16, v64
v_and_b32 v193, 0xffff0000, v64
v_pk_add_f32 v[96:97], v[96:97], v[192:193]
v_lshlrev_b32 v192, 16, v68
v_and_b32 v193, 0xffff0000, v68
v_pk_add_f32 v[96:97], v[96:97], v[192:193]
v_lshlrev_b32 v88, 16, v116
v_and_b32 v89, 0xffff0000, v116
v_fmac_f32 v88, v96, v136
v_fmac_f32 v89, v97, v137
v_cvt_pk_bf16_f32 v116, v88, v89
v_lshlrev_b32 v88, 16, v116
v_and_b32 v89, 0xffff0000, v116
v_add_f32 v6, v72, v73
v_mul_f32 v9, v72, v72
v_fmac_f32 v9, v73, v73
v_add_f32 v6, v6, v74
v_fmac_f32 v9, v74, v74
v_add_f32 v6, v6, v75
v_fmac_f32 v9, v75, v75
v_add_f32 v6, v6, v76
v_fmac_f32 v9, v76, v76
v_add_f32 v6, v6, v77
v_fmac_f32 v9, v77, v77
v_add_f32 v6, v6, v78
v_fmac_f32 v9, v78, v78
v_add_f32 v6, v6, v79
v_fmac_f32 v9, v79, v79
v_add_f32 v6, v6, v80
v_fmac_f32 v9, v80, v80
v_add_f32 v6, v6, v81
v_fmac_f32 v9, v81, v81
v_add_f32 v6, v6, v82
v_fmac_f32 v9, v82, v82
v_add_f32 v6, v6, v83
v_fmac_f32 v9, v83, v83
v_add_f32 v6, v6, v84
v_fmac_f32 v9, v84, v84
v_add_f32 v6, v6, v85
v_fmac_f32 v9, v85, v85
v_add_f32 v6, v6, v86
v_fmac_f32 v9, v86, v86
v_add_f32 v6, v6, v87
v_fmac_f32 v9, v87, v87
v_add_f32 v6, v6, v88
v_fmac_f32 v9, v88, v88
v_add_f32 v6, v6, v89
v_fmac_f32 v9, v89, v89
s_nop 0
v_add_f32_dpp v6, v6, v6 row_ror:8 row_mask:0xf bank_mask:0xf
v_add_f32_dpp v9, v9, v9 row_ror:8 row_mask:0xf bank_mask:0xf
s_nop 1
v_permlane16_swap_b32 v6, v9
v_add_f32 v6, v6, v9
v_mov_b32 v9, v6
s_nop 1
v_permlane32_swap_b32 v6, v9
v_add_f32 v6, v6, v9
v_and_b32 v17, 31, v1
v_lshlrev_b32 v17, 2, v17
s_lshl_b32 s3, s24, 7
v_add_u32 v17, s3, v17
ds_write_b32 v17, v6
v_lshlrev_b32 v9, 2, v10
v_accvgpr_write_b32 a240, v108
v_accvgpr_write_b32 a241, v109
v_accvgpr_write_b32 a242, v110
v_accvgpr_write_b32 a243, v111
v_accvgpr_write_b32 a244, v112
v_accvgpr_write_b32 a245, v113
v_accvgpr_write_b32 a246, v114
v_accvgpr_write_b32 a247, v115
v_accvgpr_write_b32 a248, v116
s_waitcnt lgkmcnt(0)
s_barrier
ds_read2_b32 v[24:25], v9 offset0:0 offset1:16
ds_read2_b32 v[26:27], v9 offset0:32 offset1:48
ds_read2_b32 v[28:29], v9 offset0:64 offset1:80
ds_read2_b32 v[30:31], v9 offset0:96 offset1:112
s_waitcnt lgkmcnt(0)
v_add_f32 v24, v24, v26
v_add_f32 v25, v25, v27
v_add_f32 v24, v24, v28
v_add_f32 v25, v25, v29
v_add_f32 v24, v24, v30
v_add_f32 v25, v25, v31
v_mul_f32 v24, 0x3ae38e39, v24
v_mul_f32 v25, 0x3ae38e39, v25
v_fma_f32 v25, -v24, v24, v25
v_max_f32 v25, 0, v25
v_add_f32 v25, 0x3727c5ac, v25
v_rsq_f32 v10, v25
s_nop 0
v_mul_f32 v11, v24, v10
v_sub_f32 v11, 0, v11
v_fma_f32 v72, v72, v10, v11
v_fma_f32 v72, v72, v144, v168
v_fma_f32 v73, v73, v10, v11
v_fma_f32 v73, v73, v145, v169
v_fma_f32 v74, v74, v10, v11
v_fma_f32 v74, v74, v146, v170
v_fma_f32 v75, v75, v10, v11
v_fma_f32 v75, v75, v147, v171
v_fma_f32 v76, v76, v10, v11
v_fma_f32 v76, v76, v148, v172
v_fma_f32 v77, v77, v10, v11
v_fma_f32 v77, v77, v149, v173
v_fma_f32 v78, v78, v10, v11
v_fma_f32 v78, v78, v150, v174
v_fma_f32 v79, v79, v10, v11
v_fma_f32 v79, v79, v151, v175
v_cvt_pk_bf16_f32 v28, v72, v73
v_cvt_pk_bf16_f32 v29, v74, v75
v_cvt_pk_bf16_f32 v30, v76, v77
v_cvt_pk_bf16_f32 v31, v78, v79
buffer_store_dwordx4 v[28:31], v243, s[8:11], 0 offen sc0 sc1
v_fma_f32 v80, v80, v10, v11
v_fma_f32 v80, v80, v152, v176
v_fma_f32 v81, v81, v10, v11
v_fma_f32 v81, v81, v153, v177
v_fma_f32 v82, v82, v10, v11
v_fma_f32 v82, v82, v154, v178
v_fma_f32 v83, v83, v10, v11
v_fma_f32 v83, v83, v155, v179
v_fma_f32 v84, v84, v10, v11
v_fma_f32 v84, v84, v156, v180
v_fma_f32 v85, v85, v10, v11
v_fma_f32 v85, v85, v157, v181
v_fma_f32 v86, v86, v10, v11
v_fma_f32 v86, v86, v158, v182
v_fma_f32 v87, v87, v10, v11
v_fma_f32 v87, v87, v159, v183
v_cvt_pk_bf16_f32 v32, v80, v81
v_cvt_pk_bf16_f32 v33, v82, v83
v_cvt_pk_bf16_f32 v34, v84, v85
v_cvt_pk_bf16_f32 v35, v86, v87
buffer_store_dwordx4 v[32:35], v244, s[8:11], 0 offen sc0 sc1
v_fma_f32 v88, v88, v10, v11
v_fma_f32 v88, v88, v160, v184
v_fma_f32 v89, v89, v10, v11
v_fma_f32 v89, v89, v161, v185
v_cvt_pk_bf16_f32 v36, v88, v89
buffer_store_dword v36, v245, s[8:11], 0 offen sc0 sc1
s_load_dwordx2 s[12:13], s[0:1], 112
s_load_dwordx2 s[16:17], s[0:1], 112
s_load_dwordx2 s[20:21], s[0:1], 112
s_load_dwordx2 s[44:45], s[0:1], 64
s_load_dwordx2 s[48:49], s[0:1], 72
s_mov_b32 s14, 9437184
s_mov_b32 s15, 0x20000
s_mov_b32 s18, 9437184
s_mov_b32 s19, 0x20000
s_mov_b32 s22, 1310720
s_mov_b32 s23, 0x20000
s_mov_b32 s46, 4096
s_mov_b32 s47, 0x20000
s_mov_b32 s50, 2654208
s_mov_b32 s51, 0x20000
s_and_b32 s25, s2, 3
s_lshl_b32 s25, s25, 2
s_bfe_u32 s3, s2, 0x20003
s_add_u32 s25, s25, s3
s_bfe_u32 s26, s2, 0x10002
s_lshl_b32 s26, s26, 3
s_lshr_b32 s3, s2, 5
s_add_u32 s26, s26, s3
s_lshl_b32 s34, s25, 2
s_add_u32 s34, s34, s24
s_lshl_b32 s36, s34, 4
s_add_u32 s36, s36, s26
s_mul_i32 s37, s36, 9216
v_lshlrev_b32 v20, 4, v1
s_mul_i32 s29, s34, 36864
s_mul_i32 s35, s26, 589824
s_mul_i32 s3, s34, 9216
s_add_u32 s35, s35, s3
s_lshl_b32 s40, s34, 12
v_add_u32 v8, 18432, v7
s_mov_b32 s3, 1179648
s_mov_b32 s39, 4290833920
s_cmp_ge_u32 s24, 2
s_cselect_b32 s41, s39, s3
s_cselect_b32 s42, s3, s39
s_lshl_b32 s27, s43, 2
s_add_u32 s27, s27, s24
s_lshl_b32 s39, s34, 4
s_waitcnt lgkmcnt(0)
s_add_u32 s12, s12, 50331648
s_addc_u32 s13, s13, 0
s_add_u32 s16, s16, 83886080
s_addc_u32 s17, s17, 0
s_add_u32 s20, s20, 9437184
s_addc_u32 s21, s21, 0
s_lshl_b32 s3, s27, 7
s_add_u32 s3, s3, 786432
s_lshl_b32 s38, s39, 7
s_add_u32 s38, s38, 786432
v_and_b32 v21, 15, v1
v_lshlrev_b32 v21, 7, v21
v_mov_b32 v9, 0
s_waitcnt vmcnt(0)
buffer_store_dword v9, v9, s[88:91], s3 offen sc0 sc1
s_barrier
s_add_u32 m0, s30, 0
s_nop 0
buffer_load_dwordx4 v216, s[84:87], s93 offen offset:0 lds
buffer_load_dwordx4 v217, s[84:87], s93 offen offset:1024 lds
buffer_load_dwordx4 v218, s[84:87], s93 offen offset:2048 lds
buffer_load_dwordx4 v219, s[84:87], s93 offen offset:3072 lds
s_add_u32 m0, s30, 4096
s_nop 0
buffer_load_dwordx4 v220, s[84:87], s93 offen offset:0 lds
buffer_load_dwordx4 v221, s[84:87], s93 offen offset:1024 lds
buffer_load_dwordx4 v222, s[84:87], s93 offen offset:2048 lds
buffer_load_dwordx4 v223, s[84:87], s93 offen offset:3072 lds
s_add_u32 m0, s30, 8192
s_nop 0
buffer_load_dwordx4 v224, s[84:87], s93 offen offset:0 lds
s_add_u32 s93, s93, 1179648
v_and_b32 v22, 3, v13
v_bfe_u32 v18, v13, 2, 1
v_lshl_add_u32 v22, v18, 3, v22
v_bfe_u32 v18, v13, 3, 1
v_lshl_add_u32 v22, v18, 2, v22
v_and_b32 v17, 1, v12
v_lshrrev_b32 v18, 1, v12
v_lshl_add_u32 v14, v17, 1, v18
v_mul_u32_u24 v14, 16, v14
v_mul_u32_u24 v19, 288, v22
v_add_u32 v14, v14, v19
v_add_u32 v15, 4608, v14
v_add_u32 v18, 16, v18
v_mul_u32_u24 v18, 16, v18
v_mul_u32_u24 v17, 4608, v17
v_add3_u32 v16, v17, v18, v19
v_mov_b32 v180, 0xbdd2d3e8
v_mov_b32 v181, 0xbdd2d3e8
v_mov_b32 v182, 0xc0135761
v_mov_b32 v183, 0xc0135761
v_mov_b32 v184, 0x3f800000
v_mov_b32 v185, 0x3f800000
k3_p1:
buffer_load_dword v6, v21, s[88:91], s38 offen sc0 sc1
s_waitcnt vmcnt(0)
v_cmp_eq_u32 vcc, -1, v6
s_nop 0
s_cbranch_vccnz k3_p1
s_lshl_b32 s38, s36, 8
v_lshlrev_b32 v21, 2, v1
buffer_load_dwordx4 a[36:39], v7, s[8:11], s29 offen offset:0
buffer_load_dwordx4 a[40:43], v8, s[8:11], s29 offen offset:0
buffer_load_dwordx4 a[44:47], v7, s[8:11], s29 offen offset:1024
buffer_load_dwordx4 a[48:51], v8, s[8:11], s29 offen offset:1024
buffer_load_dwordx4 a[52:55], v7, s[8:11], s29 offen offset:2048
buffer_load_dwordx4 a[56:59], v8, s[8:11], s29 offen offset:2048
buffer_load_dwordx4 a[60:63], v7, s[8:11], s29 offen offset:3072
buffer_load_dwordx4 a[64:67], v8, s[8:11], s29 offen offset:3072
s_add_u32 s29, s29, 4096
buffer_load_dwordx4 a[68:71], v7, s[8:11], s29 offen offset:0
buffer_load_dwordx4 a[72:75], v8, s[8:11], s29 offen offset:0
buffer_load_dwordx4 a[76:79], v7, s[8:11], s29 offen offset:1024
buffer_load_dwordx4 a[80:83], v8, s[8:11], s29 offen offset:1024
buffer_load_dwordx4 a[84:87], v7, s[8:11], s29 offen offset:2048
buffer_load_dwordx4 a[88:91], v8, s[8:11], s29 offen offset:2048
buffer_load_dwordx4 a[92:95], v7, s[8:11], s29 offen offset:3072
buffer_load_dwordx4 a[96:99], v8, s[8:11], s29 offen offset:3072
s_add_u32 s29, s29, 4096
s_waitcnt vmcnt(8)
s_barrier
ds_read_b64_tr_b16 a[0:1], v4 offset:0
ds_read_b64_tr_b16 a[2:3], v4 offset:2304
ds_read_b64_tr_b16 a[4:5], v4 offset:32
ds_read_b64_tr_b16 a[6:7], v4 offset:2336
ds_read_b64_tr_b16 a[8:9], v4 offset:64
ds_read_b64_tr_b16 a[10:11], v4 offset:2368
ds_read_b64_tr_b16 a[12:13], v4 offset:96
ds_read_b64_tr_b16 a[14:15], v4 offset:2400
ds_read_b64_tr_b16 a[16:17], v4 offset:128
ds_read_b64_tr_b16 a[18:19], v4 offset:2432
ds_read_b64_tr_b16 a[20:21], v4 offset:160
ds_read_b64_tr_b16 a[22:23], v4 offset:2464
s_waitcnt lgkmcnt(6)
v_mfma_f32_16x16x32_bf16 v[24:27], a[0:3], a[36:39], 0
ds_read_b64_tr_b16 a[24:25], v4 offset:192
v_mfma_f32_16x16x32_bf16 v[28:31], a[0:3], a[40:43], 0
ds_read_b64_tr_b16 a[26:27], v4 offset:2496
v_mfma_f32_16x16x32_bf16 v[32:35], a[4:7], a[36:39], 0
ds_read_b64_tr_b16 a[28:29], v4 offset:224
v_mfma_f32_16x16x32_bf16 v[36:39], a[4:7], a[40:43], 0
ds_read_b64_tr_b16 a[30:31], v4 offset:2528
v_mfma_f32_16x16x32_bf16 v[40:43], a[8:11], a[36:39], 0
ds_read_b64_tr_b16 a[32:33], v4 offset:256
v_mfma_f32_16x16x32_bf16 v[44:47], a[8:11], a[40:43], 0
ds_read_b64_tr_b16 a[34:35], v4 offset:2560
s_waitcnt lgkmcnt(6)
v_mfma_f32_16x16x32_bf16 v[48:51], a[12:15], a[36:39], 0
ds_read_b64_tr_b16 a[0:1], v4 offset:9216
v_mfma_f32_16x16x32_bf16 v[52:55], a[12:15], a[40:43], 0
ds_read_b64_tr_b16 a[2:3], v4 offset:11520
buffer_load_dwordx4 a[100:103], v7, s[8:11], s29 offen offset:0
v_mfma_f32_16x16x32_bf16 v[56:59], a[16:19], a[36:39], 0
ds_read_b64_tr_b16 a[4:5], v4 offset:9248
v_mfma_f32_16x16x32_bf16 v[60:63], a[16:19], a[40:43], 0
ds_read_b64_tr_b16 a[6:7], v4 offset:11552
v_mfma_f32_16x16x32_bf16 v[64:67], a[20:23], a[36:39], 0
ds_read_b64_tr_b16 a[8:9], v4 offset:9280
v_mfma_f32_16x16x32_bf16 v[68:71], a[20:23], a[40:43], 0
ds_read_b64_tr_b16 a[10:11], v4 offset:11584
s_waitcnt lgkmcnt(6)
v_mfma_f32_16x16x32_bf16 v[72:75], a[24:27], a[36:39], 0
ds_read_b64_tr_b16 a[12:13], v4 offset:9312
v_mfma_f32_16x16x32_bf16 v[76:79], a[24:27], a[40:43], 0
ds_read_b64_tr_b16 a[14:15], v4 offset:11616
v_mfma_f32_16x16x32_bf16 v[80:83], a[28:31], a[36:39], 0
ds_read_b64_tr_b16 a[16:17], v4 offset:9344
v_mfma_f32_16x16x32_bf16 v[84:87], a[28:31], a[40:43], 0
ds_read_b64_tr_b16 a[18:19], v4 offset:11648
buffer_load_dwordx4 a[104:107], v8, s[8:11], s29 offen offset:0
v_mfma_f32_16x16x32_bf16 v[88:91], a[32:35], a[36:39], 0
ds_read_b64_tr_b16 a[20:21], v4 offset:9376
v_mfma_f32_16x16x32_bf16 v[92:95], a[32:35], a[40:43], 0
ds_read_b64_tr_b16 a[22:23], v4 offset:11680
s_waitcnt lgkmcnt(6)
v_mfma_f32_16x16x32_bf16 v[24:27], a[0:3], a[44:47], v[24:27]
ds_read_b64_tr_b16 a[24:25], v4 offset:9408
v_mfma_f32_16x16x32_bf16 v[28:31], a[0:3], a[48:51], v[28:31]
ds_read_b64_tr_b16 a[26:27], v4 offset:11712
v_mfma_f32_16x16x32_bf16 v[32:35], a[4:7], a[44:47], v[32:35]
ds_read_b64_tr_b16 a[28:29], v4 offset:9440
v_mfma_f32_16x16x32_bf16 v[36:39], a[4:7], a[48:51], v[36:39]
ds_read_b64_tr_b16 a[30:31], v4 offset:11744
v_mfma_f32_16x16x32_bf16 v[40:43], a[8:11], a[44:47], v[40:43]
ds_read_b64_tr_b16 a[32:33], v4 offset:9472
v_mfma_f32_16x16x32_bf16 v[44:47], a[8:11], a[48:51], v[44:47]
ds_read_b64_tr_b16 a[34:35], v4 offset:11776
buffer_load_dwordx4 a[108:111], v7, s[8:11], s29 offen offset:1024
s_waitcnt lgkmcnt(6)
v_mfma_f32_16x16x32_bf16 v[48:51], a[12:15], a[44:47], v[48:51]
ds_read_b64_tr_b16 a[0:1], v4 offset:18432
v_mfma_f32_16x16x32_bf16 v[52:55], a[12:15], a[48:51], v[52:55]
ds_read_b64_tr_b16 a[2:3], v4 offset:20736
v_mfma_f32_16x16x32_bf16 v[56:59], a[16:19], a[44:47], v[56:59]
ds_read_b64_tr_b16 a[4:5], v4 offset:18464
v_mfma_f32_16x16x32_bf16 v[60:63], a[16:19], a[48:51], v[60:63]
ds_read_b64_tr_b16 a[6:7], v4 offset:20768
v_mfma_f32_16x16x32_bf16 v[64:67], a[20:23], a[44:47], v[64:67]
ds_read_b64_tr_b16 a[8:9], v4 offset:18496
v_mfma_f32_16x16x32_bf16 v[68:71], a[20:23], a[48:51], v[68:71]
ds_read_b64_tr_b16 a[10:11], v4 offset:20800
s_waitcnt lgkmcnt(6)
v_mfma_f32_16x16x32_bf16 v[72:75], a[24:27], a[44:47], v[72:75]
ds_read_b64_tr_b16 a[12:13], v4 offset:18528
v_mfma_f32_16x16x32_bf16 v[76:79], a[24:27], a[48:51], v[76:79]
ds_read_b64_tr_b16 a[14:15], v4 offset:20832
buffer_load_dwordx4 a[112:115], v8, s[8:11], s29 offen offset:1024
v_mfma_f32_16x16x32_bf16 v[80:83], a[28:31], a[44:47], v[80:83]
ds_read_b64_tr_b16 a[16:17], v4 offset:18560
v_mfma_f32_16x16x32_bf16 v[84:87], a[28:31], a[48:51], v[84:87]
ds_read_b64_tr_b16 a[18:19], v4 offset:20864
v_mfma_f32_16x16x32_bf16 v[88:91], a[32:35], a[44:47], v[88:91]
ds_read_b64_tr_b16 a[20:21], v4 offset:18592
v_mfma_f32_16x16x32_bf16 v[92:95], a[32:35], a[48:51], v[92:95]
ds_read_b64_tr_b16 a[22:23], v4 offset:20896
s_waitcnt lgkmcnt(6)
v_mfma_f32_16x16x32_bf16 v[24:27], a[0:3], a[52:55], v[24:27]
ds_read_b64_tr_b16 a[24:25], v4 offset:18624
v_mfma_f32_16x16x32_bf16 v[28:31], a[0:3], a[56:59], v[28:31]
ds_read_b64_tr_b16 a[26:27], v4 offset:20928
v_mfma_f32_16x16x32_bf16 v[32:35], a[4:7], a[52:55], v[32:35]
ds_read_b64_tr_b16 a[28:29], v4 offset:18656
v_mfma_f32_16x16x32_bf16 v[36:39], a[4:7], a[56:59], v[36:39]
ds_read_b64_tr_b16 a[30:31], v4 offset:20960
buffer_load_dwordx4 a[116:119], v7, s[8:11], s29 offen offset:2048
v_mfma_f32_16x16x32_bf16 v[40:43], a[8:11], a[52:55], v[40:43]
ds_read_b64_tr_b16 a[32:33], v4 offset:18688
v_mfma_f32_16x16x32_bf16 v[44:47], a[8:11], a[56:59], v[44:47]
ds_read_b64_tr_b16 a[34:35], v4 offset:20992
s_waitcnt lgkmcnt(6)
v_mfma_f32_16x16x32_bf16 v[48:51], a[12:15], a[52:55], v[48:51]
ds_read_b64_tr_b16 a[0:1], v4 offset:27648
v_mfma_f32_16x16x32_bf16 v[52:55], a[12:15], a[56:59], v[52:55]
ds_read_b64_tr_b16 a[2:3], v4 offset:29952
v_mfma_f32_16x16x32_bf16 v[56:59], a[16:19], a[52:55], v[56:59]
ds_read_b64_tr_b16 a[4:5], v4 offset:27680
v_mfma_f32_16x16x32_bf16 v[60:63], a[16:19], a[56:59], v[60:63]
ds_read_b64_tr_b16 a[6:7], v4 offset:29984
v_mfma_f32_16x16x32_bf16 v[64:67], a[20:23], a[52:55], v[64:67]
ds_read_b64_tr_b16 a[8:9], v4 offset:27712
v_mfma_f32_16x16x32_bf16 v[68:71], a[20:23], a[56:59], v[68:71]
ds_read_b64_tr_b16 a[10:11], v4 offset:30016
buffer_load_dwordx4 a[120:123], v8, s[8:11], s29 offen offset:2048
s_waitcnt lgkmcnt(6)
v_mfma_f32_16x16x32_bf16 v[72:75], a[24:27], a[52:55], v[72:75]
ds_read_b64_tr_b16 a[12:13], v4 offset:27744
v_mfma_f32_16x16x32_bf16 v[76:79], a[24:27], a[56:59], v[76:79]
ds_read_b64_tr_b16 a[14:15], v4 offset:30048
v_mfma_f32_16x16x32_bf16 v[80:83], a[28:31], a[52:55], v[80:83]
ds_read_b64_tr_b16 a[16:17], v4 offset:27776
v_mfma_f32_16x16x32_bf16 v[84:87], a[28:31], a[56:59], v[84:87]
ds_read_b64_tr_b16 a[18:19], v4 offset:30080
v_mfma_f32_16x16x32_bf16 v[88:91], a[32:35], a[52:55], v[88:91]
ds_read_b64_tr_b16 a[20:21], v4 offset:27808
v_mfma_f32_16x16x32_bf16 v[92:95], a[32:35], a[56:59], v[92:95]
ds_read_b64_tr_b16 a[22:23], v4 offset:30112
s_waitcnt lgkmcnt(6)
v_mfma_f32_16x16x32_bf16 v[24:27], a[0:3], a[60:63], v[24:27]
ds_read_b64_tr_b16 a[24:25], v4 offset:27840
v_mfma_f32_16x16x32_bf16 v[28:31], a[0:3], a[64:67], v[28:31]
ds_read_b64_tr_b16 a[26:27], v4 offset:30144
buffer_load_dwordx4 a[124:127], v7, s[8:11], s29 offen offset:3072
v_mfma_f32_16x16x32_bf16 v[32:35], a[4:7], a[60:63], v[32:35]
ds_read_b64_tr_b16 a[28:29], v4 offset:27872
v_mfma_f32_16x16x32_bf16 v[36:39], a[4:7], a[64:67], v[36:39]
ds_read_b64_tr_b16 a[30:31], v4 offset:30176
v_mfma_f32_16x16x32_bf16 v[40:43], a[8:11], a[60:63], v[40:43]
ds_read_b64_tr_b16 a[32:33], v4 offset:27904
v_mfma_f32_16x16x32_bf16 v[44:47], a[8:11], a[64:67], v[44:47]
ds_read_b64_tr_b16 a[34:35], v4 offset:30208
s_waitcnt vmcnt(7) lgkmcnt(6)
s_barrier
v_mfma_f32_16x16x32_bf16 v[48:51], a[12:15], a[60:63], v[48:51]
ds_read_b64_tr_b16 a[0:1], v5 offset:0
v_mfma_f32_16x16x32_bf16 v[52:55], a[12:15], a[64:67], v[52:55]
ds_read_b64_tr_b16 a[2:3], v5 offset:2304
v_mfma_f32_16x16x32_bf16 v[56:59], a[16:19], a[60:63], v[56:59]
ds_read_b64_tr_b16 a[4:5], v5 offset:32
v_mfma_f32_16x16x32_bf16 v[60:63], a[16:19], a[64:67], v[60:63]
ds_read_b64_tr_b16 a[6:7], v5 offset:2336
buffer_load_dwordx4 a[128:131], v8, s[8:11], s29 offen offset:3072
v_mfma_f32_16x16x32_bf16 v[64:67], a[20:23], a[60:63], v[64:67]
ds_read_b64_tr_b16 a[8:9], v5 offset:64
v_mfma_f32_16x16x32_bf16 v[68:71], a[20:23], a[64:67], v[68:71]
ds_read_b64_tr_b16 a[10:11], v5 offset:2368
s_waitcnt lgkmcnt(6)
v_mfma_f32_16x16x32_bf16 v[72:75], a[24:27], a[60:63], v[72:75]
ds_read_b64_tr_b16 a[12:13], v5 offset:96
v_mfma_f32_16x16x32_bf16 v[76:79], a[24:27], a[64:67], v[76:79]
ds_read_b64_tr_b16 a[14:15], v5 offset:2400
v_mfma_f32_16x16x32_bf16 v[80:83], a[28:31], a[60:63], v[80:83]
ds_read_b64_tr_b16 a[16:17], v5 offset:128
v_mfma_f32_16x16x32_bf16 v[84:87], a[28:31], a[64:67], v[84:87]
ds_read_b64_tr_b16 a[18:19], v5 offset:2432
v_mfma_f32_16x16x32_bf16 v[88:91], a[32:35], a[60:63], v[88:91]
ds_read_b64_tr_b16 a[20:21], v5 offset:160
v_mfma_f32_16x16x32_bf16 v[92:95], a[32:35], a[64:67], v[92:95]
ds_read_b64_tr_b16 a[22:23], v5 offset:2464
s_add_u32 s29, s29, 4096
s_waitcnt lgkmcnt(6)
v_mfma_f32_16x16x32_bf16 v[24:27], a[0:3], a[68:71], v[24:27]
ds_read_b64_tr_b16 a[24:25], v5 offset:192
v_mfma_f32_16x16x32_bf16 v[28:31], a[0:3], a[72:75], v[28:31]
ds_read_b64_tr_b16 a[26:27], v5 offset:2496
v_mfma_f32_16x16x32_bf16 v[32:35], a[4:7], a[68:71], v[32:35]
ds_read_b64_tr_b16 a[28:29], v5 offset:224
v_mfma_f32_16x16x32_bf16 v[36:39], a[4:7], a[72:75], v[36:39]
ds_read_b64_tr_b16 a[30:31], v5 offset:2528
s_add_u32 m0, s30, 36864
v_mfma_f32_16x16x32_bf16 v[40:43], a[8:11], a[68:71], v[40:43]
ds_read_b64_tr_b16 a[32:33], v5 offset:256
v_mfma_f32_16x16x32_bf16 v[44:47], a[8:11], a[72:75], v[44:47]
ds_read_b64_tr_b16 a[34:35], v5 offset:2560
s_waitcnt lgkmcnt(6)
v_mfma_f32_16x16x32_bf16 v[48:51], a[12:15], a[68:71], v[48:51]
ds_read_b64_tr_b16 a[0:1], v5 offset:9216
buffer_load_dwordx4 v216, s[84:87], s93 offen offset:0 lds
v_mfma_f32_16x16x32_bf16 v[52:55], a[12:15], a[72:75], v[52:55]
ds_read_b64_tr_b16 a[2:3], v5 offset:11520
v_mfma_f32_16x16x32_bf16 v[56:59], a[16:19], a[68:71], v[56:59]
ds_read_b64_tr_b16 a[4:5], v5 offset:9248
v_mfma_f32_16x16x32_bf16 v[60:63], a[16:19], a[72:75], v[60:63]
ds_read_b64_tr_b16 a[6:7], v5 offset:11552
buffer_load_dwordx4 a[132:135], v7, s[8:11], s29 offen offset:0
v_mfma_f32_16x16x32_bf16 v[64:67], a[20:23], a[68:71], v[64:67]
ds_read_b64_tr_b16 a[8:9], v5 offset:9280
v_mfma_f32_16x16x32_bf16 v[68:71], a[20:23], a[72:75], v[68:71]
ds_read_b64_tr_b16 a[10:11], v5 offset:11584
s_waitcnt lgkmcnt(6)
v_mfma_f32_16x16x32_bf16 v[72:75], a[24:27], a[68:71], v[72:75]
ds_read_b64_tr_b16 a[12:13], v5 offset:9312
v_mfma_f32_16x16x32_bf16 v[76:79], a[24:27], a[72:75], v[76:79]
ds_read_b64_tr_b16 a[14:15], v5 offset:11616
buffer_load_dwordx4 v217, s[84:87], s93 offen offset:1024 lds
v_mfma_f32_16x16x32_bf16 v[80:83], a[28:31], a[68:71], v[80:83]
ds_read_b64_tr_b16 a[16:17], v5 offset:9344
v_mfma_f32_16x16x32_bf16 v[84:87], a[28:31], a[72:75], v[84:87]
ds_read_b64_tr_b16 a[18:19], v5 offset:11648
v_mfma_f32_16x16x32_bf16 v[88:91], a[32:35], a[68:71], v[88:91]
ds_read_b64_tr_b16 a[20:21], v5 offset:9376
buffer_load_dwordx4 a[136:139], v8, s[8:11], s29 offen offset:0
v_mfma_f32_16x16x32_bf16 v[92:95], a[32:35], a[72:75], v[92:95]
ds_read_b64_tr_b16 a[22:23], v5 offset:11680
s_waitcnt lgkmcnt(6)
v_mfma_f32_16x16x32_bf16 v[24:27], a[0:3], a[76:79], v[24:27]
ds_read_b64_tr_b16 a[24:25], v5 offset:9408
v_mfma_f32_16x16x32_bf16 v[28:31], a[0:3], a[80:83], v[28:31]
ds_read_b64_tr_b16 a[26:27], v5 offset:11712
buffer_load_dwordx4 v218, s[84:87], s93 offen offset:2048 lds
v_mfma_f32_16x16x32_bf16 v[32:35], a[4:7], a[76:79], v[32:35]
ds_read_b64_tr_b16 a[28:29], v5 offset:9440
v_mfma_f32_16x16x32_bf16 v[36:39], a[4:7], a[80:83], v[36:39]
ds_read_b64_tr_b16 a[30:31], v5 offset:11744
v_mfma_f32_16x16x32_bf16 v[40:43], a[8:11], a[76:79], v[40:43]
ds_read_b64_tr_b16 a[32:33], v5 offset:9472
buffer_load_dwordx4 v219, s[84:87], s93 offen offset:3072 lds
v_mfma_f32_16x16x32_bf16 v[44:47], a[8:11], a[80:83], v[44:47]
ds_read_b64_tr_b16 a[34:35], v5 offset:11776
s_waitcnt lgkmcnt(6)
v_mfma_f32_16x16x32_bf16 v[48:51], a[12:15], a[76:79], v[48:51]
ds_read_b64_tr_b16 a[0:1], v5 offset:18432
v_mfma_f32_16x16x32_bf16 v[52:55], a[12:15], a[80:83], v[52:55]
ds_read_b64_tr_b16 a[2:3], v5 offset:20736
v_mfma_f32_16x16x32_bf16 v[56:59], a[16:19], a[76:79], v[56:59]
ds_read_b64_tr_b16 a[4:5], v5 offset:18464
buffer_load_dwordx4 a[140:143], v7, s[8:11], s29 offen offset:1024
v_mfma_f32_16x16x32_bf16 v[60:63], a[16:19], a[80:83], v[60:63]
ds_read_b64_tr_b16 a[6:7], v5 offset:20768
v_mfma_f32_16x16x32_bf16 v[64:67], a[20:23], a[76:79], v[64:67]
ds_read_b64_tr_b16 a[8:9], v5 offset:18496
v_mfma_f32_16x16x32_bf16 v[68:71], a[20:23], a[80:83], v[68:71]
ds_read_b64_tr_b16 a[10:11], v5 offset:20800
s_add_u32 m0, s30, 40960
s_waitcnt lgkmcnt(6)
v_mfma_f32_16x16x32_bf16 v[72:75], a[24:27], a[76:79], v[72:75]
ds_read_b64_tr_b16 a[12:13], v5 offset:18528
v_mfma_f32_16x16x32_bf16 v[76:79], a[24:27], a[80:83], v[76:79]
ds_read_b64_tr_b16 a[14:15], v5 offset:20832
v_mfma_f32_16x16x32_bf16 v[80:83], a[28:31], a[76:79], v[80:83]
ds_read_b64_tr_b16 a[16:17], v5 offset:18560
buffer_load_dwordx4 a[144:147], v8, s[8:11], s29 offen offset:1024
v_mfma_f32_16x16x32_bf16 v[84:87], a[28:31], a[80:83], v[84:87]
ds_read_b64_tr_b16 a[18:19], v5 offset:20864
v_mfma_f32_16x16x32_bf16 v[88:91], a[32:35], a[76:79], v[88:91]
ds_read_b64_tr_b16 a[20:21], v5 offset:18592
v_mfma_f32_16x16x32_bf16 v[92:95], a[32:35], a[80:83], v[92:95]
ds_read_b64_tr_b16 a[22:23], v5 offset:20896
buffer_load_dwordx4 v220, s[84:87], s93 offen offset:0 lds
s_waitcnt lgkmcnt(6)
v_mfma_f32_16x16x32_bf16 v[24:27], a[0:3], a[84:87], v[24:27]
ds_read_b64_tr_b16 a[24:25], v5 offset:18624
v_mfma_f32_16x16x32_bf16 v[28:31], a[0:3], a[88:91], v[28:31]
ds_read_b64_tr_b16 a[26:27], v5 offset:20928
v_mfma_f32_16x16x32_bf16 v[32:35], a[4:7], a[84:87], v[32:35]
ds_read_b64_tr_b16 a[28:29], v5 offset:18656
v_mfma_f32_16x16x32_bf16 v[36:39], a[4:7], a[88:91], v[36:39]
ds_read_b64_tr_b16 a[30:31], v5 offset:20960
buffer_load_dwordx4 v221, s[84:87], s93 offen offset:1024 lds
v_mfma_f32_16x16x32_bf16 v[40:43], a[8:11], a[84:87], v[40:43]
ds_read_b64_tr_b16 a[32:33], v5 offset:18688
v_mfma_f32_16x16x32_bf16 v[44:47], a[8:11], a[88:91], v[44:47]
ds_read_b64_tr_b16 a[34:35], v5 offset:20992
s_waitcnt lgkmcnt(6)
v_mfma_f32_16x16x32_bf16 v[48:51], a[12:15], a[84:87], v[48:51]
ds_read_b64_tr_b16 a[0:1], v5 offset:27648
buffer_load_dwordx4 a[148:151], v7, s[8:11], s29 offen offset:2048
v_mfma_f32_16x16x32_bf16 v[52:55], a[12:15], a[88:91], v[52:55]
ds_read_b64_tr_b16 a[2:3], v5 offset:29952
v_mfma_f32_16x16x32_bf16 v[56:59], a[16:19], a[84:87], v[56:59]
ds_read_b64_tr_b16 a[4:5], v5 offset:27680
v_mfma_f32_16x16x32_bf16 v[60:63], a[16:19], a[88:91], v[60:63]
ds_read_b64_tr_b16 a[6:7], v5 offset:29984
buffer_load_dwordx4 v222, s[84:87], s93 offen offset:2048 lds
v_mfma_f32_16x16x32_bf16 v[64:67], a[20:23], a[84:87], v[64:67]
ds_read_b64_tr_b16 a[8:9], v5 offset:27712
v_mfma_f32_16x16x32_bf16 v[68:71], a[20:23], a[88:91], v[68:71]
ds_read_b64_tr_b16 a[10:11], v5 offset:30016
s_waitcnt lgkmcnt(6)
v_mfma_f32_16x16x32_bf16 v[72:75], a[24:27], a[84:87], v[72:75]
ds_read_b64_tr_b16 a[12:13], v5 offset:27744
v_mfma_f32_16x16x32_bf16 v[76:79], a[24:27], a[88:91], v[76:79]
ds_read_b64_tr_b16 a[14:15], v5 offset:30048
buffer_load_dwordx4 a[152:155], v8, s[8:11], s29 offen offset:2048
v_mfma_f32_16x16x32_bf16 v[80:83], a[28:31], a[84:87], v[80:83]
ds_read_b64_tr_b16 a[16:17], v5 offset:27776
v_mfma_f32_16x16x32_bf16 v[84:87], a[28:31], a[88:91], v[84:87]
ds_read_b64_tr_b16 a[18:19], v5 offset:30080
v_mfma_f32_16x16x32_bf16 v[88:91], a[32:35], a[84:87], v[88:91]
ds_read_b64_tr_b16 a[20:21], v5 offset:27808
buffer_load_dwordx4 v223, s[84:87], s93 offen offset:3072 lds
v_mfma_f32_16x16x32_bf16 v[92:95], a[32:35], a[88:91], v[92:95]
ds_read_b64_tr_b16 a[22:23], v5 offset:30112
s_waitcnt lgkmcnt(6)
v_mfma_f32_16x16x32_bf16 v[24:27], a[0:3], a[92:95], v[24:27]
ds_read_b64_tr_b16 a[24:25], v5 offset:27840
v_mfma_f32_16x16x32_bf16 v[28:31], a[0:3], a[96:99], v[28:31]
ds_read_b64_tr_b16 a[26:27], v5 offset:30144
s_add_u32 m0, s30, 45056
v_mfma_f32_16x16x32_bf16 v[32:35], a[4:7], a[92:95], v[32:35]
ds_read_b64_tr_b16 a[28:29], v5 offset:27872
v_mfma_f32_16x16x32_bf16 v[36:39], a[4:7], a[96:99], v[36:39]
ds_read_b64_tr_b16 a[30:31], v5 offset:30176
v_mfma_f32_16x16x32_bf16 v[40:43], a[8:11], a[92:95], v[40:43]
ds_read_b64_tr_b16 a[32:33], v5 offset:27904
buffer_load_dwordx4 a[156:159], v7, s[8:11], s29 offen offset:3072
v_mfma_f32_16x16x32_bf16 v[44:47], a[8:11], a[96:99], v[44:47]
ds_read_b64_tr_b16 a[34:35], v5 offset:30208
s_waitcnt vmcnt(15) lgkmcnt(6)
s_barrier
v_mfma_f32_16x16x32_bf16 v[48:51], a[12:15], a[92:95], v[48:51]
ds_read_b64_tr_b16 a[0:1], v2 offset:0
v_mfma_f32_16x16x32_bf16 v[52:55], a[12:15], a[96:99], v[52:55]
ds_read_b64_tr_b16 a[2:3], v2 offset:2304
v_mfma_f32_16x16x32_bf16 v[56:59], a[16:19], a[92:95], v[56:59]
ds_read_b64_tr_b16 a[4:5], v2 offset:32
buffer_load_dwordx4 v224, s[84:87], s93 offen offset:0 lds
v_mfma_f32_16x16x32_bf16 v[60:63], a[16:19], a[96:99], v[60:63]
ds_read_b64_tr_b16 a[6:7], v2 offset:2336
v_mfma_f32_16x16x32_bf16 v[64:67], a[20:23], a[92:95], v[64:67]
ds_read_b64_tr_b16 a[8:9], v2 offset:64
v_mfma_f32_16x16x32_bf16 v[68:71], a[20:23], a[96:99], v[68:71]
ds_read_b64_tr_b16 a[10:11], v2 offset:2368
buffer_load_dwordx4 a[160:163], v8, s[8:11], s29 offen offset:3072
s_waitcnt lgkmcnt(6)
v_mfma_f32_16x16x32_bf16 v[72:75], a[24:27], a[92:95], v[72:75]
ds_read_b64_tr_b16 a[12:13], v2 offset:96
v_mfma_f32_16x16x32_bf16 v[76:79], a[24:27], a[96:99], v[76:79]
ds_read_b64_tr_b16 a[14:15], v2 offset:2400
v_mfma_f32_16x16x32_bf16 v[80:83], a[28:31], a[92:95], v[80:83]
ds_read_b64_tr_b16 a[16:17], v2 offset:128
s_add_u32 s93, s93, s41
v_mfma_f32_16x16x32_bf16 v[84:87], a[28:31], a[96:99], v[84:87]
ds_read_b64_tr_b16 a[18:19], v2 offset:2432
v_mfma_f32_16x16x32_bf16 v[88:91], a[32:35], a[92:95], v[88:91]
ds_read_b64_tr_b16 a[20:21], v2 offset:160
v_mfma_f32_16x16x32_bf16 v[92:95], a[32:35], a[96:99], v[92:95]
ds_read_b64_tr_b16 a[22:23], v2 offset:2464
s_add_u32 s29, s29, 4096
s_waitcnt lgkmcnt(6)
v_mfma_f32_16x16x32_bf16 v[24:27], a[0:3], a[100:103], v[24:27]
ds_read_b64_tr_b16 a[24:25], v2 offset:192
v_mfma_f32_16x16x32_bf16 v[28:31], a[0:3], a[104:107], v[28:31]
ds_read_b64_tr_b16 a[26:27], v2 offset:2496
v_mfma_f32_16x16x32_bf16 v[32:35], a[4:7], a[100:103], v[32:35]
ds_read_b64_tr_b16 a[28:29], v2 offset:224
v_mfma_f32_16x16x32_bf16 v[36:39], a[4:7], a[104:107], v[36:39]
ds_read_b64_tr_b16 a[30:31], v2 offset:2528
s_add_u32 m0, s30, 73728
v_mfma_f32_16x16x32_bf16 v[40:43], a[8:11], a[100:103], v[40:43]
ds_read_b64_tr_b16 a[32:33], v2 offset:256
v_mfma_f32_16x16x32_bf16 v[44:47], a[8:11], a[104:107], v[44:47]
ds_read_b64_tr_b16 a[34:35], v2 offset:2560
s_waitcnt lgkmcnt(6)
v_mfma_f32_16x16x32_bf16 v[48:51], a[12:15], a[100:103], v[48:51]
ds_read_b64_tr_b16 a[0:1], v2 offset:9216
v_mfma_f32_16x16x32_bf16 v[52:55], a[12:15], a[104:107], v[52:55]
ds_read_b64_tr_b16 a[2:3], v2 offset:11520
buffer_load_dwordx4 v216, s[84:87], s93 offen offset:0 lds
v_mfma_f32_16x16x32_bf16 v[56:59], a[16:19], a[100:103], v[56:59]
ds_read_b64_tr_b16 a[4:5], v2 offset:9248
v_mfma_f32_16x16x32_bf16 v[60:63], a[16:19], a[104:107], v[60:63]
ds_read_b64_tr_b16 a[6:7], v2 offset:11552
v_mfma_f32_16x16x32_bf16 v[64:67], a[20:23], a[100:103], v[64:67]
ds_read_b64_tr_b16 a[8:9], v2 offset:9280
v_mfma_f32_16x16x32_bf16 v[68:71], a[20:23], a[104:107], v[68:71]
ds_read_b64_tr_b16 a[10:11], v2 offset:11584
buffer_load_dwordx4 v217, s[84:87], s93 offen offset:1024 lds
s_waitcnt lgkmcnt(6)
v_mfma_f32_16x16x32_bf16 v[72:75], a[24:27], a[100:103], v[72:75]
ds_read_b64_tr_b16 a[12:13], v2 offset:9312
v_mfma_f32_16x16x32_bf16 v[76:79], a[24:27], a[104:107], v[76:79]
ds_read_b64_tr_b16 a[14:15], v2 offset:11616
v_mfma_f32_16x16x32_bf16 v[80:83], a[28:31], a[100:103], v[80:83]
ds_read_b64_tr_b16 a[16:17], v2 offset:9344
v_mfma_f32_16x16x32_bf16 v[84:87], a[28:31], a[104:107], v[84:87]
ds_read_b64_tr_b16 a[18:19], v2 offset:11648
buffer_load_dwordx4 a[164:167], v7, s[8:11], s29 offen offset:0
v_mfma_f32_16x16x32_bf16 v[88:91], a[32:35], a[100:103], v[88:91]
ds_read_b64_tr_b16 a[20:21], v2 offset:9376
v_mfma_f32_16x16x32_bf16 v[92:95], a[32:35], a[104:107], v[92:95]
ds_read_b64_tr_b16 a[22:23], v2 offset:11680
s_waitcnt lgkmcnt(6)
v_mfma_f32_16x16x32_bf16 v[24:27], a[0:3], a[108:111], v[24:27]
ds_read_b64_tr_b16 a[24:25], v2 offset:9408
v_mfma_f32_16x16x32_bf16 v[28:31], a[0:3], a[112:115], v[28:31]
ds_read_b64_tr_b16 a[26:27], v2 offset:11712
buffer_load_dwordx4 v218, s[84:87], s93 offen offset:2048 lds
v_mfma_f32_16x16x32_bf16 v[32:35], a[4:7], a[108:111], v[32:35]
ds_read_b64_tr_b16 a[28:29], v2 offset:9440
v_mfma_f32_16x16x32_bf16 v[36:39], a[4:7], a[112:115], v[36:39]
ds_read_b64_tr_b16 a[30:31], v2 offset:11744
v_mfma_f32_16x16x32_bf16 v[40:43], a[8:11], a[108:111], v[40:43]
ds_read_b64_tr_b16 a[32:33], v2 offset:9472
v_mfma_f32_16x16x32_bf16 v[44:47], a[8:11], a[112:115], v[44:47]
ds_read_b64_tr_b16 a[34:35], v2 offset:11776
buffer_load_dwordx4 v219, s[84:87], s93 offen offset:3072 lds
s_waitcnt lgkmcnt(6)
v_mfma_f32_16x16x32_bf16 v[48:51], a[12:15], a[108:111], v[48:51]
ds_read_b64_tr_b16 a[0:1], v2 offset:18432
v_mfma_f32_16x16x32_bf16 v[52:55], a[12:15], a[112:115], v[52:55]
ds_read_b64_tr_b16 a[2:3], v2 offset:20736
v_mfma_f32_16x16x32_bf16 v[56:59], a[16:19], a[108:111], v[56:59]
ds_read_b64_tr_b16 a[4:5], v2 offset:18464
v_mfma_f32_16x16x32_bf16 v[60:63], a[16:19], a[112:115], v[60:63]
ds_read_b64_tr_b16 a[6:7], v2 offset:20768
s_add_u32 m0, s30, 77824
v_mfma_f32_16x16x32_bf16 v[64:67], a[20:23], a[108:111], v[64:67]
ds_read_b64_tr_b16 a[8:9], v2 offset:18496
v_mfma_f32_16x16x32_bf16 v[68:71], a[20:23], a[112:115], v[68:71]
ds_read_b64_tr_b16 a[10:11], v2 offset:20800
s_waitcnt lgkmcnt(6)
v_mfma_f32_16x16x32_bf16 v[72:75], a[24:27], a[108:111], v[72:75]
ds_read_b64_tr_b16 a[12:13], v2 offset:18528
v_mfma_f32_16x16x32_bf16 v[76:79], a[24:27], a[112:115], v[76:79]
ds_read_b64_tr_b16 a[14:15], v2 offset:20832
buffer_load_dwordx4 a[168:171], v8, s[8:11], s29 offen offset:0
v_mfma_f32_16x16x32_bf16 v[80:83], a[28:31], a[108:111], v[80:83]
ds_read_b64_tr_b16 a[16:17], v2 offset:18560
v_mfma_f32_16x16x32_bf16 v[84:87], a[28:31], a[112:115], v[84:87]
ds_read_b64_tr_b16 a[18:19], v2 offset:20864
v_mfma_f32_16x16x32_bf16 v[88:91], a[32:35], a[108:111], v[88:91]
ds_read_b64_tr_b16 a[20:21], v2 offset:18592
v_mfma_f32_16x16x32_bf16 v[92:95], a[32:35], a[112:115], v[92:95]
ds_read_b64_tr_b16 a[22:23], v2 offset:20896
buffer_load_dwordx4 v220, s[84:87], s93 offen offset:0 lds
s_waitcnt lgkmcnt(6)
v_mfma_f32_16x16x32_bf16 v[24:27], a[0:3], a[116:119], v[24:27]
ds_read_b64_tr_b16 a[24:25], v2 offset:18624
v_mfma_f32_16x16x32_bf16 v[28:31], a[0:3], a[120:123], v[28:31]
ds_read_b64_tr_b16 a[26:27], v2 offset:20928
v_mfma_f32_16x16x32_bf16 v[32:35], a[4:7], a[116:119], v[32:35]
ds_read_b64_tr_b16 a[28:29], v2 offset:18656
v_mfma_f32_16x16x32_bf16 v[36:39], a[4:7], a[120:123], v[36:39]
ds_read_b64_tr_b16 a[30:31], v2 offset:20960
buffer_load_dwordx4 v221, s[84:87], s93 offen offset:1024 lds
v_mfma_f32_16x16x32_bf16 v[40:43], a[8:11], a[116:119], v[40:43]
ds_read_b64_tr_b16 a[32:33], v2 offset:18688
v_mfma_f32_16x16x32_bf16 v[44:47], a[8:11], a[120:123], v[44:47]
ds_read_b64_tr_b16 a[34:35], v2 offset:20992
s_waitcnt lgkmcnt(6)
v_mfma_f32_16x16x32_bf16 v[48:51], a[12:15], a[116:119], v[48:51]
ds_read_b64_tr_b16 a[0:1], v2 offset:27648
v_mfma_f32_16x16x32_bf16 v[52:55], a[12:15], a[120:123], v[52:55]
ds_read_b64_tr_b16 a[2:3], v2 offset:29952
buffer_load_dwordx4 a[172:175], v7, s[8:11], s29 offen offset:1024
v_mfma_f32_16x16x32_bf16 v[56:59], a[16:19], a[116:119], v[56:59]
ds_read_b64_tr_b16 a[4:5], v2 offset:27680
v_mfma_f32_16x16x32_bf16 v[60:63], a[16:19], a[120:123], v[60:63]
ds_read_b64_tr_b16 a[6:7], v2 offset:29984
v_mfma_f32_16x16x32_bf16 v[64:67], a[20:23], a[116:119], v[64:67]
ds_read_b64_tr_b16 a[8:9], v2 offset:27712
v_mfma_f32_16x16x32_bf16 v[68:71], a[20:23], a[120:123], v[68:71]
ds_read_b64_tr_b16 a[10:11], v2 offset:30016
buffer_load_dwordx4 v222, s[84:87], s93 offen offset:2048 lds
s_waitcnt lgkmcnt(6)
v_mfma_f32_16x16x32_bf16 v[72:75], a[24:27], a[116:119], v[72:75]
ds_read_b64_tr_b16 a[12:13], v2 offset:27744
v_mfma_f32_16x16x32_bf16 v[76:79], a[24:27], a[120:123], v[76:79]
ds_read_b64_tr_b16 a[14:15], v2 offset:30048
v_mfma_f32_16x16x32_bf16 v[80:83], a[28:31], a[116:119], v[80:83]
ds_read_b64_tr_b16 a[16:17], v2 offset:27776
v_mfma_f32_16x16x32_bf16 v[84:87], a[28:31], a[120:123], v[84:87]
ds_read_b64_tr_b16 a[18:19], v2 offset:30080
buffer_load_dwordx4 v223, s[84:87], s93 offen offset:3072 lds
v_mfma_f32_16x16x32_bf16 v[88:91], a[32:35], a[116:119], v[88:91]
ds_read_b64_tr_b16 a[20:21], v2 offset:27808
v_mfma_f32_16x16x32_bf16 v[92:95], a[32:35], a[120:123], v[92:95]
ds_read_b64_tr_b16 a[22:23], v2 offset:30112
s_waitcnt lgkmcnt(6)
v_mfma_f32_16x16x32_bf16 v[24:27], a[0:3], a[124:127], v[24:27]
ds_read_b64_tr_b16 a[24:25], v2 offset:27840
v_mfma_f32_16x16x32_bf16 v[28:31], a[0:3], a[128:131], v[28:31]
ds_read_b64_tr_b16 a[26:27], v2 offset:30144
s_add_u32 m0, s30, 81920
v_mfma_f32_16x16x32_bf16 v[32:35], a[4:7], a[124:127], v[32:35]
ds_read_b64_tr_b16 a[28:29], v2 offset:27872
v_mfma_f32_16x16x32_bf16 v[36:39], a[4:7], a[128:131], v[36:39]
ds_read_b64_tr_b16 a[30:31], v2 offset:30176
v_mfma_f32_16x16x32_bf16 v[40:43], a[8:11], a[124:127], v[40:43]
ds_read_b64_tr_b16 a[32:33], v2 offset:27904
v_mfma_f32_16x16x32_bf16 v[44:47], a[8:11], a[128:131], v[44:47]
ds_read_b64_tr_b16 a[34:35], v2 offset:30208
buffer_load_dwordx4 a[176:179], v8, s[8:11], s29 offen offset:1024
s_waitcnt vmcnt(12) lgkmcnt(6)
s_barrier
v_mfma_f32_16x16x32_bf16 v[48:51], a[12:15], a[124:127], v[48:51]
ds_read_b64_tr_b16 a[0:1], v3 offset:0
v_mfma_f32_16x16x32_bf16 v[52:55], a[12:15], a[128:131], v[52:55]
ds_read_b64_tr_b16 a[2:3], v3 offset:2304
v_mfma_f32_16x16x32_bf16 v[56:59], a[16:19], a[124:127], v[56:59]
ds_read_b64_tr_b16 a[4:5], v3 offset:32
v_mfma_f32_16x16x32_bf16 v[60:63], a[16:19], a[128:131], v[60:63]
ds_read_b64_tr_b16 a[6:7], v3 offset:2336
buffer_load_dwordx4 v224, s[84:87], s93 offen offset:0 lds
v_mfma_f32_16x16x32_bf16 v[64:67], a[20:23], a[124:127], v[64:67]
ds_read_b64_tr_b16 a[8:9], v3 offset:64
v_mfma_f32_16x16x32_bf16 v[68:71], a[20:23], a[128:131], v[68:71]
ds_read_b64_tr_b16 a[10:11], v3 offset:2368
s_waitcnt lgkmcnt(6)
v_mfma_f32_16x16x32_bf16 v[72:75], a[24:27], a[124:127], v[72:75]
ds_read_b64_tr_b16 a[12:13], v3 offset:96
v_mfma_f32_16x16x32_bf16 v[76:79], a[24:27], a[128:131], v[76:79]
ds_read_b64_tr_b16 a[14:15], v3 offset:2400
s_add_u32 s93, s93, s42
v_mfma_f32_16x16x32_bf16 v[80:83], a[28:31], a[124:127], v[80:83]
ds_read_b64_tr_b16 a[16:17], v3 offset:128
v_mfma_f32_16x16x32_bf16 v[84:87], a[28:31], a[128:131], v[84:87]
ds_read_b64_tr_b16 a[18:19], v3 offset:2432
v_mfma_f32_16x16x32_bf16 v[88:91], a[32:35], a[124:127], v[88:91]
ds_read_b64_tr_b16 a[20:21], v3 offset:160
v_mfma_f32_16x16x32_bf16 v[92:95], a[32:35], a[128:131], v[92:95]
ds_read_b64_tr_b16 a[22:23], v3 offset:2464
s_add_u32 s29, s29, 4096
s_waitcnt lgkmcnt(6)
v_mfma_f32_16x16x32_bf16 v[24:27], a[0:3], a[132:135], v[24:27]
ds_read_b64_tr_b16 a[24:25], v3 offset:192
v_mfma_f32_16x16x32_bf16 v[28:31], a[0:3], a[136:139], v[28:31]
ds_read_b64_tr_b16 a[26:27], v3 offset:2496
v_mfma_f32_16x16x32_bf16 v[32:35], a[4:7], a[132:135], v[32:35]
ds_read_b64_tr_b16 a[28:29], v3 offset:224
v_mfma_f32_16x16x32_bf16 v[36:39], a[4:7], a[136:139], v[36:39]
ds_read_b64_tr_b16 a[30:31], v3 offset:2528
v_mfma_f32_16x16x32_bf16 v[40:43], a[8:11], a[132:135], v[40:43]
ds_read_b64_tr_b16 a[32:33], v3 offset:256
v_mfma_f32_16x16x32_bf16 v[44:47], a[8:11], a[136:139], v[44:47]
ds_read_b64_tr_b16 a[34:35], v3 offset:2560
s_add_u32 m0, s30, 110592
s_waitcnt lgkmcnt(6)
v_mfma_f32_16x16x32_bf16 v[48:51], a[12:15], a[132:135], v[48:51]
ds_read_b64_tr_b16 a[0:1], v3 offset:9216
v_mfma_f32_16x16x32_bf16 v[52:55], a[12:15], a[136:139], v[52:55]
ds_read_b64_tr_b16 a[2:3], v3 offset:11520
v_mfma_f32_16x16x32_bf16 v[56:59], a[16:19], a[132:135], v[56:59]
ds_read_b64_tr_b16 a[4:5], v3 offset:9248
v_mfma_f32_16x16x32_bf16 v[60:63], a[16:19], a[136:139], v[60:63]
ds_read_b64_tr_b16 a[6:7], v3 offset:11552
v_mfma_f32_16x16x32_bf16 v[64:67], a[20:23], a[132:135], v[64:67]
ds_read_b64_tr_b16 a[8:9], v3 offset:9280
v_mfma_f32_16x16x32_bf16 v[68:71], a[20:23], a[136:139], v[68:71]
ds_read_b64_tr_b16 a[10:11], v3 offset:11584
buffer_load_dwordx4 v216, s[84:87], s93 offen offset:0 lds
s_waitcnt lgkmcnt(6)
v_mfma_f32_16x16x32_bf16 v[72:75], a[24:27], a[132:135], v[72:75]
ds_read_b64_tr_b16 a[12:13], v3 offset:9312
v_mfma_f32_16x16x32_bf16 v[76:79], a[24:27], a[136:139], v[76:79]
ds_read_b64_tr_b16 a[14:15], v3 offset:11616
v_mfma_f32_16x16x32_bf16 v[80:83], a[28:31], a[132:135], v[80:83]
ds_read_b64_tr_b16 a[16:17], v3 offset:9344
v_mfma_f32_16x16x32_bf16 v[84:87], a[28:31], a[136:139], v[84:87]
ds_read_b64_tr_b16 a[18:19], v3 offset:11648
v_mfma_f32_16x16x32_bf16 v[88:91], a[32:35], a[132:135], v[88:91]
ds_read_b64_tr_b16 a[20:21], v3 offset:9376
buffer_load_dwordx4 v217, s[84:87], s93 offen offset:1024 lds
v_mfma_f32_16x16x32_bf16 v[92:95], a[32:35], a[136:139], v[92:95]
ds_read_b64_tr_b16 a[22:23], v3 offset:11680
s_waitcnt lgkmcnt(6)
v_mfma_f32_16x16x32_bf16 v[24:27], a[0:3], a[140:143], v[24:27]
ds_read_b64_tr_b16 a[24:25], v3 offset:9408
v_mfma_f32_16x16x32_bf16 v[28:31], a[0:3], a[144:147], v[28:31]
ds_read_b64_tr_b16 a[26:27], v3 offset:11712
v_mfma_f32_16x16x32_bf16 v[32:35], a[4:7], a[140:143], v[32:35]
ds_read_b64_tr_b16 a[28:29], v3 offset:9440
v_mfma_f32_16x16x32_bf16 v[36:39], a[4:7], a[144:147], v[36:39]
ds_read_b64_tr_b16 a[30:31], v3 offset:11744
v_mfma_f32_16x16x32_bf16 v[40:43], a[8:11], a[140:143], v[40:43]
ds_read_b64_tr_b16 a[32:33], v3 offset:9472
buffer_load_dwordx4 v218, s[84:87], s93 offen offset:2048 lds
v_mfma_f32_16x16x32_bf16 v[44:47], a[8:11], a[144:147], v[44:47]
ds_read_b64_tr_b16 a[34:35], v3 offset:11776
s_waitcnt lgkmcnt(6)
v_mfma_f32_16x16x32_bf16 v[48:51], a[12:15], a[140:143], v[48:51]
ds_read_b64_tr_b16 a[0:1], v3 offset:18432
v_mfma_f32_16x16x32_bf16 v[52:55], a[12:15], a[144:147], v[52:55]
ds_read_b64_tr_b16 a[2:3], v3 offset:20736
v_mfma_f32_16x16x32_bf16 v[56:59], a[16:19], a[140:143], v[56:59]
ds_read_b64_tr_b16 a[4:5], v3 offset:18464
v_mfma_f32_16x16x32_bf16 v[60:63], a[16:19], a[144:147], v[60:63]
ds_read_b64_tr_b16 a[6:7], v3 offset:20768
buffer_load_dwordx4 v219, s[84:87], s93 offen offset:3072 lds
v_mfma_f32_16x16x32_bf16 v[64:67], a[20:23], a[140:143], v[64:67]
ds_read_b64_tr_b16 a[8:9], v3 offset:18496
v_mfma_f32_16x16x32_bf16 v[68:71], a[20:23], a[144:147], v[68:71]
ds_read_b64_tr_b16 a[10:11], v3 offset:20800
s_waitcnt lgkmcnt(6)
v_mfma_f32_16x16x32_bf16 v[72:75], a[24:27], a[140:143], v[72:75]
ds_read_b64_tr_b16 a[12:13], v3 offset:18528
v_mfma_f32_16x16x32_bf16 v[76:79], a[24:27], a[144:147], v[76:79]
ds_read_b64_tr_b16 a[14:15], v3 offset:20832
v_mfma_f32_16x16x32_bf16 v[80:83], a[28:31], a[140:143], v[80:83]
ds_read_b64_tr_b16 a[16:17], v3 offset:18560
v_mfma_f32_16x16x32_bf16 v[84:87], a[28:31], a[144:147], v[84:87]
ds_read_b64_tr_b16 a[18:19], v3 offset:20864
s_add_u32 m0, s30, 114688
v_mfma_f32_16x16x32_bf16 v[88:91], a[32:35], a[140:143], v[88:91]
ds_read_b64_tr_b16 a[20:21], v3 offset:18592
v_mfma_f32_16x16x32_bf16 v[92:95], a[32:35], a[144:147], v[92:95]
ds_read_b64_tr_b16 a[22:23], v3 offset:20896
s_waitcnt lgkmcnt(6)
v_mfma_f32_16x16x32_bf16 v[24:27], a[0:3], a[148:151], v[24:27]
ds_read_b64_tr_b16 a[24:25], v3 offset:18624
v_mfma_f32_16x16x32_bf16 v[28:31], a[0:3], a[152:155], v[28:31]
ds_read_b64_tr_b16 a[26:27], v3 offset:20928
v_mfma_f32_16x16x32_bf16 v[32:35], a[4:7], a[148:151], v[32:35]
ds_read_b64_tr_b16 a[28:29], v3 offset:18656
buffer_load_dwordx4 v220, s[84:87], s93 offen offset:0 lds
v_mfma_f32_16x16x32_bf16 v[36:39], a[4:7], a[152:155], v[36:39]
ds_read_b64_tr_b16 a[30:31], v3 offset:20960
v_mfma_f32_16x16x32_bf16 v[40:43], a[8:11], a[148:151], v[40:43]
ds_read_b64_tr_b16 a[32:33], v3 offset:18688
v_mfma_f32_16x16x32_bf16 v[44:47], a[8:11], a[152:155], v[44:47]
ds_read_b64_tr_b16 a[34:35], v3 offset:20992
s_waitcnt lgkmcnt(6)
v_mfma_f32_16x16x32_bf16 v[48:51], a[12:15], a[148:151], v[48:51]
ds_read_b64_tr_b16 a[0:1], v3 offset:27648
v_mfma_f32_16x16x32_bf16 v[52:55], a[12:15], a[152:155], v[52:55]
ds_read_b64_tr_b16 a[2:3], v3 offset:29952
v_mfma_f32_16x16x32_bf16 v[56:59], a[16:19], a[148:151], v[56:59]
ds_read_b64_tr_b16 a[4:5], v3 offset:27680
buffer_load_dwordx4 v221, s[84:87], s93 offen offset:1024 lds
v_mfma_f32_16x16x32_bf16 v[60:63], a[16:19], a[152:155], v[60:63]
ds_read_b64_tr_b16 a[6:7], v3 offset:29984
v_mfma_f32_16x16x32_bf16 v[64:67], a[20:23], a[148:151], v[64:67]
ds_read_b64_tr_b16 a[8:9], v3 offset:27712
v_mfma_f32_16x16x32_bf16 v[68:71], a[20:23], a[152:155], v[68:71]
ds_read_b64_tr_b16 a[10:11], v3 offset:30016
s_waitcnt lgkmcnt(6)
v_mfma_f32_16x16x32_bf16 v[72:75], a[24:27], a[148:151], v[72:75]
ds_read_b64_tr_b16 a[12:13], v3 offset:27744
v_mfma_f32_16x16x32_bf16 v[76:79], a[24:27], a[152:155], v[76:79]
ds_read_b64_tr_b16 a[14:15], v3 offset:30048
buffer_load_dwordx4 v222, s[84:87], s93 offen offset:2048 lds
v_mfma_f32_16x16x32_bf16 v[80:83], a[28:31], a[148:151], v[80:83]
ds_read_b64_tr_b16 a[16:17], v3 offset:27776
v_mfma_f32_16x16x32_bf16 v[84:87], a[28:31], a[152:155], v[84:87]
ds_read_b64_tr_b16 a[18:19], v3 offset:30080
v_mfma_f32_16x16x32_bf16 v[88:91], a[32:35], a[148:151], v[88:91]
ds_read_b64_tr_b16 a[20:21], v3 offset:27808
v_mfma_f32_16x16x32_bf16 v[92:95], a[32:35], a[152:155], v[92:95]
ds_read_b64_tr_b16 a[22:23], v3 offset:30112
s_waitcnt lgkmcnt(6)
v_mfma_f32_16x16x32_bf16 v[24:27], a[0:3], a[156:159], v[24:27]
ds_read_b64_tr_b16 a[24:25], v3 offset:27840
v_mfma_f32_16x16x32_bf16 v[28:31], a[0:3], a[160:163], v[28:31]
ds_read_b64_tr_b16 a[26:27], v3 offset:30144
buffer_load_dwordx4 v223, s[84:87], s93 offen offset:3072 lds
v_mfma_f32_16x16x32_bf16 v[32:35], a[4:7], a[156:159], v[32:35]
ds_read_b64_tr_b16 a[28:29], v3 offset:27872
v_mfma_f32_16x16x32_bf16 v[36:39], a[4:7], a[160:163], v[36:39]
ds_read_b64_tr_b16 a[30:31], v3 offset:30176
v_mfma_f32_16x16x32_bf16 v[40:43], a[8:11], a[156:159], v[40:43]
ds_read_b64_tr_b16 a[32:33], v3 offset:27904
v_mfma_f32_16x16x32_bf16 v[44:47], a[8:11], a[160:163], v[44:47]
ds_read_b64_tr_b16 a[34:35], v3 offset:30208
s_waitcnt vmcnt(8) lgkmcnt(6)
s_barrier
v_mfma_f32_16x16x32_bf16 v[48:51], a[12:15], a[156:159], v[48:51]
ds_read_b64_tr_b16 a[0:1], v4 offset:0
s_add_u32 m0, s30, 118784
v_mfma_f32_16x16x32_bf16 v[52:55], a[12:15], a[160:163], v[52:55]
ds_read_b64_tr_b16 a[2:3], v4 offset:2304
v_mfma_f32_16x16x32_bf16 v[56:59], a[16:19], a[156:159], v[56:59]
ds_read_b64_tr_b16 a[4:5], v4 offset:32
v_mfma_f32_16x16x32_bf16 v[60:63], a[16:19], a[160:163], v[60:63]
ds_read_b64_tr_b16 a[6:7], v4 offset:2336
v_mfma_f32_16x16x32_bf16 v[64:67], a[20:23], a[156:159], v[64:67]
ds_read_b64_tr_b16 a[8:9], v4 offset:64
v_mfma_f32_16x16x32_bf16 v[68:71], a[20:23], a[160:163], v[68:71]
ds_read_b64_tr_b16 a[10:11], v4 offset:2368
s_waitcnt lgkmcnt(6)
v_mfma_f32_16x16x32_bf16 v[72:75], a[24:27], a[156:159], v[72:75]
ds_read_b64_tr_b16 a[12:13], v4 offset:96
buffer_load_dwordx4 v224, s[84:87], s93 offen offset:0 lds
v_mfma_f32_16x16x32_bf16 v[76:79], a[24:27], a[160:163], v[76:79]
ds_read_b64_tr_b16 a[14:15], v4 offset:2400
v_mfma_f32_16x16x32_bf16 v[80:83], a[28:31], a[156:159], v[80:83]
ds_read_b64_tr_b16 a[16:17], v4 offset:128
v_mfma_f32_16x16x32_bf16 v[84:87], a[28:31], a[160:163], v[84:87]
ds_read_b64_tr_b16 a[18:19], v4 offset:2432
v_mfma_f32_16x16x32_bf16 v[88:91], a[32:35], a[156:159], v[88:91]
ds_read_b64_tr_b16 a[20:21], v4 offset:160
v_mfma_f32_16x16x32_bf16 v[92:95], a[32:35], a[160:163], v[92:95]
ds_read_b64_tr_b16 a[22:23], v4 offset:2464
s_add_u32 s93, s93, 1179648
s_waitcnt lgkmcnt(6)
v_mfma_f32_16x16x32_bf16 v[24:27], a[0:3], a[164:167], v[24:27]
ds_read_b64_tr_b16 a[24:25], v4 offset:192
v_mfma_f32_16x16x32_bf16 v[28:31], a[0:3], a[168:171], v[28:31]
ds_read_b64_tr_b16 a[26:27], v4 offset:2496
v_mfma_f32_16x16x32_bf16 v[32:35], a[4:7], a[164:167], v[32:35]
ds_read_b64_tr_b16 a[28:29], v4 offset:224
v_mfma_f32_16x16x32_bf16 v[36:39], a[4:7], a[168:171], v[36:39]
ds_read_b64_tr_b16 a[30:31], v4 offset:2528
v_mfma_f32_16x16x32_bf16 v[40:43], a[8:11], a[164:167], v[40:43]
ds_read_b64_tr_b16 a[32:33], v4 offset:256
v_mfma_f32_16x16x32_bf16 v[44:47], a[8:11], a[168:171], v[44:47]
ds_read_b64_tr_b16 a[34:35], v4 offset:2560
s_add_u32 m0, s30, 0
s_waitcnt lgkmcnt(6)
v_mfma_f32_16x16x32_bf16 v[48:51], a[12:15], a[164:167], v[48:51]
ds_read_b64_tr_b16 a[0:1], v4 offset:9216
v_mfma_f32_16x16x32_bf16 v[52:55], a[12:15], a[168:171], v[52:55]
ds_read_b64_tr_b16 a[2:3], v4 offset:11520
v_mfma_f32_16x16x32_bf16 v[56:59], a[16:19], a[164:167], v[56:59]
ds_read_b64_tr_b16 a[4:5], v4 offset:9248
v_mfma_f32_16x16x32_bf16 v[60:63], a[16:19], a[168:171], v[60:63]
ds_read_b64_tr_b16 a[6:7], v4 offset:11552
v_mfma_f32_16x16x32_bf16 v[64:67], a[20:23], a[164:167], v[64:67]
ds_read_b64_tr_b16 a[8:9], v4 offset:9280
v_mfma_f32_16x16x32_bf16 v[68:71], a[20:23], a[168:171], v[68:71]
ds_read_b64_tr_b16 a[10:11], v4 offset:11584
buffer_load_dwordx4 v216, s[84:87], s93 offen offset:0 lds
s_waitcnt lgkmcnt(6)
v_mfma_f32_16x16x32_bf16 v[72:75], a[24:27], a[164:167], v[72:75]
ds_read_b64_tr_b16 a[12:13], v4 offset:9312
v_mfma_f32_16x16x32_bf16 v[76:79], a[24:27], a[168:171], v[76:79]
ds_read_b64_tr_b16 a[14:15], v4 offset:11616
v_mfma_f32_16x16x32_bf16 v[80:83], a[28:31], a[164:167], v[80:83]
ds_read_b64_tr_b16 a[16:17], v4 offset:9344
v_mfma_f32_16x16x32_bf16 v[84:87], a[28:31], a[168:171], v[84:87]
ds_read_b64_tr_b16 a[18:19], v4 offset:11648
v_mfma_f32_16x16x32_bf16 v[88:91], a[32:35], a[164:167], v[88:91]
ds_read_b64_tr_b16 a[20:21], v4 offset:9376
buffer_load_dwordx4 v217, s[84:87], s93 offen offset:1024 lds
v_mfma_f32_16x16x32_bf16 v[92:95], a[32:35], a[168:171], v[92:95]
ds_read_b64_tr_b16 a[22:23], v4 offset:11680
s_waitcnt lgkmcnt(6)
v_mfma_f32_16x16x32_bf16 v[24:27], a[0:3], a[172:175], v[24:27]
ds_read_b64_tr_b16 a[24:25], v4 offset:9408
v_mfma_f32_16x16x32_bf16 v[28:31], a[0:3], a[176:179], v[28:31]
ds_read_b64_tr_b16 a[26:27], v4 offset:11712
v_mfma_f32_16x16x32_bf16 v[32:35], a[4:7], a[172:175], v[32:35]
ds_read_b64_tr_b16 a[28:29], v4 offset:9440
v_mfma_f32_16x16x32_bf16 v[36:39], a[4:7], a[176:179], v[36:39]
ds_read_b64_tr_b16 a[30:31], v4 offset:11744
v_mfma_f32_16x16x32_bf16 v[40:43], a[8:11], a[172:175], v[40:43]
ds_read_b64_tr_b16 a[32:33], v4 offset:9472
buffer_load_dwordx4 v218, s[84:87], s93 offen offset:2048 lds
v_mfma_f32_16x16x32_bf16 v[44:47], a[8:11], a[176:179], v[44:47]
ds_read_b64_tr_b16 a[34:35], v4 offset:11776
s_waitcnt lgkmcnt(6)
v_mfma_f32_16x16x32_bf16 v[48:51], a[12:15], a[172:175], v[48:51]
ds_read_b64_tr_b16 a[0:1], v4 offset:18432
v_mfma_f32_16x16x32_bf16 v[52:55], a[12:15], a[176:179], v[52:55]
ds_read_b64_tr_b16 a[2:3], v4 offset:20736
v_mfma_f32_16x16x32_bf16 v[56:59], a[16:19], a[172:175], v[56:59]
ds_read_b64_tr_b16 a[4:5], v4 offset:18464
v_mfma_f32_16x16x32_bf16 v[60:63], a[16:19], a[176:179], v[60:63]
ds_read_b64_tr_b16 a[6:7], v4 offset:20768
buffer_load_dwordx4 v219, s[84:87], s93 offen offset:3072 lds
v_mfma_f32_16x16x32_bf16 v[64:67], a[20:23], a[172:175], v[64:67]
ds_read_b64_tr_b16 a[8:9], v4 offset:18496
v_mfma_f32_16x16x32_bf16 v[68:71], a[20:23], a[176:179], v[68:71]
ds_read_b64_tr_b16 a[10:11], v4 offset:20800
s_waitcnt lgkmcnt(6)
v_mfma_f32_16x16x32_bf16 v[72:75], a[24:27], a[172:175], v[72:75]
ds_read_b64_tr_b16 a[12:13], v4 offset:18528
v_mfma_f32_16x16x32_bf16 v[76:79], a[24:27], a[176:179], v[76:79]
ds_read_b64_tr_b16 a[14:15], v4 offset:20832
v_mfma_f32_16x16x32_bf16 v[80:83], a[28:31], a[172:175], v[80:83]
ds_read_b64_tr_b16 a[16:17], v4 offset:18560
v_mfma_f32_16x16x32_bf16 v[84:87], a[28:31], a[176:179], v[84:87]
ds_read_b64_tr_b16 a[18:19], v4 offset:20864
s_add_u32 m0, s30, 4096
v_mfma_f32_16x16x32_bf16 v[88:91], a[32:35], a[172:175], v[88:91]
ds_read_b64_tr_b16 a[20:21], v4 offset:18592
v_mfma_f32_16x16x32_bf16 v[92:95], a[32:35], a[176:179], v[92:95]
ds_read_b64_tr_b16 a[22:23], v4 offset:20896
buffer_store_dwordx4 a[192:195], v7, s[76:79], s92 offen offset:0 sc0 sc1
v_pk_mul_f32 v[168:169], v[24:25], v[24:25]
v_pk_mul_f32 v[170:171], v[26:27], v[26:27]
v_pk_mul_f32 v[172:173], v[28:29], v[28:29]
v_pk_mul_f32 v[174:175], v[30:31], v[30:31]
v_pk_fma_f32 v[168:169], v[168:169], v[180:181], v[182:183]
v_pk_fma_f32 v[170:171], v[170:171], v[180:181], v[182:183]
v_pk_fma_f32 v[172:173], v[172:173], v[180:181], v[182:183]
v_pk_fma_f32 v[174:175], v[174:175], v[180:181], v[182:183]
v_pk_mul_f32 v[168:169], v[168:169], v[24:25]
v_pk_mul_f32 v[170:171], v[170:171], v[26:27]
v_pk_mul_f32 v[172:173], v[172:173], v[28:29]
v_pk_mul_f32 v[174:175], v[174:175], v[30:31]
v_exp_f32 v168, v168
v_exp_f32 v170, v170
v_exp_f32 v172, v172
v_exp_f32 v174, v174
v_exp_f32 v169, v169
v_exp_f32 v171, v171
v_exp_f32 v173, v173
v_exp_f32 v175, v175
v_pk_add_f32 v[168:169], v[168:169], v[184:185]
v_pk_add_f32 v[170:171], v[170:171], v[184:185]
v_pk_add_f32 v[172:173], v[172:173], v[184:185]
v_pk_add_f32 v[174:175], v[174:175], v[184:185]
v_rcp_f32 v168, v168
v_rcp_f32 v170, v170
v_rcp_f32 v172, v172
v_rcp_f32 v174, v174
v_rcp_f32 v169, v169
v_rcp_f32 v171, v171
v_rcp_f32 v173, v173
v_rcp_f32 v175, v175
v_pk_mul_f32 v[24:25], v[24:25], v[168:169]
v_pk_mul_f32 v[26:27], v[26:27], v[170:171]
v_pk_mul_f32 v[28:29], v[28:29], v[172:173]
v_pk_mul_f32 v[30:31], v[30:31], v[174:175]
buffer_store_dwordx4 a[196:199], v7, s[76:79], s92 offen offset:1024 sc0 sc1
v_pk_mul_f32 v[168:169], v[32:33], v[32:33]
v_pk_mul_f32 v[170:171], v[34:35], v[34:35]
v_pk_mul_f32 v[172:173], v[36:37], v[36:37]
v_pk_mul_f32 v[174:175], v[38:39], v[38:39]
v_pk_fma_f32 v[168:169], v[168:169], v[180:181], v[182:183]
v_pk_fma_f32 v[170:171], v[170:171], v[180:181], v[182:183]
v_pk_fma_f32 v[172:173], v[172:173], v[180:181], v[182:183]
v_pk_fma_f32 v[174:175], v[174:175], v[180:181], v[182:183]
v_pk_mul_f32 v[168:169], v[168:169], v[32:33]
v_pk_mul_f32 v[170:171], v[170:171], v[34:35]
v_pk_mul_f32 v[172:173], v[172:173], v[36:37]
v_pk_mul_f32 v[174:175], v[174:175], v[38:39]
v_exp_f32 v168, v168
v_exp_f32 v170, v170
v_exp_f32 v172, v172
v_exp_f32 v174, v174
v_exp_f32 v169, v169
v_exp_f32 v171, v171
v_exp_f32 v173, v173
v_exp_f32 v175, v175
v_pk_add_f32 v[168:169], v[168:169], v[184:185]
v_pk_add_f32 v[170:171], v[170:171], v[184:185]
v_pk_add_f32 v[172:173], v[172:173], v[184:185]
v_pk_add_f32 v[174:175], v[174:175], v[184:185]
v_rcp_f32 v168, v168
v_rcp_f32 v170, v170
v_rcp_f32 v172, v172
v_rcp_f32 v174, v174
v_rcp_f32 v169, v169
v_rcp_f32 v171, v171
v_rcp_f32 v173, v173
v_rcp_f32 v175, v175
v_pk_mul_f32 v[32:33], v[32:33], v[168:169]
v_pk_mul_f32 v[34:35], v[34:35], v[170:171]
v_pk_mul_f32 v[36:37], v[36:37], v[172:173]
v_pk_mul_f32 v[38:39], v[38:39], v[174:175]
buffer_store_dwordx4 a[216:219], v7, s[76:79], s92 offen offset:2048 sc0 sc1
v_pk_mul_f32 v[168:169], v[40:41], v[40:41]
v_pk_mul_f32 v[170:171], v[42:43], v[42:43]
v_pk_mul_f32 v[172:173], v[44:45], v[44:45]
v_pk_mul_f32 v[174:175], v[46:47], v[46:47]
v_pk_fma_f32 v[168:169], v[168:169], v[180:181], v[182:183]
v_pk_fma_f32 v[170:171], v[170:171], v[180:181], v[182:183]
v_pk_fma_f32 v[172:173], v[172:173], v[180:181], v[182:183]
v_pk_fma_f32 v[174:175], v[174:175], v[180:181], v[182:183]
v_pk_mul_f32 v[168:169], v[168:169], v[40:41]
v_pk_mul_f32 v[170:171], v[170:171], v[42:43]
v_pk_mul_f32 v[172:173], v[172:173], v[44:45]
v_pk_mul_f32 v[174:175], v[174:175], v[46:47]
v_exp_f32 v168, v168
v_exp_f32 v170, v170
v_exp_f32 v172, v172
v_exp_f32 v174, v174
v_exp_f32 v169, v169
v_exp_f32 v171, v171
v_exp_f32 v173, v173
v_exp_f32 v175, v175
v_pk_add_f32 v[168:169], v[168:169], v[184:185]
v_pk_add_f32 v[170:171], v[170:171], v[184:185]
v_pk_add_f32 v[172:173], v[172:173], v[184:185]
v_pk_add_f32 v[174:175], v[174:175], v[184:185]
v_rcp_f32 v168, v168
v_rcp_f32 v170, v170
v_rcp_f32 v172, v172
v_rcp_f32 v174, v174
v_rcp_f32 v169, v169
v_rcp_f32 v171, v171
v_rcp_f32 v173, v173
v_rcp_f32 v175, v175
v_pk_mul_f32 v[40:41], v[40:41], v[168:169]
v_pk_mul_f32 v[42:43], v[42:43], v[170:171]
v_pk_mul_f32 v[44:45], v[44:45], v[172:173]
v_pk_mul_f32 v[46:47], v[46:47], v[174:175]
buffer_store_dwordx4 a[220:223], v7, s[76:79], s92 offen offset:3072 sc0 sc1
v_pk_mul_f32 v[168:169], v[48:49], v[48:49]
v_pk_mul_f32 v[170:171], v[50:51], v[50:51]
v_pk_mul_f32 v[172:173], v[52:53], v[52:53]
v_pk_mul_f32 v[174:175], v[54:55], v[54:55]
v_pk_fma_f32 v[168:169], v[168:169], v[180:181], v[182:183]
v_pk_fma_f32 v[170:171], v[170:171], v[180:181], v[182:183]
v_pk_fma_f32 v[172:173], v[172:173], v[180:181], v[182:183]
v_pk_fma_f32 v[174:175], v[174:175], v[180:181], v[182:183]
v_pk_mul_f32 v[168:169], v[168:169], v[48:49]
v_pk_mul_f32 v[170:171], v[170:171], v[50:51]
v_pk_mul_f32 v[172:173], v[172:173], v[52:53]
v_pk_mul_f32 v[174:175], v[174:175], v[54:55]
v_exp_f32 v168, v168
v_exp_f32 v170, v170
v_exp_f32 v172, v172
v_exp_f32 v174, v174
v_exp_f32 v169, v169
v_exp_f32 v171, v171
v_exp_f32 v173, v173
v_exp_f32 v175, v175
v_pk_add_f32 v[168:169], v[168:169], v[184:185]
v_pk_add_f32 v[170:171], v[170:171], v[184:185]
v_pk_add_f32 v[172:173], v[172:173], v[184:185]
v_pk_add_f32 v[174:175], v[174:175], v[184:185]
v_rcp_f32 v168, v168
v_rcp_f32 v170, v170
v_rcp_f32 v172, v172
v_rcp_f32 v174, v174
v_rcp_f32 v169, v169
v_rcp_f32 v171, v171
v_rcp_f32 v173, v173
v_rcp_f32 v175, v175
v_pk_mul_f32 v[48:49], v[48:49], v[168:169]
v_pk_mul_f32 v[50:51], v[50:51], v[170:171]
v_pk_mul_f32 v[52:53], v[52:53], v[172:173]
v_pk_mul_f32 v[54:55], v[54:55], v[174:175]
buffer_store_dwordx4 a[208:211], v7, s[76:79], s94 offen offset:0 sc0 sc1
v_pk_mul_f32 v[168:169], v[56:57], v[56:57]
v_pk_mul_f32 v[170:171], v[58:59], v[58:59]
v_pk_mul_f32 v[172:173], v[60:61], v[60:61]
v_pk_mul_f32 v[174:175], v[62:63], v[62:63]
v_pk_fma_f32 v[168:169], v[168:169], v[180:181], v[182:183]
v_pk_fma_f32 v[170:171], v[170:171], v[180:181], v[182:183]
v_pk_fma_f32 v[172:173], v[172:173], v[180:181], v[182:183]
v_pk_fma_f32 v[174:175], v[174:175], v[180:181], v[182:183]
v_pk_mul_f32 v[168:169], v[168:169], v[56:57]
v_pk_mul_f32 v[170:171], v[170:171], v[58:59]
v_pk_mul_f32 v[172:173], v[172:173], v[60:61]
v_pk_mul_f32 v[174:175], v[174:175], v[62:63]
v_exp_f32 v168, v168
v_exp_f32 v170, v170
v_exp_f32 v172, v172
v_exp_f32 v174, v174
v_exp_f32 v169, v169
v_exp_f32 v171, v171
v_exp_f32 v173, v173
v_exp_f32 v175, v175
v_pk_add_f32 v[168:169], v[168:169], v[184:185]
v_pk_add_f32 v[170:171], v[170:171], v[184:185]
v_pk_add_f32 v[172:173], v[172:173], v[184:185]
v_pk_add_f32 v[174:175], v[174:175], v[184:185]
v_rcp_f32 v168, v168
v_rcp_f32 v170, v170
v_rcp_f32 v172, v172
v_rcp_f32 v174, v174
v_rcp_f32 v169, v169
v_rcp_f32 v171, v171
v_rcp_f32 v173, v173
v_rcp_f32 v175, v175
v_pk_mul_f32 v[56:57], v[56:57], v[168:169]
v_pk_mul_f32 v[58:59], v[58:59], v[170:171]
v_pk_mul_f32 v[60:61], v[60:61], v[172:173]
v_pk_mul_f32 v[62:63], v[62:63], v[174:175]
buffer_store_dwordx4 a[212:215], v7, s[76:79], s94 offen offset:1024 sc0 sc1
v_pk_mul_f32 v[168:169], v[64:65], v[64:65]
v_pk_mul_f32 v[170:171], v[66:67], v[66:67]
v_pk_mul_f32 v[172:173], v[68:69], v[68:69]
v_pk_mul_f32 v[174:175], v[70:71], v[70:71]
v_pk_fma_f32 v[168:169], v[168:169], v[180:181], v[182:183]
v_pk_fma_f32 v[170:171], v[170:171], v[180:181], v[182:183]
v_pk_fma_f32 v[172:173], v[172:173], v[180:181], v[182:183]
v_pk_fma_f32 v[174:175], v[174:175], v[180:181], v[182:183]
v_pk_mul_f32 v[168:169], v[168:169], v[64:65]
v_pk_mul_f32 v[170:171], v[170:171], v[66:67]
v_pk_mul_f32 v[172:173], v[172:173], v[68:69]
v_pk_mul_f32 v[174:175], v[174:175], v[70:71]
v_exp_f32 v168, v168
v_exp_f32 v170, v170
v_exp_f32 v172, v172
v_exp_f32 v174, v174
v_exp_f32 v169, v169
v_exp_f32 v171, v171
v_exp_f32 v173, v173
v_exp_f32 v175, v175
v_pk_add_f32 v[168:169], v[168:169], v[184:185]
v_pk_add_f32 v[170:171], v[170:171], v[184:185]
v_pk_add_f32 v[172:173], v[172:173], v[184:185]
v_pk_add_f32 v[174:175], v[174:175], v[184:185]
v_rcp_f32 v168, v168
v_rcp_f32 v170, v170
v_rcp_f32 v172, v172
v_rcp_f32 v174, v174
v_rcp_f32 v169, v169
v_rcp_f32 v171, v171
v_rcp_f32 v173, v173
v_rcp_f32 v175, v175
v_pk_mul_f32 v[64:65], v[64:65], v[168:169]
v_pk_mul_f32 v[66:67], v[66:67], v[170:171]
v_pk_mul_f32 v[68:69], v[68:69], v[172:173]
v_pk_mul_f32 v[70:71], v[70:71], v[174:175]
buffer_store_dwordx4 a[200:203], v7, s[76:79], s94 offen offset:2048 sc0 sc1
v_pk_mul_f32 v[168:169], v[72:73], v[72:73]
v_pk_mul_f32 v[170:171], v[74:75], v[74:75]
v_pk_mul_f32 v[172:173], v[76:77], v[76:77]
v_pk_mul_f32 v[174:175], v[78:79], v[78:79]
v_pk_fma_f32 v[168:169], v[168:169], v[180:181], v[182:183]
v_pk_fma_f32 v[170:171], v[170:171], v[180:181], v[182:183]
v_pk_fma_f32 v[172:173], v[172:173], v[180:181], v[182:183]
v_pk_fma_f32 v[174:175], v[174:175], v[180:181], v[182:183]
v_pk_mul_f32 v[168:169], v[168:169], v[72:73]
v_pk_mul_f32 v[170:171], v[170:171], v[74:75]
v_pk_mul_f32 v[172:173], v[172:173], v[76:77]
v_pk_mul_f32 v[174:175], v[174:175], v[78:79]
v_exp_f32 v168, v168
v_exp_f32 v170, v170
v_exp_f32 v172, v172
v_exp_f32 v174, v174
v_exp_f32 v169, v169
v_exp_f32 v171, v171
v_exp_f32 v173, v173
v_exp_f32 v175, v175
v_pk_add_f32 v[168:169], v[168:169], v[184:185]
v_pk_add_f32 v[170:171], v[170:171], v[184:185]
v_pk_add_f32 v[172:173], v[172:173], v[184:185]
v_pk_add_f32 v[174:175], v[174:175], v[184:185]
v_rcp_f32 v168, v168
v_rcp_f32 v170, v170
v_rcp_f32 v172, v172
v_rcp_f32 v174, v174
v_rcp_f32 v169, v169
v_rcp_f32 v171, v171
v_rcp_f32 v173, v173
v_rcp_f32 v175, v175
v_pk_mul_f32 v[72:73], v[72:73], v[168:169]
v_pk_mul_f32 v[74:75], v[74:75], v[170:171]
v_pk_mul_f32 v[76:77], v[76:77], v[172:173]
v_pk_mul_f32 v[78:79], v[78:79], v[174:175]
buffer_store_dwordx4 a[204:207], v7, s[76:79], s94 offen offset:3072 sc0 sc1
v_pk_mul_f32 v[168:169], v[80:81], v[80:81]
v_pk_mul_f32 v[170:171], v[82:83], v[82:83]
v_pk_mul_f32 v[172:173], v[84:85], v[84:85]
v_pk_mul_f32 v[174:175], v[86:87], v[86:87]
v_pk_fma_f32 v[168:169], v[168:169], v[180:181], v[182:183]
v_pk_fma_f32 v[170:171], v[170:171], v[180:181], v[182:183]
v_pk_fma_f32 v[172:173], v[172:173], v[180:181], v[182:183]
v_pk_fma_f32 v[174:175], v[174:175], v[180:181], v[182:183]
v_pk_mul_f32 v[168:169], v[168:169], v[80:81]
v_pk_mul_f32 v[170:171], v[170:171], v[82:83]
v_pk_mul_f32 v[172:173], v[172:173], v[84:85]
v_pk_mul_f32 v[174:175], v[174:175], v[86:87]
v_exp_f32 v168, v168
v_exp_f32 v170, v170
v_exp_f32 v172, v172
v_exp_f32 v174, v174
v_exp_f32 v169, v169
v_exp_f32 v171, v171
v_exp_f32 v173, v173
v_exp_f32 v175, v175
v_pk_add_f32 v[168:169], v[168:169], v[184:185]
v_pk_add_f32 v[170:171], v[170:171], v[184:185]
v_pk_add_f32 v[172:173], v[172:173], v[184:185]
v_pk_add_f32 v[174:175], v[174:175], v[184:185]
v_rcp_f32 v168, v168
v_rcp_f32 v170, v170
v_rcp_f32 v172, v172
v_rcp_f32 v174, v174
v_rcp_f32 v169, v169
v_rcp_f32 v171, v171
v_rcp_f32 v173, v173
v_rcp_f32 v175, v175
v_pk_mul_f32 v[80:81], v[80:81], v[168:169]
v_pk_mul_f32 v[82:83], v[82:83], v[170:171]
v_pk_mul_f32 v[84:85], v[84:85], v[172:173]
v_pk_mul_f32 v[86:87], v[86:87], v[174:175]
v_pk_mul_f32 v[168:169], v[88:89], v[88:89]
v_pk_mul_f32 v[170:171], v[90:91], v[90:91]
v_pk_mul_f32 v[172:173], v[92:93], v[92:93]
v_pk_mul_f32 v[174:175], v[94:95], v[94:95]
v_pk_fma_f32 v[168:169], v[168:169], v[180:181], v[182:183]
v_pk_fma_f32 v[170:171], v[170:171], v[180:181], v[182:183]
v_pk_fma_f32 v[172:173], v[172:173], v[180:181], v[182:183]
v_pk_fma_f32 v[174:175], v[174:175], v[180:181], v[182:183]
v_pk_mul_f32 v[168:169], v[168:169], v[88:89]
v_pk_mul_f32 v[170:171], v[170:171], v[90:91]
v_pk_mul_f32 v[172:173], v[172:173], v[92:93]
v_pk_mul_f32 v[174:175], v[174:175], v[94:95]
v_exp_f32 v168, v168
v_exp_f32 v170, v170
v_exp_f32 v172, v172
v_exp_f32 v174, v174
v_exp_f32 v169, v169
v_exp_f32 v171, v171
v_exp_f32 v173, v173
v_exp_f32 v175, v175
v_pk_add_f32 v[168:169], v[168:169], v[184:185]
v_pk_add_f32 v[170:171], v[170:171], v[184:185]
v_pk_add_f32 v[172:173], v[172:173], v[184:185]
v_pk_add_f32 v[174:175], v[174:175], v[184:185]
v_rcp_f32 v168, v168
v_rcp_f32 v170, v170
v_rcp_f32 v172, v172
v_rcp_f32 v174, v174
v_rcp_f32 v169, v169
v_rcp_f32 v171, v171
v_rcp_f32 v173, v173
v_rcp_f32 v175, v175
v_pk_mul_f32 v[88:89], v[88:89], v[168:169]
v_pk_mul_f32 v[90:91], v[90:91], v[170:171]
v_pk_mul_f32 v[92:93], v[92:93], v[172:173]
v_pk_mul_f32 v[94:95], v[94:95], v[174:175]
v_mov_b32 v168, v24
v_mov_b32 v169, v25
v_pk_mul_f32 v[170:171], v[24:25], v[24:25]
v_pk_add_f32 v[168:169], v[168:169], v[26:27]
v_pk_fma_f32 v[170:171], v[26:27], v[26:27], v[170:171]
v_pk_add_f32 v[168:169], v[168:169], v[32:33]
v_pk_fma_f32 v[170:171], v[32:33], v[32:33], v[170:171]
v_pk_add_f32 v[168:169], v[168:169], v[34:35]
v_pk_fma_f32 v[170:171], v[34:35], v[34:35], v[170:171]
v_pk_add_f32 v[168:169], v[168:169], v[40:41]
v_pk_fma_f32 v[170:171], v[40:41], v[40:41], v[170:171]
v_pk_add_f32 v[168:169], v[168:169], v[42:43]
v_pk_fma_f32 v[170:171], v[42:43], v[42:43], v[170:171]
v_pk_add_f32 v[168:169], v[168:169], v[48:49]
v_pk_fma_f32 v[170:171], v[48:49], v[48:49], v[170:171]
v_pk_add_f32 v[168:169], v[168:169], v[50:51]
v_pk_fma_f32 v[170:171], v[50:51], v[50:51], v[170:171]
v_pk_add_f32 v[168:169], v[168:169], v[56:57]
v_pk_fma_f32 v[170:171], v[56:57], v[56:57], v[170:171]
v_pk_add_f32 v[168:169], v[168:169], v[58:59]
v_pk_fma_f32 v[170:171], v[58:59], v[58:59], v[170:171]
v_pk_add_f32 v[168:169], v[168:169], v[64:65]
v_pk_fma_f32 v[170:171], v[64:65], v[64:65], v[170:171]
v_pk_add_f32 v[168:169], v[168:169], v[66:67]
v_pk_fma_f32 v[170:171], v[66:67], v[66:67], v[170:171]
v_pk_add_f32 v[168:169], v[168:169], v[72:73]
v_pk_fma_f32 v[170:171], v[72:73], v[72:73], v[170:171]
v_pk_add_f32 v[168:169], v[168:169], v[74:75]
v_pk_fma_f32 v[170:171], v[74:75], v[74:75], v[170:171]
v_pk_add_f32 v[168:169], v[168:169], v[80:81]
v_pk_fma_f32 v[170:171], v[80:81], v[80:81], v[170:171]
v_pk_add_f32 v[168:169], v[168:169], v[82:83]
v_pk_fma_f32 v[170:171], v[82:83], v[82:83], v[170:171]
v_pk_add_f32 v[168:169], v[168:169], v[88:89]
v_pk_fma_f32 v[170:171], v[88:89], v[88:89], v[170:171]
v_pk_add_f32 v[168:169], v[168:169], v[90:91]
v_pk_fma_f32 v[170:171], v[90:91], v[90:91], v[170:171]
v_mov_b32 v172, v28
v_mov_b32 v173, v29
v_pk_mul_f32 v[174:175], v[28:29], v[28:29]
v_pk_add_f32 v[172:173], v[172:173], v[30:31]
v_pk_fma_f32 v[174:175], v[30:31], v[30:31], v[174:175]
v_pk_add_f32 v[172:173], v[172:173], v[36:37]
v_pk_fma_f32 v[174:175], v[36:37], v[36:37], v[174:175]
v_pk_add_f32 v[172:173], v[172:173], v[38:39]
v_pk_fma_f32 v[174:175], v[38:39], v[38:39], v[174:175]
v_pk_add_f32 v[172:173], v[172:173], v[44:45]
v_pk_fma_f32 v[174:175], v[44:45], v[44:45], v[174:175]
v_pk_add_f32 v[172:173], v[172:173], v[46:47]
v_pk_fma_f32 v[174:175], v[46:47], v[46:47], v[174:175]
v_pk_add_f32 v[172:173], v[172:173], v[52:53]
v_pk_fma_f32 v[174:175], v[52:53], v[52:53], v[174:175]
v_pk_add_f32 v[172:173], v[172:173], v[54:55]
v_pk_fma_f32 v[174:175], v[54:55], v[54:55], v[174:175]
v_pk_add_f32 v[172:173], v[172:173], v[60:61]
v_pk_fma_f32 v[174:175], v[60:61], v[60:61], v[174:175]
v_pk_add_f32 v[172:173], v[172:173], v[62:63]
v_pk_fma_f32 v[174:175], v[62:63], v[62:63], v[174:175]
v_pk_add_f32 v[172:173], v[172:173], v[68:69]
v_pk_fma_f32 v[174:175], v[68:69], v[68:69], v[174:175]
v_pk_add_f32 v[172:173], v[172:173], v[70:71]
v_pk_fma_f32 v[174:175], v[70:71], v[70:71], v[174:175]
v_pk_add_f32 v[172:173], v[172:173], v[76:77]
v_pk_fma_f32 v[174:175], v[76:77], v[76:77], v[174:175]
v_pk_add_f32 v[172:173], v[172:173], v[78:79]
v_pk_fma_f32 v[174:175], v[78:79], v[78:79], v[174:175]
v_pk_add_f32 v[172:173], v[172:173], v[84:85]
v_pk_fma_f32 v[174:175], v[84:85], v[84:85], v[174:175]
v_pk_add_f32 v[172:173], v[172:173], v[86:87]
v_pk_fma_f32 v[174:175], v[86:87], v[86:87], v[174:175]
v_pk_add_f32 v[172:173], v[172:173], v[92:93]
v_pk_fma_f32 v[174:175], v[92:93], v[92:93], v[174:175]
v_pk_add_f32 v[172:173], v[172:173], v[94:95]
v_pk_fma_f32 v[174:175], v[94:95], v[94:95], v[174:175]
v_add_f32 v168, v168, v169
v_add_f32 v170, v170, v171
v_add_f32 v172, v172, v173
v_add_f32 v174, v174, v175
s_nop 0
v_permlane16_swap_b32 v168, v172
v_permlane16_swap_b32 v170, v174
v_add_f32 v168, v168, v172
v_add_f32 v170, v170, v174
s_nop 1
v_permlane32_swap_b32 v168, v170
v_add_f32 v168, v168, v170
v_min_u32 v186, -2, v168
s_waitcnt vmcnt(0)
buffer_store_dword v186, v21, s[20:23], s38 offen sc0 sc1
s_waitcnt lgkmcnt(6)
v_mfma_f32_16x16x32_bf16 v[96:99], a[0:3], a[36:39], 0
ds_read_b64_tr_b16 a[24:25], v4 offset:18624
v_mfma_f32_16x16x32_bf16 v[100:103], a[0:3], a[40:43], 0
ds_read_b64_tr_b16 a[26:27], v4 offset:20928
v_mfma_f32_16x16x32_bf16 v[104:107], a[4:7], a[36:39], 0
ds_read_b64_tr_b16 a[28:29], v4 offset:18656
buffer_load_dwordx4 v220, s[84:87], s93 offen offset:0 lds
v_mfma_f32_16x16x32_bf16 v[108:111], a[4:7], a[40:43], 0
ds_read_b64_tr_b16 a[30:31], v4 offset:20960
v_mfma_f32_16x16x32_bf16 v[112:115], a[8:11], a[36:39], 0
ds_read_b64_tr_b16 a[32:33], v4 offset:18688
v_mfma_f32_16x16x32_bf16 v[116:119], a[8:11], a[40:43], 0
ds_read_b64_tr_b16 a[34:35], v4 offset:20992
s_waitcnt lgkmcnt(6)
v_mfma_f32_16x16x32_bf16 v[120:123], a[12:15], a[36:39], 0
ds_read_b64_tr_b16 a[0:1], v4 offset:27648
v_mfma_f32_16x16x32_bf16 v[124:127], a[12:15], a[40:43], 0
ds_read_b64_tr_b16 a[2:3], v4 offset:29952
v_mfma_f32_16x16x32_bf16 v[128:131], a[16:19], a[36:39], 0
ds_read_b64_tr_b16 a[4:5], v4 offset:27680
buffer_load_dwordx4 v221, s[84:87], s93 offen offset:1024 lds
v_mfma_f32_16x16x32_bf16 v[132:135], a[16:19], a[40:43], 0
ds_read_b64_tr_b16 a[6:7], v4 offset:29984
v_mfma_f32_16x16x32_bf16 v[136:139], a[20:23], a[36:39], 0
ds_read_b64_tr_b16 a[8:9], v4 offset:27712
v_mfma_f32_16x16x32_bf16 v[140:143], a[20:23], a[40:43], 0
ds_read_b64_tr_b16 a[10:11], v4 offset:30016
s_waitcnt lgkmcnt(6)
v_mfma_f32_16x16x32_bf16 v[144:147], a[24:27], a[36:39], 0
ds_read_b64_tr_b16 a[12:13], v4 offset:27744
v_mfma_f32_16x16x32_bf16 v[148:151], a[24:27], a[40:43], 0
ds_read_b64_tr_b16 a[14:15], v4 offset:30048
buffer_load_dwordx4 v222, s[84:87], s93 offen offset:2048 lds
v_mfma_f32_16x16x32_bf16 v[152:155], a[28:31], a[36:39], 0
ds_read_b64_tr_b16 a[16:17], v4 offset:27776
v_mfma_f32_16x16x32_bf16 v[156:159], a[28:31], a[40:43], 0
ds_read_b64_tr_b16 a[18:19], v4 offset:30080
v_mfma_f32_16x16x32_bf16 v[160:163], a[32:35], a[36:39], 0
ds_read_b64_tr_b16 a[20:21], v4 offset:27808
v_mfma_f32_16x16x32_bf16 v[164:167], a[32:35], a[40:43], 0
ds_read_b64_tr_b16 a[22:23], v4 offset:30112
s_waitcnt lgkmcnt(6)
v_mfma_f32_16x16x32_bf16 v[96:99], a[0:3], a[44:47], v[96:99]
ds_read_b64_tr_b16 a[24:25], v4 offset:27840
v_mfma_f32_16x16x32_bf16 v[100:103], a[0:3], a[48:51], v[100:103]
ds_read_b64_tr_b16 a[26:27], v4 offset:30144
buffer_load_dwordx4 v223, s[84:87], s93 offen offset:3072 lds
v_mfma_f32_16x16x32_bf16 v[104:107], a[4:7], a[44:47], v[104:107]
ds_read_b64_tr_b16 a[28:29], v4 offset:27872
v_mfma_f32_16x16x32_bf16 v[108:111], a[4:7], a[48:51], v[108:111]
ds_read_b64_tr_b16 a[30:31], v4 offset:30176
v_mfma_f32_16x16x32_bf16 v[112:115], a[8:11], a[44:47], v[112:115]
ds_read_b64_tr_b16 a[32:33], v4 offset:27904
v_mfma_f32_16x16x32_bf16 v[116:119], a[8:11], a[48:51], v[116:119]
ds_read_b64_tr_b16 a[34:35], v4 offset:30208
s_waitcnt lgkmcnt(6)
s_barrier
v_mfma_f32_16x16x32_bf16 v[120:123], a[12:15], a[44:47], v[120:123]
ds_read_b64_tr_b16 a[0:1], v5 offset:0
s_add_u32 m0, s30, 8192
v_mfma_f32_16x16x32_bf16 v[124:127], a[12:15], a[48:51], v[124:127]
ds_read_b64_tr_b16 a[2:3], v5 offset:2304
v_mfma_f32_16x16x32_bf16 v[128:131], a[16:19], a[44:47], v[128:131]
ds_read_b64_tr_b16 a[4:5], v5 offset:32
v_mfma_f32_16x16x32_bf16 v[132:135], a[16:19], a[48:51], v[132:135]
ds_read_b64_tr_b16 a[6:7], v5 offset:2336
v_mfma_f32_16x16x32_bf16 v[136:139], a[20:23], a[44:47], v[136:139]
ds_read_b64_tr_b16 a[8:9], v5 offset:64
v_mfma_f32_16x16x32_bf16 v[140:143], a[20:23], a[48:51], v[140:143]
ds_read_b64_tr_b16 a[10:11], v5 offset:2368
s_waitcnt lgkmcnt(6)
v_mfma_f32_16x16x32_bf16 v[144:147], a[24:27], a[44:47], v[144:147]
ds_read_b64_tr_b16 a[12:13], v5 offset:96
buffer_load_dwordx4 v224, s[84:87], s93 offen offset:0 lds
v_mfma_f32_16x16x32_bf16 v[148:151], a[24:27], a[48:51], v[148:151]
ds_read_b64_tr_b16 a[14:15], v5 offset:2400
v_mfma_f32_16x16x32_bf16 v[152:155], a[28:31], a[44:47], v[152:155]
ds_read_b64_tr_b16 a[16:17], v5 offset:128
v_mfma_f32_16x16x32_bf16 v[156:159], a[28:31], a[48:51], v[156:159]
ds_read_b64_tr_b16 a[18:19], v5 offset:2432
v_mfma_f32_16x16x32_bf16 v[160:163], a[32:35], a[44:47], v[160:163]
ds_read_b64_tr_b16 a[20:21], v5 offset:160
v_mfma_f32_16x16x32_bf16 v[164:167], a[32:35], a[48:51], v[164:167]
ds_read_b64_tr_b16 a[22:23], v5 offset:2464
s_add_u32 s93, s93, 1179648
s_waitcnt lgkmcnt(6)
v_mfma_f32_16x16x32_bf16 v[96:99], a[0:3], a[52:55], v[96:99]
ds_read_b64_tr_b16 a[24:25], v5 offset:192
v_mfma_f32_16x16x32_bf16 v[100:103], a[0:3], a[56:59], v[100:103]
ds_read_b64_tr_b16 a[26:27], v5 offset:2496
v_mfma_f32_16x16x32_bf16 v[104:107], a[4:7], a[52:55], v[104:107]
ds_read_b64_tr_b16 a[28:29], v5 offset:224
v_mfma_f32_16x16x32_bf16 v[108:111], a[4:7], a[56:59], v[108:111]
ds_read_b64_tr_b16 a[30:31], v5 offset:2528
v_mfma_f32_16x16x32_bf16 v[112:115], a[8:11], a[52:55], v[112:115]
ds_read_b64_tr_b16 a[32:33], v5 offset:256
v_mfma_f32_16x16x32_bf16 v[116:119], a[8:11], a[56:59], v[116:119]
ds_read_b64_tr_b16 a[34:35], v5 offset:2560
s_add_u32 m0, s30, 36864
s_waitcnt lgkmcnt(6)
v_mfma_f32_16x16x32_bf16 v[120:123], a[12:15], a[52:55], v[120:123]
ds_read_b64_tr_b16 a[0:1], v5 offset:9216
v_mfma_f32_16x16x32_bf16 v[124:127], a[12:15], a[56:59], v[124:127]
ds_read_b64_tr_b16 a[2:3], v5 offset:11520
v_mfma_f32_16x16x32_bf16 v[128:131], a[16:19], a[52:55], v[128:131]
ds_read_b64_tr_b16 a[4:5], v5 offset:9248
v_mfma_f32_16x16x32_bf16 v[132:135], a[16:19], a[56:59], v[132:135]
ds_read_b64_tr_b16 a[6:7], v5 offset:11552
v_mfma_f32_16x16x32_bf16 v[136:139], a[20:23], a[52:55], v[136:139]
ds_read_b64_tr_b16 a[8:9], v5 offset:9280
v_mfma_f32_16x16x32_bf16 v[140:143], a[20:23], a[56:59], v[140:143]
ds_read_b64_tr_b16 a[10:11], v5 offset:11584
buffer_load_dwordx4 v216, s[84:87], s93 offen offset:0 lds
s_waitcnt lgkmcnt(6)
v_mfma_f32_16x16x32_bf16 v[144:147], a[24:27], a[52:55], v[144:147]
ds_read_b64_tr_b16 a[12:13], v5 offset:9312
v_mfma_f32_16x16x32_bf16 v[148:151], a[24:27], a[56:59], v[148:151]
ds_read_b64_tr_b16 a[14:15], v5 offset:11616
v_mfma_f32_16x16x32_bf16 v[152:155], a[28:31], a[52:55], v[152:155]
ds_read_b64_tr_b16 a[16:17], v5 offset:9344
v_mfma_f32_16x16x32_bf16 v[156:159], a[28:31], a[56:59], v[156:159]
ds_read_b64_tr_b16 a[18:19], v5 offset:11648
v_mfma_f32_16x16x32_bf16 v[160:163], a[32:35], a[52:55], v[160:163]
ds_read_b64_tr_b16 a[20:21], v5 offset:9376
buffer_load_dwordx4 v217, s[84:87], s93 offen offset:1024 lds
v_mfma_f32_16x16x32_bf16 v[164:167], a[32:35], a[56:59], v[164:167]
ds_read_b64_tr_b16 a[22:23], v5 offset:11680
s_waitcnt lgkmcnt(6)
v_mfma_f32_16x16x32_bf16 v[96:99], a[0:3], a[60:63], v[96:99]
ds_read_b64_tr_b16 a[24:25], v5 offset:9408
v_mfma_f32_16x16x32_bf16 v[100:103], a[0:3], a[64:67], v[100:103]
ds_read_b64_tr_b16 a[26:27], v5 offset:11712
v_mfma_f32_16x16x32_bf16 v[104:107], a[4:7], a[60:63], v[104:107]
ds_read_b64_tr_b16 a[28:29], v5 offset:9440
v_mfma_f32_16x16x32_bf16 v[108:111], a[4:7], a[64:67], v[108:111]
ds_read_b64_tr_b16 a[30:31], v5 offset:11744
v_mfma_f32_16x16x32_bf16 v[112:115], a[8:11], a[60:63], v[112:115]
ds_read_b64_tr_b16 a[32:33], v5 offset:9472
buffer_load_dwordx4 v218, s[84:87], s93 offen offset:2048 lds
v_mfma_f32_16x16x32_bf16 v[116:119], a[8:11], a[64:67], v[116:119]
ds_read_b64_tr_b16 a[34:35], v5 offset:11776
s_waitcnt lgkmcnt(6)
v_mfma_f32_16x16x32_bf16 v[120:123], a[12:15], a[60:63], v[120:123]
ds_read_b64_tr_b16 a[0:1], v5 offset:18432
v_mfma_f32_16x16x32_bf16 v[124:127], a[12:15], a[64:67], v[124:127]
ds_read_b64_tr_b16 a[2:3], v5 offset:20736
v_mfma_f32_16x16x32_bf16 v[128:131], a[16:19], a[60:63], v[128:131]
ds_read_b64_tr_b16 a[4:5], v5 offset:18464
v_mfma_f32_16x16x32_bf16 v[132:135], a[16:19], a[64:67], v[132:135]
ds_read_b64_tr_b16 a[6:7], v5 offset:20768
buffer_load_dwordx4 v219, s[84:87], s93 offen offset:3072 lds
v_mfma_f32_16x16x32_bf16 v[136:139], a[20:23], a[60:63], v[136:139]
ds_read_b64_tr_b16 a[8:9], v5 offset:18496
v_mfma_f32_16x16x32_bf16 v[140:143], a[20:23], a[64:67], v[140:143]
ds_read_b64_tr_b16 a[10:11], v5 offset:20800
s_waitcnt lgkmcnt(6)
v_mfma_f32_16x16x32_bf16 v[144:147], a[24:27], a[60:63], v[144:147]
ds_read_b64_tr_b16 a[12:13], v5 offset:18528
v_mfma_f32_16x16x32_bf16 v[148:151], a[24:27], a[64:67], v[148:151]
ds_read_b64_tr_b16 a[14:15], v5 offset:20832
v_mfma_f32_16x16x32_bf16 v[152:155], a[28:31], a[60:63], v[152:155]
ds_read_b64_tr_b16 a[16:17], v5 offset:18560
v_mfma_f32_16x16x32_bf16 v[156:159], a[28:31], a[64:67], v[156:159]
ds_read_b64_tr_b16 a[18:19], v5 offset:20864
s_add_u32 m0, s30, 40960
v_mfma_f32_16x16x32_bf16 v[160:163], a[32:35], a[60:63], v[160:163]
ds_read_b64_tr_b16 a[20:21], v5 offset:18592
v_mfma_f32_16x16x32_bf16 v[164:167], a[32:35], a[64:67], v[164:167]
ds_read_b64_tr_b16 a[22:23], v5 offset:20896
s_waitcnt lgkmcnt(6)
v_mfma_f32_16x16x32_bf16 v[96:99], a[0:3], a[68:71], v[96:99]
ds_read_b64_tr_b16 a[24:25], v5 offset:18624
v_mfma_f32_16x16x32_bf16 v[100:103], a[0:3], a[72:75], v[100:103]
ds_read_b64_tr_b16 a[26:27], v5 offset:20928
v_mfma_f32_16x16x32_bf16 v[104:107], a[4:7], a[68:71], v[104:107]
ds_read_b64_tr_b16 a[28:29], v5 offset:18656
buffer_load_dwordx4 v220, s[84:87], s93 offen offset:0 lds
v_mfma_f32_16x16x32_bf16 v[108:111], a[4:7], a[72:75], v[108:111]
ds_read_b64_tr_b16 a[30:31], v5 offset:20960
v_mfma_f32_16x16x32_bf16 v[112:115], a[8:11], a[68:71], v[112:115]
ds_read_b64_tr_b16 a[32:33], v5 offset:18688
v_mfma_f32_16x16x32_bf16 v[116:119], a[8:11], a[72:75], v[116:119]
ds_read_b64_tr_b16 a[34:35], v5 offset:20992
s_waitcnt lgkmcnt(6)
v_mfma_f32_16x16x32_bf16 v[120:123], a[12:15], a[68:71], v[120:123]
ds_read_b64_tr_b16 a[0:1], v5 offset:27648
v_mfma_f32_16x16x32_bf16 v[124:127], a[12:15], a[72:75], v[124:127]
ds_read_b64_tr_b16 a[2:3], v5 offset:29952
v_mfma_f32_16x16x32_bf16 v[128:131], a[16:19], a[68:71], v[128:131]
ds_read_b64_tr_b16 a[4:5], v5 offset:27680
buffer_load_dwordx4 v221, s[84:87], s93 offen offset:1024 lds
v_mfma_f32_16x16x32_bf16 v[132:135], a[16:19], a[72:75], v[132:135]
ds_read_b64_tr_b16 a[6:7], v5 offset:29984
v_mfma_f32_16x16x32_bf16 v[136:139], a[20:23], a[68:71], v[136:139]
ds_read_b64_tr_b16 a[8:9], v5 offset:27712
v_mfma_f32_16x16x32_bf16 v[140:143], a[20:23], a[72:75], v[140:143]
ds_read_b64_tr_b16 a[10:11], v5 offset:30016
s_waitcnt lgkmcnt(6)
v_mfma_f32_16x16x32_bf16 v[144:147], a[24:27], a[68:71], v[144:147]
ds_read_b64_tr_b16 a[12:13], v5 offset:27744
v_mfma_f32_16x16x32_bf16 v[148:151], a[24:27], a[72:75], v[148:151]
ds_read_b64_tr_b16 a[14:15], v5 offset:30048
buffer_load_dwordx4 v222, s[84:87], s93 offen offset:2048 lds
v_mfma_f32_16x16x32_bf16 v[152:155], a[28:31], a[68:71], v[152:155]
ds_read_b64_tr_b16 a[16:17], v5 offset:27776
v_mfma_f32_16x16x32_bf16 v[156:159], a[28:31], a[72:75], v[156:159]
ds_read_b64_tr_b16 a[18:19], v5 offset:30080
v_mfma_f32_16x16x32_bf16 v[160:163], a[32:35], a[68:71], v[160:163]
ds_read_b64_tr_b16 a[20:21], v5 offset:27808
v_mfma_f32_16x16x32_bf16 v[164:167], a[32:35], a[72:75], v[164:167]
ds_read_b64_tr_b16 a[22:23], v5 offset:30112
s_waitcnt lgkmcnt(6)
v_mfma_f32_16x16x32_bf16 v[96:99], a[0:3], a[76:79], v[96:99]
ds_read_b64_tr_b16 a[24:25], v5 offset:27840
v_mfma_f32_16x16x32_bf16 v[100:103], a[0:3], a[80:83], v[100:103]
ds_read_b64_tr_b16 a[26:27], v5 offset:30144
buffer_load_dwordx4 v223, s[84:87], s93 offen offset:3072 lds
v_mfma_f32_16x16x32_bf16 v[104:107], a[4:7], a[76:79], v[104:107]
ds_read_b64_tr_b16 a[28:29], v5 offset:27872
v_mfma_f32_16x16x32_bf16 v[108:111], a[4:7], a[80:83], v[108:111]
ds_read_b64_tr_b16 a[30:31], v5 offset:30176
v_mfma_f32_16x16x32_bf16 v[112:115], a[8:11], a[76:79], v[112:115]
ds_read_b64_tr_b16 a[32:33], v5 offset:27904
v_mfma_f32_16x16x32_bf16 v[116:119], a[8:11], a[80:83], v[116:119]
ds_read_b64_tr_b16 a[34:35], v5 offset:30208
s_waitcnt vmcnt(8) lgkmcnt(6)
s_barrier
v_mfma_f32_16x16x32_bf16 v[120:123], a[12:15], a[76:79], v[120:123]
ds_read_b64_tr_b16 a[0:1], v2 offset:0
s_add_u32 m0, s30, 45056
v_mfma_f32_16x16x32_bf16 v[124:127], a[12:15], a[80:83], v[124:127]
ds_read_b64_tr_b16 a[2:3], v2 offset:2304
v_mfma_f32_16x16x32_bf16 v[128:131], a[16:19], a[76:79], v[128:131]
ds_read_b64_tr_b16 a[4:5], v2 offset:32
v_mfma_f32_16x16x32_bf16 v[132:135], a[16:19], a[80:83], v[132:135]
ds_read_b64_tr_b16 a[6:7], v2 offset:2336
v_mfma_f32_16x16x32_bf16 v[136:139], a[20:23], a[76:79], v[136:139]
ds_read_b64_tr_b16 a[8:9], v2 offset:64
v_mfma_f32_16x16x32_bf16 v[140:143], a[20:23], a[80:83], v[140:143]
ds_read_b64_tr_b16 a[10:11], v2 offset:2368
s_waitcnt lgkmcnt(6)
v_mfma_f32_16x16x32_bf16 v[144:147], a[24:27], a[76:79], v[144:147]
ds_read_b64_tr_b16 a[12:13], v2 offset:96
buffer_load_dwordx4 v224, s[84:87], s93 offen offset:0 lds
v_mfma_f32_16x16x32_bf16 v[148:151], a[24:27], a[80:83], v[148:151]
ds_read_b64_tr_b16 a[14:15], v2 offset:2400
v_mfma_f32_16x16x32_bf16 v[152:155], a[28:31], a[76:79], v[152:155]
ds_read_b64_tr_b16 a[16:17], v2 offset:128
v_mfma_f32_16x16x32_bf16 v[156:159], a[28:31], a[80:83], v[156:159]
ds_read_b64_tr_b16 a[18:19], v2 offset:2432
v_mfma_f32_16x16x32_bf16 v[160:163], a[32:35], a[76:79], v[160:163]
ds_read_b64_tr_b16 a[20:21], v2 offset:160
v_mfma_f32_16x16x32_bf16 v[164:167], a[32:35], a[80:83], v[164:167]
ds_read_b64_tr_b16 a[22:23], v2 offset:2464
s_add_u32 s93, s93, 1179648
s_waitcnt lgkmcnt(6)
v_mfma_f32_16x16x32_bf16 v[96:99], a[0:3], a[84:87], v[96:99]
ds_read_b64_tr_b16 a[24:25], v2 offset:192
v_mfma_f32_16x16x32_bf16 v[100:103], a[0:3], a[88:91], v[100:103]
ds_read_b64_tr_b16 a[26:27], v2 offset:2496
v_mfma_f32_16x16x32_bf16 v[104:107], a[4:7], a[84:87], v[104:107]
ds_read_b64_tr_b16 a[28:29], v2 offset:224
v_mfma_f32_16x16x32_bf16 v[108:111], a[4:7], a[88:91], v[108:111]
ds_read_b64_tr_b16 a[30:31], v2 offset:2528
v_mfma_f32_16x16x32_bf16 v[112:115], a[8:11], a[84:87], v[112:115]
ds_read_b64_tr_b16 a[32:33], v2 offset:256
v_mfma_f32_16x16x32_bf16 v[116:119], a[8:11], a[88:91], v[116:119]
ds_read_b64_tr_b16 a[34:35], v2 offset:2560
s_add_u32 m0, s30, 73728
s_waitcnt lgkmcnt(6)
v_mfma_f32_16x16x32_bf16 v[120:123], a[12:15], a[84:87], v[120:123]
ds_read_b64_tr_b16 a[0:1], v2 offset:9216
v_mfma_f32_16x16x32_bf16 v[124:127], a[12:15], a[88:91], v[124:127]
ds_read_b64_tr_b16 a[2:3], v2 offset:11520
v_mfma_f32_16x16x32_bf16 v[128:131], a[16:19], a[84:87], v[128:131]
ds_read_b64_tr_b16 a[4:5], v2 offset:9248
v_mfma_f32_16x16x32_bf16 v[132:135], a[16:19], a[88:91], v[132:135]
ds_read_b64_tr_b16 a[6:7], v2 offset:11552
v_mfma_f32_16x16x32_bf16 v[136:139], a[20:23], a[84:87], v[136:139]
ds_read_b64_tr_b16 a[8:9], v2 offset:9280
v_mfma_f32_16x16x32_bf16 v[140:143], a[20:23], a[88:91], v[140:143]
ds_read_b64_tr_b16 a[10:11], v2 offset:11584
buffer_load_dwordx4 v216, s[84:87], s93 offen offset:0 lds
s_waitcnt lgkmcnt(6)
v_mfma_f32_16x16x32_bf16 v[144:147], a[24:27], a[84:87], v[144:147]
ds_read_b64_tr_b16 a[12:13], v2 offset:9312
v_mfma_f32_16x16x32_bf16 v[148:151], a[24:27], a[88:91], v[148:151]
ds_read_b64_tr_b16 a[14:15], v2 offset:11616
v_mfma_f32_16x16x32_bf16 v[152:155], a[28:31], a[84:87], v[152:155]
ds_read_b64_tr_b16 a[16:17], v2 offset:9344
v_mfma_f32_16x16x32_bf16 v[156:159], a[28:31], a[88:91], v[156:159]
ds_read_b64_tr_b16 a[18:19], v2 offset:11648
v_mfma_f32_16x16x32_bf16 v[160:163], a[32:35], a[84:87], v[160:163]
ds_read_b64_tr_b16 a[20:21], v2 offset:9376
buffer_load_dwordx4 v217, s[84:87], s93 offen offset:1024 lds
v_mfma_f32_16x16x32_bf16 v[164:167], a[32:35], a[88:91], v[164:167]
ds_read_b64_tr_b16 a[22:23], v2 offset:11680
buffer_load_dword v188, v21, s[20:23], s40 offen offset:0 sc0 sc1
buffer_load_dword v189, v21, s[20:23], s40 offen offset:256 sc0 sc1
buffer_load_dword v190, v21, s[20:23], s40 offen offset:512 sc0 sc1
buffer_load_dword v191, v21, s[20:23], s40 offen offset:768 sc0 sc1
buffer_load_dword v192, v21, s[20:23], s40 offen offset:1024 sc0 sc1
buffer_load_dword v193, v21, s[20:23], s40 offen offset:1280 sc0 sc1
buffer_load_dword v194, v21, s[20:23], s40 offen offset:1536 sc0 sc1
buffer_load_dword v195, v21, s[20:23], s40 offen offset:1792 sc0 sc1
buffer_load_dword v196, v21, s[20:23], s40 offen offset:2048 sc0 sc1
buffer_load_dword v197, v21, s[20:23], s40 offen offset:2304 sc0 sc1
buffer_load_dword v198, v21, s[20:23], s40 offen offset:2560 sc0 sc1
buffer_load_dword v199, v21, s[20:23], s40 offen offset:2816 sc0 sc1
buffer_load_dword v200, v21, s[20:23], s40 offen offset:3072 sc0 sc1
buffer_load_dword v201, v21, s[20:23], s40 offen offset:3328 sc0 sc1
buffer_load_dword v202, v21, s[20:23], s40 offen offset:3584 sc0 sc1
buffer_load_dword v203, v21, s[20:23], s40 offen offset:3840 sc0 sc1
s_waitcnt lgkmcnt(6)
v_mfma_f32_16x16x32_bf16 v[96:99], a[0:3], a[92:95], v[96:99]
ds_read_b64_tr_b16 a[24:25], v2 offset:9408
v_mfma_f32_16x16x32_bf16 v[100:103], a[0:3], a[96:99], v[100:103]
ds_read_b64_tr_b16 a[26:27], v2 offset:11712
v_mfma_f32_16x16x32_bf16 v[104:107], a[4:7], a[92:95], v[104:107]
ds_read_b64_tr_b16 a[28:29], v2 offset:9440
v_mfma_f32_16x16x32_bf16 v[108:111], a[4:7], a[96:99], v[108:111]
ds_read_b64_tr_b16 a[30:31], v2 offset:11744
v_mfma_f32_16x16x32_bf16 v[112:115], a[8:11], a[92:95], v[112:115]
ds_read_b64_tr_b16 a[32:33], v2 offset:9472
buffer_load_dwordx4 v218, s[84:87], s93 offen offset:2048 lds
v_mfma_f32_16x16x32_bf16 v[116:119], a[8:11], a[96:99], v[116:119]
ds_read_b64_tr_b16 a[34:35], v2 offset:11776
s_waitcnt lgkmcnt(6)
v_mfma_f32_16x16x32_bf16 v[120:123], a[12:15], a[92:95], v[120:123]
ds_read_b64_tr_b16 a[0:1], v2 offset:18432
v_mfma_f32_16x16x32_bf16 v[124:127], a[12:15], a[96:99], v[124:127]
ds_read_b64_tr_b16 a[2:3], v2 offset:20736
v_mfma_f32_16x16x32_bf16 v[128:131], a[16:19], a[92:95], v[128:131]
ds_read_b64_tr_b16 a[4:5], v2 offset:18464
v_mfma_f32_16x16x32_bf16 v[132:135], a[16:19], a[96:99], v[132:135]
ds_read_b64_tr_b16 a[6:7], v2 offset:20768
buffer_load_dwordx4 v219, s[84:87], s93 offen offset:3072 lds
v_mfma_f32_16x16x32_bf16 v[136:139], a[20:23], a[92:95], v[136:139]
ds_read_b64_tr_b16 a[8:9], v2 offset:18496
v_mfma_f32_16x16x32_bf16 v[140:143], a[20:23], a[96:99], v[140:143]
ds_read_b64_tr_b16 a[10:11], v2 offset:20800
s_waitcnt lgkmcnt(6)
v_mfma_f32_16x16x32_bf16 v[144:147], a[24:27], a[92:95], v[144:147]
ds_read_b64_tr_b16 a[12:13], v2 offset:18528
v_mfma_f32_16x16x32_bf16 v[148:151], a[24:27], a[96:99], v[148:151]
ds_read_b64_tr_b16 a[14:15], v2 offset:20832
v_mfma_f32_16x16x32_bf16 v[152:155], a[28:31], a[92:95], v[152:155]
ds_read_b64_tr_b16 a[16:17], v2 offset:18560
v_mfma_f32_16x16x32_bf16 v[156:159], a[28:31], a[96:99], v[156:159]
ds_read_b64_tr_b16 a[18:19], v2 offset:20864
s_add_u32 m0, s30, 77824
v_mfma_f32_16x16x32_bf16 v[160:163], a[32:35], a[92:95], v[160:163]
ds_read_b64_tr_b16 a[20:21], v2 offset:18592
v_mfma_f32_16x16x32_bf16 v[164:167], a[32:35], a[96:99], v[164:167]
ds_read_b64_tr_b16 a[22:23], v2 offset:20896
s_waitcnt lgkmcnt(6)
v_mfma_f32_16x16x32_bf16 v[96:99], a[0:3], a[100:103], v[96:99]
ds_read_b64_tr_b16 a[24:25], v2 offset:18624
v_mfma_f32_16x16x32_bf16 v[100:103], a[0:3], a[104:107], v[100:103]
ds_read_b64_tr_b16 a[26:27], v2 offset:20928
v_mfma_f32_16x16x32_bf16 v[104:107], a[4:7], a[100:103], v[104:107]
ds_read_b64_tr_b16 a[28:29], v2 offset:18656
buffer_load_dwordx4 v220, s[84:87], s93 offen offset:0 lds
v_mfma_f32_16x16x32_bf16 v[108:111], a[4:7], a[104:107], v[108:111]
ds_read_b64_tr_b16 a[30:31], v2 offset:20960
v_mfma_f32_16x16x32_bf16 v[112:115], a[8:11], a[100:103], v[112:115]
ds_read_b64_tr_b16 a[32:33], v2 offset:18688
v_mfma_f32_16x16x32_bf16 v[116:119], a[8:11], a[104:107], v[116:119]
ds_read_b64_tr_b16 a[34:35], v2 offset:20992
s_waitcnt lgkmcnt(6)
v_mfma_f32_16x16x32_bf16 v[120:123], a[12:15], a[100:103], v[120:123]
ds_read_b64_tr_b16 a[0:1], v2 offset:27648
v_mfma_f32_16x16x32_bf16 v[124:127], a[12:15], a[104:107], v[124:127]
ds_read_b64_tr_b16 a[2:3], v2 offset:29952
v_mfma_f32_16x16x32_bf16 v[128:131], a[16:19], a[100:103], v[128:131]
ds_read_b64_tr_b16 a[4:5], v2 offset:27680
buffer_load_dwordx4 v221, s[84:87], s93 offen offset:1024 lds
v_mfma_f32_16x16x32_bf16 v[132:135], a[16:19], a[104:107], v[132:135]
ds_read_b64_tr_b16 a[6:7], v2 offset:29984
v_mfma_f32_16x16x32_bf16 v[136:139], a[20:23], a[100:103], v[136:139]
ds_read_b64_tr_b16 a[8:9], v2 offset:27712
v_mfma_f32_16x16x32_bf16 v[140:143], a[20:23], a[104:107], v[140:143]
ds_read_b64_tr_b16 a[10:11], v2 offset:30016
s_waitcnt lgkmcnt(6)
v_mfma_f32_16x16x32_bf16 v[144:147], a[24:27], a[100:103], v[144:147]
ds_read_b64_tr_b16 a[12:13], v2 offset:27744
v_mfma_f32_16x16x32_bf16 v[148:151], a[24:27], a[104:107], v[148:151]
ds_read_b64_tr_b16 a[14:15], v2 offset:30048
buffer_load_dwordx4 v222, s[84:87], s93 offen offset:2048 lds
v_mfma_f32_16x16x32_bf16 v[152:155], a[28:31], a[100:103], v[152:155]
ds_read_b64_tr_b16 a[16:17], v2 offset:27776
v_mfma_f32_16x16x32_bf16 v[156:159], a[28:31], a[104:107], v[156:159]
ds_read_b64_tr_b16 a[18:19], v2 offset:30080
v_mfma_f32_16x16x32_bf16 v[160:163], a[32:35], a[100:103], v[160:163]
ds_read_b64_tr_b16 a[20:21], v2 offset:27808
v_mfma_f32_16x16x32_bf16 v[164:167], a[32:35], a[104:107], v[164:167]
ds_read_b64_tr_b16 a[22:23], v2 offset:30112
s_waitcnt lgkmcnt(6)
v_mfma_f32_16x16x32_bf16 v[96:99], a[0:3], a[108:111], v[96:99]
ds_read_b64_tr_b16 a[24:25], v2 offset:27840
v_mfma_f32_16x16x32_bf16 v[100:103], a[0:3], a[112:115], v[100:103]
ds_read_b64_tr_b16 a[26:27], v2 offset:30144
buffer_load_dwordx4 v223, s[84:87], s93 offen offset:3072 lds
v_mfma_f32_16x16x32_bf16 v[104:107], a[4:7], a[108:111], v[104:107]
ds_read_b64_tr_b16 a[28:29], v2 offset:27872
v_mfma_f32_16x16x32_bf16 v[108:111], a[4:7], a[112:115], v[108:111]
ds_read_b64_tr_b16 a[30:31], v2 offset:30176
v_mfma_f32_16x16x32_bf16 v[112:115], a[8:11], a[108:111], v[112:115]
ds_read_b64_tr_b16 a[32:33], v2 offset:27904
v_mfma_f32_16x16x32_bf16 v[116:119], a[8:11], a[112:115], v[116:119]
ds_read_b64_tr_b16 a[34:35], v2 offset:30208
s_waitcnt vmcnt(24) lgkmcnt(6)
s_barrier
v_mfma_f32_16x16x32_bf16 v[120:123], a[12:15], a[108:111], v[120:123]
ds_read_b64_tr_b16 a[0:1], v3 offset:0
s_add_u32 m0, s30, 81920
v_mfma_f32_16x16x32_bf16 v[124:127], a[12:15], a[112:115], v[124:127]
ds_read_b64_tr_b16 a[2:3], v3 offset:2304
v_mfma_f32_16x16x32_bf16 v[128:131], a[16:19], a[108:111], v[128:131]
ds_read_b64_tr_b16 a[4:5], v3 offset:32
v_mfma_f32_16x16x32_bf16 v[132:135], a[16:19], a[112:115], v[132:135]
ds_read_b64_tr_b16 a[6:7], v3 offset:2336
v_mfma_f32_16x16x32_bf16 v[136:139], a[20:23], a[108:111], v[136:139]
ds_read_b64_tr_b16 a[8:9], v3 offset:64
v_mfma_f32_16x16x32_bf16 v[140:143], a[20:23], a[112:115], v[140:143]
ds_read_b64_tr_b16 a[10:11], v3 offset:2368
s_waitcnt lgkmcnt(6)
v_mfma_f32_16x16x32_bf16 v[144:147], a[24:27], a[108:111], v[144:147]
ds_read_b64_tr_b16 a[12:13], v3 offset:96
buffer_load_dwordx4 v224, s[84:87], s93 offen offset:0 lds
v_mfma_f32_16x16x32_bf16 v[148:151], a[24:27], a[112:115], v[148:151]
ds_read_b64_tr_b16 a[14:15], v3 offset:2400
v_mfma_f32_16x16x32_bf16 v[152:155], a[28:31], a[108:111], v[152:155]
ds_read_b64_tr_b16 a[16:17], v3 offset:128
v_mfma_f32_16x16x32_bf16 v[156:159], a[28:31], a[112:115], v[156:159]
ds_read_b64_tr_b16 a[18:19], v3 offset:2432
v_mfma_f32_16x16x32_bf16 v[160:163], a[32:35], a[108:111], v[160:163]
ds_read_b64_tr_b16 a[20:21], v3 offset:160
v_mfma_f32_16x16x32_bf16 v[164:167], a[32:35], a[112:115], v[164:167]
ds_read_b64_tr_b16 a[22:23], v3 offset:2464
s_add_u32 s93, s93, 1179648
s_waitcnt vmcnt(7)
k3_chk:
v_max3_u32 v187, v188, v189, v190
v_max3_u32 v187, v187, v191, v192
v_max3_u32 v187, v187, v193, v194
v_max3_u32 v187, v187, v195, v196
v_max3_u32 v187, v187, v197, v198
v_max3_u32 v187, v187, v199, v200
v_max3_u32 v187, v187, v201, v202
v_max_u32 v187, v187, v203
v_cmp_eq_u32 vcc, -1, v187
s_nop 0
s_cbranch_vccz k3_go
s_sleep 1
buffer_load_dword v188, v21, s[20:23], s40 offen offset:0 sc0 sc1
buffer_load_dword v189, v21, s[20:23], s40 offen offset:256 sc0 sc1
buffer_load_dword v190, v21, s[20:23], s40 offen offset:512 sc0 sc1
buffer_load_dword v191, v21, s[20:23], s40 offen offset:768 sc0 sc1
buffer_load_dword v192, v21, s[20:23], s40 offen offset:1024 sc0 sc1
buffer_load_dword v193, v21, s[20:23], s40 offen offset:1280 sc0 sc1
buffer_load_dword v194, v21, s[20:23], s40 offen offset:1536 sc0 sc1
buffer_load_dword v195, v21, s[20:23], s40 offen offset:1792 sc0 sc1
buffer_load_dword v196, v21, s[20:23], s40 offen offset:2048 sc0 sc1
buffer_load_dword v197, v21, s[20:23], s40 offen offset:2304 sc0 sc1
buffer_load_dword v198, v21, s[20:23], s40 offen offset:2560 sc0 sc1
buffer_load_dword v199, v21, s[20:23], s40 offen offset:2816 sc0 sc1
buffer_load_dword v200, v21, s[20:23], s40 offen offset:3072 sc0 sc1
buffer_load_dword v201, v21, s[20:23], s40 offen offset:3328 sc0 sc1
buffer_load_dword v202, v21, s[20:23], s40 offen offset:3584 sc0 sc1
buffer_load_dword v203, v21, s[20:23], s40 offen offset:3840 sc0 sc1
s_waitcnt vmcnt(0)
s_branch k3_chk
k3_go:
v_add_f32 v188, v188, v189
v_add_f32 v188, v188, v190
v_add_f32 v188, v188, v191
v_add_f32 v188, v188, v192
v_add_f32 v188, v188, v193
v_add_f32 v188, v188, v194
v_add_f32 v188, v188, v195
v_add_f32 v188, v188, v196
v_add_f32 v188, v188, v197
v_add_f32 v188, v188, v198
v_add_f32 v188, v188, v199
v_add_f32 v188, v188, v200
v_add_f32 v188, v188, v201
v_add_f32 v188, v188, v202
v_add_f32 v188, v188, v203
v_mul_f32 v188, 0x39e38e39, v188
v_mov_b32 v189, v188
s_nop 1
v_permlane32_swap_b32 v188, v189
v_fma_f32 v189, -v188, v188, v189
v_max_f32 v189, 0, v189
v_add_f32 v189, 0x3727c5ac, v189
v_rsq_f32 v190, v189
s_nop 0
v_mul_f32 v192, v188, v190
v_sub_f32 v192, 0, v192
v_mov_b32 v191, v190
v_mov_b32 v193, v192
s_nop 0
v_permlane16_swap_b32 v190, v191
v_permlane16_swap_b32 v192, v193
v_fma_f32 v24, v24, v190, v192
v_fma_f32 v25, v25, v190, v192
v_fma_f32 v26, v26, v190, v192
v_fma_f32 v27, v27, v190, v192
v_fma_f32 v28, v28, v191, v193
v_fma_f32 v29, v29, v191, v193
v_fma_f32 v30, v30, v191, v193
v_fma_f32 v31, v31, v191, v193
v_fma_f32 v32, v32, v190, v192
v_fma_f32 v33, v33, v190, v192
v_fma_f32 v34, v34, v190, v192
v_fma_f32 v35, v35, v190, v192
v_fma_f32 v36, v36, v191, v193
v_fma_f32 v37, v37, v191, v193
v_fma_f32 v38, v38, v191, v193
v_fma_f32 v39, v39, v191, v193
v_fma_f32 v40, v40, v190, v192
v_fma_f32 v41, v41, v190, v192
v_fma_f32 v42, v42, v190, v192
v_fma_f32 v43, v43, v190, v192
v_fma_f32 v44, v44, v191, v193
v_fma_f32 v45, v45, v191, v193
v_fma_f32 v46, v46, v191, v193
v_fma_f32 v47, v47, v191, v193
v_fma_f32 v48, v48, v190, v192
v_fma_f32 v49, v49, v190, v192
v_fma_f32 v50, v50, v190, v192
v_fma_f32 v51, v51, v190, v192
v_fma_f32 v52, v52, v191, v193
v_fma_f32 v53, v53, v191, v193
v_fma_f32 v54, v54, v191, v193
v_fma_f32 v55, v55, v191, v193
v_fma_f32 v56, v56, v190, v192
v_fma_f32 v57, v57, v190, v192
v_fma_f32 v58, v58, v190, v192
v_fma_f32 v59, v59, v190, v192
v_fma_f32 v60, v60, v191, v193
v_fma_f32 v61, v61, v191, v193
v_fma_f32 v62, v62, v191, v193
v_fma_f32 v63, v63, v191, v193
v_fma_f32 v64, v64, v190, v192
v_fma_f32 v65, v65, v190, v192
v_fma_f32 v66, v66, v190, v192
v_fma_f32 v67, v67, v190, v192
v_fma_f32 v68, v68, v191, v193
v_fma_f32 v69, v69, v191, v193
v_fma_f32 v70, v70, v191, v193
v_fma_f32 v71, v71, v191, v193
v_fma_f32 v72, v72, v190, v192
v_fma_f32 v73, v73, v190, v192
v_fma_f32 v74, v74, v190, v192
v_fma_f32 v75, v75, v190, v192
v_fma_f32 v76, v76, v191, v193
v_fma_f32 v77, v77, v191, v193
v_fma_f32 v78, v78, v191, v193
v_fma_f32 v79, v79, v191, v193
v_fma_f32 v80, v80, v190, v192
v_fma_f32 v81, v81, v190, v192
v_fma_f32 v82, v82, v190, v192
v_fma_f32 v83, v83, v190, v192
v_fma_f32 v84, v84, v191, v193
v_fma_f32 v85, v85, v191, v193
v_fma_f32 v86, v86, v191, v193
v_fma_f32 v87, v87, v191, v193
v_fma_f32 v88, v88, v190, v192
v_fma_f32 v89, v89, v190, v192
v_fma_f32 v90, v90, v190, v192
v_fma_f32 v91, v91, v190, v192
v_fma_f32 v92, v92, v191, v193
v_fma_f32 v93, v93, v191, v193
v_fma_f32 v94, v94, v191, v193
v_fma_f32 v95, v95, v191, v193
s_add_u32 s3, s30, 110592
v_add_u32 v14, s3, v14
v_add_u32 v15, s3, v15
v_add_u32 v16, s3, v16
v_add_u32 v9, s3, v20
v_cvt_pk_bf16_f32 v168, v24, v25
v_cvt_pk_bf16_f32 v169, v26, v27
v_cvt_pk_bf16_f32 v170, v32, v33
v_cvt_pk_bf16_f32 v171, v34, v35
s_nop 0
v_permlane16_swap_b32 v168, v170
v_permlane16_swap_b32 v169, v171
ds_write_b128 v14, v[168:171] offset:0
v_cvt_pk_bf16_f32 v172, v28, v29
v_cvt_pk_bf16_f32 v173, v30, v31
v_cvt_pk_bf16_f32 v174, v36, v37
v_cvt_pk_bf16_f32 v175, v38, v39
s_nop 0
v_permlane16_swap_b32 v172, v174
v_permlane16_swap_b32 v173, v175
ds_write_b128 v15, v[172:175] offset:0
v_cvt_pk_bf16_f32 v176, v40, v41
v_cvt_pk_bf16_f32 v177, v42, v43
v_cvt_pk_bf16_f32 v178, v48, v49
v_cvt_pk_bf16_f32 v179, v50, v51
s_nop 0
v_permlane16_swap_b32 v176, v178
v_permlane16_swap_b32 v177, v179
ds_write_b128 v14, v[176:179] offset:64
v_cvt_pk_bf16_f32 v168, v44, v45
v_cvt_pk_bf16_f32 v169, v46, v47
v_cvt_pk_bf16_f32 v170, v52, v53
v_cvt_pk_bf16_f32 v171, v54, v55
s_nop 0
v_permlane16_swap_b32 v168, v170
v_permlane16_swap_b32 v169, v171
ds_write_b128 v15, v[168:171] offset:64
v_cvt_pk_bf16_f32 v172, v56, v57
v_cvt_pk_bf16_f32 v173, v58, v59
v_cvt_pk_bf16_f32 v174, v64, v65
v_cvt_pk_bf16_f32 v175, v66, v67
s_nop 0
v_permlane16_swap_b32 v172, v174
v_permlane16_swap_b32 v173, v175
ds_write_b128 v14, v[172:175] offset:128
v_cvt_pk_bf16_f32 v176, v60, v61
v_cvt_pk_bf16_f32 v177, v62, v63
v_cvt_pk_bf16_f32 v178, v68, v69
v_cvt_pk_bf16_f32 v179, v70, v71
s_nop 0
v_permlane16_swap_b32 v176, v178
v_permlane16_swap_b32 v177, v179
ds_write_b128 v15, v[176:179] offset:128
v_cvt_pk_bf16_f32 v168, v72, v73
v_cvt_pk_bf16_f32 v169, v74, v75
v_cvt_pk_bf16_f32 v170, v80, v81
v_cvt_pk_bf16_f32 v171, v82, v83
s_nop 0
v_permlane16_swap_b32 v168, v170
v_permlane16_swap_b32 v169, v171
ds_write_b128 v14, v[168:171] offset:192
v_cvt_pk_bf16_f32 v172, v76, v77
v_cvt_pk_bf16_f32 v173, v78, v79
v_cvt_pk_bf16_f32 v174, v84, v85
v_cvt_pk_bf16_f32 v175, v86, v87
s_nop 0
v_permlane16_swap_b32 v172, v174
v_permlane16_swap_b32 v173, v175
ds_write_b128 v15, v[172:175] offset:192
v_cvt_pk_bf16_f32 v176, v88, v89
v_cvt_pk_bf16_f32 v177, v90, v91
v_cvt_pk_bf16_f32 v178, v92, v93
v_cvt_pk_bf16_f32 v179, v94, v95
s_nop 0
v_permlane16_swap_b32 v176, v178
v_permlane16_swap_b32 v177, v179
ds_write_b128 v16, v[176:179] offset:0
s_waitcnt lgkmcnt(0)
ds_read_b128 v[24:27], v9 offset:0
ds_read_b128 v[28:31], v9 offset:1024
ds_read_b128 v[32:35], v9 offset:2048
ds_read_b128 v[36:39], v9 offset:3072
ds_read_b128 v[40:43], v9 offset:4096
ds_read_b128 v[44:47], v9 offset:5120
ds_read_b128 v[48:51], v9 offset:6144
ds_read_b128 v[52:55], v9 offset:7168
ds_read_b128 v[56:59], v9 offset:8192
s_waitcnt lgkmcnt(0)
buffer_store_dwordx4 v[24:27], v20, s[12:15], s35 offen offset:0 sc0 sc1
buffer_store_dwordx4 v[28:31], v20, s[12:15], s35 offen offset:1024 sc0 sc1
buffer_store_dwordx4 v[32:35], v20, s[12:15], s35 offen offset:2048 sc0 sc1
buffer_store_dwordx4 v[36:39], v20, s[12:15], s35 offen offset:3072 sc0 sc1
s_add_u32 s35, s35, 4096
buffer_store_dwordx4 v[40:43], v20, s[12:15], s35 offen offset:0 sc0 sc1
buffer_store_dwordx4 v[44:47], v20, s[12:15], s35 offen offset:1024 sc0 sc1
buffer_store_dwordx4 v[48:51], v20, s[12:15], s35 offen offset:2048 sc0 sc1
buffer_store_dwordx4 v[52:55], v20, s[12:15], s35 offen offset:3072 sc0 sc1
s_add_u32 s35, s35, 4096
buffer_store_dwordx4 v[56:59], v20, s[12:15], s35 offen offset:0 sc0 sc1
s_waitcnt lgkmcnt(6)
v_mfma_f32_16x16x32_bf16 v[96:99], a[0:3], a[116:119], v[96:99]
ds_read_b64_tr_b16 a[24:25], v3 offset:192
v_mfma_f32_16x16x32_bf16 v[100:103], a[0:3], a[120:123], v[100:103]
ds_read_b64_tr_b16 a[26:27], v3 offset:2496
v_mfma_f32_16x16x32_bf16 v[104:107], a[4:7], a[116:119], v[104:107]
ds_read_b64_tr_b16 a[28:29], v3 offset:224
v_mfma_f32_16x16x32_bf16 v[108:111], a[4:7], a[120:123], v[108:111]
ds_read_b64_tr_b16 a[30:31], v3 offset:2528
v_mfma_f32_16x16x32_bf16 v[112:115], a[8:11], a[116:119], v[112:115]
ds_read_b64_tr_b16 a[32:33], v3 offset:256
v_mfma_f32_16x16x32_bf16 v[116:119], a[8:11], a[120:123], v[116:119]
ds_read_b64_tr_b16 a[34:35], v3 offset:2560
s_waitcnt lgkmcnt(6)
v_mfma_f32_16x16x32_bf16 v[120:123], a[12:15], a[116:119], v[120:123]
ds_read_b64_tr_b16 a[0:1], v3 offset:9216
v_mfma_f32_16x16x32_bf16 v[124:127], a[12:15], a[120:123], v[124:127]
ds_read_b64_tr_b16 a[2:3], v3 offset:11520
v_mfma_f32_16x16x32_bf16 v[128:131], a[16:19], a[116:119], v[128:131]
ds_read_b64_tr_b16 a[4:5], v3 offset:9248
v_mfma_f32_16x16x32_bf16 v[132:135], a[16:19], a[120:123], v[132:135]
ds_read_b64_tr_b16 a[6:7], v3 offset:11552
v_mfma_f32_16x16x32_bf16 v[136:139], a[20:23], a[116:119], v[136:139]
ds_read_b64_tr_b16 a[8:9], v3 offset:9280
v_mfma_f32_16x16x32_bf16 v[140:143], a[20:23], a[120:123], v[140:143]
ds_read_b64_tr_b16 a[10:11], v3 offset:11584
s_waitcnt lgkmcnt(6)
v_mfma_f32_16x16x32_bf16 v[144:147], a[24:27], a[116:119], v[144:147]
ds_read_b64_tr_b16 a[12:13], v3 offset:9312
v_mfma_f32_16x16x32_bf16 v[148:151], a[24:27], a[120:123], v[148:151]
ds_read_b64_tr_b16 a[14:15], v3 offset:11616
v_mfma_f32_16x16x32_bf16 v[152:155], a[28:31], a[116:119], v[152:155]
ds_read_b64_tr_b16 a[16:17], v3 offset:9344
v_mfma_f32_16x16x32_bf16 v[156:159], a[28:31], a[120:123], v[156:159]
ds_read_b64_tr_b16 a[18:19], v3 offset:11648
v_mfma_f32_16x16x32_bf16 v[160:163], a[32:35], a[116:119], v[160:163]
ds_read_b64_tr_b16 a[20:21], v3 offset:9376
v_mfma_f32_16x16x32_bf16 v[164:167], a[32:35], a[120:123], v[164:167]
ds_read_b64_tr_b16 a[22:23], v3 offset:11680
s_waitcnt lgkmcnt(6)
v_mfma_f32_16x16x32_bf16 v[96:99], a[0:3], a[124:127], v[96:99]
ds_read_b64_tr_b16 a[24:25], v3 offset:9408
v_mfma_f32_16x16x32_bf16 v[100:103], a[0:3], a[128:131], v[100:103]
ds_read_b64_tr_b16 a[26:27], v3 offset:11712
v_mfma_f32_16x16x32_bf16 v[104:107], a[4:7], a[124:127], v[104:107]
ds_read_b64_tr_b16 a[28:29], v3 offset:9440
v_mfma_f32_16x16x32_bf16 v[108:111], a[4:7], a[128:131], v[108:111]
ds_read_b64_tr_b16 a[30:31], v3 offset:11744
v_mfma_f32_16x16x32_bf16 v[112:115], a[8:11], a[124:127], v[112:115]
ds_read_b64_tr_b16 a[32:33], v3 offset:9472
v_mfma_f32_16x16x32_bf16 v[116:119], a[8:11], a[128:131], v[116:119]
ds_read_b64_tr_b16 a[34:35], v3 offset:11776
s_waitcnt lgkmcnt(6)
v_mfma_f32_16x16x32_bf16 v[120:123], a[12:15], a[124:127], v[120:123]
ds_read_b64_tr_b16 a[0:1], v3 offset:18432
v_mfma_f32_16x16x32_bf16 v[124:127], a[12:15], a[128:131], v[124:127]
ds_read_b64_tr_b16 a[2:3], v3 offset:20736
v_mfma_f32_16x16x32_bf16 v[128:131], a[16:19], a[124:127], v[128:131]
ds_read_b64_tr_b16 a[4:5], v3 offset:18464
v_mfma_f32_16x16x32_bf16 v[132:135], a[16:19], a[128:131], v[132:135]
ds_read_b64_tr_b16 a[6:7], v3 offset:20768
v_mfma_f32_16x16x32_bf16 v[136:139], a[20:23], a[124:127], v[136:139]
ds_read_b64_tr_b16 a[8:9], v3 offset:18496
v_mfma_f32_16x16x32_bf16 v[140:143], a[20:23], a[128:131], v[140:143]
ds_read_b64_tr_b16 a[10:11], v3 offset:20800
s_waitcnt lgkmcnt(6)
v_mfma_f32_16x16x32_bf16 v[144:147], a[24:27], a[124:127], v[144:147]
ds_read_b64_tr_b16 a[12:13], v3 offset:18528
v_mfma_f32_16x16x32_bf16 v[148:151], a[24:27], a[128:131], v[148:151]
ds_read_b64_tr_b16 a[14:15], v3 offset:20832
v_mfma_f32_16x16x32_bf16 v[152:155], a[28:31], a[124:127], v[152:155]
ds_read_b64_tr_b16 a[16:17], v3 offset:18560
v_mfma_f32_16x16x32_bf16 v[156:159], a[28:31], a[128:131], v[156:159]
ds_read_b64_tr_b16 a[18:19], v3 offset:20864
v_mfma_f32_16x16x32_bf16 v[160:163], a[32:35], a[124:127], v[160:163]
ds_read_b64_tr_b16 a[20:21], v3 offset:18592
v_mfma_f32_16x16x32_bf16 v[164:167], a[32:35], a[128:131], v[164:167]
ds_read_b64_tr_b16 a[22:23], v3 offset:20896
s_waitcnt lgkmcnt(6)
v_mfma_f32_16x16x32_bf16 v[96:99], a[0:3], a[132:135], v[96:99]
ds_read_b64_tr_b16 a[24:25], v3 offset:18624
v_mfma_f32_16x16x32_bf16 v[100:103], a[0:3], a[136:139], v[100:103]
ds_read_b64_tr_b16 a[26:27], v3 offset:20928
v_mfma_f32_16x16x32_bf16 v[104:107], a[4:7], a[132:135], v[104:107]
ds_read_b64_tr_b16 a[28:29], v3 offset:18656
v_mfma_f32_16x16x32_bf16 v[108:111], a[4:7], a[136:139], v[108:111]
ds_read_b64_tr_b16 a[30:31], v3 offset:20960
v_mfma_f32_16x16x32_bf16 v[112:115], a[8:11], a[132:135], v[112:115]
ds_read_b64_tr_b16 a[32:33], v3 offset:18688
v_mfma_f32_16x16x32_bf16 v[116:119], a[8:11], a[136:139], v[116:119]
ds_read_b64_tr_b16 a[34:35], v3 offset:20992
s_waitcnt lgkmcnt(6)
v_mfma_f32_16x16x32_bf16 v[120:123], a[12:15], a[132:135], v[120:123]
ds_read_b64_tr_b16 a[0:1], v3 offset:27648
v_mfma_f32_16x16x32_bf16 v[124:127], a[12:15], a[136:139], v[124:127]
ds_read_b64_tr_b16 a[2:3], v3 offset:29952
v_mfma_f32_16x16x32_bf16 v[128:131], a[16:19], a[132:135], v[128:131]
ds_read_b64_tr_b16 a[4:5], v3 offset:27680
v_mfma_f32_16x16x32_bf16 v[132:135], a[16:19], a[136:139], v[132:135]
ds_read_b64_tr_b16 a[6:7], v3 offset:29984
v_mfma_f32_16x16x32_bf16 v[136:139], a[20:23], a[132:135], v[136:139]
ds_read_b64_tr_b16 a[8:9], v3 offset:27712
v_mfma_f32_16x16x32_bf16 v[140:143], a[20:23], a[136:139], v[140:143]
ds_read_b64_tr_b16 a[10:11], v3 offset:30016
s_waitcnt lgkmcnt(6)
v_mfma_f32_16x16x32_bf16 v[144:147], a[24:27], a[132:135], v[144:147]
ds_read_b64_tr_b16 a[12:13], v3 offset:27744
v_mfma_f32_16x16x32_bf16 v[148:151], a[24:27], a[136:139], v[148:151]
ds_read_b64_tr_b16 a[14:15], v3 offset:30048
v_mfma_f32_16x16x32_bf16 v[152:155], a[28:31], a[132:135], v[152:155]
ds_read_b64_tr_b16 a[16:17], v3 offset:27776
v_mfma_f32_16x16x32_bf16 v[156:159], a[28:31], a[136:139], v[156:159]
ds_read_b64_tr_b16 a[18:19], v3 offset:30080
v_mfma_f32_16x16x32_bf16 v[160:163], a[32:35], a[132:135], v[160:163]
ds_read_b64_tr_b16 a[20:21], v3 offset:27808
v_mfma_f32_16x16x32_bf16 v[164:167], a[32:35], a[136:139], v[164:167]
ds_read_b64_tr_b16 a[22:23], v3 offset:30112
s_waitcnt lgkmcnt(6)
v_mfma_f32_16x16x32_bf16 v[96:99], a[0:3], a[140:143], v[96:99]
ds_read_b64_tr_b16 a[24:25], v3 offset:27840
v_mfma_f32_16x16x32_bf16 v[100:103], a[0:3], a[144:147], v[100:103]
ds_read_b64_tr_b16 a[26:27], v3 offset:30144
v_mfma_f32_16x16x32_bf16 v[104:107], a[4:7], a[140:143], v[104:107]
ds_read_b64_tr_b16 a[28:29], v3 offset:27872
v_mfma_f32_16x16x32_bf16 v[108:111], a[4:7], a[144:147], v[108:111]
ds_read_b64_tr_b16 a[30:31], v3 offset:30176
v_mfma_f32_16x16x32_bf16 v[112:115], a[8:11], a[140:143], v[112:115]
ds_read_b64_tr_b16 a[32:33], v3 offset:27904
v_mfma_f32_16x16x32_bf16 v[116:119], a[8:11], a[144:147], v[116:119]
ds_read_b64_tr_b16 a[34:35], v3 offset:30208
s_waitcnt vmcnt(9) lgkmcnt(6)
s_barrier
v_mfma_f32_16x16x32_bf16 v[120:123], a[12:15], a[140:143], v[120:123]
ds_read_b64_tr_b16 a[0:1], v4 offset:0
v_mfma_f32_16x16x32_bf16 v[124:127], a[12:15], a[144:147], v[124:127]
ds_read_b64_tr_b16 a[2:3], v4 offset:2304
v_mfma_f32_16x16x32_bf16 v[128:131], a[16:19], a[140:143], v[128:131]
ds_read_b64_tr_b16 a[4:5], v4 offset:32
v_mfma_f32_16x16x32_bf16 v[132:135], a[16:19], a[144:147], v[132:135]
ds_read_b64_tr_b16 a[6:7], v4 offset:2336
v_mfma_f32_16x16x32_bf16 v[136:139], a[20:23], a[140:143], v[136:139]
ds_read_b64_tr_b16 a[8:9], v4 offset:64
v_mfma_f32_16x16x32_bf16 v[140:143], a[20:23], a[144:147], v[140:143]
ds_read_b64_tr_b16 a[10:11], v4 offset:2368
s_waitcnt lgkmcnt(6)
v_mfma_f32_16x16x32_bf16 v[144:147], a[24:27], a[140:143], v[144:147]
ds_read_b64_tr_b16 a[12:13], v4 offset:96
v_mfma_f32_16x16x32_bf16 v[148:151], a[24:27], a[144:147], v[148:151]
ds_read_b64_tr_b16 a[14:15], v4 offset:2400
v_mfma_f32_16x16x32_bf16 v[152:155], a[28:31], a[140:143], v[152:155]
ds_read_b64_tr_b16 a[16:17], v4 offset:128
v_mfma_f32_16x16x32_bf16 v[156:159], a[28:31], a[144:147], v[156:159]
ds_read_b64_tr_b16 a[18:19], v4 offset:2432
v_mfma_f32_16x16x32_bf16 v[160:163], a[32:35], a[140:143], v[160:163]
ds_read_b64_tr_b16 a[20:21], v4 offset:160
v_mfma_f32_16x16x32_bf16 v[164:167], a[32:35], a[144:147], v[164:167]
ds_read_b64_tr_b16 a[22:23], v4 offset:2464
s_waitcnt lgkmcnt(6)
v_mfma_f32_16x16x32_bf16 v[96:99], a[0:3], a[148:151], v[96:99]
ds_read_b64_tr_b16 a[24:25], v4 offset:192
v_mfma_f32_16x16x32_bf16 v[100:103], a[0:3], a[152:155], v[100:103]
ds_read_b64_tr_b16 a[26:27], v4 offset:2496
v_mfma_f32_16x16x32_bf16 v[104:107], a[4:7], a[148:151], v[104:107]
ds_read_b64_tr_b16 a[28:29], v4 offset:224
v_mfma_f32_16x16x32_bf16 v[108:111], a[4:7], a[152:155], v[108:111]
ds_read_b64_tr_b16 a[30:31], v4 offset:2528
v_mfma_f32_16x16x32_bf16 v[112:115], a[8:11], a[148:151], v[112:115]
ds_read_b64_tr_b16 a[32:33], v4 offset:256
v_mfma_f32_16x16x32_bf16 v[116:119], a[8:11], a[152:155], v[116:119]
ds_read_b64_tr_b16 a[34:35], v4 offset:2560
s_waitcnt lgkmcnt(6)
v_mfma_f32_16x16x32_bf16 v[120:123], a[12:15], a[148:151], v[120:123]
ds_read_b64_tr_b16 a[0:1], v4 offset:9216
v_mfma_f32_16x16x32_bf16 v[124:127], a[12:15], a[152:155], v[124:127]
ds_read_b64_tr_b16 a[2:3], v4 offset:11520
v_mfma_f32_16x16x32_bf16 v[128:131], a[16:19], a[148:151], v[128:131]
ds_read_b64_tr_b16 a[4:5], v4 offset:9248
v_mfma_f32_16x16x32_bf16 v[132:135], a[16:19], a[152:155], v[132:135]
ds_read_b64_tr_b16 a[6:7], v4 offset:11552
v_mfma_f32_16x16x32_bf16 v[136:139], a[20:23], a[148:151], v[136:139]
ds_read_b64_tr_b16 a[8:9], v4 offset:9280
v_mfma_f32_16x16x32_bf16 v[140:143], a[20:23], a[152:155], v[140:143]
ds_read_b64_tr_b16 a[10:11], v4 offset:11584
s_waitcnt lgkmcnt(6)
v_mfma_f32_16x16x32_bf16 v[144:147], a[24:27], a[148:151], v[144:147]
ds_read_b64_tr_b16 a[12:13], v4 offset:9312
v_mfma_f32_16x16x32_bf16 v[148:151], a[24:27], a[152:155], v[148:151]
ds_read_b64_tr_b16 a[14:15], v4 offset:11616
v_mfma_f32_16x16x32_bf16 v[152:155], a[28:31], a[148:151], v[152:155]
ds_read_b64_tr_b16 a[16:17], v4 offset:9344
v_mfma_f32_16x16x32_bf16 v[156:159], a[28:31], a[152:155], v[156:159]
ds_read_b64_tr_b16 a[18:19], v4 offset:11648
v_mfma_f32_16x16x32_bf16 v[160:163], a[32:35], a[148:151], v[160:163]
ds_read_b64_tr_b16 a[20:21], v4 offset:9376
v_mfma_f32_16x16x32_bf16 v[164:167], a[32:35], a[152:155], v[164:167]
ds_read_b64_tr_b16 a[22:23], v4 offset:11680
s_waitcnt lgkmcnt(6)
v_mfma_f32_16x16x32_bf16 v[96:99], a[0:3], a[156:159], v[96:99]
ds_read_b64_tr_b16 a[24:25], v4 offset:9408
v_mfma_f32_16x16x32_bf16 v[100:103], a[0:3], a[160:163], v[100:103]
ds_read_b64_tr_b16 a[26:27], v4 offset:11712
v_mfma_f32_16x16x32_bf16 v[104:107], a[4:7], a[156:159], v[104:107]
ds_read_b64_tr_b16 a[28:29], v4 offset:9440
v_mfma_f32_16x16x32_bf16 v[108:111], a[4:7], a[160:163], v[108:111]
ds_read_b64_tr_b16 a[30:31], v4 offset:11744
v_mfma_f32_16x16x32_bf16 v[112:115], a[8:11], a[156:159], v[112:115]
ds_read_b64_tr_b16 a[32:33], v4 offset:9472
v_mfma_f32_16x16x32_bf16 v[116:119], a[8:11], a[160:163], v[116:119]
ds_read_b64_tr_b16 a[34:35], v4 offset:11776
s_waitcnt lgkmcnt(6)
v_mfma_f32_16x16x32_bf16 v[120:123], a[12:15], a[156:159], v[120:123]
ds_read_b64_tr_b16 a[0:1], v4 offset:18432
v_mfma_f32_16x16x32_bf16 v[124:127], a[12:15], a[160:163], v[124:127]
ds_read_b64_tr_b16 a[2:3], v4 offset:20736
v_mfma_f32_16x16x32_bf16 v[128:131], a[16:19], a[156:159], v[128:131]
ds_read_b64_tr_b16 a[4:5], v4 offset:18464
v_mfma_f32_16x16x32_bf16 v[132:135], a[16:19], a[160:163], v[132:135]
ds_read_b64_tr_b16 a[6:7], v4 offset:20768
v_mfma_f32_16x16x32_bf16 v[136:139], a[20:23], a[156:159], v[136:139]
ds_read_b64_tr_b16 a[8:9], v4 offset:18496
v_mfma_f32_16x16x32_bf16 v[140:143], a[20:23], a[160:163], v[140:143]
ds_read_b64_tr_b16 a[10:11], v4 offset:20800
s_waitcnt lgkmcnt(6)
v_mfma_f32_16x16x32_bf16 v[144:147], a[24:27], a[156:159], v[144:147]
ds_read_b64_tr_b16 a[12:13], v4 offset:18528
v_mfma_f32_16x16x32_bf16 v[148:151], a[24:27], a[160:163], v[148:151]
ds_read_b64_tr_b16 a[14:15], v4 offset:20832
v_mfma_f32_16x16x32_bf16 v[152:155], a[28:31], a[156:159], v[152:155]
ds_read_b64_tr_b16 a[16:17], v4 offset:18560
v_mfma_f32_16x16x32_bf16 v[156:159], a[28:31], a[160:163], v[156:159]
ds_read_b64_tr_b16 a[18:19], v4 offset:20864
v_mfma_f32_16x16x32_bf16 v[160:163], a[32:35], a[156:159], v[160:163]
ds_read_b64_tr_b16 a[20:21], v4 offset:18592
v_mfma_f32_16x16x32_bf16 v[164:167], a[32:35], a[160:163], v[164:167]
ds_read_b64_tr_b16 a[22:23], v4 offset:20896
s_waitcnt lgkmcnt(6)
v_mfma_f32_16x16x32_bf16 v[96:99], a[0:3], a[164:167], v[96:99]
ds_read_b64_tr_b16 a[24:25], v4 offset:18624
v_mfma_f32_16x16x32_bf16 v[100:103], a[0:3], a[168:171], v[100:103]
ds_read_b64_tr_b16 a[26:27], v4 offset:20928
v_mfma_f32_16x16x32_bf16 v[104:107], a[4:7], a[164:167], v[104:107]
ds_read_b64_tr_b16 a[28:29], v4 offset:18656
v_mfma_f32_16x16x32_bf16 v[108:111], a[4:7], a[168:171], v[108:111]
ds_read_b64_tr_b16 a[30:31], v4 offset:20960
v_mfma_f32_16x16x32_bf16 v[112:115], a[8:11], a[164:167], v[112:115]
ds_read_b64_tr_b16 a[32:33], v4 offset:18688
v_mfma_f32_16x16x32_bf16 v[116:119], a[8:11], a[168:171], v[116:119]
ds_read_b64_tr_b16 a[34:35], v4 offset:20992
s_waitcnt lgkmcnt(6)
v_mfma_f32_16x16x32_bf16 v[120:123], a[12:15], a[164:167], v[120:123]
ds_read_b64_tr_b16 a[0:1], v4 offset:27648
v_mfma_f32_16x16x32_bf16 v[124:127], a[12:15], a[168:171], v[124:127]
ds_read_b64_tr_b16 a[2:3], v4 offset:29952
v_mfma_f32_16x16x32_bf16 v[128:131], a[16:19], a[164:167], v[128:131]
ds_read_b64_tr_b16 a[4:5], v4 offset:27680
v_mfma_f32_16x16x32_bf16 v[132:135], a[16:19], a[168:171], v[132:135]
ds_read_b64_tr_b16 a[6:7], v4 offset:29984
v_mfma_f32_16x16x32_bf16 v[136:139], a[20:23], a[164:167], v[136:139]
ds_read_b64_tr_b16 a[8:9], v4 offset:27712
v_mfma_f32_16x16x32_bf16 v[140:143], a[20:23], a[168:171], v[140:143]
ds_read_b64_tr_b16 a[10:11], v4 offset:30016
s_waitcnt lgkmcnt(6)
v_mfma_f32_16x16x32_bf16 v[144:147], a[24:27], a[164:167], v[144:147]
ds_read_b64_tr_b16 a[12:13], v4 offset:27744
v_mfma_f32_16x16x32_bf16 v[148:151], a[24:27], a[168:171], v[148:151]
ds_read_b64_tr_b16 a[14:15], v4 offset:30048
v_mfma_f32_16x16x32_bf16 v[152:155], a[28:31], a[164:167], v[152:155]
ds_read_b64_tr_b16 a[16:17], v4 offset:27776
v_mfma_f32_16x16x32_bf16 v[156:159], a[28:31], a[168:171], v[156:159]
ds_read_b64_tr_b16 a[18:19], v4 offset:30080
v_mfma_f32_16x16x32_bf16 v[160:163], a[32:35], a[164:167], v[160:163]
ds_read_b64_tr_b16 a[20:21], v4 offset:27808
v_mfma_f32_16x16x32_bf16 v[164:167], a[32:35], a[168:171], v[164:167]
ds_read_b64_tr_b16 a[22:23], v4 offset:30112
s_waitcnt lgkmcnt(6)
v_mfma_f32_16x16x32_bf16 v[96:99], a[0:3], a[172:175], v[96:99]
ds_read_b64_tr_b16 a[24:25], v4 offset:27840
v_mfma_f32_16x16x32_bf16 v[100:103], a[0:3], a[176:179], v[100:103]
ds_read_b64_tr_b16 a[26:27], v4 offset:30144
v_mfma_f32_16x16x32_bf16 v[104:107], a[4:7], a[172:175], v[104:107]
ds_read_b64_tr_b16 a[28:29], v4 offset:27872
v_mfma_f32_16x16x32_bf16 v[108:111], a[4:7], a[176:179], v[108:111]
ds_read_b64_tr_b16 a[30:31], v4 offset:30176
v_mfma_f32_16x16x32_bf16 v[112:115], a[8:11], a[172:175], v[112:115]
ds_read_b64_tr_b16 a[32:33], v4 offset:27904
v_mfma_f32_16x16x32_bf16 v[116:119], a[8:11], a[176:179], v[116:119]
ds_read_b64_tr_b16 a[34:35], v4 offset:30208
s_waitcnt lgkmcnt(6)
v_mfma_f32_16x16x32_bf16 v[120:123], a[12:15], a[172:175], v[120:123]
v_mfma_f32_16x16x32_bf16 v[124:127], a[12:15], a[176:179], v[124:127]
v_mfma_f32_16x16x32_bf16 v[128:131], a[16:19], a[172:175], v[128:131]
v_mfma_f32_16x16x32_bf16 v[132:135], a[16:19], a[176:179], v[132:135]
v_mfma_f32_16x16x32_bf16 v[136:139], a[20:23], a[172:175], v[136:139]
v_mfma_f32_16x16x32_bf16 v[140:143], a[20:23], a[176:179], v[140:143]
s_waitcnt lgkmcnt(0)
v_mfma_f32_16x16x32_bf16 v[144:147], a[24:27], a[172:175], v[144:147]
v_mfma_f32_16x16x32_bf16 v[148:151], a[24:27], a[176:179], v[148:151]
v_mfma_f32_16x16x32_bf16 v[152:155], a[28:31], a[172:175], v[152:155]
v_mfma_f32_16x16x32_bf16 v[156:159], a[28:31], a[176:179], v[156:159]
v_mfma_f32_16x16x32_bf16 v[160:163], a[32:35], a[172:175], v[160:163]
v_mfma_f32_16x16x32_bf16 v[164:167], a[32:35], a[176:179], v[164:167]
s_add_u32 s8, s8, 94371840
s_addc_u32 s9, s9, 0
s_mov_b32 s10, 8388608
s_lshl_b32 s29, s34, 17
v_add_u32 v8, 65536, v7
s_lshl_b32 s27, s34, 6
v_lshlrev_b32 v10, 1, v13
s_lshl_b32 s38, s24, 4
s_add_u32 s38, s38, s26
s_lshl_b32 s38, s38, 11
s_add_u32 s38, s38, 262144
s_lshl_b32 s3, s25, 7
s_add_u32 s3, s3, s38
v_mov_b32 v9, 0
v_lshlrev_b32 v21, 7, v13
v_pk_mul_f32 v[168:169], v[96:97], v[96:97]
v_pk_mul_f32 v[170:171], v[98:99], v[98:99]
v_pk_mul_f32 v[172:173], v[100:101], v[100:101]
v_pk_mul_f32 v[174:175], v[102:103], v[102:103]
v_pk_fma_f32 v[168:169], v[168:169], v[180:181], v[182:183]
v_pk_fma_f32 v[170:171], v[170:171], v[180:181], v[182:183]
v_pk_fma_f32 v[172:173], v[172:173], v[180:181], v[182:183]
v_pk_fma_f32 v[174:175], v[174:175], v[180:181], v[182:183]
v_pk_mul_f32 v[168:169], v[168:169], v[96:97]
v_pk_mul_f32 v[170:171], v[170:171], v[98:99]
v_pk_mul_f32 v[172:173], v[172:173], v[100:101]
v_pk_mul_f32 v[174:175], v[174:175], v[102:103]
v_exp_f32 v168, v168
v_exp_f32 v170, v170
v_exp_f32 v172, v172
v_exp_f32 v174, v174
v_exp_f32 v169, v169
v_exp_f32 v171, v171
v_exp_f32 v173, v173
v_exp_f32 v175, v175
v_pk_add_f32 v[168:169], v[168:169], v[184:185]
v_pk_add_f32 v[170:171], v[170:171], v[184:185]
v_pk_add_f32 v[172:173], v[172:173], v[184:185]
v_pk_add_f32 v[174:175], v[174:175], v[184:185]
v_rcp_f32 v168, v168
v_rcp_f32 v170, v170
v_rcp_f32 v172, v172
v_rcp_f32 v174, v174
v_rcp_f32 v169, v169
v_rcp_f32 v171, v171
v_rcp_f32 v173, v173
v_rcp_f32 v175, v175
v_pk_mul_f32 v[96:97], v[96:97], v[168:169]
v_pk_mul_f32 v[98:99], v[98:99], v[170:171]
v_pk_mul_f32 v[100:101], v[100:101], v[172:173]
v_pk_mul_f32 v[102:103], v[102:103], v[174:175]
v_pk_mul_f32 v[168:169], v[104:105], v[104:105]
v_pk_mul_f32 v[170:171], v[106:107], v[106:107]
v_pk_mul_f32 v[172:173], v[108:109], v[108:109]
v_pk_mul_f32 v[174:175], v[110:111], v[110:111]
v_pk_fma_f32 v[168:169], v[168:169], v[180:181], v[182:183]
v_pk_fma_f32 v[170:171], v[170:171], v[180:181], v[182:183]
v_pk_fma_f32 v[172:173], v[172:173], v[180:181], v[182:183]
v_pk_fma_f32 v[174:175], v[174:175], v[180:181], v[182:183]
v_pk_mul_f32 v[168:169], v[168:169], v[104:105]
v_pk_mul_f32 v[170:171], v[170:171], v[106:107]
v_pk_mul_f32 v[172:173], v[172:173], v[108:109]
v_pk_mul_f32 v[174:175], v[174:175], v[110:111]
v_exp_f32 v168, v168
v_exp_f32 v170, v170
v_exp_f32 v172, v172
v_exp_f32 v174, v174
v_exp_f32 v169, v169
v_exp_f32 v171, v171
v_exp_f32 v173, v173
v_exp_f32 v175, v175
v_pk_add_f32 v[168:169], v[168:169], v[184:185]
v_pk_add_f32 v[170:171], v[170:171], v[184:185]
v_pk_add_f32 v[172:173], v[172:173], v[184:185]
v_pk_add_f32 v[174:175], v[174:175], v[184:185]
v_rcp_f32 v168, v168
v_rcp_f32 v170, v170
v_rcp_f32 v172, v172
v_rcp_f32 v174, v174
v_rcp_f32 v169, v169
v_rcp_f32 v171, v171
v_rcp_f32 v173, v173
v_rcp_f32 v175, v175
v_pk_mul_f32 v[104:105], v[104:105], v[168:169]
v_pk_mul_f32 v[106:107], v[106:107], v[170:171]
v_pk_mul_f32 v[108:109], v[108:109], v[172:173]
v_pk_mul_f32 v[110:111], v[110:111], v[174:175]
v_pk_mul_f32 v[168:169], v[112:113], v[112:113]
v_pk_mul_f32 v[170:171], v[114:115], v[114:115]
v_pk_mul_f32 v[172:173], v[116:117], v[116:117]
v_pk_mul_f32 v[174:175], v[118:119], v[118:119]
v_pk_fma_f32 v[168:169], v[168:169], v[180:181], v[182:183]
v_pk_fma_f32 v[170:171], v[170:171], v[180:181], v[182:183]
v_pk_fma_f32 v[172:173], v[172:173], v[180:181], v[182:183]
v_pk_fma_f32 v[174:175], v[174:175], v[180:181], v[182:183]
v_pk_mul_f32 v[168:169], v[168:169], v[112:113]
v_pk_mul_f32 v[170:171], v[170:171], v[114:115]
v_pk_mul_f32 v[172:173], v[172:173], v[116:117]
v_pk_mul_f32 v[174:175], v[174:175], v[118:119]
v_exp_f32 v168, v168
v_exp_f32 v170, v170
v_exp_f32 v172, v172
v_exp_f32 v174, v174
v_exp_f32 v169, v169
v_exp_f32 v171, v171
v_exp_f32 v173, v173
v_exp_f32 v175, v175
v_pk_add_f32 v[168:169], v[168:169], v[184:185]
v_pk_add_f32 v[170:171], v[170:171], v[184:185]
v_pk_add_f32 v[172:173], v[172:173], v[184:185]
v_pk_add_f32 v[174:175], v[174:175], v[184:185]
v_rcp_f32 v168, v168
v_rcp_f32 v170, v170
v_rcp_f32 v172, v172
v_rcp_f32 v174, v174
v_rcp_f32 v169, v169
v_rcp_f32 v171, v171
v_rcp_f32 v173, v173
v_rcp_f32 v175, v175
v_pk_mul_f32 v[112:113], v[112:113], v[168:169]
v_pk_mul_f32 v[114:115], v[114:115], v[170:171]
v_pk_mul_f32 v[116:117], v[116:117], v[172:173]
v_pk_mul_f32 v[118:119], v[118:119], v[174:175]
s_waitcnt vmcnt(0)
buffer_store_dword v9, v9, s[20:23], s3 offen sc0 sc1
buffer_load_dwordx4 a[36:39], v7, s[8:11], s29 offen offset:0
buffer_load_dwordx4 a[40:43], v8, s[8:11], s29 offen offset:0
buffer_load_dwordx4 a[44:47], v7, s[8:11], s29 offen offset:1024
buffer_load_dwordx4 a[48:51], v8, s[8:11], s29 offen offset:1024
v_pk_mul_f32 v[168:169], v[120:121], v[120:121]
v_pk_mul_f32 v[170:171], v[122:123], v[122:123]
v_pk_mul_f32 v[172:173], v[124:125], v[124:125]
v_pk_mul_f32 v[174:175], v[126:127], v[126:127]
v_pk_fma_f32 v[168:169], v[168:169], v[180:181], v[182:183]
v_pk_fma_f32 v[170:171], v[170:171], v[180:181], v[182:183]
v_pk_fma_f32 v[172:173], v[172:173], v[180:181], v[182:183]
v_pk_fma_f32 v[174:175], v[174:175], v[180:181], v[182:183]
v_pk_mul_f32 v[168:169], v[168:169], v[120:121]
v_pk_mul_f32 v[170:171], v[170:171], v[122:123]
v_pk_mul_f32 v[172:173], v[172:173], v[124:125]
v_pk_mul_f32 v[174:175], v[174:175], v[126:127]
v_exp_f32 v168, v168
v_exp_f32 v170, v170
v_exp_f32 v172, v172
v_exp_f32 v174, v174
v_exp_f32 v169, v169
v_exp_f32 v171, v171
v_exp_f32 v173, v173
v_exp_f32 v175, v175
v_pk_add_f32 v[168:169], v[168:169], v[184:185]
v_pk_add_f32 v[170:171], v[170:171], v[184:185]
v_pk_add_f32 v[172:173], v[172:173], v[184:185]
v_pk_add_f32 v[174:175], v[174:175], v[184:185]
v_rcp_f32 v168, v168
v_rcp_f32 v170, v170
v_rcp_f32 v172, v172
v_rcp_f32 v174, v174
v_rcp_f32 v169, v169
v_rcp_f32 v171, v171
v_rcp_f32 v173, v173
v_rcp_f32 v175, v175
v_pk_mul_f32 v[120:121], v[120:121], v[168:169]
v_pk_mul_f32 v[122:123], v[122:123], v[170:171]
v_pk_mul_f32 v[124:125], v[124:125], v[172:173]
v_pk_mul_f32 v[126:127], v[126:127], v[174:175]
buffer_load_dwordx4 a[52:55], v7, s[8:11], s29 offen offset:2048
buffer_load_dwordx4 a[56:59], v8, s[8:11], s29 offen offset:2048
buffer_load_dwordx4 a[60:63], v7, s[8:11], s29 offen offset:3072
buffer_load_dwordx4 a[64:67], v8, s[8:11], s29 offen offset:3072
s_add_u32 s29, s29, 4096
v_pk_mul_f32 v[168:169], v[128:129], v[128:129]
v_pk_mul_f32 v[170:171], v[130:131], v[130:131]
v_pk_mul_f32 v[172:173], v[132:133], v[132:133]
v_pk_mul_f32 v[174:175], v[134:135], v[134:135]
v_pk_fma_f32 v[168:169], v[168:169], v[180:181], v[182:183]
v_pk_fma_f32 v[170:171], v[170:171], v[180:181], v[182:183]
v_pk_fma_f32 v[172:173], v[172:173], v[180:181], v[182:183]
v_pk_fma_f32 v[174:175], v[174:175], v[180:181], v[182:183]
v_pk_mul_f32 v[168:169], v[168:169], v[128:129]
v_pk_mul_f32 v[170:171], v[170:171], v[130:131]
v_pk_mul_f32 v[172:173], v[172:173], v[132:133]
v_pk_mul_f32 v[174:175], v[174:175], v[134:135]
v_exp_f32 v168, v168
v_exp_f32 v170, v170
v_exp_f32 v172, v172
v_exp_f32 v174, v174
v_exp_f32 v169, v169
v_exp_f32 v171, v171
v_exp_f32 v173, v173
v_exp_f32 v175, v175
v_pk_add_f32 v[168:169], v[168:169], v[184:185]
v_pk_add_f32 v[170:171], v[170:171], v[184:185]
v_pk_add_f32 v[172:173], v[172:173], v[184:185]
v_pk_add_f32 v[174:175], v[174:175], v[184:185]
v_rcp_f32 v168, v168
v_rcp_f32 v170, v170
v_rcp_f32 v172, v172
v_rcp_f32 v174, v174
v_rcp_f32 v169, v169
v_rcp_f32 v171, v171
v_rcp_f32 v173, v173
v_rcp_f32 v175, v175
v_pk_mul_f32 v[128:129], v[128:129], v[168:169]
v_pk_mul_f32 v[130:131], v[130:131], v[170:171]
v_pk_mul_f32 v[132:133], v[132:133], v[172:173]
v_pk_mul_f32 v[134:135], v[134:135], v[174:175]
buffer_load_dwordx4 a[68:71], v7, s[8:11], s29 offen offset:0
buffer_load_dwordx4 a[72:75], v8, s[8:11], s29 offen offset:0
buffer_load_dwordx4 a[76:79], v7, s[8:11], s29 offen offset:1024
buffer_load_dwordx4 a[80:83], v8, s[8:11], s29 offen offset:1024
buffer_load_dwordx4 a[84:87], v7, s[8:11], s29 offen offset:2048
v_pk_mul_f32 v[168:169], v[136:137], v[136:137]
v_pk_mul_f32 v[170:171], v[138:139], v[138:139]
v_pk_mul_f32 v[172:173], v[140:141], v[140:141]
v_pk_mul_f32 v[174:175], v[142:143], v[142:143]
v_pk_fma_f32 v[168:169], v[168:169], v[180:181], v[182:183]
v_pk_fma_f32 v[170:171], v[170:171], v[180:181], v[182:183]
v_pk_fma_f32 v[172:173], v[172:173], v[180:181], v[182:183]
v_pk_fma_f32 v[174:175], v[174:175], v[180:181], v[182:183]
v_pk_mul_f32 v[168:169], v[168:169], v[136:137]
v_pk_mul_f32 v[170:171], v[170:171], v[138:139]
v_pk_mul_f32 v[172:173], v[172:173], v[140:141]
v_pk_mul_f32 v[174:175], v[174:175], v[142:143]
v_exp_f32 v168, v168
v_exp_f32 v170, v170
v_exp_f32 v172, v172
v_exp_f32 v174, v174
v_exp_f32 v169, v169
v_exp_f32 v171, v171
v_exp_f32 v173, v173
v_exp_f32 v175, v175
v_pk_add_f32 v[168:169], v[168:169], v[184:185]
v_pk_add_f32 v[170:171], v[170:171], v[184:185]
v_pk_add_f32 v[172:173], v[172:173], v[184:185]
v_pk_add_f32 v[174:175], v[174:175], v[184:185]
v_rcp_f32 v168, v168
v_rcp_f32 v170, v170
v_rcp_f32 v172, v172
v_rcp_f32 v174, v174
v_rcp_f32 v169, v169
v_rcp_f32 v171, v171
v_rcp_f32 v173, v173
v_rcp_f32 v175, v175
v_pk_mul_f32 v[136:137], v[136:137], v[168:169]
v_pk_mul_f32 v[138:139], v[138:139], v[170:171]
v_pk_mul_f32 v[140:141], v[140:141], v[172:173]
v_pk_mul_f32 v[142:143], v[142:143], v[174:175]
buffer_load_dwordx4 a[88:91], v8, s[8:11], s29 offen offset:2048
buffer_load_dwordx4 a[92:95], v7, s[8:11], s29 offen offset:3072
buffer_load_dwordx4 a[96:99], v8, s[8:11], s29 offen offset:3072
s_add_u32 s29, s29, 4096
buffer_load_dwordx4 a[100:103], v7, s[8:11], s29 offen offset:0
v_pk_mul_f32 v[168:169], v[144:145], v[144:145]
v_pk_mul_f32 v[170:171], v[146:147], v[146:147]
v_pk_mul_f32 v[172:173], v[148:149], v[148:149]
v_pk_mul_f32 v[174:175], v[150:151], v[150:151]
v_pk_fma_f32 v[168:169], v[168:169], v[180:181], v[182:183]
v_pk_fma_f32 v[170:171], v[170:171], v[180:181], v[182:183]
v_pk_fma_f32 v[172:173], v[172:173], v[180:181], v[182:183]
v_pk_fma_f32 v[174:175], v[174:175], v[180:181], v[182:183]
v_pk_mul_f32 v[168:169], v[168:169], v[144:145]
v_pk_mul_f32 v[170:171], v[170:171], v[146:147]
v_pk_mul_f32 v[172:173], v[172:173], v[148:149]
v_pk_mul_f32 v[174:175], v[174:175], v[150:151]
v_exp_f32 v168, v168
v_exp_f32 v170, v170
v_exp_f32 v172, v172
v_exp_f32 v174, v174
v_exp_f32 v169, v169
v_exp_f32 v171, v171
v_exp_f32 v173, v173
v_exp_f32 v175, v175
v_pk_add_f32 v[168:169], v[168:169], v[184:185]
v_pk_add_f32 v[170:171], v[170:171], v[184:185]
v_pk_add_f32 v[172:173], v[172:173], v[184:185]
v_pk_add_f32 v[174:175], v[174:175], v[184:185]
v_rcp_f32 v168, v168
v_rcp_f32 v170, v170
v_rcp_f32 v172, v172
v_rcp_f32 v174, v174
v_rcp_f32 v169, v169
v_rcp_f32 v171, v171
v_rcp_f32 v173, v173
v_rcp_f32 v175, v175
v_pk_mul_f32 v[144:145], v[144:145], v[168:169]
v_pk_mul_f32 v[146:147], v[146:147], v[170:171]
v_pk_mul_f32 v[148:149], v[148:149], v[172:173]
v_pk_mul_f32 v[150:151], v[150:151], v[174:175]
buffer_load_dwordx4 a[104:107], v8, s[8:11], s29 offen offset:0
buffer_load_dwordx4 a[108:111], v7, s[8:11], s29 offen offset:1024
buffer_load_dwordx4 a[112:115], v8, s[8:11], s29 offen offset:1024
buffer_load_dwordx4 a[116:119], v7, s[8:11], s29 offen offset:2048
buffer_load_dwordx4 a[120:123], v8, s[8:11], s29 offen offset:2048
v_pk_mul_f32 v[168:169], v[152:153], v[152:153]
v_pk_mul_f32 v[170:171], v[154:155], v[154:155]
v_pk_mul_f32 v[172:173], v[156:157], v[156:157]
v_pk_mul_f32 v[174:175], v[158:159], v[158:159]
v_pk_fma_f32 v[168:169], v[168:169], v[180:181], v[182:183]
v_pk_fma_f32 v[170:171], v[170:171], v[180:181], v[182:183]
v_pk_fma_f32 v[172:173], v[172:173], v[180:181], v[182:183]
v_pk_fma_f32 v[174:175], v[174:175], v[180:181], v[182:183]
v_pk_mul_f32 v[168:169], v[168:169], v[152:153]
v_pk_mul_f32 v[170:171], v[170:171], v[154:155]
v_pk_mul_f32 v[172:173], v[172:173], v[156:157]
v_pk_mul_f32 v[174:175], v[174:175], v[158:159]
v_exp_f32 v168, v168
v_exp_f32 v170, v170
v_exp_f32 v172, v172
v_exp_f32 v174, v174
v_exp_f32 v169, v169
v_exp_f32 v171, v171
v_exp_f32 v173, v173
v_exp_f32 v175, v175
v_pk_add_f32 v[168:169], v[168:169], v[184:185]
v_pk_add_f32 v[170:171], v[170:171], v[184:185]
v_pk_add_f32 v[172:173], v[172:173], v[184:185]
v_pk_add_f32 v[174:175], v[174:175], v[184:185]
v_rcp_f32 v168, v168
v_rcp_f32 v170, v170
v_rcp_f32 v172, v172
v_rcp_f32 v174, v174
v_rcp_f32 v169, v169
v_rcp_f32 v171, v171
v_rcp_f32 v173, v173
v_rcp_f32 v175, v175
v_pk_mul_f32 v[152:153], v[152:153], v[168:169]
v_pk_mul_f32 v[154:155], v[154:155], v[170:171]
v_pk_mul_f32 v[156:157], v[156:157], v[172:173]
v_pk_mul_f32 v[158:159], v[158:159], v[174:175]
buffer_load_dwordx4 a[124:127], v7, s[8:11], s29 offen offset:3072
buffer_load_dwordx4 a[128:131], v8, s[8:11], s29 offen offset:3072
s_add_u32 s29, s29, 4096
buffer_load_ushort v252, v10, s[44:47], s27 offen offset:0
buffer_load_ushort v253, v10, s[44:47], s27 offen offset:32
v_pk_mul_f32 v[168:169], v[160:161], v[160:161]
v_pk_mul_f32 v[170:171], v[162:163], v[162:163]
v_pk_mul_f32 v[172:173], v[164:165], v[164:165]
v_pk_mul_f32 v[174:175], v[166:167], v[166:167]
v_pk_fma_f32 v[168:169], v[168:169], v[180:181], v[182:183]
v_pk_fma_f32 v[170:171], v[170:171], v[180:181], v[182:183]
v_pk_fma_f32 v[172:173], v[172:173], v[180:181], v[182:183]
v_pk_fma_f32 v[174:175], v[174:175], v[180:181], v[182:183]
v_pk_mul_f32 v[168:169], v[168:169], v[160:161]
v_pk_mul_f32 v[170:171], v[170:171], v[162:163]
v_pk_mul_f32 v[172:173], v[172:173], v[164:165]
v_pk_mul_f32 v[174:175], v[174:175], v[166:167]
v_exp_f32 v168, v168
v_exp_f32 v170, v170
v_exp_f32 v172, v172
v_exp_f32 v174, v174
v_exp_f32 v169, v169
v_exp_f32 v171, v171
v_exp_f32 v173, v173
v_exp_f32 v175, v175
v_pk_add_f32 v[168:169], v[168:169], v[184:185]
v_pk_add_f32 v[170:171], v[170:171], v[184:185]
v_pk_add_f32 v[172:173], v[172:173], v[184:185]
v_pk_add_f32 v[174:175], v[174:175], v[184:185]
v_rcp_f32 v168, v168
v_rcp_f32 v170, v170
v_rcp_f32 v172, v172
v_rcp_f32 v174, v174
v_rcp_f32 v169, v169
v_rcp_f32 v171, v171
v_rcp_f32 v173, v173
v_rcp_f32 v175, v175
v_pk_mul_f32 v[160:161], v[160:161], v[168:169]
v_pk_mul_f32 v[162:163], v[162:163], v[170:171]
v_pk_mul_f32 v[164:165], v[164:165], v[172:173]
v_pk_mul_f32 v[166:167], v[166:167], v[174:175]
buffer_load_dword v6, v21, s[20:23], s38 offen sc0 sc1
v_cvt_pk_bf16_f32 v216, v96, v97
v_cvt_pk_bf16_f32 v217, v98, v99
v_cvt_pk_bf16_f32 v218, v100, v101
v_cvt_pk_bf16_f32 v219, v102, v103
v_cvt_pk_bf16_f32 v220, v104, v105
v_cvt_pk_bf16_f32 v221, v106, v107
v_cvt_pk_bf16_f32 v222, v108, v109
v_cvt_pk_bf16_f32 v223, v110, v111
v_cvt_pk_bf16_f32 v224, v112, v113
v_cvt_pk_bf16_f32 v225, v114, v115
v_cvt_pk_bf16_f32 v226, v116, v117
v_cvt_pk_bf16_f32 v227, v118, v119
v_cvt_pk_bf16_f32 v228, v120, v121
v_cvt_pk_bf16_f32 v229, v122, v123
v_cvt_pk_bf16_f32 v230, v124, v125
v_cvt_pk_bf16_f32 v231, v126, v127
v_cvt_pk_bf16_f32 v232, v128, v129
v_cvt_pk_bf16_f32 v233, v130, v131
v_cvt_pk_bf16_f32 v234, v132, v133
v_cvt_pk_bf16_f32 v235, v134, v135
v_cvt_pk_bf16_f32 v236, v136, v137
v_cvt_pk_bf16_f32 v237, v138, v139
v_cvt_pk_bf16_f32 v238, v140, v141
v_cvt_pk_bf16_f32 v239, v142, v143
v_cvt_pk_bf16_f32 v240, v144, v145
v_cvt_pk_bf16_f32 v241, v146, v147
v_cvt_pk_bf16_f32 v242, v148, v149
v_cvt_pk_bf16_f32 v243, v150, v151
v_cvt_pk_bf16_f32 v244, v152, v153
v_cvt_pk_bf16_f32 v245, v154, v155
v_cvt_pk_bf16_f32 v246, v156, v157
v_cvt_pk_bf16_f32 v247, v158, v159
v_cvt_pk_bf16_f32 v248, v160, v161
v_cvt_pk_bf16_f32 v249, v162, v163
v_cvt_pk_bf16_f32 v250, v164, v165
v_cvt_pk_bf16_f32 v251, v166, v167
v_and_b32 v17, 1, v12
v_lshrrev_b32 v18, 1, v12
v_lshl_add_u32 v14, v17, 1, v18
v_mul_u32_u24 v14, 256, v14
v_mul_u32_u24 v19, 16, v13
v_add_u32 v14, v14, v19
v_add_u32 v15, 73728, v14
v_add_u32 v18, 16, v18
v_mul_u32_u24 v18, 256, v18
v_mul_u32_u24 v17, 73728, v17
v_add3_u32 v16, v17, v18, v19
v_mov_b32 v108, v204
v_add_u32 v204, 0, v7
v_mov_b32 v109, v205
v_add_u32 v205, 0, v7
v_mov_b32 v110, v206
v_add_u32 v206, 0, v7
v_mov_b32 v111, v207
v_add_u32 v207, 0, v7
v_mov_b32 v112, v208
v_add_u32 v208, 4096, v7
v_mov_b32 v113, v209
v_add_u32 v209, 4096, v7
v_mov_b32 v114, v210
v_add_u32 v210, 4096, v7
v_mov_b32 v115, v211
v_add_u32 v211, 4096, v7
v_mov_b32 v116, v212
v_add_u32 v212, 8192, v7
s_lshr_b32 s41, s26, 2
s_and_b32 s42, s26, 3
s_mul_i32 s40, s41, 663552
s_mul_i32 s3, s42, 288
s_add_u32 s40, s40, s3
s_mul_i32 s3, s24, 36864
s_add_u32 s40, s40, s3
s_mov_b32 s4, s12
s_mov_b32 s5, s13
s_mov_b32 s6, s14
s_mul_i32 s28, s26, 589824
s_add_u32 s28, s28, s30
s_mul_i32 s35, s34, 147456
s_mul_i32 s3, s26, 4608
s_add_u32 s35, s35, s3
s_mul_i32 s39, s36, 2688
v_lshlrev_b32 v10, 7, v1
v_add_u32 v10, s39, v10
v_mov_b32 v11, 0x40000000
v_cmp_gt_u32 vcc, 21, v1
s_nop 1
v_cndmask_b32 v10, v11, v10, vcc
k3_p2:
s_waitcnt vmcnt(0)
v_cmp_eq_u32 vcc, -1, v6
s_nop 0
s_cbranch_vccz k3_g2
buffer_load_dword v6, v21, s[20:23], s38 offen sc0 sc1
s_branch k3_p2
k3_g2:
s_barrier
s_add_u32 m0, s30, 73728
s_nop 0
buffer_load_dwordx4 v204, s[4:7], s28 offen offset:0 lds
buffer_load_dwordx4 v205, s[4:7], s28 offen offset:1024 lds
buffer_load_dwordx4 v206, s[4:7], s28 offen offset:2048 lds
buffer_load_dwordx4 v207, s[4:7], s28 offen offset:3072 lds
s_add_u32 m0, s30, 77824
s_nop 0
buffer_load_dwordx4 v208, s[4:7], s28 offen offset:0 lds
buffer_load_dwordx4 v209, s[4:7], s28 offen offset:1024 lds
buffer_load_dwordx4 v210, s[4:7], s28 offen offset:2048 lds
buffer_load_dwordx4 v211, s[4:7], s28 offen offset:3072 lds
s_add_u32 m0, s30, 81920
s_nop 0
buffer_load_dwordx4 v212, s[4:7], s28 offen offset:0 lds
s_add_u32 s28, s28, 36864
s_add_u32 m0, s30, 110592
s_nop 0
buffer_load_dwordx4 v204, s[4:7], s28 offen offset:0 lds
buffer_load_dwordx4 v205, s[4:7], s28 offen offset:1024 lds
buffer_load_dwordx4 v206, s[4:7], s28 offen offset:2048 lds
buffer_load_dwordx4 v207, s[4:7], s28 offen offset:3072 lds
s_add_u32 m0, s30, 114688
s_nop 0
buffer_load_dwordx4 v208, s[4:7], s28 offen offset:0 lds
buffer_load_dwordx4 v209, s[4:7], s28 offen offset:1024 lds
buffer_load_dwordx4 v210, s[4:7], s28 offen offset:2048 lds
buffer_load_dwordx4 v211, s[4:7], s28 offen offset:3072 lds
s_add_u32 m0, s30, 118784
s_nop 0
buffer_load_dwordx4 v212, s[4:7], s28 offen offset:0 lds
s_add_u32 s28, s28, 36864
s_waitcnt vmcnt(9)
s_barrier
ds_read_b64_tr_b16 a[0:1], v4 offset:0
ds_read_b64_tr_b16 a[2:3], v4 offset:2304
ds_read_b64_tr_b16 a[4:5], v4 offset:32
ds_read_b64_tr_b16 a[6:7], v4 offset:2336
ds_read_b64_tr_b16 a[8:9], v4 offset:64
ds_read_b64_tr_b16 a[10:11], v4 offset:2368
ds_read_b64_tr_b16 a[12:13], v4 offset:96
ds_read_b64_tr_b16 a[14:15], v4 offset:2400
ds_read_b64_tr_b16 a[16:17], v4 offset:128
ds_read_b64_tr_b16 a[18:19], v4 offset:2432
ds_read_b64_tr_b16 a[20:21], v4 offset:160
ds_read_b64_tr_b16 a[22:23], v4 offset:2464
s_waitcnt lgkmcnt(6)
v_mfma_f32_16x16x32_bf16 v[24:27], a[0:3], a[36:39], 0
ds_read_b64_tr_b16 a[24:25], v4 offset:192
v_mfma_f32_16x16x32_bf16 v[28:31], a[0:3], a[40:43], 0
ds_read_b64_tr_b16 a[26:27], v4 offset:2496
v_mfma_f32_16x16x32_bf16 v[32:35], a[4:7], a[36:39], 0
ds_read_b64_tr_b16 a[28:29], v4 offset:224
v_mfma_f32_16x16x32_bf16 v[36:39], a[4:7], a[40:43], 0
ds_read_b64_tr_b16 a[30:31], v4 offset:2528
v_mfma_f32_16x16x32_bf16 v[40:43], a[8:11], a[36:39], 0
ds_read_b64_tr_b16 a[32:33], v4 offset:256
v_mfma_f32_16x16x32_bf16 v[44:47], a[8:11], a[40:43], 0
ds_read_b64_tr_b16 a[34:35], v4 offset:2560
s_add_u32 m0, s30, 0
s_waitcnt lgkmcnt(6)
v_mfma_f32_16x16x32_bf16 v[48:51], a[12:15], a[36:39], 0
ds_read_b64_tr_b16 a[0:1], v4 offset:9216
v_mfma_f32_16x16x32_bf16 v[52:55], a[12:15], a[40:43], 0
ds_read_b64_tr_b16 a[2:3], v4 offset:11520
v_mfma_f32_16x16x32_bf16 v[56:59], a[16:19], a[36:39], 0
ds_read_b64_tr_b16 a[4:5], v4 offset:9248
v_mfma_f32_16x16x32_bf16 v[60:63], a[16:19], a[40:43], 0
ds_read_b64_tr_b16 a[6:7], v4 offset:11552
v_mfma_f32_16x16x32_bf16 v[64:67], a[20:23], a[36:39], 0
ds_read_b64_tr_b16 a[8:9], v4 offset:9280
v_mfma_f32_16x16x32_bf16 v[68:71], a[20:23], a[40:43], 0
ds_read_b64_tr_b16 a[10:11], v4 offset:11584
buffer_load_dwordx4 v204, s[4:7], s28 offen offset:0 lds
s_waitcnt lgkmcnt(6)
v_mfma_f32_16x16x32_bf16 v[72:75], a[24:27], a[36:39], 0
ds_read_b64_tr_b16 a[12:13], v4 offset:9312
v_mfma_f32_16x16x32_bf16 v[76:79], a[24:27], a[40:43], 0
ds_read_b64_tr_b16 a[14:15], v4 offset:11616
v_mfma_f32_16x16x32_bf16 v[80:83], a[28:31], a[36:39], 0
ds_read_b64_tr_b16 a[16:17], v4 offset:9344
v_mfma_f32_16x16x32_bf16 v[84:87], a[28:31], a[40:43], 0
ds_read_b64_tr_b16 a[18:19], v4 offset:11648
v_mfma_f32_16x16x32_bf16 v[88:91], a[32:35], a[36:39], 0
ds_read_b64_tr_b16 a[20:21], v4 offset:9376
buffer_load_dwordx4 v205, s[4:7], s28 offen offset:1024 lds
v_mfma_f32_16x16x32_bf16 v[92:95], a[32:35], a[40:43], 0
ds_read_b64_tr_b16 a[22:23], v4 offset:11680
s_waitcnt lgkmcnt(6)
v_mfma_f32_16x16x32_bf16 v[24:27], a[0:3], a[44:47], v[24:27]
ds_read_b64_tr_b16 a[24:25], v4 offset:9408
v_mfma_f32_16x16x32_bf16 v[28:31], a[0:3], a[48:51], v[28:31]
ds_read_b64_tr_b16 a[26:27], v4 offset:11712
v_mfma_f32_16x16x32_bf16 v[32:35], a[4:7], a[44:47], v[32:35]
ds_read_b64_tr_b16 a[28:29], v4 offset:9440
v_mfma_f32_16x16x32_bf16 v[36:39], a[4:7], a[48:51], v[36:39]
ds_read_b64_tr_b16 a[30:31], v4 offset:11744
v_mfma_f32_16x16x32_bf16 v[40:43], a[8:11], a[44:47], v[40:43]
ds_read_b64_tr_b16 a[32:33], v4 offset:9472
buffer_load_dwordx4 v206, s[4:7], s28 offen offset:2048 lds
v_mfma_f32_16x16x32_bf16 v[44:47], a[8:11], a[48:51], v[44:47]
ds_read_b64_tr_b16 a[34:35], v4 offset:11776
s_waitcnt lgkmcnt(6)
v_mfma_f32_16x16x32_bf16 v[48:51], a[12:15], a[44:47], v[48:51]
ds_read_b64_tr_b16 a[0:1], v4 offset:18432
v_mfma_f32_16x16x32_bf16 v[52:55], a[12:15], a[48:51], v[52:55]
ds_read_b64_tr_b16 a[2:3], v4 offset:20736
v_mfma_f32_16x16x32_bf16 v[56:59], a[16:19], a[44:47], v[56:59]
ds_read_b64_tr_b16 a[4:5], v4 offset:18464
v_mfma_f32_16x16x32_bf16 v[60:63], a[16:19], a[48:51], v[60:63]
ds_read_b64_tr_b16 a[6:7], v4 offset:20768
buffer_load_dwordx4 v207, s[4:7], s28 offen offset:3072 lds
v_mfma_f32_16x16x32_bf16 v[64:67], a[20:23], a[44:47], v[64:67]
ds_read_b64_tr_b16 a[8:9], v4 offset:18496
v_mfma_f32_16x16x32_bf16 v[68:71], a[20:23], a[48:51], v[68:71]
ds_read_b64_tr_b16 a[10:11], v4 offset:20800
s_waitcnt lgkmcnt(6)
v_mfma_f32_16x16x32_bf16 v[72:75], a[24:27], a[44:47], v[72:75]
ds_read_b64_tr_b16 a[12:13], v4 offset:18528
v_mfma_f32_16x16x32_bf16 v[76:79], a[24:27], a[48:51], v[76:79]
ds_read_b64_tr_b16 a[14:15], v4 offset:20832
v_mfma_f32_16x16x32_bf16 v[80:83], a[28:31], a[44:47], v[80:83]
ds_read_b64_tr_b16 a[16:17], v4 offset:18560
v_mfma_f32_16x16x32_bf16 v[84:87], a[28:31], a[48:51], v[84:87]
ds_read_b64_tr_b16 a[18:19], v4 offset:20864
s_add_u32 m0, s30, 4096
v_mfma_f32_16x16x32_bf16 v[88:91], a[32:35], a[44:47], v[88:91]
ds_read_b64_tr_b16 a[20:21], v4 offset:18592
v_mfma_f32_16x16x32_bf16 v[92:95], a[32:35], a[48:51], v[92:95]
ds_read_b64_tr_b16 a[22:23], v4 offset:20896
s_waitcnt lgkmcnt(6)
v_mfma_f32_16x16x32_bf16 v[24:27], a[0:3], a[52:55], v[24:27]
ds_read_b64_tr_b16 a[24:25], v4 offset:18624
v_mfma_f32_16x16x32_bf16 v[28:31], a[0:3], a[56:59], v[28:31]
ds_read_b64_tr_b16 a[26:27], v4 offset:20928
v_mfma_f32_16x16x32_bf16 v[32:35], a[4:7], a[52:55], v[32:35]
ds_read_b64_tr_b16 a[28:29], v4 offset:18656
buffer_load_dwordx4 v208, s[4:7], s28 offen offset:0 lds
v_mfma_f32_16x16x32_bf16 v[36:39], a[4:7], a[56:59], v[36:39]
ds_read_b64_tr_b16 a[30:31], v4 offset:20960
v_mfma_f32_16x16x32_bf16 v[40:43], a[8:11], a[52:55], v[40:43]
ds_read_b64_tr_b16 a[32:33], v4 offset:18688
v_mfma_f32_16x16x32_bf16 v[44:47], a[8:11], a[56:59], v[44:47]
ds_read_b64_tr_b16 a[34:35], v4 offset:20992
s_waitcnt lgkmcnt(6)
v_mfma_f32_16x16x32_bf16 v[48:51], a[12:15], a[52:55], v[48:51]
ds_read_b64_tr_b16 a[0:1], v4 offset:27648
v_mfma_f32_16x16x32_bf16 v[52:55], a[12:15], a[56:59], v[52:55]
ds_read_b64_tr_b16 a[2:3], v4 offset:29952
v_mfma_f32_16x16x32_bf16 v[56:59], a[16:19], a[52:55], v[56:59]
ds_read_b64_tr_b16 a[4:5], v4 offset:27680
buffer_load_dwordx4 v209, s[4:7], s28 offen offset:1024 lds
v_mfma_f32_16x16x32_bf16 v[60:63], a[16:19], a[56:59], v[60:63]
ds_read_b64_tr_b16 a[6:7], v4 offset:29984
v_mfma_f32_16x16x32_bf16 v[64:67], a[20:23], a[52:55], v[64:67]
ds_read_b64_tr_b16 a[8:9], v4 offset:27712
v_mfma_f32_16x16x32_bf16 v[68:71], a[20:23], a[56:59], v[68:71]
ds_read_b64_tr_b16 a[10:11], v4 offset:30016
s_waitcnt lgkmcnt(6)
v_mfma_f32_16x16x32_bf16 v[72:75], a[24:27], a[52:55], v[72:75]
ds_read_b64_tr_b16 a[12:13], v4 offset:27744
v_mfma_f32_16x16x32_bf16 v[76:79], a[24:27], a[56:59], v[76:79]
ds_read_b64_tr_b16 a[14:15], v4 offset:30048
buffer_load_dwordx4 v210, s[4:7], s28 offen offset:2048 lds
v_mfma_f32_16x16x32_bf16 v[80:83], a[28:31], a[52:55], v[80:83]
ds_read_b64_tr_b16 a[16:17], v4 offset:27776
v_mfma_f32_16x16x32_bf16 v[84:87], a[28:31], a[56:59], v[84:87]
ds_read_b64_tr_b16 a[18:19], v4 offset:30080
v_mfma_f32_16x16x32_bf16 v[88:91], a[32:35], a[52:55], v[88:91]
ds_read_b64_tr_b16 a[20:21], v4 offset:27808
v_mfma_f32_16x16x32_bf16 v[92:95], a[32:35], a[56:59], v[92:95]
ds_read_b64_tr_b16 a[22:23], v4 offset:30112
s_waitcnt lgkmcnt(6)
v_mfma_f32_16x16x32_bf16 v[24:27], a[0:3], a[60:63], v[24:27]
ds_read_b64_tr_b16 a[24:25], v4 offset:27840
v_mfma_f32_16x16x32_bf16 v[28:31], a[0:3], a[64:67], v[28:31]
ds_read_b64_tr_b16 a[26:27], v4 offset:30144
buffer_load_dwordx4 v211, s[4:7], s28 offen offset:3072 lds
v_mfma_f32_16x16x32_bf16 v[32:35], a[4:7], a[60:63], v[32:35]
ds_read_b64_tr_b16 a[28:29], v4 offset:27872
v_mfma_f32_16x16x32_bf16 v[36:39], a[4:7], a[64:67], v[36:39]
ds_read_b64_tr_b16 a[30:31], v4 offset:30176
v_mfma_f32_16x16x32_bf16 v[40:43], a[8:11], a[60:63], v[40:43]
ds_read_b64_tr_b16 a[32:33], v4 offset:27904
v_mfma_f32_16x16x32_bf16 v[44:47], a[8:11], a[64:67], v[44:47]
ds_read_b64_tr_b16 a[34:35], v4 offset:30208
s_waitcnt vmcnt(8) lgkmcnt(6)
s_barrier
v_mfma_f32_16x16x32_bf16 v[48:51], a[12:15], a[60:63], v[48:51]
ds_read_b64_tr_b16 a[0:1], v5 offset:0
s_add_u32 m0, s30, 8192
v_mfma_f32_16x16x32_bf16 v[52:55], a[12:15], a[64:67], v[52:55]
ds_read_b64_tr_b16 a[2:3], v5 offset:2304
v_mfma_f32_16x16x32_bf16 v[56:59], a[16:19], a[60:63], v[56:59]
ds_read_b64_tr_b16 a[4:5], v5 offset:32
v_mfma_f32_16x16x32_bf16 v[60:63], a[16:19], a[64:67], v[60:63]
ds_read_b64_tr_b16 a[6:7], v5 offset:2336
v_mfma_f32_16x16x32_bf16 v[64:67], a[20:23], a[60:63], v[64:67]
ds_read_b64_tr_b16 a[8:9], v5 offset:64
v_mfma_f32_16x16x32_bf16 v[68:71], a[20:23], a[64:67], v[68:71]
ds_read_b64_tr_b16 a[10:11], v5 offset:2368
s_waitcnt lgkmcnt(6)
v_mfma_f32_16x16x32_bf16 v[72:75], a[24:27], a[60:63], v[72:75]
ds_read_b64_tr_b16 a[12:13], v5 offset:96
buffer_load_dwordx4 v212, s[4:7], s28 offen offset:0 lds
v_mfma_f32_16x16x32_bf16 v[76:79], a[24:27], a[64:67], v[76:79]
ds_read_b64_tr_b16 a[14:15], v5 offset:2400
v_mfma_f32_16x16x32_bf16 v[80:83], a[28:31], a[60:63], v[80:83]
ds_read_b64_tr_b16 a[16:17], v5 offset:128
v_mfma_f32_16x16x32_bf16 v[84:87], a[28:31], a[64:67], v[84:87]
ds_read_b64_tr_b16 a[18:19], v5 offset:2432
v_mfma_f32_16x16x32_bf16 v[88:91], a[32:35], a[60:63], v[88:91]
ds_read_b64_tr_b16 a[20:21], v5 offset:160
v_mfma_f32_16x16x32_bf16 v[92:95], a[32:35], a[64:67], v[92:95]
ds_read_b64_tr_b16 a[22:23], v5 offset:2464
s_add_u32 s28, s28, 36864
s_mov_b32 s31, 3
k1_kernel_lp9569:
s_waitcnt lgkmcnt(6)
v_mfma_f32_16x16x32_bf16 v[24:27], a[0:3], a[68:71], v[24:27]
ds_read_b64_tr_b16 a[24:25], v5 offset:192
v_mfma_f32_16x16x32_bf16 v[28:31], a[0:3], a[72:75], v[28:31]
ds_read_b64_tr_b16 a[26:27], v5 offset:2496
v_mfma_f32_16x16x32_bf16 v[32:35], a[4:7], a[68:71], v[32:35]
ds_read_b64_tr_b16 a[28:29], v5 offset:224
v_mfma_f32_16x16x32_bf16 v[36:39], a[4:7], a[72:75], v[36:39]
ds_read_b64_tr_b16 a[30:31], v5 offset:2528
s_add_u32 m0, s30, 36864
v_mfma_f32_16x16x32_bf16 v[40:43], a[8:11], a[68:71], v[40:43]
ds_read_b64_tr_b16 a[32:33], v5 offset:256
v_mfma_f32_16x16x32_bf16 v[44:47], a[8:11], a[72:75], v[44:47]
ds_read_b64_tr_b16 a[34:35], v5 offset:2560
s_waitcnt lgkmcnt(6)
v_mfma_f32_16x16x32_bf16 v[48:51], a[12:15], a[68:71], v[48:51]
ds_read_b64_tr_b16 a[0:1], v5 offset:9216
buffer_load_dwordx4 v204, s[4:7], s28 offen offset:0 lds
v_mfma_f32_16x16x32_bf16 v[52:55], a[12:15], a[72:75], v[52:55]
ds_read_b64_tr_b16 a[2:3], v5 offset:11520
v_mfma_f32_16x16x32_bf16 v[56:59], a[16:19], a[68:71], v[56:59]
ds_read_b64_tr_b16 a[4:5], v5 offset:9248
v_mfma_f32_16x16x32_bf16 v[60:63], a[16:19], a[72:75], v[60:63]
ds_read_b64_tr_b16 a[6:7], v5 offset:11552
buffer_load_dwordx4 a[132:135], v7, s[8:11], s29 offen offset:0
v_mfma_f32_16x16x32_bf16 v[64:67], a[20:23], a[68:71], v[64:67]
ds_read_b64_tr_b16 a[8:9], v5 offset:9280
v_mfma_f32_16x16x32_bf16 v[68:71], a[20:23], a[72:75], v[68:71]
ds_read_b64_tr_b16 a[10:11], v5 offset:11584
s_waitcnt lgkmcnt(6)
v_mfma_f32_16x16x32_bf16 v[72:75], a[24:27], a[68:71], v[72:75]
ds_read_b64_tr_b16 a[12:13], v5 offset:9312
v_mfma_f32_16x16x32_bf16 v[76:79], a[24:27], a[72:75], v[76:79]
ds_read_b64_tr_b16 a[14:15], v5 offset:11616
buffer_load_dwordx4 v205, s[4:7], s28 offen offset:1024 lds
v_mfma_f32_16x16x32_bf16 v[80:83], a[28:31], a[68:71], v[80:83]
ds_read_b64_tr_b16 a[16:17], v5 offset:9344
v_mfma_f32_16x16x32_bf16 v[84:87], a[28:31], a[72:75], v[84:87]
ds_read_b64_tr_b16 a[18:19], v5 offset:11648
v_mfma_f32_16x16x32_bf16 v[88:91], a[32:35], a[68:71], v[88:91]
ds_read_b64_tr_b16 a[20:21], v5 offset:9376
buffer_load_dwordx4 a[136:139], v8, s[8:11], s29 offen offset:0
v_mfma_f32_16x16x32_bf16 v[92:95], a[32:35], a[72:75], v[92:95]
ds_read_b64_tr_b16 a[22:23], v5 offset:11680
s_waitcnt lgkmcnt(6)
v_mfma_f32_16x16x32_bf16 v[24:27], a[0:3], a[76:79], v[24:27]
ds_read_b64_tr_b16 a[24:25], v5 offset:9408
v_mfma_f32_16x16x32_bf16 v[28:31], a[0:3], a[80:83], v[28:31]
ds_read_b64_tr_b16 a[26:27], v5 offset:11712
buffer_load_dwordx4 v206, s[4:7], s28 offen offset:2048 lds
v_mfma_f32_16x16x32_bf16 v[32:35], a[4:7], a[76:79], v[32:35]
ds_read_b64_tr_b16 a[28:29], v5 offset:9440
v_mfma_f32_16x16x32_bf16 v[36:39], a[4:7], a[80:83], v[36:39]
ds_read_b64_tr_b16 a[30:31], v5 offset:11744
v_mfma_f32_16x16x32_bf16 v[40:43], a[8:11], a[76:79], v[40:43]
ds_read_b64_tr_b16 a[32:33], v5 offset:9472
buffer_load_dwordx4 v207, s[4:7], s28 offen offset:3072 lds
v_mfma_f32_16x16x32_bf16 v[44:47], a[8:11], a[80:83], v[44:47]
ds_read_b64_tr_b16 a[34:35], v5 offset:11776
s_waitcnt lgkmcnt(6)
v_mfma_f32_16x16x32_bf16 v[48:51], a[12:15], a[76:79], v[48:51]
ds_read_b64_tr_b16 a[0:1], v5 offset:18432
v_mfma_f32_16x16x32_bf16 v[52:55], a[12:15], a[80:83], v[52:55]
ds_read_b64_tr_b16 a[2:3], v5 offset:20736
v_mfma_f32_16x16x32_bf16 v[56:59], a[16:19], a[76:79], v[56:59]
ds_read_b64_tr_b16 a[4:5], v5 offset:18464
buffer_load_dwordx4 a[140:143], v7, s[8:11], s29 offen offset:1024
v_mfma_f32_16x16x32_bf16 v[60:63], a[16:19], a[80:83], v[60:63]
ds_read_b64_tr_b16 a[6:7], v5 offset:20768
v_mfma_f32_16x16x32_bf16 v[64:67], a[20:23], a[76:79], v[64:67]
ds_read_b64_tr_b16 a[8:9], v5 offset:18496
v_mfma_f32_16x16x32_bf16 v[68:71], a[20:23], a[80:83], v[68:71]
ds_read_b64_tr_b16 a[10:11], v5 offset:20800
s_add_u32 m0, s30, 40960
s_waitcnt lgkmcnt(6)
v_mfma_f32_16x16x32_bf16 v[72:75], a[24:27], a[76:79], v[72:75]
ds_read_b64_tr_b16 a[12:13], v5 offset:18528
v_mfma_f32_16x16x32_bf16 v[76:79], a[24:27], a[80:83], v[76:79]
ds_read_b64_tr_b16 a[14:15], v5 offset:20832
v_mfma_f32_16x16x32_bf16 v[80:83], a[28:31], a[76:79], v[80:83]
ds_read_b64_tr_b16 a[16:17], v5 offset:18560
buffer_load_dwordx4 a[144:147], v8, s[8:11], s29 offen offset:1024
v_mfma_f32_16x16x32_bf16 v[84:87], a[28:31], a[80:83], v[84:87]
ds_read_b64_tr_b16 a[18:19], v5 offset:20864
v_mfma_f32_16x16x32_bf16 v[88:91], a[32:35], a[76:79], v[88:91]
ds_read_b64_tr_b16 a[20:21], v5 offset:18592
v_mfma_f32_16x16x32_bf16 v[92:95], a[32:35], a[80:83], v[92:95]
ds_read_b64_tr_b16 a[22:23], v5 offset:20896
buffer_load_dwordx4 v208, s[4:7], s28 offen offset:0 lds
s_waitcnt lgkmcnt(6)
v_mfma_f32_16x16x32_bf16 v[24:27], a[0:3], a[84:87], v[24:27]
ds_read_b64_tr_b16 a[24:25], v5 offset:18624
v_mfma_f32_16x16x32_bf16 v[28:31], a[0:3], a[88:91], v[28:31]
ds_read_b64_tr_b16 a[26:27], v5 offset:20928
v_mfma_f32_16x16x32_bf16 v[32:35], a[4:7], a[84:87], v[32:35]
ds_read_b64_tr_b16 a[28:29], v5 offset:18656
v_mfma_f32_16x16x32_bf16 v[36:39], a[4:7], a[88:91], v[36:39]
ds_read_b64_tr_b16 a[30:31], v5 offset:20960
buffer_load_dwordx4 v209, s[4:7], s28 offen offset:1024 lds
v_mfma_f32_16x16x32_bf16 v[40:43], a[8:11], a[84:87], v[40:43]
ds_read_b64_tr_b16 a[32:33], v5 offset:18688
v_mfma_f32_16x16x32_bf16 v[44:47], a[8:11], a[88:91], v[44:47]
ds_read_b64_tr_b16 a[34:35], v5 offset:20992
s_waitcnt lgkmcnt(6)
v_mfma_f32_16x16x32_bf16 v[48:51], a[12:15], a[84:87], v[48:51]
ds_read_b64_tr_b16 a[0:1], v5 offset:27648
buffer_load_dwordx4 a[148:151], v7, s[8:11], s29 offen offset:2048
v_mfma_f32_16x16x32_bf16 v[52:55], a[12:15], a[88:91], v[52:55]
ds_read_b64_tr_b16 a[2:3], v5 offset:29952
v_mfma_f32_16x16x32_bf16 v[56:59], a[16:19], a[84:87], v[56:59]
ds_read_b64_tr_b16 a[4:5], v5 offset:27680
v_mfma_f32_16x16x32_bf16 v[60:63], a[16:19], a[88:91], v[60:63]
ds_read_b64_tr_b16 a[6:7], v5 offset:29984
buffer_load_dwordx4 v210, s[4:7], s28 offen offset:2048 lds
v_mfma_f32_16x16x32_bf16 v[64:67], a[20:23], a[84:87], v[64:67]
ds_read_b64_tr_b16 a[8:9], v5 offset:27712
v_mfma_f32_16x16x32_bf16 v[68:71], a[20:23], a[88:91], v[68:71]
ds_read_b64_tr_b16 a[10:11], v5 offset:30016
s_waitcnt lgkmcnt(6)
v_mfma_f32_16x16x32_bf16 v[72:75], a[24:27], a[84:87], v[72:75]
ds_read_b64_tr_b16 a[12:13], v5 offset:27744
v_mfma_f32_16x16x32_bf16 v[76:79], a[24:27], a[88:91], v[76:79]
ds_read_b64_tr_b16 a[14:15], v5 offset:30048
buffer_load_dwordx4 a[152:155], v8, s[8:11], s29 offen offset:2048
v_mfma_f32_16x16x32_bf16 v[80:83], a[28:31], a[84:87], v[80:83]
ds_read_b64_tr_b16 a[16:17], v5 offset:27776
v_mfma_f32_16x16x32_bf16 v[84:87], a[28:31], a[88:91], v[84:87]
ds_read_b64_tr_b16 a[18:19], v5 offset:30080
v_mfma_f32_16x16x32_bf16 v[88:91], a[32:35], a[84:87], v[88:91]
ds_read_b64_tr_b16 a[20:21], v5 offset:27808
buffer_load_dwordx4 v211, s[4:7], s28 offen offset:3072 lds
v_mfma_f32_16x16x32_bf16 v[92:95], a[32:35], a[88:91], v[92:95]
ds_read_b64_tr_b16 a[22:23], v5 offset:30112
s_waitcnt lgkmcnt(6)
v_mfma_f32_16x16x32_bf16 v[24:27], a[0:3], a[92:95], v[24:27]
ds_read_b64_tr_b16 a[24:25], v5 offset:27840
v_mfma_f32_16x16x32_bf16 v[28:31], a[0:3], a[96:99], v[28:31]
ds_read_b64_tr_b16 a[26:27], v5 offset:30144
s_add_u32 m0, s30, 45056
v_mfma_f32_16x16x32_bf16 v[32:35], a[4:7], a[92:95], v[32:35]
ds_read_b64_tr_b16 a[28:29], v5 offset:27872
v_mfma_f32_16x16x32_bf16 v[36:39], a[4:7], a[96:99], v[36:39]
ds_read_b64_tr_b16 a[30:31], v5 offset:30176
v_mfma_f32_16x16x32_bf16 v[40:43], a[8:11], a[92:95], v[40:43]
ds_read_b64_tr_b16 a[32:33], v5 offset:27904
buffer_load_dwordx4 a[156:159], v7, s[8:11], s29 offen offset:3072
v_mfma_f32_16x16x32_bf16 v[44:47], a[8:11], a[96:99], v[44:47]
ds_read_b64_tr_b16 a[34:35], v5 offset:30208
s_waitcnt vmcnt(15) lgkmcnt(6)
s_barrier
v_mfma_f32_16x16x32_bf16 v[48:51], a[12:15], a[92:95], v[48:51]
ds_read_b64_tr_b16 a[0:1], v2 offset:0
v_mfma_f32_16x16x32_bf16 v[52:55], a[12:15], a[96:99], v[52:55]
ds_read_b64_tr_b16 a[2:3], v2 offset:2304
v_mfma_f32_16x16x32_bf16 v[56:59], a[16:19], a[92:95], v[56:59]
ds_read_b64_tr_b16 a[4:5], v2 offset:32
buffer_load_dwordx4 v212, s[4:7], s28 offen offset:0 lds
v_mfma_f32_16x16x32_bf16 v[60:63], a[16:19], a[96:99], v[60:63]
ds_read_b64_tr_b16 a[6:7], v2 offset:2336
v_mfma_f32_16x16x32_bf16 v[64:67], a[20:23], a[92:95], v[64:67]
ds_read_b64_tr_b16 a[8:9], v2 offset:64
v_mfma_f32_16x16x32_bf16 v[68:71], a[20:23], a[96:99], v[68:71]
ds_read_b64_tr_b16 a[10:11], v2 offset:2368
buffer_load_dwordx4 a[160:163], v8, s[8:11], s29 offen offset:3072
s_waitcnt lgkmcnt(6)
v_mfma_f32_16x16x32_bf16 v[72:75], a[24:27], a[92:95], v[72:75]
ds_read_b64_tr_b16 a[12:13], v2 offset:96
v_mfma_f32_16x16x32_bf16 v[76:79], a[24:27], a[96:99], v[76:79]
ds_read_b64_tr_b16 a[14:15], v2 offset:2400
v_mfma_f32_16x16x32_bf16 v[80:83], a[28:31], a[92:95], v[80:83]
ds_read_b64_tr_b16 a[16:17], v2 offset:128
s_add_u32 s28, s28, 36864
v_mfma_f32_16x16x32_bf16 v[84:87], a[28:31], a[96:99], v[84:87]
ds_read_b64_tr_b16 a[18:19], v2 offset:2432
v_mfma_f32_16x16x32_bf16 v[88:91], a[32:35], a[92:95], v[88:91]
ds_read_b64_tr_b16 a[20:21], v2 offset:160
v_mfma_f32_16x16x32_bf16 v[92:95], a[32:35], a[96:99], v[92:95]
ds_read_b64_tr_b16 a[22:23], v2 offset:2464
s_add_u32 s29, s29, 4096
s_waitcnt lgkmcnt(6)
v_mfma_f32_16x16x32_bf16 v[24:27], a[0:3], a[100:103], v[24:27]
ds_read_b64_tr_b16 a[24:25], v2 offset:192
v_mfma_f32_16x16x32_bf16 v[28:31], a[0:3], a[104:107], v[28:31]
ds_read_b64_tr_b16 a[26:27], v2 offset:2496
v_mfma_f32_16x16x32_bf16 v[32:35], a[4:7], a[100:103], v[32:35]
ds_read_b64_tr_b16 a[28:29], v2 offset:224
v_mfma_f32_16x16x32_bf16 v[36:39], a[4:7], a[104:107], v[36:39]
ds_read_b64_tr_b16 a[30:31], v2 offset:2528
s_add_u32 m0, s30, 73728
v_mfma_f32_16x16x32_bf16 v[40:43], a[8:11], a[100:103], v[40:43]
ds_read_b64_tr_b16 a[32:33], v2 offset:256
v_mfma_f32_16x16x32_bf16 v[44:47], a[8:11], a[104:107], v[44:47]
ds_read_b64_tr_b16 a[34:35], v2 offset:2560
s_waitcnt lgkmcnt(6)
v_mfma_f32_16x16x32_bf16 v[48:51], a[12:15], a[100:103], v[48:51]
ds_read_b64_tr_b16 a[0:1], v2 offset:9216
buffer_load_dwordx4 v204, s[4:7], s28 offen offset:0 lds
v_mfma_f32_16x16x32_bf16 v[52:55], a[12:15], a[104:107], v[52:55]
ds_read_b64_tr_b16 a[2:3], v2 offset:11520
v_mfma_f32_16x16x32_bf16 v[56:59], a[16:19], a[100:103], v[56:59]
ds_read_b64_tr_b16 a[4:5], v2 offset:9248
v_mfma_f32_16x16x32_bf16 v[60:63], a[16:19], a[104:107], v[60:63]
ds_read_b64_tr_b16 a[6:7], v2 offset:11552
buffer_load_dwordx4 a[36:39], v7, s[8:11], s29 offen offset:0
v_mfma_f32_16x16x32_bf16 v[64:67], a[20:23], a[100:103], v[64:67]
ds_read_b64_tr_b16 a[8:9], v2 offset:9280
v_mfma_f32_16x16x32_bf16 v[68:71], a[20:23], a[104:107], v[68:71]
ds_read_b64_tr_b16 a[10:11], v2 offset:11584
s_waitcnt lgkmcnt(6)
v_mfma_f32_16x16x32_bf16 v[72:75], a[24:27], a[100:103], v[72:75]
ds_read_b64_tr_b16 a[12:13], v2 offset:9312
v_mfma_f32_16x16x32_bf16 v[76:79], a[24:27], a[104:107], v[76:79]
ds_read_b64_tr_b16 a[14:15], v2 offset:11616
buffer_load_dwordx4 v205, s[4:7], s28 offen offset:1024 lds
v_mfma_f32_16x16x32_bf16 v[80:83], a[28:31], a[100:103], v[80:83]
ds_read_b64_tr_b16 a[16:17], v2 offset:9344
v_mfma_f32_16x16x32_bf16 v[84:87], a[28:31], a[104:107], v[84:87]
ds_read_b64_tr_b16 a[18:19], v2 offset:11648
v_mfma_f32_16x16x32_bf16 v[88:91], a[32:35], a[100:103], v[88:91]
ds_read_b64_tr_b16 a[20:21], v2 offset:9376
buffer_load_dwordx4 a[40:43], v8, s[8:11], s29 offen offset:0
v_mfma_f32_16x16x32_bf16 v[92:95], a[32:35], a[104:107], v[92:95]
ds_read_b64_tr_b16 a[22:23], v2 offset:11680
s_waitcnt lgkmcnt(6)
v_mfma_f32_16x16x32_bf16 v[24:27], a[0:3], a[108:111], v[24:27]
ds_read_b64_tr_b16 a[24:25], v2 offset:9408
v_mfma_f32_16x16x32_bf16 v[28:31], a[0:3], a[112:115], v[28:31]
ds_read_b64_tr_b16 a[26:27], v2 offset:11712
buffer_load_dwordx4 v206, s[4:7], s28 offen offset:2048 lds
v_mfma_f32_16x16x32_bf16 v[32:35], a[4:7], a[108:111], v[32:35]
ds_read_b64_tr_b16 a[28:29], v2 offset:9440
v_mfma_f32_16x16x32_bf16 v[36:39], a[4:7], a[112:115], v[36:39]
ds_read_b64_tr_b16 a[30:31], v2 offset:11744
v_mfma_f32_16x16x32_bf16 v[40:43], a[8:11], a[108:111], v[40:43]
ds_read_b64_tr_b16 a[32:33], v2 offset:9472
buffer_load_dwordx4 v207, s[4:7], s28 offen offset:3072 lds
v_mfma_f32_16x16x32_bf16 v[44:47], a[8:11], a[112:115], v[44:47]
ds_read_b64_tr_b16 a[34:35], v2 offset:11776
s_waitcnt lgkmcnt(6)
v_mfma_f32_16x16x32_bf16 v[48:51], a[12:15], a[108:111], v[48:51]
ds_read_b64_tr_b16 a[0:1], v2 offset:18432
v_mfma_f32_16x16x32_bf16 v[52:55], a[12:15], a[112:115], v[52:55]
ds_read_b64_tr_b16 a[2:3], v2 offset:20736
v_mfma_f32_16x16x32_bf16 v[56:59], a[16:19], a[108:111], v[56:59]
ds_read_b64_tr_b16 a[4:5], v2 offset:18464
buffer_load_dwordx4 a[44:47], v7, s[8:11], s29 offen offset:1024
v_mfma_f32_16x16x32_bf16 v[60:63], a[16:19], a[112:115], v[60:63]
ds_read_b64_tr_b16 a[6:7], v2 offset:20768
v_mfma_f32_16x16x32_bf16 v[64:67], a[20:23], a[108:111], v[64:67]
ds_read_b64_tr_b16 a[8:9], v2 offset:18496
v_mfma_f32_16x16x32_bf16 v[68:71], a[20:23], a[112:115], v[68:71]
ds_read_b64_tr_b16 a[10:11], v2 offset:20800
s_add_u32 m0, s30, 77824
s_waitcnt lgkmcnt(6)
v_mfma_f32_16x16x32_bf16 v[72:75], a[24:27], a[108:111], v[72:75]
ds_read_b64_tr_b16 a[12:13], v2 offset:18528
v_mfma_f32_16x16x32_bf16 v[76:79], a[24:27], a[112:115], v[76:79]
ds_read_b64_tr_b16 a[14:15], v2 offset:20832
v_mfma_f32_16x16x32_bf16 v[80:83], a[28:31], a[108:111], v[80:83]
ds_read_b64_tr_b16 a[16:17], v2 offset:18560
buffer_load_dwordx4 a[48:51], v8, s[8:11], s29 offen offset:1024
v_mfma_f32_16x16x32_bf16 v[84:87], a[28:31], a[112:115], v[84:87]
ds_read_b64_tr_b16 a[18:19], v2 offset:20864
v_mfma_f32_16x16x32_bf16 v[88:91], a[32:35], a[108:111], v[88:91]
ds_read_b64_tr_b16 a[20:21], v2 offset:18592
v_mfma_f32_16x16x32_bf16 v[92:95], a[32:35], a[112:115], v[92:95]
ds_read_b64_tr_b16 a[22:23], v2 offset:20896
buffer_load_dwordx4 v208, s[4:7], s28 offen offset:0 lds
s_waitcnt lgkmcnt(6)
v_mfma_f32_16x16x32_bf16 v[24:27], a[0:3], a[116:119], v[24:27]
ds_read_b64_tr_b16 a[24:25], v2 offset:18624
v_mfma_f32_16x16x32_bf16 v[28:31], a[0:3], a[120:123], v[28:31]
ds_read_b64_tr_b16 a[26:27], v2 offset:20928
v_mfma_f32_16x16x32_bf16 v[32:35], a[4:7], a[116:119], v[32:35]
ds_read_b64_tr_b16 a[28:29], v2 offset:18656
v_mfma_f32_16x16x32_bf16 v[36:39], a[4:7], a[120:123], v[36:39]
ds_read_b64_tr_b16 a[30:31], v2 offset:20960
buffer_load_dwordx4 v209, s[4:7], s28 offen offset:1024 lds
v_mfma_f32_16x16x32_bf16 v[40:43], a[8:11], a[116:119], v[40:43]
ds_read_b64_tr_b16 a[32:33], v2 offset:18688
v_mfma_f32_16x16x32_bf16 v[44:47], a[8:11], a[120:123], v[44:47]
ds_read_b64_tr_b16 a[34:35], v2 offset:20992
s_waitcnt lgkmcnt(6)
v_mfma_f32_16x16x32_bf16 v[48:51], a[12:15], a[116:119], v[48:51]
ds_read_b64_tr_b16 a[0:1], v2 offset:27648
buffer_load_dwordx4 a[52:55], v7, s[8:11], s29 offen offset:2048
v_mfma_f32_16x16x32_bf16 v[52:55], a[12:15], a[120:123], v[52:55]
ds_read_b64_tr_b16 a[2:3], v2 offset:29952
v_mfma_f32_16x16x32_bf16 v[56:59], a[16:19], a[116:119], v[56:59]
ds_read_b64_tr_b16 a[4:5], v2 offset:27680
v_mfma_f32_16x16x32_bf16 v[60:63], a[16:19], a[120:123], v[60:63]
ds_read_b64_tr_b16 a[6:7], v2 offset:29984
buffer_load_dwordx4 v210, s[4:7], s28 offen offset:2048 lds
v_mfma_f32_16x16x32_bf16 v[64:67], a[20:23], a[116:119], v[64:67]
ds_read_b64_tr_b16 a[8:9], v2 offset:27712
v_mfma_f32_16x16x32_bf16 v[68:71], a[20:23], a[120:123], v[68:71]
ds_read_b64_tr_b16 a[10:11], v2 offset:30016
s_waitcnt lgkmcnt(6)
v_mfma_f32_16x16x32_bf16 v[72:75], a[24:27], a[116:119], v[72:75]
ds_read_b64_tr_b16 a[12:13], v2 offset:27744
v_mfma_f32_16x16x32_bf16 v[76:79], a[24:27], a[120:123], v[76:79]
ds_read_b64_tr_b16 a[14:15], v2 offset:30048
buffer_load_dwordx4 a[56:59], v8, s[8:11], s29 offen offset:2048
v_mfma_f32_16x16x32_bf16 v[80:83], a[28:31], a[116:119], v[80:83]
ds_read_b64_tr_b16 a[16:17], v2 offset:27776
v_mfma_f32_16x16x32_bf16 v[84:87], a[28:31], a[120:123], v[84:87]
ds_read_b64_tr_b16 a[18:19], v2 offset:30080
v_mfma_f32_16x16x32_bf16 v[88:91], a[32:35], a[116:119], v[88:91]
ds_read_b64_tr_b16 a[20:21], v2 offset:27808
buffer_load_dwordx4 v211, s[4:7], s28 offen offset:3072 lds
v_mfma_f32_16x16x32_bf16 v[92:95], a[32:35], a[120:123], v[92:95]
ds_read_b64_tr_b16 a[22:23], v2 offset:30112
s_waitcnt lgkmcnt(6)
v_mfma_f32_16x16x32_bf16 v[24:27], a[0:3], a[124:127], v[24:27]
ds_read_b64_tr_b16 a[24:25], v2 offset:27840
v_mfma_f32_16x16x32_bf16 v[28:31], a[0:3], a[128:131], v[28:31]
ds_read_b64_tr_b16 a[26:27], v2 offset:30144
s_add_u32 m0, s30, 81920
v_mfma_f32_16x16x32_bf16 v[32:35], a[4:7], a[124:127], v[32:35]
ds_read_b64_tr_b16 a[28:29], v2 offset:27872
v_mfma_f32_16x16x32_bf16 v[36:39], a[4:7], a[128:131], v[36:39]
ds_read_b64_tr_b16 a[30:31], v2 offset:30176
v_mfma_f32_16x16x32_bf16 v[40:43], a[8:11], a[124:127], v[40:43]
ds_read_b64_tr_b16 a[32:33], v2 offset:27904
buffer_load_dwordx4 a[60:63], v7, s[8:11], s29 offen offset:3072
v_mfma_f32_16x16x32_bf16 v[44:47], a[8:11], a[128:131], v[44:47]
ds_read_b64_tr_b16 a[34:35], v2 offset:30208
s_waitcnt vmcnt(15) lgkmcnt(6)
s_barrier
v_mfma_f32_16x16x32_bf16 v[48:51], a[12:15], a[124:127], v[48:51]
ds_read_b64_tr_b16 a[0:1], v3 offset:0
v_mfma_f32_16x16x32_bf16 v[52:55], a[12:15], a[128:131], v[52:55]
ds_read_b64_tr_b16 a[2:3], v3 offset:2304
v_mfma_f32_16x16x32_bf16 v[56:59], a[16:19], a[124:127], v[56:59]
ds_read_b64_tr_b16 a[4:5], v3 offset:32
buffer_load_dwordx4 v212, s[4:7], s28 offen offset:0 lds
v_mfma_f32_16x16x32_bf16 v[60:63], a[16:19], a[128:131], v[60:63]
ds_read_b64_tr_b16 a[6:7], v3 offset:2336
v_mfma_f32_16x16x32_bf16 v[64:67], a[20:23], a[124:127], v[64:67]
ds_read_b64_tr_b16 a[8:9], v3 offset:64
v_mfma_f32_16x16x32_bf16 v[68:71], a[20:23], a[128:131], v[68:71]
ds_read_b64_tr_b16 a[10:11], v3 offset:2368
buffer_load_dwordx4 a[64:67], v8, s[8:11], s29 offen offset:3072
s_waitcnt lgkmcnt(6)
v_mfma_f32_16x16x32_bf16 v[72:75], a[24:27], a[124:127], v[72:75]
ds_read_b64_tr_b16 a[12:13], v3 offset:96
v_mfma_f32_16x16x32_bf16 v[76:79], a[24:27], a[128:131], v[76:79]
ds_read_b64_tr_b16 a[14:15], v3 offset:2400
v_mfma_f32_16x16x32_bf16 v[80:83], a[28:31], a[124:127], v[80:83]
ds_read_b64_tr_b16 a[16:17], v3 offset:128
s_add_u32 s28, s28, 36864
v_mfma_f32_16x16x32_bf16 v[84:87], a[28:31], a[128:131], v[84:87]
ds_read_b64_tr_b16 a[18:19], v3 offset:2432
v_mfma_f32_16x16x32_bf16 v[88:91], a[32:35], a[124:127], v[88:91]
ds_read_b64_tr_b16 a[20:21], v3 offset:160
v_mfma_f32_16x16x32_bf16 v[92:95], a[32:35], a[128:131], v[92:95]
ds_read_b64_tr_b16 a[22:23], v3 offset:2464
s_add_u32 s29, s29, 4096
s_waitcnt lgkmcnt(6)
v_mfma_f32_16x16x32_bf16 v[24:27], a[0:3], a[132:135], v[24:27]
ds_read_b64_tr_b16 a[24:25], v3 offset:192
v_mfma_f32_16x16x32_bf16 v[28:31], a[0:3], a[136:139], v[28:31]
ds_read_b64_tr_b16 a[26:27], v3 offset:2496
v_mfma_f32_16x16x32_bf16 v[32:35], a[4:7], a[132:135], v[32:35]
ds_read_b64_tr_b16 a[28:29], v3 offset:224
v_mfma_f32_16x16x32_bf16 v[36:39], a[4:7], a[136:139], v[36:39]
ds_read_b64_tr_b16 a[30:31], v3 offset:2528
s_add_u32 m0, s30, 110592
v_mfma_f32_16x16x32_bf16 v[40:43], a[8:11], a[132:135], v[40:43]
ds_read_b64_tr_b16 a[32:33], v3 offset:256
v_mfma_f32_16x16x32_bf16 v[44:47], a[8:11], a[136:139], v[44:47]
ds_read_b64_tr_b16 a[34:35], v3 offset:2560
s_waitcnt lgkmcnt(6)
v_mfma_f32_16x16x32_bf16 v[48:51], a[12:15], a[132:135], v[48:51]
ds_read_b64_tr_b16 a[0:1], v3 offset:9216
buffer_load_dwordx4 v204, s[4:7], s28 offen offset:0 lds
v_mfma_f32_16x16x32_bf16 v[52:55], a[12:15], a[136:139], v[52:55]
ds_read_b64_tr_b16 a[2:3], v3 offset:11520
v_mfma_f32_16x16x32_bf16 v[56:59], a[16:19], a[132:135], v[56:59]
ds_read_b64_tr_b16 a[4:5], v3 offset:9248
v_mfma_f32_16x16x32_bf16 v[60:63], a[16:19], a[136:139], v[60:63]
ds_read_b64_tr_b16 a[6:7], v3 offset:11552
buffer_load_dwordx4 a[68:71], v7, s[8:11], s29 offen offset:0
v_mfma_f32_16x16x32_bf16 v[64:67], a[20:23], a[132:135], v[64:67]
ds_read_b64_tr_b16 a[8:9], v3 offset:9280
v_mfma_f32_16x16x32_bf16 v[68:71], a[20:23], a[136:139], v[68:71]
ds_read_b64_tr_b16 a[10:11], v3 offset:11584
s_waitcnt lgkmcnt(6)
v_mfma_f32_16x16x32_bf16 v[72:75], a[24:27], a[132:135], v[72:75]
ds_read_b64_tr_b16 a[12:13], v3 offset:9312
v_mfma_f32_16x16x32_bf16 v[76:79], a[24:27], a[136:139], v[76:79]
ds_read_b64_tr_b16 a[14:15], v3 offset:11616
buffer_load_dwordx4 v205, s[4:7], s28 offen offset:1024 lds
v_mfma_f32_16x16x32_bf16 v[80:83], a[28:31], a[132:135], v[80:83]
ds_read_b64_tr_b16 a[16:17], v3 offset:9344
v_mfma_f32_16x16x32_bf16 v[84:87], a[28:31], a[136:139], v[84:87]
ds_read_b64_tr_b16 a[18:19], v3 offset:11648
v_mfma_f32_16x16x32_bf16 v[88:91], a[32:35], a[132:135], v[88:91]
ds_read_b64_tr_b16 a[20:21], v3 offset:9376
buffer_load_dwordx4 a[72:75], v8, s[8:11], s29 offen offset:0
v_mfma_f32_16x16x32_bf16 v[92:95], a[32:35], a[136:139], v[92:95]
ds_read_b64_tr_b16 a[22:23], v3 offset:11680
s_waitcnt lgkmcnt(6)
v_mfma_f32_16x16x32_bf16 v[24:27], a[0:3], a[140:143], v[24:27]
ds_read_b64_tr_b16 a[24:25], v3 offset:9408
v_mfma_f32_16x16x32_bf16 v[28:31], a[0:3], a[144:147], v[28:31]
ds_read_b64_tr_b16 a[26:27], v3 offset:11712
buffer_load_dwordx4 v206, s[4:7], s28 offen offset:2048 lds
v_mfma_f32_16x16x32_bf16 v[32:35], a[4:7], a[140:143], v[32:35]
ds_read_b64_tr_b16 a[28:29], v3 offset:9440
v_mfma_f32_16x16x32_bf16 v[36:39], a[4:7], a[144:147], v[36:39]
ds_read_b64_tr_b16 a[30:31], v3 offset:11744
v_mfma_f32_16x16x32_bf16 v[40:43], a[8:11], a[140:143], v[40:43]
ds_read_b64_tr_b16 a[32:33], v3 offset:9472
buffer_load_dwordx4 v207, s[4:7], s28 offen offset:3072 lds
v_mfma_f32_16x16x32_bf16 v[44:47], a[8:11], a[144:147], v[44:47]
ds_read_b64_tr_b16 a[34:35], v3 offset:11776
s_waitcnt lgkmcnt(6)
v_mfma_f32_16x16x32_bf16 v[48:51], a[12:15], a[140:143], v[48:51]
ds_read_b64_tr_b16 a[0:1], v3 offset:18432
v_mfma_f32_16x16x32_bf16 v[52:55], a[12:15], a[144:147], v[52:55]
ds_read_b64_tr_b16 a[2:3], v3 offset:20736
v_mfma_f32_16x16x32_bf16 v[56:59], a[16:19], a[140:143], v[56:59]
ds_read_b64_tr_b16 a[4:5], v3 offset:18464
buffer_load_dwordx4 a[76:79], v7, s[8:11], s29 offen offset:1024
v_mfma_f32_16x16x32_bf16 v[60:63], a[16:19], a[144:147], v[60:63]
ds_read_b64_tr_b16 a[6:7], v3 offset:20768
v_mfma_f32_16x16x32_bf16 v[64:67], a[20:23], a[140:143], v[64:67]
ds_read_b64_tr_b16 a[8:9], v3 offset:18496
v_mfma_f32_16x16x32_bf16 v[68:71], a[20:23], a[144:147], v[68:71]
ds_read_b64_tr_b16 a[10:11], v3 offset:20800
s_add_u32 m0, s30, 114688
s_waitcnt lgkmcnt(6)
v_mfma_f32_16x16x32_bf16 v[72:75], a[24:27], a[140:143], v[72:75]
ds_read_b64_tr_b16 a[12:13], v3 offset:18528
v_mfma_f32_16x16x32_bf16 v[76:79], a[24:27], a[144:147], v[76:79]
ds_read_b64_tr_b16 a[14:15], v3 offset:20832
v_mfma_f32_16x16x32_bf16 v[80:83], a[28:31], a[140:143], v[80:83]
ds_read_b64_tr_b16 a[16:17], v3 offset:18560
buffer_load_dwordx4 a[80:83], v8, s[8:11], s29 offen offset:1024
v_mfma_f32_16x16x32_bf16 v[84:87], a[28:31], a[144:147], v[84:87]
ds_read_b64_tr_b16 a[18:19], v3 offset:20864
v_mfma_f32_16x16x32_bf16 v[88:91], a[32:35], a[140:143], v[88:91]
ds_read_b64_tr_b16 a[20:21], v3 offset:18592
v_mfma_f32_16x16x32_bf16 v[92:95], a[32:35], a[144:147], v[92:95]
ds_read_b64_tr_b16 a[22:23], v3 offset:20896
buffer_load_dwordx4 v208, s[4:7], s28 offen offset:0 lds
s_waitcnt lgkmcnt(6)
v_mfma_f32_16x16x32_bf16 v[24:27], a[0:3], a[148:151], v[24:27]
ds_read_b64_tr_b16 a[24:25], v3 offset:18624
v_mfma_f32_16x16x32_bf16 v[28:31], a[0:3], a[152:155], v[28:31]
ds_read_b64_tr_b16 a[26:27], v3 offset:20928
v_mfma_f32_16x16x32_bf16 v[32:35], a[4:7], a[148:151], v[32:35]
ds_read_b64_tr_b16 a[28:29], v3 offset:18656
v_mfma_f32_16x16x32_bf16 v[36:39], a[4:7], a[152:155], v[36:39]
ds_read_b64_tr_b16 a[30:31], v3 offset:20960
buffer_load_dwordx4 v209, s[4:7], s28 offen offset:1024 lds
v_mfma_f32_16x16x32_bf16 v[40:43], a[8:11], a[148:151], v[40:43]
ds_read_b64_tr_b16 a[32:33], v3 offset:18688
v_mfma_f32_16x16x32_bf16 v[44:47], a[8:11], a[152:155], v[44:47]
ds_read_b64_tr_b16 a[34:35], v3 offset:20992
s_waitcnt lgkmcnt(6)
v_mfma_f32_16x16x32_bf16 v[48:51], a[12:15], a[148:151], v[48:51]
ds_read_b64_tr_b16 a[0:1], v3 offset:27648
buffer_load_dwordx4 a[84:87], v7, s[8:11], s29 offen offset:2048
v_mfma_f32_16x16x32_bf16 v[52:55], a[12:15], a[152:155], v[52:55]
ds_read_b64_tr_b16 a[2:3], v3 offset:29952
v_mfma_f32_16x16x32_bf16 v[56:59], a[16:19], a[148:151], v[56:59]
ds_read_b64_tr_b16 a[4:5], v3 offset:27680
v_mfma_f32_16x16x32_bf16 v[60:63], a[16:19], a[152:155], v[60:63]
ds_read_b64_tr_b16 a[6:7], v3 offset:29984
buffer_load_dwordx4 v210, s[4:7], s28 offen offset:2048 lds
v_mfma_f32_16x16x32_bf16 v[64:67], a[20:23], a[148:151], v[64:67]
ds_read_b64_tr_b16 a[8:9], v3 offset:27712
v_mfma_f32_16x16x32_bf16 v[68:71], a[20:23], a[152:155], v[68:71]
ds_read_b64_tr_b16 a[10:11], v3 offset:30016
s_waitcnt lgkmcnt(6)
v_mfma_f32_16x16x32_bf16 v[72:75], a[24:27], a[148:151], v[72:75]
ds_read_b64_tr_b16 a[12:13], v3 offset:27744
v_mfma_f32_16x16x32_bf16 v[76:79], a[24:27], a[152:155], v[76:79]
ds_read_b64_tr_b16 a[14:15], v3 offset:30048
buffer_load_dwordx4 a[88:91], v8, s[8:11], s29 offen offset:2048
v_mfma_f32_16x16x32_bf16 v[80:83], a[28:31], a[148:151], v[80:83]
ds_read_b64_tr_b16 a[16:17], v3 offset:27776
v_mfma_f32_16x16x32_bf16 v[84:87], a[28:31], a[152:155], v[84:87]
ds_read_b64_tr_b16 a[18:19], v3 offset:30080
v_mfma_f32_16x16x32_bf16 v[88:91], a[32:35], a[148:151], v[88:91]
ds_read_b64_tr_b16 a[20:21], v3 offset:27808
buffer_load_dwordx4 v211, s[4:7], s28 offen offset:3072 lds
v_mfma_f32_16x16x32_bf16 v[92:95], a[32:35], a[152:155], v[92:95]
ds_read_b64_tr_b16 a[22:23], v3 offset:30112
s_waitcnt lgkmcnt(6)
v_mfma_f32_16x16x32_bf16 v[24:27], a[0:3], a[156:159], v[24:27]
ds_read_b64_tr_b16 a[24:25], v3 offset:27840
v_mfma_f32_16x16x32_bf16 v[28:31], a[0:3], a[160:163], v[28:31]
ds_read_b64_tr_b16 a[26:27], v3 offset:30144
s_add_u32 m0, s30, 118784
v_mfma_f32_16x16x32_bf16 v[32:35], a[4:7], a[156:159], v[32:35]
ds_read_b64_tr_b16 a[28:29], v3 offset:27872
v_mfma_f32_16x16x32_bf16 v[36:39], a[4:7], a[160:163], v[36:39]
ds_read_b64_tr_b16 a[30:31], v3 offset:30176
v_mfma_f32_16x16x32_bf16 v[40:43], a[8:11], a[156:159], v[40:43]
ds_read_b64_tr_b16 a[32:33], v3 offset:27904
buffer_load_dwordx4 a[92:95], v7, s[8:11], s29 offen offset:3072
v_mfma_f32_16x16x32_bf16 v[44:47], a[8:11], a[160:163], v[44:47]
ds_read_b64_tr_b16 a[34:35], v3 offset:30208
s_waitcnt vmcnt(15) lgkmcnt(6)
s_barrier
v_mfma_f32_16x16x32_bf16 v[48:51], a[12:15], a[156:159], v[48:51]
ds_read_b64_tr_b16 a[0:1], v4 offset:0
v_mfma_f32_16x16x32_bf16 v[52:55], a[12:15], a[160:163], v[52:55]
ds_read_b64_tr_b16 a[2:3], v4 offset:2304
v_mfma_f32_16x16x32_bf16 v[56:59], a[16:19], a[156:159], v[56:59]
ds_read_b64_tr_b16 a[4:5], v4 offset:32
buffer_load_dwordx4 v212, s[4:7], s28 offen offset:0 lds
v_mfma_f32_16x16x32_bf16 v[60:63], a[16:19], a[160:163], v[60:63]
ds_read_b64_tr_b16 a[6:7], v4 offset:2336
v_mfma_f32_16x16x32_bf16 v[64:67], a[20:23], a[156:159], v[64:67]
ds_read_b64_tr_b16 a[8:9], v4 offset:64
v_mfma_f32_16x16x32_bf16 v[68:71], a[20:23], a[160:163], v[68:71]
ds_read_b64_tr_b16 a[10:11], v4 offset:2368
buffer_load_dwordx4 a[96:99], v8, s[8:11], s29 offen offset:3072
s_waitcnt lgkmcnt(6)
v_mfma_f32_16x16x32_bf16 v[72:75], a[24:27], a[156:159], v[72:75]
ds_read_b64_tr_b16 a[12:13], v4 offset:96
v_mfma_f32_16x16x32_bf16 v[76:79], a[24:27], a[160:163], v[76:79]
ds_read_b64_tr_b16 a[14:15], v4 offset:2400
v_mfma_f32_16x16x32_bf16 v[80:83], a[28:31], a[156:159], v[80:83]
ds_read_b64_tr_b16 a[16:17], v4 offset:128
s_add_u32 s28, s28, 36864
v_mfma_f32_16x16x32_bf16 v[84:87], a[28:31], a[160:163], v[84:87]
ds_read_b64_tr_b16 a[18:19], v4 offset:2432
v_mfma_f32_16x16x32_bf16 v[88:91], a[32:35], a[156:159], v[88:91]
ds_read_b64_tr_b16 a[20:21], v4 offset:160
v_mfma_f32_16x16x32_bf16 v[92:95], a[32:35], a[160:163], v[92:95]
ds_read_b64_tr_b16 a[22:23], v4 offset:2464
s_add_u32 s29, s29, 4096
s_waitcnt lgkmcnt(6)
v_mfma_f32_16x16x32_bf16 v[24:27], a[0:3], a[36:39], v[24:27]
ds_read_b64_tr_b16 a[24:25], v4 offset:192
v_mfma_f32_16x16x32_bf16 v[28:31], a[0:3], a[40:43], v[28:31]
ds_read_b64_tr_b16 a[26:27], v4 offset:2496
v_mfma_f32_16x16x32_bf16 v[32:35], a[4:7], a[36:39], v[32:35]
ds_read_b64_tr_b16 a[28:29], v4 offset:224
v_mfma_f32_16x16x32_bf16 v[36:39], a[4:7], a[40:43], v[36:39]
ds_read_b64_tr_b16 a[30:31], v4 offset:2528
s_add_u32 m0, s30, 0
v_mfma_f32_16x16x32_bf16 v[40:43], a[8:11], a[36:39], v[40:43]
ds_read_b64_tr_b16 a[32:33], v4 offset:256
v_mfma_f32_16x16x32_bf16 v[44:47], a[8:11], a[40:43], v[44:47]
ds_read_b64_tr_b16 a[34:35], v4 offset:2560
s_waitcnt lgkmcnt(6)
v_mfma_f32_16x16x32_bf16 v[48:51], a[12:15], a[36:39], v[48:51]
ds_read_b64_tr_b16 a[0:1], v4 offset:9216
buffer_load_dwordx4 v204, s[4:7], s28 offen offset:0 lds
v_mfma_f32_16x16x32_bf16 v[52:55], a[12:15], a[40:43], v[52:55]
ds_read_b64_tr_b16 a[2:3], v4 offset:11520
v_mfma_f32_16x16x32_bf16 v[56:59], a[16:19], a[36:39], v[56:59]
ds_read_b64_tr_b16 a[4:5], v4 offset:9248
v_mfma_f32_16x16x32_bf16 v[60:63], a[16:19], a[40:43], v[60:63]
ds_read_b64_tr_b16 a[6:7], v4 offset:11552
buffer_load_dwordx4 a[100:103], v7, s[8:11], s29 offen offset:0
v_mfma_f32_16x16x32_bf16 v[64:67], a[20:23], a[36:39], v[64:67]
ds_read_b64_tr_b16 a[8:9], v4 offset:9280
v_mfma_f32_16x16x32_bf16 v[68:71], a[20:23], a[40:43], v[68:71]
ds_read_b64_tr_b16 a[10:11], v4 offset:11584
s_waitcnt lgkmcnt(6)
v_mfma_f32_16x16x32_bf16 v[72:75], a[24:27], a[36:39], v[72:75]
ds_read_b64_tr_b16 a[12:13], v4 offset:9312
v_mfma_f32_16x16x32_bf16 v[76:79], a[24:27], a[40:43], v[76:79]
ds_read_b64_tr_b16 a[14:15], v4 offset:11616
buffer_load_dwordx4 v205, s[4:7], s28 offen offset:1024 lds
v_mfma_f32_16x16x32_bf16 v[80:83], a[28:31], a[36:39], v[80:83]
ds_read_b64_tr_b16 a[16:17], v4 offset:9344
v_mfma_f32_16x16x32_bf16 v[84:87], a[28:31], a[40:43], v[84:87]
ds_read_b64_tr_b16 a[18:19], v4 offset:11648
v_mfma_f32_16x16x32_bf16 v[88:91], a[32:35], a[36:39], v[88:91]
ds_read_b64_tr_b16 a[20:21], v4 offset:9376
buffer_load_dwordx4 a[104:107], v8, s[8:11], s29 offen offset:0
v_mfma_f32_16x16x32_bf16 v[92:95], a[32:35], a[40:43], v[92:95]
ds_read_b64_tr_b16 a[22:23], v4 offset:11680
s_waitcnt lgkmcnt(6)
v_mfma_f32_16x16x32_bf16 v[24:27], a[0:3], a[44:47], v[24:27]
ds_read_b64_tr_b16 a[24:25], v4 offset:9408
v_mfma_f32_16x16x32_bf16 v[28:31], a[0:3], a[48:51], v[28:31]
ds_read_b64_tr_b16 a[26:27], v4 offset:11712
buffer_load_dwordx4 v206, s[4:7], s28 offen offset:2048 lds
v_mfma_f32_16x16x32_bf16 v[32:35], a[4:7], a[44:47], v[32:35]
ds_read_b64_tr_b16 a[28:29], v4 offset:9440
v_mfma_f32_16x16x32_bf16 v[36:39], a[4:7], a[48:51], v[36:39]
ds_read_b64_tr_b16 a[30:31], v4 offset:11744
v_mfma_f32_16x16x32_bf16 v[40:43], a[8:11], a[44:47], v[40:43]
ds_read_b64_tr_b16 a[32:33], v4 offset:9472
buffer_load_dwordx4 v207, s[4:7], s28 offen offset:3072 lds
v_mfma_f32_16x16x32_bf16 v[44:47], a[8:11], a[48:51], v[44:47]
ds_read_b64_tr_b16 a[34:35], v4 offset:11776
s_waitcnt lgkmcnt(6)
v_mfma_f32_16x16x32_bf16 v[48:51], a[12:15], a[44:47], v[48:51]
ds_read_b64_tr_b16 a[0:1], v4 offset:18432
v_mfma_f32_16x16x32_bf16 v[52:55], a[12:15], a[48:51], v[52:55]
ds_read_b64_tr_b16 a[2:3], v4 offset:20736
v_mfma_f32_16x16x32_bf16 v[56:59], a[16:19], a[44:47], v[56:59]
ds_read_b64_tr_b16 a[4:5], v4 offset:18464
buffer_load_dwordx4 a[108:111], v7, s[8:11], s29 offen offset:1024
v_mfma_f32_16x16x32_bf16 v[60:63], a[16:19], a[48:51], v[60:63]
ds_read_b64_tr_b16 a[6:7], v4 offset:20768
v_mfma_f32_16x16x32_bf16 v[64:67], a[20:23], a[44:47], v[64:67]
ds_read_b64_tr_b16 a[8:9], v4 offset:18496
v_mfma_f32_16x16x32_bf16 v[68:71], a[20:23], a[48:51], v[68:71]
ds_read_b64_tr_b16 a[10:11], v4 offset:20800
s_add_u32 m0, s30, 4096
s_waitcnt lgkmcnt(6)
v_mfma_f32_16x16x32_bf16 v[72:75], a[24:27], a[44:47], v[72:75]
ds_read_b64_tr_b16 a[12:13], v4 offset:18528
v_mfma_f32_16x16x32_bf16 v[76:79], a[24:27], a[48:51], v[76:79]
ds_read_b64_tr_b16 a[14:15], v4 offset:20832
v_mfma_f32_16x16x32_bf16 v[80:83], a[28:31], a[44:47], v[80:83]
ds_read_b64_tr_b16 a[16:17], v4 offset:18560
buffer_load_dwordx4 a[112:115], v8, s[8:11], s29 offen offset:1024
v_mfma_f32_16x16x32_bf16 v[84:87], a[28:31], a[48:51], v[84:87]
ds_read_b64_tr_b16 a[18:19], v4 offset:20864
v_mfma_f32_16x16x32_bf16 v[88:91], a[32:35], a[44:47], v[88:91]
ds_read_b64_tr_b16 a[20:21], v4 offset:18592
v_mfma_f32_16x16x32_bf16 v[92:95], a[32:35], a[48:51], v[92:95]
ds_read_b64_tr_b16 a[22:23], v4 offset:20896
buffer_load_dwordx4 v208, s[4:7], s28 offen offset:0 lds
s_waitcnt lgkmcnt(6)
v_mfma_f32_16x16x32_bf16 v[24:27], a[0:3], a[52:55], v[24:27]
ds_read_b64_tr_b16 a[24:25], v4 offset:18624
v_mfma_f32_16x16x32_bf16 v[28:31], a[0:3], a[56:59], v[28:31]
ds_read_b64_tr_b16 a[26:27], v4 offset:20928
v_mfma_f32_16x16x32_bf16 v[32:35], a[4:7], a[52:55], v[32:35]
ds_read_b64_tr_b16 a[28:29], v4 offset:18656
v_mfma_f32_16x16x32_bf16 v[36:39], a[4:7], a[56:59], v[36:39]
ds_read_b64_tr_b16 a[30:31], v4 offset:20960
buffer_load_dwordx4 v209, s[4:7], s28 offen offset:1024 lds
v_mfma_f32_16x16x32_bf16 v[40:43], a[8:11], a[52:55], v[40:43]
ds_read_b64_tr_b16 a[32:33], v4 offset:18688
v_mfma_f32_16x16x32_bf16 v[44:47], a[8:11], a[56:59], v[44:47]
ds_read_b64_tr_b16 a[34:35], v4 offset:20992
s_waitcnt lgkmcnt(6)
v_mfma_f32_16x16x32_bf16 v[48:51], a[12:15], a[52:55], v[48:51]
ds_read_b64_tr_b16 a[0:1], v4 offset:27648
buffer_load_dwordx4 a[116:119], v7, s[8:11], s29 offen offset:2048
v_mfma_f32_16x16x32_bf16 v[52:55], a[12:15], a[56:59], v[52:55]
ds_read_b64_tr_b16 a[2:3], v4 offset:29952
v_mfma_f32_16x16x32_bf16 v[56:59], a[16:19], a[52:55], v[56:59]
ds_read_b64_tr_b16 a[4:5], v4 offset:27680
v_mfma_f32_16x16x32_bf16 v[60:63], a[16:19], a[56:59], v[60:63]
ds_read_b64_tr_b16 a[6:7], v4 offset:29984
buffer_load_dwordx4 v210, s[4:7], s28 offen offset:2048 lds
v_mfma_f32_16x16x32_bf16 v[64:67], a[20:23], a[52:55], v[64:67]
ds_read_b64_tr_b16 a[8:9], v4 offset:27712
v_mfma_f32_16x16x32_bf16 v[68:71], a[20:23], a[56:59], v[68:71]
ds_read_b64_tr_b16 a[10:11], v4 offset:30016
s_waitcnt lgkmcnt(6)
v_mfma_f32_16x16x32_bf16 v[72:75], a[24:27], a[52:55], v[72:75]
ds_read_b64_tr_b16 a[12:13], v4 offset:27744
v_mfma_f32_16x16x32_bf16 v[76:79], a[24:27], a[56:59], v[76:79]
ds_read_b64_tr_b16 a[14:15], v4 offset:30048
buffer_load_dwordx4 a[120:123], v8, s[8:11], s29 offen offset:2048
v_mfma_f32_16x16x32_bf16 v[80:83], a[28:31], a[52:55], v[80:83]
ds_read_b64_tr_b16 a[16:17], v4 offset:27776
v_mfma_f32_16x16x32_bf16 v[84:87], a[28:31], a[56:59], v[84:87]
ds_read_b64_tr_b16 a[18:19], v4 offset:30080
v_mfma_f32_16x16x32_bf16 v[88:91], a[32:35], a[52:55], v[88:91]
ds_read_b64_tr_b16 a[20:21], v4 offset:27808
buffer_load_dwordx4 v211, s[4:7], s28 offen offset:3072 lds
v_mfma_f32_16x16x32_bf16 v[92:95], a[32:35], a[56:59], v[92:95]
ds_read_b64_tr_b16 a[22:23], v4 offset:30112
s_waitcnt lgkmcnt(6)
v_mfma_f32_16x16x32_bf16 v[24:27], a[0:3], a[60:63], v[24:27]
ds_read_b64_tr_b16 a[24:25], v4 offset:27840
v_mfma_f32_16x16x32_bf16 v[28:31], a[0:3], a[64:67], v[28:31]
ds_read_b64_tr_b16 a[26:27], v4 offset:30144
s_add_u32 m0, s30, 8192
v_mfma_f32_16x16x32_bf16 v[32:35], a[4:7], a[60:63], v[32:35]
ds_read_b64_tr_b16 a[28:29], v4 offset:27872
v_mfma_f32_16x16x32_bf16 v[36:39], a[4:7], a[64:67], v[36:39]
ds_read_b64_tr_b16 a[30:31], v4 offset:30176
v_mfma_f32_16x16x32_bf16 v[40:43], a[8:11], a[60:63], v[40:43]
ds_read_b64_tr_b16 a[32:33], v4 offset:27904
buffer_load_dwordx4 a[124:127], v7, s[8:11], s29 offen offset:3072
v_mfma_f32_16x16x32_bf16 v[44:47], a[8:11], a[64:67], v[44:47]
ds_read_b64_tr_b16 a[34:35], v4 offset:30208
s_waitcnt vmcnt(15) lgkmcnt(6)
s_barrier
v_mfma_f32_16x16x32_bf16 v[48:51], a[12:15], a[60:63], v[48:51]
ds_read_b64_tr_b16 a[0:1], v5 offset:0
v_mfma_f32_16x16x32_bf16 v[52:55], a[12:15], a[64:67], v[52:55]
ds_read_b64_tr_b16 a[2:3], v5 offset:2304
v_mfma_f32_16x16x32_bf16 v[56:59], a[16:19], a[60:63], v[56:59]
ds_read_b64_tr_b16 a[4:5], v5 offset:32
buffer_load_dwordx4 v212, s[4:7], s28 offen offset:0 lds
v_mfma_f32_16x16x32_bf16 v[60:63], a[16:19], a[64:67], v[60:63]
ds_read_b64_tr_b16 a[6:7], v5 offset:2336
v_mfma_f32_16x16x32_bf16 v[64:67], a[20:23], a[60:63], v[64:67]
ds_read_b64_tr_b16 a[8:9], v5 offset:64
v_mfma_f32_16x16x32_bf16 v[68:71], a[20:23], a[64:67], v[68:71]
ds_read_b64_tr_b16 a[10:11], v5 offset:2368
buffer_load_dwordx4 a[128:131], v8, s[8:11], s29 offen offset:3072
s_waitcnt lgkmcnt(6)
v_mfma_f32_16x16x32_bf16 v[72:75], a[24:27], a[60:63], v[72:75]
ds_read_b64_tr_b16 a[12:13], v5 offset:96
v_mfma_f32_16x16x32_bf16 v[76:79], a[24:27], a[64:67], v[76:79]
ds_read_b64_tr_b16 a[14:15], v5 offset:2400
v_mfma_f32_16x16x32_bf16 v[80:83], a[28:31], a[60:63], v[80:83]
ds_read_b64_tr_b16 a[16:17], v5 offset:128
s_add_u32 s28, s28, 36864
v_mfma_f32_16x16x32_bf16 v[84:87], a[28:31], a[64:67], v[84:87]
ds_read_b64_tr_b16 a[18:19], v5 offset:2432
v_mfma_f32_16x16x32_bf16 v[88:91], a[32:35], a[60:63], v[88:91]
ds_read_b64_tr_b16 a[20:21], v5 offset:160
v_mfma_f32_16x16x32_bf16 v[92:95], a[32:35], a[64:67], v[92:95]
ds_read_b64_tr_b16 a[22:23], v5 offset:2464
s_add_u32 s29, s29, 4096
s_sub_u32 s31, s31, 1
s_cmp_lg_u32 s31, 0
s_cbranch_scc1 k1_kernel_lp9569
s_waitcnt lgkmcnt(6)
v_mfma_f32_16x16x32_bf16 v[24:27], a[0:3], a[68:71], v[24:27]
ds_read_b64_tr_b16 a[24:25], v5 offset:192
v_mfma_f32_16x16x32_bf16 v[28:31], a[0:3], a[72:75], v[28:31]
ds_read_b64_tr_b16 a[26:27], v5 offset:2496
v_mfma_f32_16x16x32_bf16 v[32:35], a[4:7], a[68:71], v[32:35]
ds_read_b64_tr_b16 a[28:29], v5 offset:224
v_mfma_f32_16x16x32_bf16 v[36:39], a[4:7], a[72:75], v[36:39]
ds_read_b64_tr_b16 a[30:31], v5 offset:2528
s_add_u32 m0, s30, 36864
v_mfma_f32_16x16x32_bf16 v[40:43], a[8:11], a[68:71], v[40:43]
ds_read_b64_tr_b16 a[32:33], v5 offset:256
v_mfma_f32_16x16x32_bf16 v[44:47], a[8:11], a[72:75], v[44:47]
ds_read_b64_tr_b16 a[34:35], v5 offset:2560
s_waitcnt lgkmcnt(6)
v_mfma_f32_16x16x32_bf16 v[48:51], a[12:15], a[68:71], v[48:51]
ds_read_b64_tr_b16 a[0:1], v5 offset:9216
buffer_load_dwordx4 v204, s[4:7], s28 offen offset:0 lds
v_mfma_f32_16x16x32_bf16 v[52:55], a[12:15], a[72:75], v[52:55]
ds_read_b64_tr_b16 a[2:3], v5 offset:11520
v_mfma_f32_16x16x32_bf16 v[56:59], a[16:19], a[68:71], v[56:59]
ds_read_b64_tr_b16 a[4:5], v5 offset:9248
v_mfma_f32_16x16x32_bf16 v[60:63], a[16:19], a[72:75], v[60:63]
ds_read_b64_tr_b16 a[6:7], v5 offset:11552
buffer_load_dwordx4 a[132:135], v7, s[8:11], s29 offen offset:0
v_mfma_f32_16x16x32_bf16 v[64:67], a[20:23], a[68:71], v[64:67]
ds_read_b64_tr_b16 a[8:9], v5 offset:9280
v_mfma_f32_16x16x32_bf16 v[68:71], a[20:23], a[72:75], v[68:71]
ds_read_b64_tr_b16 a[10:11], v5 offset:11584
s_waitcnt lgkmcnt(6)
v_mfma_f32_16x16x32_bf16 v[72:75], a[24:27], a[68:71], v[72:75]
ds_read_b64_tr_b16 a[12:13], v5 offset:9312
v_mfma_f32_16x16x32_bf16 v[76:79], a[24:27], a[72:75], v[76:79]
ds_read_b64_tr_b16 a[14:15], v5 offset:11616
buffer_load_dwordx4 v205, s[4:7], s28 offen offset:1024 lds
v_mfma_f32_16x16x32_bf16 v[80:83], a[28:31], a[68:71], v[80:83]
ds_read_b64_tr_b16 a[16:17], v5 offset:9344
v_mfma_f32_16x16x32_bf16 v[84:87], a[28:31], a[72:75], v[84:87]
ds_read_b64_tr_b16 a[18:19], v5 offset:11648
v_mfma_f32_16x16x32_bf16 v[88:91], a[32:35], a[68:71], v[88:91]
ds_read_b64_tr_b16 a[20:21], v5 offset:9376
buffer_load_dwordx4 a[136:139], v8, s[8:11], s29 offen offset:0
v_mfma_f32_16x16x32_bf16 v[92:95], a[32:35], a[72:75], v[92:95]
ds_read_b64_tr_b16 a[22:23], v5 offset:11680
s_waitcnt lgkmcnt(6)
v_mfma_f32_16x16x32_bf16 v[24:27], a[0:3], a[76:79], v[24:27]
ds_read_b64_tr_b16 a[24:25], v5 offset:9408
v_mfma_f32_16x16x32_bf16 v[28:31], a[0:3], a[80:83], v[28:31]
ds_read_b64_tr_b16 a[26:27], v5 offset:11712
buffer_load_dwordx4 v206, s[4:7], s28 offen offset:2048 lds
v_mfma_f32_16x16x32_bf16 v[32:35], a[4:7], a[76:79], v[32:35]
ds_read_b64_tr_b16 a[28:29], v5 offset:9440
v_mfma_f32_16x16x32_bf16 v[36:39], a[4:7], a[80:83], v[36:39]
ds_read_b64_tr_b16 a[30:31], v5 offset:11744
v_mfma_f32_16x16x32_bf16 v[40:43], a[8:11], a[76:79], v[40:43]
ds_read_b64_tr_b16 a[32:33], v5 offset:9472
buffer_load_dwordx4 v207, s[4:7], s28 offen offset:3072 lds
v_mfma_f32_16x16x32_bf16 v[44:47], a[8:11], a[80:83], v[44:47]
ds_read_b64_tr_b16 a[34:35], v5 offset:11776
s_waitcnt lgkmcnt(6)
v_mfma_f32_16x16x32_bf16 v[48:51], a[12:15], a[76:79], v[48:51]
ds_read_b64_tr_b16 a[0:1], v5 offset:18432
v_mfma_f32_16x16x32_bf16 v[52:55], a[12:15], a[80:83], v[52:55]
ds_read_b64_tr_b16 a[2:3], v5 offset:20736
v_mfma_f32_16x16x32_bf16 v[56:59], a[16:19], a[76:79], v[56:59]
ds_read_b64_tr_b16 a[4:5], v5 offset:18464
buffer_load_dwordx4 a[140:143], v7, s[8:11], s29 offen offset:1024
v_mfma_f32_16x16x32_bf16 v[60:63], a[16:19], a[80:83], v[60:63]
ds_read_b64_tr_b16 a[6:7], v5 offset:20768
v_mfma_f32_16x16x32_bf16 v[64:67], a[20:23], a[76:79], v[64:67]
ds_read_b64_tr_b16 a[8:9], v5 offset:18496
v_mfma_f32_16x16x32_bf16 v[68:71], a[20:23], a[80:83], v[68:71]
ds_read_b64_tr_b16 a[10:11], v5 offset:20800
s_add_u32 m0, s30, 40960
s_waitcnt lgkmcnt(6)
v_mfma_f32_16x16x32_bf16 v[72:75], a[24:27], a[76:79], v[72:75]
ds_read_b64_tr_b16 a[12:13], v5 offset:18528
v_mfma_f32_16x16x32_bf16 v[76:79], a[24:27], a[80:83], v[76:79]
ds_read_b64_tr_b16 a[14:15], v5 offset:20832
v_mfma_f32_16x16x32_bf16 v[80:83], a[28:31], a[76:79], v[80:83]
ds_read_b64_tr_b16 a[16:17], v5 offset:18560
buffer_load_dwordx4 a[144:147], v8, s[8:11], s29 offen offset:1024
v_mfma_f32_16x16x32_bf16 v[84:87], a[28:31], a[80:83], v[84:87]
ds_read_b64_tr_b16 a[18:19], v5 offset:20864
v_mfma_f32_16x16x32_bf16 v[88:91], a[32:35], a[76:79], v[88:91]
ds_read_b64_tr_b16 a[20:21], v5 offset:18592
v_mfma_f32_16x16x32_bf16 v[92:95], a[32:35], a[80:83], v[92:95]
ds_read_b64_tr_b16 a[22:23], v5 offset:20896
buffer_load_dwordx4 v208, s[4:7], s28 offen offset:0 lds
s_waitcnt lgkmcnt(6)
v_mfma_f32_16x16x32_bf16 v[24:27], a[0:3], a[84:87], v[24:27]
ds_read_b64_tr_b16 a[24:25], v5 offset:18624
v_mfma_f32_16x16x32_bf16 v[28:31], a[0:3], a[88:91], v[28:31]
ds_read_b64_tr_b16 a[26:27], v5 offset:20928
v_mfma_f32_16x16x32_bf16 v[32:35], a[4:7], a[84:87], v[32:35]
ds_read_b64_tr_b16 a[28:29], v5 offset:18656
v_mfma_f32_16x16x32_bf16 v[36:39], a[4:7], a[88:91], v[36:39]
ds_read_b64_tr_b16 a[30:31], v5 offset:20960
buffer_load_dwordx4 v209, s[4:7], s28 offen offset:1024 lds
v_mfma_f32_16x16x32_bf16 v[40:43], a[8:11], a[84:87], v[40:43]
ds_read_b64_tr_b16 a[32:33], v5 offset:18688
v_mfma_f32_16x16x32_bf16 v[44:47], a[8:11], a[88:91], v[44:47]
ds_read_b64_tr_b16 a[34:35], v5 offset:20992
s_waitcnt lgkmcnt(6)
v_mfma_f32_16x16x32_bf16 v[48:51], a[12:15], a[84:87], v[48:51]
ds_read_b64_tr_b16 a[0:1], v5 offset:27648
buffer_load_dwordx4 a[148:151], v7, s[8:11], s29 offen offset:2048
v_mfma_f32_16x16x32_bf16 v[52:55], a[12:15], a[88:91], v[52:55]
ds_read_b64_tr_b16 a[2:3], v5 offset:29952
v_mfma_f32_16x16x32_bf16 v[56:59], a[16:19], a[84:87], v[56:59]
ds_read_b64_tr_b16 a[4:5], v5 offset:27680
v_mfma_f32_16x16x32_bf16 v[60:63], a[16:19], a[88:91], v[60:63]
ds_read_b64_tr_b16 a[6:7], v5 offset:29984
buffer_load_dwordx4 v210, s[4:7], s28 offen offset:2048 lds
v_mfma_f32_16x16x32_bf16 v[64:67], a[20:23], a[84:87], v[64:67]
ds_read_b64_tr_b16 a[8:9], v5 offset:27712
v_mfma_f32_16x16x32_bf16 v[68:71], a[20:23], a[88:91], v[68:71]
ds_read_b64_tr_b16 a[10:11], v5 offset:30016
s_waitcnt lgkmcnt(6)
v_mfma_f32_16x16x32_bf16 v[72:75], a[24:27], a[84:87], v[72:75]
ds_read_b64_tr_b16 a[12:13], v5 offset:27744
v_mfma_f32_16x16x32_bf16 v[76:79], a[24:27], a[88:91], v[76:79]
ds_read_b64_tr_b16 a[14:15], v5 offset:30048
buffer_load_dwordx4 a[152:155], v8, s[8:11], s29 offen offset:2048
v_mfma_f32_16x16x32_bf16 v[80:83], a[28:31], a[84:87], v[80:83]
ds_read_b64_tr_b16 a[16:17], v5 offset:27776
v_mfma_f32_16x16x32_bf16 v[84:87], a[28:31], a[88:91], v[84:87]
ds_read_b64_tr_b16 a[18:19], v5 offset:30080
v_mfma_f32_16x16x32_bf16 v[88:91], a[32:35], a[84:87], v[88:91]
ds_read_b64_tr_b16 a[20:21], v5 offset:27808
buffer_load_dwordx4 v211, s[4:7], s28 offen offset:3072 lds
v_mfma_f32_16x16x32_bf16 v[92:95], a[32:35], a[88:91], v[92:95]
ds_read_b64_tr_b16 a[22:23], v5 offset:30112
s_waitcnt lgkmcnt(6)
v_mfma_f32_16x16x32_bf16 v[24:27], a[0:3], a[92:95], v[24:27]
ds_read_b64_tr_b16 a[24:25], v5 offset:27840
v_mfma_f32_16x16x32_bf16 v[28:31], a[0:3], a[96:99], v[28:31]
ds_read_b64_tr_b16 a[26:27], v5 offset:30144
s_add_u32 m0, s30, 45056
v_mfma_f32_16x16x32_bf16 v[32:35], a[4:7], a[92:95], v[32:35]
ds_read_b64_tr_b16 a[28:29], v5 offset:27872
v_mfma_f32_16x16x32_bf16 v[36:39], a[4:7], a[96:99], v[36:39]
ds_read_b64_tr_b16 a[30:31], v5 offset:30176
v_mfma_f32_16x16x32_bf16 v[40:43], a[8:11], a[92:95], v[40:43]
ds_read_b64_tr_b16 a[32:33], v5 offset:27904
buffer_load_dwordx4 a[156:159], v7, s[8:11], s29 offen offset:3072
v_mfma_f32_16x16x32_bf16 v[44:47], a[8:11], a[96:99], v[44:47]
ds_read_b64_tr_b16 a[34:35], v5 offset:30208
s_waitcnt vmcnt(15) lgkmcnt(6)
s_barrier
v_mfma_f32_16x16x32_bf16 v[48:51], a[12:15], a[92:95], v[48:51]
ds_read_b64_tr_b16 a[0:1], v2 offset:0
v_mfma_f32_16x16x32_bf16 v[52:55], a[12:15], a[96:99], v[52:55]
ds_read_b64_tr_b16 a[2:3], v2 offset:2304
v_mfma_f32_16x16x32_bf16 v[56:59], a[16:19], a[92:95], v[56:59]
ds_read_b64_tr_b16 a[4:5], v2 offset:32
buffer_load_dwordx4 v212, s[4:7], s28 offen offset:0 lds
v_mfma_f32_16x16x32_bf16 v[60:63], a[16:19], a[96:99], v[60:63]
ds_read_b64_tr_b16 a[6:7], v2 offset:2336
v_mfma_f32_16x16x32_bf16 v[64:67], a[20:23], a[92:95], v[64:67]
ds_read_b64_tr_b16 a[8:9], v2 offset:64
v_mfma_f32_16x16x32_bf16 v[68:71], a[20:23], a[96:99], v[68:71]
ds_read_b64_tr_b16 a[10:11], v2 offset:2368
buffer_load_dwordx4 a[160:163], v8, s[8:11], s29 offen offset:3072
s_waitcnt lgkmcnt(6)
v_mfma_f32_16x16x32_bf16 v[72:75], a[24:27], a[92:95], v[72:75]
ds_read_b64_tr_b16 a[12:13], v2 offset:96
v_mfma_f32_16x16x32_bf16 v[76:79], a[24:27], a[96:99], v[76:79]
ds_read_b64_tr_b16 a[14:15], v2 offset:2400
v_mfma_f32_16x16x32_bf16 v[80:83], a[28:31], a[92:95], v[80:83]
ds_read_b64_tr_b16 a[16:17], v2 offset:128
s_add_u32 s28, s28, 36864
v_mfma_f32_16x16x32_bf16 v[84:87], a[28:31], a[96:99], v[84:87]
ds_read_b64_tr_b16 a[18:19], v2 offset:2432
v_mfma_f32_16x16x32_bf16 v[88:91], a[32:35], a[92:95], v[88:91]
ds_read_b64_tr_b16 a[20:21], v2 offset:160
v_mfma_f32_16x16x32_bf16 v[92:95], a[32:35], a[96:99], v[92:95]
ds_read_b64_tr_b16 a[22:23], v2 offset:2464
s_add_u32 s29, s29, 4096
buffer_load_dword v11, v10, s[48:51], 0 offen
s_waitcnt lgkmcnt(6)
v_mfma_f32_16x16x32_bf16 v[24:27], a[0:3], a[100:103], v[24:27]
ds_read_b64_tr_b16 a[24:25], v2 offset:192
v_mfma_f32_16x16x32_bf16 v[28:31], a[0:3], a[104:107], v[28:31]
ds_read_b64_tr_b16 a[26:27], v2 offset:2496
v_mfma_f32_16x16x32_bf16 v[32:35], a[4:7], a[100:103], v[32:35]
ds_read_b64_tr_b16 a[28:29], v2 offset:224
v_mfma_f32_16x16x32_bf16 v[36:39], a[4:7], a[104:107], v[36:39]
ds_read_b64_tr_b16 a[30:31], v2 offset:2528
v_mfma_f32_16x16x32_bf16 v[40:43], a[8:11], a[100:103], v[40:43]
ds_read_b64_tr_b16 a[32:33], v2 offset:256
v_mfma_f32_16x16x32_bf16 v[44:47], a[8:11], a[104:107], v[44:47]
ds_read_b64_tr_b16 a[34:35], v2 offset:2560
s_add_u32 m0, s30, 73728
s_waitcnt lgkmcnt(6)
v_mfma_f32_16x16x32_bf16 v[48:51], a[12:15], a[100:103], v[48:51]
ds_read_b64_tr_b16 a[0:1], v2 offset:9216
v_mfma_f32_16x16x32_bf16 v[52:55], a[12:15], a[104:107], v[52:55]
ds_read_b64_tr_b16 a[2:3], v2 offset:11520
v_mfma_f32_16x16x32_bf16 v[56:59], a[16:19], a[100:103], v[56:59]
ds_read_b64_tr_b16 a[4:5], v2 offset:9248
v_mfma_f32_16x16x32_bf16 v[60:63], a[16:19], a[104:107], v[60:63]
ds_read_b64_tr_b16 a[6:7], v2 offset:11552
v_mfma_f32_16x16x32_bf16 v[64:67], a[20:23], a[100:103], v[64:67]
ds_read_b64_tr_b16 a[8:9], v2 offset:9280
v_mfma_f32_16x16x32_bf16 v[68:71], a[20:23], a[104:107], v[68:71]
ds_read_b64_tr_b16 a[10:11], v2 offset:11584
buffer_load_dwordx4 v108, s[48:51], s40 offen offset:0 lds
s_waitcnt lgkmcnt(6)
v_mfma_f32_16x16x32_bf16 v[72:75], a[24:27], a[100:103], v[72:75]
ds_read_b64_tr_b16 a[12:13], v2 offset:9312
v_mfma_f32_16x16x32_bf16 v[76:79], a[24:27], a[104:107], v[76:79]
ds_read_b64_tr_b16 a[14:15], v2 offset:11616
v_mfma_f32_16x16x32_bf16 v[80:83], a[28:31], a[100:103], v[80:83]
ds_read_b64_tr_b16 a[16:17], v2 offset:9344
v_mfma_f32_16x16x32_bf16 v[84:87], a[28:31], a[104:107], v[84:87]
ds_read_b64_tr_b16 a[18:19], v2 offset:11648
v_mfma_f32_16x16x32_bf16 v[88:91], a[32:35], a[100:103], v[88:91]
ds_read_b64_tr_b16 a[20:21], v2 offset:9376
buffer_load_dwordx4 v109, s[48:51], s40 offen offset:1024 lds
v_mfma_f32_16x16x32_bf16 v[92:95], a[32:35], a[104:107], v[92:95]
ds_read_b64_tr_b16 a[22:23], v2 offset:11680
s_waitcnt lgkmcnt(6)
v_mfma_f32_16x16x32_bf16 v[24:27], a[0:3], a[108:111], v[24:27]
ds_read_b64_tr_b16 a[24:25], v2 offset:9408
v_mfma_f32_16x16x32_bf16 v[28:31], a[0:3], a[112:115], v[28:31]
ds_read_b64_tr_b16 a[26:27], v2 offset:11712
v_mfma_f32_16x16x32_bf16 v[32:35], a[4:7], a[108:111], v[32:35]
ds_read_b64_tr_b16 a[28:29], v2 offset:9440
v_mfma_f32_16x16x32_bf16 v[36:39], a[4:7], a[112:115], v[36:39]
ds_read_b64_tr_b16 a[30:31], v2 offset:11744
v_mfma_f32_16x16x32_bf16 v[40:43], a[8:11], a[108:111], v[40:43]
ds_read_b64_tr_b16 a[32:33], v2 offset:9472
buffer_load_dwordx4 v110, s[48:51], s40 offen offset:2048 lds
v_mfma_f32_16x16x32_bf16 v[44:47], a[8:11], a[112:115], v[44:47]
ds_read_b64_tr_b16 a[34:35], v2 offset:11776
s_waitcnt lgkmcnt(6)
v_mfma_f32_16x16x32_bf16 v[48:51], a[12:15], a[108:111], v[48:51]
ds_read_b64_tr_b16 a[0:1], v2 offset:18432
v_mfma_f32_16x16x32_bf16 v[52:55], a[12:15], a[112:115], v[52:55]
ds_read_b64_tr_b16 a[2:3], v2 offset:20736
v_mfma_f32_16x16x32_bf16 v[56:59], a[16:19], a[108:111], v[56:59]
ds_read_b64_tr_b16 a[4:5], v2 offset:18464
v_mfma_f32_16x16x32_bf16 v[60:63], a[16:19], a[112:115], v[60:63]
ds_read_b64_tr_b16 a[6:7], v2 offset:20768
buffer_load_dwordx4 v111, s[48:51], s40 offen offset:3072 lds
v_mfma_f32_16x16x32_bf16 v[64:67], a[20:23], a[108:111], v[64:67]
ds_read_b64_tr_b16 a[8:9], v2 offset:18496
v_mfma_f32_16x16x32_bf16 v[68:71], a[20:23], a[112:115], v[68:71]
ds_read_b64_tr_b16 a[10:11], v2 offset:20800
s_waitcnt lgkmcnt(6)
v_mfma_f32_16x16x32_bf16 v[72:75], a[24:27], a[108:111], v[72:75]
ds_read_b64_tr_b16 a[12:13], v2 offset:18528
v_mfma_f32_16x16x32_bf16 v[76:79], a[24:27], a[112:115], v[76:79]
ds_read_b64_tr_b16 a[14:15], v2 offset:20832
v_mfma_f32_16x16x32_bf16 v[80:83], a[28:31], a[108:111], v[80:83]
ds_read_b64_tr_b16 a[16:17], v2 offset:18560
v_mfma_f32_16x16x32_bf16 v[84:87], a[28:31], a[112:115], v[84:87]
ds_read_b64_tr_b16 a[18:19], v2 offset:20864
s_add_u32 m0, s30, 77824
v_mfma_f32_16x16x32_bf16 v[88:91], a[32:35], a[108:111], v[88:91]
ds_read_b64_tr_b16 a[20:21], v2 offset:18592
v_mfma_f32_16x16x32_bf16 v[92:95], a[32:35], a[112:115], v[92:95]
ds_read_b64_tr_b16 a[22:23], v2 offset:20896
s_waitcnt lgkmcnt(6)
v_mfma_f32_16x16x32_bf16 v[24:27], a[0:3], a[116:119], v[24:27]
ds_read_b64_tr_b16 a[24:25], v2 offset:18624
v_mfma_f32_16x16x32_bf16 v[28:31], a[0:3], a[120:123], v[28:31]
ds_read_b64_tr_b16 a[26:27], v2 offset:20928
v_mfma_f32_16x16x32_bf16 v[32:35], a[4:7], a[116:119], v[32:35]
ds_read_b64_tr_b16 a[28:29], v2 offset:18656
buffer_load_dwordx4 v112, s[48:51], s40 offen offset:0 lds
v_mfma_f32_16x16x32_bf16 v[36:39], a[4:7], a[120:123], v[36:39]
ds_read_b64_tr_b16 a[30:31], v2 offset:20960
v_mfma_f32_16x16x32_bf16 v[40:43], a[8:11], a[116:119], v[40:43]
ds_read_b64_tr_b16 a[32:33], v2 offset:18688
v_mfma_f32_16x16x32_bf16 v[44:47], a[8:11], a[120:123], v[44:47]
ds_read_b64_tr_b16 a[34:35], v2 offset:20992
s_waitcnt lgkmcnt(6)
v_mfma_f32_16x16x32_bf16 v[48:51], a[12:15], a[116:119], v[48:51]
ds_read_b64_tr_b16 a[0:1], v2 offset:27648
v_mfma_f32_16x16x32_bf16 v[52:55], a[12:15], a[120:123], v[52:55]
ds_read_b64_tr_b16 a[2:3], v2 offset:29952
v_mfma_f32_16x16x32_bf16 v[56:59], a[16:19], a[116:119], v[56:59]
ds_read_b64_tr_b16 a[4:5], v2 offset:27680
buffer_load_dwordx4 v113, s[48:51], s40 offen offset:1024 lds
v_mfma_f32_16x16x32_bf16 v[60:63], a[16:19], a[120:123], v[60:63]
ds_read_b64_tr_b16 a[6:7], v2 offset:29984
v_mfma_f32_16x16x32_bf16 v[64:67], a[20:23], a[116:119], v[64:67]
ds_read_b64_tr_b16 a[8:9], v2 offset:27712
v_mfma_f32_16x16x32_bf16 v[68:71], a[20:23], a[120:123], v[68:71]
ds_read_b64_tr_b16 a[10:11], v2 offset:30016
s_waitcnt lgkmcnt(6)
v_mfma_f32_16x16x32_bf16 v[72:75], a[24:27], a[116:119], v[72:75]
ds_read_b64_tr_b16 a[12:13], v2 offset:27744
v_mfma_f32_16x16x32_bf16 v[76:79], a[24:27], a[120:123], v[76:79]
ds_read_b64_tr_b16 a[14:15], v2 offset:30048
buffer_load_dwordx4 v114, s[48:51], s40 offen offset:2048 lds
v_mfma_f32_16x16x32_bf16 v[80:83], a[28:31], a[116:119], v[80:83]
ds_read_b64_tr_b16 a[16:17], v2 offset:27776
v_mfma_f32_16x16x32_bf16 v[84:87], a[28:31], a[120:123], v[84:87]
ds_read_b64_tr_b16 a[18:19], v2 offset:30080
v_mfma_f32_16x16x32_bf16 v[88:91], a[32:35], a[116:119], v[88:91]
ds_read_b64_tr_b16 a[20:21], v2 offset:27808
v_mfma_f32_16x16x32_bf16 v[92:95], a[32:35], a[120:123], v[92:95]
ds_read_b64_tr_b16 a[22:23], v2 offset:30112
s_waitcnt lgkmcnt(6)
v_mfma_f32_16x16x32_bf16 v[24:27], a[0:3], a[124:127], v[24:27]
ds_read_b64_tr_b16 a[24:25], v2 offset:27840
v_mfma_f32_16x16x32_bf16 v[28:31], a[0:3], a[128:131], v[28:31]
ds_read_b64_tr_b16 a[26:27], v2 offset:30144
buffer_load_dwordx4 v115, s[48:51], s40 offen offset:3072 lds
v_mfma_f32_16x16x32_bf16 v[32:35], a[4:7], a[124:127], v[32:35]
ds_read_b64_tr_b16 a[28:29], v2 offset:27872
v_mfma_f32_16x16x32_bf16 v[36:39], a[4:7], a[128:131], v[36:39]
ds_read_b64_tr_b16 a[30:31], v2 offset:30176
v_mfma_f32_16x16x32_bf16 v[40:43], a[8:11], a[124:127], v[40:43]
ds_read_b64_tr_b16 a[32:33], v2 offset:27904
v_mfma_f32_16x16x32_bf16 v[44:47], a[8:11], a[128:131], v[44:47]
ds_read_b64_tr_b16 a[34:35], v2 offset:30208
s_waitcnt vmcnt(9) lgkmcnt(6)
s_barrier
v_mfma_f32_16x16x32_bf16 v[48:51], a[12:15], a[124:127], v[48:51]
ds_read_b64_tr_b16 a[0:1], v3 offset:0
s_add_u32 m0, s30, 81920
v_mfma_f32_16x16x32_bf16 v[52:55], a[12:15], a[128:131], v[52:55]
ds_read_b64_tr_b16 a[2:3], v3 offset:2304
v_mfma_f32_16x16x32_bf16 v[56:59], a[16:19], a[124:127], v[56:59]
ds_read_b64_tr_b16 a[4:5], v3 offset:32
v_mfma_f32_16x16x32_bf16 v[60:63], a[16:19], a[128:131], v[60:63]
ds_read_b64_tr_b16 a[6:7], v3 offset:2336
v_mfma_f32_16x16x32_bf16 v[64:67], a[20:23], a[124:127], v[64:67]
ds_read_b64_tr_b16 a[8:9], v3 offset:64
v_mfma_f32_16x16x32_bf16 v[68:71], a[20:23], a[128:131], v[68:71]
ds_read_b64_tr_b16 a[10:11], v3 offset:2368
s_waitcnt lgkmcnt(6)
v_mfma_f32_16x16x32_bf16 v[72:75], a[24:27], a[124:127], v[72:75]
ds_read_b64_tr_b16 a[12:13], v3 offset:96
buffer_load_dwordx4 v116, s[48:51], s40 offen offset:0 lds
v_mfma_f32_16x16x32_bf16 v[76:79], a[24:27], a[128:131], v[76:79]
ds_read_b64_tr_b16 a[14:15], v3 offset:2400
v_mfma_f32_16x16x32_bf16 v[80:83], a[28:31], a[124:127], v[80:83]
ds_read_b64_tr_b16 a[16:17], v3 offset:128
v_mfma_f32_16x16x32_bf16 v[84:87], a[28:31], a[128:131], v[84:87]
ds_read_b64_tr_b16 a[18:19], v3 offset:2432
v_mfma_f32_16x16x32_bf16 v[88:91], a[32:35], a[124:127], v[88:91]
ds_read_b64_tr_b16 a[20:21], v3 offset:160
v_mfma_f32_16x16x32_bf16 v[92:95], a[32:35], a[128:131], v[92:95]
ds_read_b64_tr_b16 a[22:23], v3 offset:2464
s_add_u32 s40, s40, 147456
s_waitcnt lgkmcnt(6)
v_mfma_f32_16x16x32_bf16 v[24:27], a[0:3], a[132:135], v[24:27]
ds_read_b64_tr_b16 a[24:25], v3 offset:192
v_mfma_f32_16x16x32_bf16 v[28:31], a[0:3], a[136:139], v[28:31]
ds_read_b64_tr_b16 a[26:27], v3 offset:2496
v_mfma_f32_16x16x32_bf16 v[32:35], a[4:7], a[132:135], v[32:35]
ds_read_b64_tr_b16 a[28:29], v3 offset:224
v_mfma_f32_16x16x32_bf16 v[36:39], a[4:7], a[136:139], v[36:39]
ds_read_b64_tr_b16 a[30:31], v3 offset:2528
v_mfma_f32_16x16x32_bf16 v[40:43], a[8:11], a[132:135], v[40:43]
ds_read_b64_tr_b16 a[32:33], v3 offset:256
v_mfma_f32_16x16x32_bf16 v[44:47], a[8:11], a[136:139], v[44:47]
ds_read_b64_tr_b16 a[34:35], v3 offset:2560
s_add_u32 m0, s30, 110592
s_waitcnt lgkmcnt(6)
v_mfma_f32_16x16x32_bf16 v[48:51], a[12:15], a[132:135], v[48:51]
ds_read_b64_tr_b16 a[0:1], v3 offset:9216
v_mfma_f32_16x16x32_bf16 v[52:55], a[12:15], a[136:139], v[52:55]
ds_read_b64_tr_b16 a[2:3], v3 offset:11520
v_mfma_f32_16x16x32_bf16 v[56:59], a[16:19], a[132:135], v[56:59]
ds_read_b64_tr_b16 a[4:5], v3 offset:9248
v_mfma_f32_16x16x32_bf16 v[60:63], a[16:19], a[136:139], v[60:63]
ds_read_b64_tr_b16 a[6:7], v3 offset:11552
v_mfma_f32_16x16x32_bf16 v[64:67], a[20:23], a[132:135], v[64:67]
ds_read_b64_tr_b16 a[8:9], v3 offset:9280
v_mfma_f32_16x16x32_bf16 v[68:71], a[20:23], a[136:139], v[68:71]
ds_read_b64_tr_b16 a[10:11], v3 offset:11584
buffer_load_dwordx4 v108, s[48:51], s40 offen offset:0 lds
s_waitcnt lgkmcnt(6)
v_mfma_f32_16x16x32_bf16 v[72:75], a[24:27], a[132:135], v[72:75]
ds_read_b64_tr_b16 a[12:13], v3 offset:9312
v_mfma_f32_16x16x32_bf16 v[76:79], a[24:27], a[136:139], v[76:79]
ds_read_b64_tr_b16 a[14:15], v3 offset:11616
v_mfma_f32_16x16x32_bf16 v[80:83], a[28:31], a[132:135], v[80:83]
ds_read_b64_tr_b16 a[16:17], v3 offset:9344
v_mfma_f32_16x16x32_bf16 v[84:87], a[28:31], a[136:139], v[84:87]
ds_read_b64_tr_b16 a[18:19], v3 offset:11648
v_mfma_f32_16x16x32_bf16 v[88:91], a[32:35], a[132:135], v[88:91]
ds_read_b64_tr_b16 a[20:21], v3 offset:9376
buffer_load_dwordx4 v109, s[48:51], s40 offen offset:1024 lds
v_mfma_f32_16x16x32_bf16 v[92:95], a[32:35], a[136:139], v[92:95]
ds_read_b64_tr_b16 a[22:23], v3 offset:11680
s_waitcnt lgkmcnt(6)
v_mfma_f32_16x16x32_bf16 v[24:27], a[0:3], a[140:143], v[24:27]
ds_read_b64_tr_b16 a[24:25], v3 offset:9408
v_mfma_f32_16x16x32_bf16 v[28:31], a[0:3], a[144:147], v[28:31]
ds_read_b64_tr_b16 a[26:27], v3 offset:11712
v_mfma_f32_16x16x32_bf16 v[32:35], a[4:7], a[140:143], v[32:35]
ds_read_b64_tr_b16 a[28:29], v3 offset:9440
v_mfma_f32_16x16x32_bf16 v[36:39], a[4:7], a[144:147], v[36:39]
ds_read_b64_tr_b16 a[30:31], v3 offset:11744
v_mfma_f32_16x16x32_bf16 v[40:43], a[8:11], a[140:143], v[40:43]
ds_read_b64_tr_b16 a[32:33], v3 offset:9472
buffer_load_dwordx4 v110, s[48:51], s40 offen offset:2048 lds
v_mfma_f32_16x16x32_bf16 v[44:47], a[8:11], a[144:147], v[44:47]
ds_read_b64_tr_b16 a[34:35], v3 offset:11776
s_waitcnt lgkmcnt(6)
v_mfma_f32_16x16x32_bf16 v[48:51], a[12:15], a[140:143], v[48:51]
ds_read_b64_tr_b16 a[0:1], v3 offset:18432
v_mfma_f32_16x16x32_bf16 v[52:55], a[12:15], a[144:147], v[52:55]
ds_read_b64_tr_b16 a[2:3], v3 offset:20736
v_mfma_f32_16x16x32_bf16 v[56:59], a[16:19], a[140:143], v[56:59]
ds_read_b64_tr_b16 a[4:5], v3 offset:18464
v_mfma_f32_16x16x32_bf16 v[60:63], a[16:19], a[144:147], v[60:63]
ds_read_b64_tr_b16 a[6:7], v3 offset:20768
buffer_load_dwordx4 v111, s[48:51], s40 offen offset:3072 lds
v_mfma_f32_16x16x32_bf16 v[64:67], a[20:23], a[140:143], v[64:67]
ds_read_b64_tr_b16 a[8:9], v3 offset:18496
v_mfma_f32_16x16x32_bf16 v[68:71], a[20:23], a[144:147], v[68:71]
ds_read_b64_tr_b16 a[10:11], v3 offset:20800
s_waitcnt lgkmcnt(6)
v_mfma_f32_16x16x32_bf16 v[72:75], a[24:27], a[140:143], v[72:75]
ds_read_b64_tr_b16 a[12:13], v3 offset:18528
v_mfma_f32_16x16x32_bf16 v[76:79], a[24:27], a[144:147], v[76:79]
ds_read_b64_tr_b16 a[14:15], v3 offset:20832
v_mfma_f32_16x16x32_bf16 v[80:83], a[28:31], a[140:143], v[80:83]
ds_read_b64_tr_b16 a[16:17], v3 offset:18560
v_mfma_f32_16x16x32_bf16 v[84:87], a[28:31], a[144:147], v[84:87]
ds_read_b64_tr_b16 a[18:19], v3 offset:20864
s_add_u32 m0, s30, 114688
v_mfma_f32_16x16x32_bf16 v[88:91], a[32:35], a[140:143], v[88:91]
ds_read_b64_tr_b16 a[20:21], v3 offset:18592
v_mfma_f32_16x16x32_bf16 v[92:95], a[32:35], a[144:147], v[92:95]
ds_read_b64_tr_b16 a[22:23], v3 offset:20896
s_waitcnt lgkmcnt(6)
v_mfma_f32_16x16x32_bf16 v[24:27], a[0:3], a[148:151], v[24:27]
ds_read_b64_tr_b16 a[24:25], v3 offset:18624
v_mfma_f32_16x16x32_bf16 v[28:31], a[0:3], a[152:155], v[28:31]
ds_read_b64_tr_b16 a[26:27], v3 offset:20928
v_mfma_f32_16x16x32_bf16 v[32:35], a[4:7], a[148:151], v[32:35]
ds_read_b64_tr_b16 a[28:29], v3 offset:18656
buffer_load_dwordx4 v112, s[48:51], s40 offen offset:0 lds
v_mfma_f32_16x16x32_bf16 v[36:39], a[4:7], a[152:155], v[36:39]
ds_read_b64_tr_b16 a[30:31], v3 offset:20960
v_mfma_f32_16x16x32_bf16 v[40:43], a[8:11], a[148:151], v[40:43]
ds_read_b64_tr_b16 a[32:33], v3 offset:18688
v_mfma_f32_16x16x32_bf16 v[44:47], a[8:11], a[152:155], v[44:47]
ds_read_b64_tr_b16 a[34:35], v3 offset:20992
s_waitcnt lgkmcnt(6)
v_mfma_f32_16x16x32_bf16 v[48:51], a[12:15], a[148:151], v[48:51]
ds_read_b64_tr_b16 a[0:1], v3 offset:27648
v_mfma_f32_16x16x32_bf16 v[52:55], a[12:15], a[152:155], v[52:55]
ds_read_b64_tr_b16 a[2:3], v3 offset:29952
v_mfma_f32_16x16x32_bf16 v[56:59], a[16:19], a[148:151], v[56:59]
ds_read_b64_tr_b16 a[4:5], v3 offset:27680
buffer_load_dwordx4 v113, s[48:51], s40 offen offset:1024 lds
v_mfma_f32_16x16x32_bf16 v[60:63], a[16:19], a[152:155], v[60:63]
ds_read_b64_tr_b16 a[6:7], v3 offset:29984
v_mfma_f32_16x16x32_bf16 v[64:67], a[20:23], a[148:151], v[64:67]
ds_read_b64_tr_b16 a[8:9], v3 offset:27712
v_mfma_f32_16x16x32_bf16 v[68:71], a[20:23], a[152:155], v[68:71]
ds_read_b64_tr_b16 a[10:11], v3 offset:30016
s_waitcnt lgkmcnt(6)
v_mfma_f32_16x16x32_bf16 v[72:75], a[24:27], a[148:151], v[72:75]
ds_read_b64_tr_b16 a[12:13], v3 offset:27744
v_mfma_f32_16x16x32_bf16 v[76:79], a[24:27], a[152:155], v[76:79]
ds_read_b64_tr_b16 a[14:15], v3 offset:30048
buffer_load_dwordx4 v114, s[48:51], s40 offen offset:2048 lds
v_mfma_f32_16x16x32_bf16 v[80:83], a[28:31], a[148:151], v[80:83]
ds_read_b64_tr_b16 a[16:17], v3 offset:27776
v_mfma_f32_16x16x32_bf16 v[84:87], a[28:31], a[152:155], v[84:87]
ds_read_b64_tr_b16 a[18:19], v3 offset:30080
v_mfma_f32_16x16x32_bf16 v[88:91], a[32:35], a[148:151], v[88:91]
ds_read_b64_tr_b16 a[20:21], v3 offset:27808
v_mfma_f32_16x16x32_bf16 v[92:95], a[32:35], a[152:155], v[92:95]
ds_read_b64_tr_b16 a[22:23], v3 offset:30112
s_waitcnt lgkmcnt(6)
v_mfma_f32_16x16x32_bf16 v[24:27], a[0:3], a[156:159], v[24:27]
ds_read_b64_tr_b16 a[24:25], v3 offset:27840
v_mfma_f32_16x16x32_bf16 v[28:31], a[0:3], a[160:163], v[28:31]
ds_read_b64_tr_b16 a[26:27], v3 offset:30144
buffer_load_dwordx4 v115, s[48:51], s40 offen offset:3072 lds
v_mfma_f32_16x16x32_bf16 v[32:35], a[4:7], a[156:159], v[32:35]
ds_read_b64_tr_b16 a[28:29], v3 offset:27872
v_mfma_f32_16x16x32_bf16 v[36:39], a[4:7], a[160:163], v[36:39]
ds_read_b64_tr_b16 a[30:31], v3 offset:30176
v_mfma_f32_16x16x32_bf16 v[40:43], a[8:11], a[156:159], v[40:43]
ds_read_b64_tr_b16 a[32:33], v3 offset:27904
v_mfma_f32_16x16x32_bf16 v[44:47], a[8:11], a[160:163], v[44:47]
ds_read_b64_tr_b16 a[34:35], v3 offset:30208
s_waitcnt lgkmcnt(6)
v_mfma_f32_16x16x32_bf16 v[48:51], a[12:15], a[156:159], v[48:51]
s_add_u32 m0, s30, 118784
v_mfma_f32_16x16x32_bf16 v[52:55], a[12:15], a[160:163], v[52:55]
v_mfma_f32_16x16x32_bf16 v[56:59], a[16:19], a[156:159], v[56:59]
v_mfma_f32_16x16x32_bf16 v[60:63], a[16:19], a[160:163], v[60:63]
v_mfma_f32_16x16x32_bf16 v[64:67], a[20:23], a[156:159], v[64:67]
v_mfma_f32_16x16x32_bf16 v[68:71], a[20:23], a[160:163], v[68:71]
s_waitcnt lgkmcnt(0)
v_mfma_f32_16x16x32_bf16 v[72:75], a[24:27], a[156:159], v[72:75]
buffer_load_dwordx4 v116, s[48:51], s40 offen offset:0 lds
v_mfma_f32_16x16x32_bf16 v[76:79], a[24:27], a[160:163], v[76:79]
v_mfma_f32_16x16x32_bf16 v[80:83], a[28:31], a[156:159], v[80:83]
v_mfma_f32_16x16x32_bf16 v[84:87], a[28:31], a[160:163], v[84:87]
v_mfma_f32_16x16x32_bf16 v[88:91], a[32:35], a[156:159], v[88:91]
v_mfma_f32_16x16x32_bf16 v[92:95], a[32:35], a[160:163], v[92:95]
s_add_u32 s40, s40, 147456
v_lshlrev_b32 v22, 16, v252
v_lshlrev_b32 v23, 16, v253
v_add_f32 v24, v24, v22
v_lshlrev_b32 v17, 16, v216
v_mul_f32 v24, v24, v17
v_add_f32 v25, v25, v22
v_and_b32 v17, 0xffff0000, v216
v_mul_f32 v25, v25, v17
v_add_f32 v26, v26, v22
v_lshlrev_b32 v17, 16, v217
v_mul_f32 v26, v26, v17
v_add_f32 v27, v27, v22
v_and_b32 v17, 0xffff0000, v217
v_mul_f32 v27, v27, v17
v_add_f32 v32, v32, v22
v_lshlrev_b32 v17, 16, v220
v_mul_f32 v32, v32, v17
v_add_f32 v33, v33, v22
v_and_b32 v17, 0xffff0000, v220
v_mul_f32 v33, v33, v17
v_add_f32 v34, v34, v22
v_lshlrev_b32 v17, 16, v221
v_mul_f32 v34, v34, v17
v_add_f32 v35, v35, v22
v_and_b32 v17, 0xffff0000, v221
v_mul_f32 v35, v35, v17
v_cvt_pk_bf16_f32 v96, v24, v25
v_cvt_pk_bf16_f32 v97, v26, v27
v_cvt_pk_bf16_f32 v98, v32, v33
v_cvt_pk_bf16_f32 v99, v34, v35
s_nop 0
v_permlane16_swap_b32 v96, v98
v_permlane16_swap_b32 v97, v99
buffer_store_dwordx4 v[96:99], v14, s[16:19], s35 offen offset:0 sc0 sc1
v_add_f32 v28, v28, v23
v_lshlrev_b32 v17, 16, v218
v_mul_f32 v28, v28, v17
v_add_f32 v29, v29, v23
v_and_b32 v17, 0xffff0000, v218
v_mul_f32 v29, v29, v17
v_add_f32 v30, v30, v23
v_lshlrev_b32 v17, 16, v219
v_mul_f32 v30, v30, v17
v_add_f32 v31, v31, v23
v_and_b32 v17, 0xffff0000, v219
v_mul_f32 v31, v31, v17
v_add_f32 v36, v36, v23
v_lshlrev_b32 v17, 16, v222
v_mul_f32 v36, v36, v17
v_add_f32 v37, v37, v23
v_and_b32 v17, 0xffff0000, v222
v_mul_f32 v37, v37, v17
v_add_f32 v38, v38, v23
v_lshlrev_b32 v17, 16, v223
v_mul_f32 v38, v38, v17
v_add_f32 v39, v39, v23
v_and_b32 v17, 0xffff0000, v223
v_mul_f32 v39, v39, v17
v_cvt_pk_bf16_f32 v100, v28, v29
v_cvt_pk_bf16_f32 v101, v30, v31
v_cvt_pk_bf16_f32 v102, v36, v37
v_cvt_pk_bf16_f32 v103, v38, v39
s_nop 0
v_permlane16_swap_b32 v100, v102
v_permlane16_swap_b32 v101, v103
buffer_store_dwordx4 v[100:103], v15, s[16:19], s35 offen offset:0 sc0 sc1
v_add_f32 v40, v40, v22
v_lshlrev_b32 v17, 16, v224
v_mul_f32 v40, v40, v17
v_add_f32 v41, v41, v22
v_and_b32 v17, 0xffff0000, v224
v_mul_f32 v41, v41, v17
v_add_f32 v42, v42, v22
v_lshlrev_b32 v17, 16, v225
v_mul_f32 v42, v42, v17
v_add_f32 v43, v43, v22
v_and_b32 v17, 0xffff0000, v225
v_mul_f32 v43, v43, v17
v_add_f32 v48, v48, v22
v_lshlrev_b32 v17, 16, v228
v_mul_f32 v48, v48, v17
v_add_f32 v49, v49, v22
v_and_b32 v17, 0xffff0000, v228
v_mul_f32 v49, v49, v17
v_add_f32 v50, v50, v22
v_lshlrev_b32 v17, 16, v229
v_mul_f32 v50, v50, v17
v_add_f32 v51, v51, v22
v_and_b32 v17, 0xffff0000, v229
v_mul_f32 v51, v51, v17
v_cvt_pk_bf16_f32 v104, v40, v41
v_cvt_pk_bf16_f32 v105, v42, v43
v_cvt_pk_bf16_f32 v106, v48, v49
v_cvt_pk_bf16_f32 v107, v50, v51
s_nop 0
v_permlane16_swap_b32 v104, v106
v_permlane16_swap_b32 v105, v107
buffer_store_dwordx4 v[104:107], v14, s[16:19], s35 offen offset:1024 sc0 sc1
v_add_f32 v44, v44, v23
v_lshlrev_b32 v17, 16, v226
v_mul_f32 v44, v44, v17
v_add_f32 v45, v45, v23
v_and_b32 v17, 0xffff0000, v226
v_mul_f32 v45, v45, v17
v_add_f32 v46, v46, v23
v_lshlrev_b32 v17, 16, v227
v_mul_f32 v46, v46, v17
v_add_f32 v47, v47, v23
v_and_b32 v17, 0xffff0000, v227
v_mul_f32 v47, v47, v17
v_add_f32 v52, v52, v23
v_lshlrev_b32 v17, 16, v230
v_mul_f32 v52, v52, v17
v_add_f32 v53, v53, v23
v_and_b32 v17, 0xffff0000, v230
v_mul_f32 v53, v53, v17
v_add_f32 v54, v54, v23
v_lshlrev_b32 v17, 16, v231
v_mul_f32 v54, v54, v17
v_add_f32 v55, v55, v23
v_and_b32 v17, 0xffff0000, v231
v_mul_f32 v55, v55, v17
v_cvt_pk_bf16_f32 v96, v44, v45
v_cvt_pk_bf16_f32 v97, v46, v47
v_cvt_pk_bf16_f32 v98, v52, v53
v_cvt_pk_bf16_f32 v99, v54, v55
s_nop 0
v_permlane16_swap_b32 v96, v98
v_permlane16_swap_b32 v97, v99
buffer_store_dwordx4 v[96:99], v15, s[16:19], s35 offen offset:1024 sc0 sc1
v_add_f32 v56, v56, v22
v_lshlrev_b32 v17, 16, v232
v_mul_f32 v56, v56, v17
v_add_f32 v57, v57, v22
v_and_b32 v17, 0xffff0000, v232
v_mul_f32 v57, v57, v17
v_add_f32 v58, v58, v22
v_lshlrev_b32 v17, 16, v233
v_mul_f32 v58, v58, v17
v_add_f32 v59, v59, v22
v_and_b32 v17, 0xffff0000, v233
v_mul_f32 v59, v59, v17
v_add_f32 v64, v64, v22
v_lshlrev_b32 v17, 16, v236
v_mul_f32 v64, v64, v17
v_add_f32 v65, v65, v22
v_and_b32 v17, 0xffff0000, v236
v_mul_f32 v65, v65, v17
v_add_f32 v66, v66, v22
v_lshlrev_b32 v17, 16, v237
v_mul_f32 v66, v66, v17
v_add_f32 v67, v67, v22
v_and_b32 v17, 0xffff0000, v237
v_mul_f32 v67, v67, v17
v_cvt_pk_bf16_f32 v100, v56, v57
v_cvt_pk_bf16_f32 v101, v58, v59
v_cvt_pk_bf16_f32 v102, v64, v65
v_cvt_pk_bf16_f32 v103, v66, v67
s_nop 0
v_permlane16_swap_b32 v100, v102
v_permlane16_swap_b32 v101, v103
buffer_store_dwordx4 v[100:103], v14, s[16:19], s35 offen offset:2048 sc0 sc1
v_add_f32 v60, v60, v23
v_lshlrev_b32 v17, 16, v234
v_mul_f32 v60, v60, v17
v_add_f32 v61, v61, v23
v_and_b32 v17, 0xffff0000, v234
v_mul_f32 v61, v61, v17
v_add_f32 v62, v62, v23
v_lshlrev_b32 v17, 16, v235
v_mul_f32 v62, v62, v17
v_add_f32 v63, v63, v23
v_and_b32 v17, 0xffff0000, v235
v_mul_f32 v63, v63, v17
v_add_f32 v68, v68, v23
v_lshlrev_b32 v17, 16, v238
v_mul_f32 v68, v68, v17
v_add_f32 v69, v69, v23
v_and_b32 v17, 0xffff0000, v238
v_mul_f32 v69, v69, v17
v_add_f32 v70, v70, v23
v_lshlrev_b32 v17, 16, v239
v_mul_f32 v70, v70, v17
v_add_f32 v71, v71, v23
v_and_b32 v17, 0xffff0000, v239
v_mul_f32 v71, v71, v17
v_cvt_pk_bf16_f32 v104, v60, v61
v_cvt_pk_bf16_f32 v105, v62, v63
v_cvt_pk_bf16_f32 v106, v68, v69
v_cvt_pk_bf16_f32 v107, v70, v71
s_nop 0
v_permlane16_swap_b32 v104, v106
v_permlane16_swap_b32 v105, v107
buffer_store_dwordx4 v[104:107], v15, s[16:19], s35 offen offset:2048 sc0 sc1
v_add_f32 v72, v72, v22
v_lshlrev_b32 v17, 16, v240
v_mul_f32 v72, v72, v17
v_add_f32 v73, v73, v22
v_and_b32 v17, 0xffff0000, v240
v_mul_f32 v73, v73, v17
v_add_f32 v74, v74, v22
v_lshlrev_b32 v17, 16, v241
v_mul_f32 v74, v74, v17
v_add_f32 v75, v75, v22
v_and_b32 v17, 0xffff0000, v241
v_mul_f32 v75, v75, v17
v_add_f32 v80, v80, v22
v_lshlrev_b32 v17, 16, v244
v_mul_f32 v80, v80, v17
v_add_f32 v81, v81, v22
v_and_b32 v17, 0xffff0000, v244
v_mul_f32 v81, v81, v17
v_add_f32 v82, v82, v22
v_lshlrev_b32 v17, 16, v245
v_mul_f32 v82, v82, v17
v_add_f32 v83, v83, v22
v_and_b32 v17, 0xffff0000, v245
v_mul_f32 v83, v83, v17
v_cvt_pk_bf16_f32 v96, v72, v73
v_cvt_pk_bf16_f32 v97, v74, v75
v_cvt_pk_bf16_f32 v98, v80, v81
v_cvt_pk_bf16_f32 v99, v82, v83
s_nop 0
v_permlane16_swap_b32 v96, v98
v_permlane16_swap_b32 v97, v99
buffer_store_dwordx4 v[96:99], v14, s[16:19], s35 offen offset:3072 sc0 sc1
v_add_f32 v76, v76, v23
v_lshlrev_b32 v17, 16, v242
v_mul_f32 v76, v76, v17
v_add_f32 v77, v77, v23
v_and_b32 v17, 0xffff0000, v242
v_mul_f32 v77, v77, v17
v_add_f32 v78, v78, v23
v_lshlrev_b32 v17, 16, v243
v_mul_f32 v78, v78, v17
v_add_f32 v79, v79, v23
v_and_b32 v17, 0xffff0000, v243
v_mul_f32 v79, v79, v17
v_add_f32 v84, v84, v23
v_lshlrev_b32 v17, 16, v246
v_mul_f32 v84, v84, v17
v_add_f32 v85, v85, v23
v_and_b32 v17, 0xffff0000, v246
v_mul_f32 v85, v85, v17
v_add_f32 v86, v86, v23
v_lshlrev_b32 v17, 16, v247
v_mul_f32 v86, v86, v17
v_add_f32 v87, v87, v23
v_and_b32 v17, 0xffff0000, v247
v_mul_f32 v87, v87, v17
v_cvt_pk_bf16_f32 v100, v76, v77
v_cvt_pk_bf16_f32 v101, v78, v79
v_cvt_pk_bf16_f32 v102, v84, v85
v_cvt_pk_bf16_f32 v103, v86, v87
s_nop 0
v_permlane16_swap_b32 v100, v102
v_permlane16_swap_b32 v101, v103
buffer_store_dwordx4 v[100:103], v15, s[16:19], s35 offen offset:3072 sc0 sc1
v_add_f32 v88, v88, v22
v_lshlrev_b32 v17, 16, v248
v_mul_f32 v88, v88, v17
v_add_f32 v89, v89, v22
v_and_b32 v17, 0xffff0000, v248
v_mul_f32 v89, v89, v17
v_add_f32 v90, v90, v22
v_lshlrev_b32 v17, 16, v249
v_mul_f32 v90, v90, v17
v_add_f32 v91, v91, v22
v_and_b32 v17, 0xffff0000, v249
v_mul_f32 v91, v91, v17
v_add_f32 v92, v92, v23
v_lshlrev_b32 v17, 16, v250
v_mul_f32 v92, v92, v17
v_add_f32 v93, v93, v23
v_and_b32 v17, 0xffff0000, v250
v_mul_f32 v93, v93, v17
v_add_f32 v94, v94, v23
v_lshlrev_b32 v17, 16, v251
v_mul_f32 v94, v94, v17
v_add_f32 v95, v95, v23
v_and_b32 v17, 0xffff0000, v251
v_mul_f32 v95, v95, v17
v_cvt_pk_bf16_f32 v104, v88, v89
v_cvt_pk_bf16_f32 v105, v90, v91
v_cvt_pk_bf16_f32 v106, v92, v93
v_cvt_pk_bf16_f32 v107, v94, v95
s_nop 0
v_permlane16_swap_b32 v104, v106
v_permlane16_swap_b32 v105, v107
buffer_store_dwordx4 v[104:107], v16, s[16:19], s35 offen offset:0 sc0 sc1
v_and_b32 v17, 1, v12
v_lshrrev_b32 v18, 1, v12
v_lshl_add_u32 v14, v17, 1, v18
v_mul_u32_u24 v14, 256, v14
v_mul_u32_u24 v19, 16, v13
v_add_u32 v14, v14, v19
v_add_u32 v15, 18432, v14
v_add_u32 v18, 16, v18
v_mul_u32_u24 v18, 256, v18
v_mul_u32_u24 v17, 18432, v17
v_add3_u32 v16, v17, v18, v19
s_mov_b32 s8, s16
s_mov_b32 s9, s17
s_mov_b32 s10, s18
v_add_u32 v8, 73728, v7
s_mul_i32 s29, s34, 147456
s_mul_i32 s3, s41, 18432
s_add_u32 s29, s29, s3
s_add_u32 s12, s12, 16777216
s_addc_u32 s13, s13, 0
s_mov_b32 s14, 9437184
s_mul_i32 s35, s34, 36864
s_mul_i32 s3, s41, 2359296
s_add_u32 s35, s35, s3
s_mul_i32 s3, s42, 4608
s_add_u32 s35, s35, s3
s_and_b32 s27, s36, -4
s_lshl_b32 s3, s36, 7
s_add_u32 s3, s3, 393216
s_lshl_b32 s38, s27, 7
s_add_u32 s38, s38, 393216
v_and_b32 v21, 3, v1
v_lshlrev_b32 v21, 7, v21
v_mov_b32 v9, 0
s_waitcnt vmcnt(0)
buffer_store_dword v9, v9, s[88:91], s3 offen sc0 sc1
s_barrier
s_add_u32 m0, s30, 0
s_nop 0
buffer_load_dwordx4 v108, s[48:51], s40 offen offset:0 lds
buffer_load_dwordx4 v109, s[48:51], s40 offen offset:1024 lds
buffer_load_dwordx4 v110, s[48:51], s40 offen offset:2048 lds
buffer_load_dwordx4 v111, s[48:51], s40 offen offset:3072 lds
s_add_u32 m0, s30, 4096
s_nop 0
buffer_load_dwordx4 v112, s[48:51], s40 offen offset:0 lds
buffer_load_dwordx4 v113, s[48:51], s40 offen offset:1024 lds
buffer_load_dwordx4 v114, s[48:51], s40 offen offset:2048 lds
buffer_load_dwordx4 v115, s[48:51], s40 offen offset:3072 lds
s_add_u32 m0, s30, 8192
s_nop 0
buffer_load_dwordx4 v116, s[48:51], s40 offen offset:0 lds
s_add_u32 s40, s40, 147456
k3_p3:
buffer_load_dword v6, v21, s[88:91], s38 offen sc0 sc1
s_waitcnt vmcnt(0)
v_cmp_eq_u32 vcc, -1, v6
s_nop 0
s_cbranch_vccnz k3_p3
buffer_load_dwordx4 a[36:39], v7, s[8:11], s29 offen offset:0
buffer_load_dwordx4 a[40:43], v8, s[8:11], s29 offen offset:0
buffer_load_dwordx4 a[44:47], v7, s[8:11], s29 offen offset:1024
buffer_load_dwordx4 a[48:51], v8, s[8:11], s29 offen offset:1024
buffer_load_dwordx4 a[52:55], v7, s[8:11], s29 offen offset:2048
buffer_load_dwordx4 a[56:59], v8, s[8:11], s29 offen offset:2048
buffer_load_dwordx4 a[60:63], v7, s[8:11], s29 offen offset:3072
buffer_load_dwordx4 a[64:67], v8, s[8:11], s29 offen offset:3072
s_add_u32 s29, s29, 4096
buffer_load_dwordx4 a[68:71], v7, s[8:11], s29 offen offset:0
buffer_load_dwordx4 a[72:75], v8, s[8:11], s29 offen offset:0
buffer_load_dwordx4 a[76:79], v7, s[8:11], s29 offen offset:1024
buffer_load_dwordx4 a[80:83], v8, s[8:11], s29 offen offset:1024
buffer_load_dwordx4 a[84:87], v7, s[8:11], s29 offen offset:2048
buffer_load_dwordx4 a[88:91], v8, s[8:11], s29 offen offset:2048
buffer_load_dwordx4 a[92:95], v7, s[8:11], s29 offen offset:3072
buffer_load_dwordx4 a[96:99], v8, s[8:11], s29 offen offset:3072
s_add_u32 s29, s29, 4096
s_waitcnt vmcnt(8)
s_barrier
ds_read_b64_tr_b16 a[0:1], v4 offset:0
ds_read_b64_tr_b16 a[2:3], v4 offset:2304
ds_read_b64_tr_b16 a[4:5], v4 offset:32
ds_read_b64_tr_b16 a[6:7], v4 offset:2336
ds_read_b64_tr_b16 a[8:9], v4 offset:64
ds_read_b64_tr_b16 a[10:11], v4 offset:2368
ds_read_b64_tr_b16 a[12:13], v4 offset:96
ds_read_b64_tr_b16 a[14:15], v4 offset:2400
ds_read_b64_tr_b16 a[16:17], v4 offset:128
ds_read_b64_tr_b16 a[18:19], v4 offset:2432
ds_read_b64_tr_b16 a[20:21], v4 offset:160
ds_read_b64_tr_b16 a[22:23], v4 offset:2464
s_waitcnt lgkmcnt(6)
v_mfma_f32_16x16x32_bf16 v[24:27], a[0:3], a[36:39], 0
ds_read_b64_tr_b16 a[24:25], v4 offset:192
v_mfma_f32_16x16x32_bf16 v[28:31], a[0:3], a[40:43], 0
ds_read_b64_tr_b16 a[26:27], v4 offset:2496
v_mfma_f32_16x16x32_bf16 v[32:35], a[4:7], a[36:39], 0
ds_read_b64_tr_b16 a[28:29], v4 offset:224
v_mfma_f32_16x16x32_bf16 v[36:39], a[4:7], a[40:43], 0
ds_read_b64_tr_b16 a[30:31], v4 offset:2528
v_mfma_f32_16x16x32_bf16 v[40:43], a[8:11], a[36:39], 0
ds_read_b64_tr_b16 a[32:33], v4 offset:256
v_mfma_f32_16x16x32_bf16 v[44:47], a[8:11], a[40:43], 0
ds_read_b64_tr_b16 a[34:35], v4 offset:2560
s_waitcnt lgkmcnt(6)
v_mfma_f32_16x16x32_bf16 v[48:51], a[12:15], a[36:39], 0
ds_read_b64_tr_b16 a[0:1], v4 offset:9216
v_mfma_f32_16x16x32_bf16 v[52:55], a[12:15], a[40:43], 0
ds_read_b64_tr_b16 a[2:3], v4 offset:11520
buffer_load_dwordx4 a[100:103], v7, s[8:11], s29 offen offset:0
v_mfma_f32_16x16x32_bf16 v[56:59], a[16:19], a[36:39], 0
ds_read_b64_tr_b16 a[4:5], v4 offset:9248
v_mfma_f32_16x16x32_bf16 v[60:63], a[16:19], a[40:43], 0
ds_read_b64_tr_b16 a[6:7], v4 offset:11552
v_mfma_f32_16x16x32_bf16 v[64:67], a[20:23], a[36:39], 0
ds_read_b64_tr_b16 a[8:9], v4 offset:9280
v_mfma_f32_16x16x32_bf16 v[68:71], a[20:23], a[40:43], 0
ds_read_b64_tr_b16 a[10:11], v4 offset:11584
s_waitcnt lgkmcnt(6)
v_mfma_f32_16x16x32_bf16 v[72:75], a[24:27], a[36:39], 0
ds_read_b64_tr_b16 a[12:13], v4 offset:9312
v_mfma_f32_16x16x32_bf16 v[76:79], a[24:27], a[40:43], 0
ds_read_b64_tr_b16 a[14:15], v4 offset:11616
v_mfma_f32_16x16x32_bf16 v[80:83], a[28:31], a[36:39], 0
ds_read_b64_tr_b16 a[16:17], v4 offset:9344
v_mfma_f32_16x16x32_bf16 v[84:87], a[28:31], a[40:43], 0
ds_read_b64_tr_b16 a[18:19], v4 offset:11648
buffer_load_dwordx4 a[104:107], v8, s[8:11], s29 offen offset:0
v_mfma_f32_16x16x32_bf16 v[88:91], a[32:35], a[36:39], 0
ds_read_b64_tr_b16 a[20:21], v4 offset:9376
v_mfma_f32_16x16x32_bf16 v[92:95], a[32:35], a[40:43], 0
ds_read_b64_tr_b16 a[22:23], v4 offset:11680
s_waitcnt lgkmcnt(6)
v_mfma_f32_16x16x32_bf16 v[24:27], a[0:3], a[44:47], v[24:27]
ds_read_b64_tr_b16 a[24:25], v4 offset:9408
v_mfma_f32_16x16x32_bf16 v[28:31], a[0:3], a[48:51], v[28:31]
ds_read_b64_tr_b16 a[26:27], v4 offset:11712
v_mfma_f32_16x16x32_bf16 v[32:35], a[4:7], a[44:47], v[32:35]
ds_read_b64_tr_b16 a[28:29], v4 offset:9440
v_mfma_f32_16x16x32_bf16 v[36:39], a[4:7], a[48:51], v[36:39]
ds_read_b64_tr_b16 a[30:31], v4 offset:11744
v_mfma_f32_16x16x32_bf16 v[40:43], a[8:11], a[44:47], v[40:43]
ds_read_b64_tr_b16 a[32:33], v4 offset:9472
v_mfma_f32_16x16x32_bf16 v[44:47], a[8:11], a[48:51], v[44:47]
ds_read_b64_tr_b16 a[34:35], v4 offset:11776
buffer_load_dwordx4 a[108:111], v7, s[8:11], s29 offen offset:1024
s_waitcnt lgkmcnt(6)
v_mfma_f32_16x16x32_bf16 v[48:51], a[12:15], a[44:47], v[48:51]
ds_read_b64_tr_b16 a[0:1], v4 offset:18432
v_mfma_f32_16x16x32_bf16 v[52:55], a[12:15], a[48:51], v[52:55]
ds_read_b64_tr_b16 a[2:3], v4 offset:20736
v_mfma_f32_16x16x32_bf16 v[56:59], a[16:19], a[44:47], v[56:59]
ds_read_b64_tr_b16 a[4:5], v4 offset:18464
v_mfma_f32_16x16x32_bf16 v[60:63], a[16:19], a[48:51], v[60:63]
ds_read_b64_tr_b16 a[6:7], v4 offset:20768
v_mfma_f32_16x16x32_bf16 v[64:67], a[20:23], a[44:47], v[64:67]
ds_read_b64_tr_b16 a[8:9], v4 offset:18496
v_mfma_f32_16x16x32_bf16 v[68:71], a[20:23], a[48:51], v[68:71]
ds_read_b64_tr_b16 a[10:11], v4 offset:20800
s_waitcnt lgkmcnt(6)
v_mfma_f32_16x16x32_bf16 v[72:75], a[24:27], a[44:47], v[72:75]
ds_read_b64_tr_b16 a[12:13], v4 offset:18528
v_mfma_f32_16x16x32_bf16 v[76:79], a[24:27], a[48:51], v[76:79]
ds_read_b64_tr_b16 a[14:15], v4 offset:20832
buffer_load_dwordx4 a[112:115], v8, s[8:11], s29 offen offset:1024
v_mfma_f32_16x16x32_bf16 v[80:83], a[28:31], a[44:47], v[80:83]
ds_read_b64_tr_b16 a[16:17], v4 offset:18560
v_mfma_f32_16x16x32_bf16 v[84:87], a[28:31], a[48:51], v[84:87]
ds_read_b64_tr_b16 a[18:19], v4 offset:20864
v_mfma_f32_16x16x32_bf16 v[88:91], a[32:35], a[44:47], v[88:91]
ds_read_b64_tr_b16 a[20:21], v4 offset:18592
v_mfma_f32_16x16x32_bf16 v[92:95], a[32:35], a[48:51], v[92:95]
ds_read_b64_tr_b16 a[22:23], v4 offset:20896
s_waitcnt lgkmcnt(6)
v_mfma_f32_16x16x32_bf16 v[24:27], a[0:3], a[52:55], v[24:27]
ds_read_b64_tr_b16 a[24:25], v4 offset:18624
v_mfma_f32_16x16x32_bf16 v[28:31], a[0:3], a[56:59], v[28:31]
ds_read_b64_tr_b16 a[26:27], v4 offset:20928
v_mfma_f32_16x16x32_bf16 v[32:35], a[4:7], a[52:55], v[32:35]
ds_read_b64_tr_b16 a[28:29], v4 offset:18656
v_mfma_f32_16x16x32_bf16 v[36:39], a[4:7], a[56:59], v[36:39]
ds_read_b64_tr_b16 a[30:31], v4 offset:20960
buffer_load_dwordx4 a[116:119], v7, s[8:11], s29 offen offset:2048
v_mfma_f32_16x16x32_bf16 v[40:43], a[8:11], a[52:55], v[40:43]
ds_read_b64_tr_b16 a[32:33], v4 offset:18688
v_mfma_f32_16x16x32_bf16 v[44:47], a[8:11], a[56:59], v[44:47]
ds_read_b64_tr_b16 a[34:35], v4 offset:20992
s_waitcnt lgkmcnt(6)
v_mfma_f32_16x16x32_bf16 v[48:51], a[12:15], a[52:55], v[48:51]
ds_read_b64_tr_b16 a[0:1], v4 offset:27648
v_mfma_f32_16x16x32_bf16 v[52:55], a[12:15], a[56:59], v[52:55]
ds_read_b64_tr_b16 a[2:3], v4 offset:29952
v_mfma_f32_16x16x32_bf16 v[56:59], a[16:19], a[52:55], v[56:59]
ds_read_b64_tr_b16 a[4:5], v4 offset:27680
v_mfma_f32_16x16x32_bf16 v[60:63], a[16:19], a[56:59], v[60:63]
ds_read_b64_tr_b16 a[6:7], v4 offset:29984
v_mfma_f32_16x16x32_bf16 v[64:67], a[20:23], a[52:55], v[64:67]
ds_read_b64_tr_b16 a[8:9], v4 offset:27712
v_mfma_f32_16x16x32_bf16 v[68:71], a[20:23], a[56:59], v[68:71]
ds_read_b64_tr_b16 a[10:11], v4 offset:30016
buffer_load_dwordx4 a[120:123], v8, s[8:11], s29 offen offset:2048
s_waitcnt lgkmcnt(6)
v_mfma_f32_16x16x32_bf16 v[72:75], a[24:27], a[52:55], v[72:75]
ds_read_b64_tr_b16 a[12:13], v4 offset:27744
v_mfma_f32_16x16x32_bf16 v[76:79], a[24:27], a[56:59], v[76:79]
ds_read_b64_tr_b16 a[14:15], v4 offset:30048
v_mfma_f32_16x16x32_bf16 v[80:83], a[28:31], a[52:55], v[80:83]
ds_read_b64_tr_b16 a[16:17], v4 offset:27776
v_mfma_f32_16x16x32_bf16 v[84:87], a[28:31], a[56:59], v[84:87]
ds_read_b64_tr_b16 a[18:19], v4 offset:30080
v_mfma_f32_16x16x32_bf16 v[88:91], a[32:35], a[52:55], v[88:91]
ds_read_b64_tr_b16 a[20:21], v4 offset:27808
v_mfma_f32_16x16x32_bf16 v[92:95], a[32:35], a[56:59], v[92:95]
ds_read_b64_tr_b16 a[22:23], v4 offset:30112
s_waitcnt lgkmcnt(6)
v_mfma_f32_16x16x32_bf16 v[24:27], a[0:3], a[60:63], v[24:27]
ds_read_b64_tr_b16 a[24:25], v4 offset:27840
v_mfma_f32_16x16x32_bf16 v[28:31], a[0:3], a[64:67], v[28:31]
ds_read_b64_tr_b16 a[26:27], v4 offset:30144
buffer_load_dwordx4 a[124:127], v7, s[8:11], s29 offen offset:3072
v_mfma_f32_16x16x32_bf16 v[32:35], a[4:7], a[60:63], v[32:35]
ds_read_b64_tr_b16 a[28:29], v4 offset:27872
v_mfma_f32_16x16x32_bf16 v[36:39], a[4:7], a[64:67], v[36:39]
ds_read_b64_tr_b16 a[30:31], v4 offset:30176
v_mfma_f32_16x16x32_bf16 v[40:43], a[8:11], a[60:63], v[40:43]
ds_read_b64_tr_b16 a[32:33], v4 offset:27904
v_mfma_f32_16x16x32_bf16 v[44:47], a[8:11], a[64:67], v[44:47]
ds_read_b64_tr_b16 a[34:35], v4 offset:30208
s_waitcnt vmcnt(7) lgkmcnt(6)
s_barrier
v_mfma_f32_16x16x32_bf16 v[48:51], a[12:15], a[60:63], v[48:51]
ds_read_b64_tr_b16 a[0:1], v5 offset:0
v_mfma_f32_16x16x32_bf16 v[52:55], a[12:15], a[64:67], v[52:55]
ds_read_b64_tr_b16 a[2:3], v5 offset:2304
v_mfma_f32_16x16x32_bf16 v[56:59], a[16:19], a[60:63], v[56:59]
ds_read_b64_tr_b16 a[4:5], v5 offset:32
v_mfma_f32_16x16x32_bf16 v[60:63], a[16:19], a[64:67], v[60:63]
ds_read_b64_tr_b16 a[6:7], v5 offset:2336
buffer_load_dwordx4 a[128:131], v8, s[8:11], s29 offen offset:3072
v_mfma_f32_16x16x32_bf16 v[64:67], a[20:23], a[60:63], v[64:67]
ds_read_b64_tr_b16 a[8:9], v5 offset:64
v_mfma_f32_16x16x32_bf16 v[68:71], a[20:23], a[64:67], v[68:71]
ds_read_b64_tr_b16 a[10:11], v5 offset:2368
s_waitcnt lgkmcnt(6)
v_mfma_f32_16x16x32_bf16 v[72:75], a[24:27], a[60:63], v[72:75]
ds_read_b64_tr_b16 a[12:13], v5 offset:96
v_mfma_f32_16x16x32_bf16 v[76:79], a[24:27], a[64:67], v[76:79]
ds_read_b64_tr_b16 a[14:15], v5 offset:2400
v_mfma_f32_16x16x32_bf16 v[80:83], a[28:31], a[60:63], v[80:83]
ds_read_b64_tr_b16 a[16:17], v5 offset:128
v_mfma_f32_16x16x32_bf16 v[84:87], a[28:31], a[64:67], v[84:87]
ds_read_b64_tr_b16 a[18:19], v5 offset:2432
v_mfma_f32_16x16x32_bf16 v[88:91], a[32:35], a[60:63], v[88:91]
ds_read_b64_tr_b16 a[20:21], v5 offset:160
v_mfma_f32_16x16x32_bf16 v[92:95], a[32:35], a[64:67], v[92:95]
ds_read_b64_tr_b16 a[22:23], v5 offset:2464
s_add_u32 s29, s29, 4096
s_waitcnt lgkmcnt(6)
v_mfma_f32_16x16x32_bf16 v[24:27], a[0:3], a[68:71], v[24:27]
ds_read_b64_tr_b16 a[24:25], v5 offset:192
v_mfma_f32_16x16x32_bf16 v[28:31], a[0:3], a[72:75], v[28:31]
ds_read_b64_tr_b16 a[26:27], v5 offset:2496
v_mfma_f32_16x16x32_bf16 v[32:35], a[4:7], a[68:71], v[32:35]
ds_read_b64_tr_b16 a[28:29], v5 offset:224
v_mfma_f32_16x16x32_bf16 v[36:39], a[4:7], a[72:75], v[36:39]
ds_read_b64_tr_b16 a[30:31], v5 offset:2528
s_add_u32 m0, s30, 36864
v_mfma_f32_16x16x32_bf16 v[40:43], a[8:11], a[68:71], v[40:43]
ds_read_b64_tr_b16 a[32:33], v5 offset:256
v_mfma_f32_16x16x32_bf16 v[44:47], a[8:11], a[72:75], v[44:47]
ds_read_b64_tr_b16 a[34:35], v5 offset:2560
s_waitcnt lgkmcnt(6)
v_mfma_f32_16x16x32_bf16 v[48:51], a[12:15], a[68:71], v[48:51]
ds_read_b64_tr_b16 a[0:1], v5 offset:9216
buffer_load_dwordx4 v108, s[48:51], s40 offen offset:0 lds
v_mfma_f32_16x16x32_bf16 v[52:55], a[12:15], a[72:75], v[52:55]
ds_read_b64_tr_b16 a[2:3], v5 offset:11520
v_mfma_f32_16x16x32_bf16 v[56:59], a[16:19], a[68:71], v[56:59]
ds_read_b64_tr_b16 a[4:5], v5 offset:9248
v_mfma_f32_16x16x32_bf16 v[60:63], a[16:19], a[72:75], v[60:63]
ds_read_b64_tr_b16 a[6:7], v5 offset:11552
buffer_load_dwordx4 a[132:135], v7, s[8:11], s29 offen offset:0
v_mfma_f32_16x16x32_bf16 v[64:67], a[20:23], a[68:71], v[64:67]
ds_read_b64_tr_b16 a[8:9], v5 offset:9280
v_mfma_f32_16x16x32_bf16 v[68:71], a[20:23], a[72:75], v[68:71]
ds_read_b64_tr_b16 a[10:11], v5 offset:11584
s_waitcnt lgkmcnt(6)
v_mfma_f32_16x16x32_bf16 v[72:75], a[24:27], a[68:71], v[72:75]
ds_read_b64_tr_b16 a[12:13], v5 offset:9312
v_mfma_f32_16x16x32_bf16 v[76:79], a[24:27], a[72:75], v[76:79]
ds_read_b64_tr_b16 a[14:15], v5 offset:11616
buffer_load_dwordx4 v109, s[48:51], s40 offen offset:1024 lds
v_mfma_f32_16x16x32_bf16 v[80:83], a[28:31], a[68:71], v[80:83]
ds_read_b64_tr_b16 a[16:17], v5 offset:9344
v_mfma_f32_16x16x32_bf16 v[84:87], a[28:31], a[72:75], v[84:87]
ds_read_b64_tr_b16 a[18:19], v5 offset:11648
v_mfma_f32_16x16x32_bf16 v[88:91], a[32:35], a[68:71], v[88:91]
ds_read_b64_tr_b16 a[20:21], v5 offset:9376
buffer_load_dwordx4 a[136:139], v8, s[8:11], s29 offen offset:0
v_mfma_f32_16x16x32_bf16 v[92:95], a[32:35], a[72:75], v[92:95]
ds_read_b64_tr_b16 a[22:23], v5 offset:11680
s_waitcnt lgkmcnt(6)
v_mfma_f32_16x16x32_bf16 v[24:27], a[0:3], a[76:79], v[24:27]
ds_read_b64_tr_b16 a[24:25], v5 offset:9408
v_mfma_f32_16x16x32_bf16 v[28:31], a[0:3], a[80:83], v[28:31]
ds_read_b64_tr_b16 a[26:27], v5 offset:11712
buffer_load_dwordx4 v110, s[48:51], s40 offen offset:2048 lds
v_mfma_f32_16x16x32_bf16 v[32:35], a[4:7], a[76:79], v[32:35]
ds_read_b64_tr_b16 a[28:29], v5 offset:9440
v_mfma_f32_16x16x32_bf16 v[36:39], a[4:7], a[80:83], v[36:39]
ds_read_b64_tr_b16 a[30:31], v5 offset:11744
v_mfma_f32_16x16x32_bf16 v[40:43], a[8:11], a[76:79], v[40:43]
ds_read_b64_tr_b16 a[32:33], v5 offset:9472
buffer_load_dwordx4 v111, s[48:51], s40 offen offset:3072 lds
v_mfma_f32_16x16x32_bf16 v[44:47], a[8:11], a[80:83], v[44:47]
ds_read_b64_tr_b16 a[34:35], v5 offset:11776
s_waitcnt lgkmcnt(6)
v_mfma_f32_16x16x32_bf16 v[48:51], a[12:15], a[76:79], v[48:51]
ds_read_b64_tr_b16 a[0:1], v5 offset:18432
v_mfma_f32_16x16x32_bf16 v[52:55], a[12:15], a[80:83], v[52:55]
ds_read_b64_tr_b16 a[2:3], v5 offset:20736
v_mfma_f32_16x16x32_bf16 v[56:59], a[16:19], a[76:79], v[56:59]
ds_read_b64_tr_b16 a[4:5], v5 offset:18464
buffer_load_dwordx4 a[140:143], v7, s[8:11], s29 offen offset:1024
v_mfma_f32_16x16x32_bf16 v[60:63], a[16:19], a[80:83], v[60:63]
ds_read_b64_tr_b16 a[6:7], v5 offset:20768
v_mfma_f32_16x16x32_bf16 v[64:67], a[20:23], a[76:79], v[64:67]
ds_read_b64_tr_b16 a[8:9], v5 offset:18496
v_mfma_f32_16x16x32_bf16 v[68:71], a[20:23], a[80:83], v[68:71]
ds_read_b64_tr_b16 a[10:11], v5 offset:20800
s_add_u32 m0, s30, 40960
s_waitcnt lgkmcnt(6)
v_mfma_f32_16x16x32_bf16 v[72:75], a[24:27], a[76:79], v[72:75]
ds_read_b64_tr_b16 a[12:13], v5 offset:18528
v_mfma_f32_16x16x32_bf16 v[76:79], a[24:27], a[80:83], v[76:79]
ds_read_b64_tr_b16 a[14:15], v5 offset:20832
v_mfma_f32_16x16x32_bf16 v[80:83], a[28:31], a[76:79], v[80:83]
ds_read_b64_tr_b16 a[16:17], v5 offset:18560
buffer_load_dwordx4 a[144:147], v8, s[8:11], s29 offen offset:1024
v_mfma_f32_16x16x32_bf16 v[84:87], a[28:31], a[80:83], v[84:87]
ds_read_b64_tr_b16 a[18:19], v5 offset:20864
v_mfma_f32_16x16x32_bf16 v[88:91], a[32:35], a[76:79], v[88:91]
ds_read_b64_tr_b16 a[20:21], v5 offset:18592
v_mfma_f32_16x16x32_bf16 v[92:95], a[32:35], a[80:83], v[92:95]
ds_read_b64_tr_b16 a[22:23], v5 offset:20896
buffer_load_dwordx4 v112, s[48:51], s40 offen offset:0 lds
s_waitcnt lgkmcnt(6)
v_mfma_f32_16x16x32_bf16 v[24:27], a[0:3], a[84:87], v[24:27]
ds_read_b64_tr_b16 a[24:25], v5 offset:18624
v_mfma_f32_16x16x32_bf16 v[28:31], a[0:3], a[88:91], v[28:31]
ds_read_b64_tr_b16 a[26:27], v5 offset:20928
v_mfma_f32_16x16x32_bf16 v[32:35], a[4:7], a[84:87], v[32:35]
ds_read_b64_tr_b16 a[28:29], v5 offset:18656
v_mfma_f32_16x16x32_bf16 v[36:39], a[4:7], a[88:91], v[36:39]
ds_read_b64_tr_b16 a[30:31], v5 offset:20960
buffer_load_dwordx4 v113, s[48:51], s40 offen offset:1024 lds
v_mfma_f32_16x16x32_bf16 v[40:43], a[8:11], a[84:87], v[40:43]
ds_read_b64_tr_b16 a[32:33], v5 offset:18688
v_mfma_f32_16x16x32_bf16 v[44:47], a[8:11], a[88:91], v[44:47]
ds_read_b64_tr_b16 a[34:35], v5 offset:20992
s_waitcnt lgkmcnt(6)
v_mfma_f32_16x16x32_bf16 v[48:51], a[12:15], a[84:87], v[48:51]
ds_read_b64_tr_b16 a[0:1], v5 offset:27648
buffer_load_dwordx4 a[148:151], v7, s[8:11], s29 offen offset:2048
v_mfma_f32_16x16x32_bf16 v[52:55], a[12:15], a[88:91], v[52:55]
ds_read_b64_tr_b16 a[2:3], v5 offset:29952
v_mfma_f32_16x16x32_bf16 v[56:59], a[16:19], a[84:87], v[56:59]
ds_read_b64_tr_b16 a[4:5], v5 offset:27680
v_mfma_f32_16x16x32_bf16 v[60:63], a[16:19], a[88:91], v[60:63]
ds_read_b64_tr_b16 a[6:7], v5 offset:29984
buffer_load_dwordx4 v114, s[48:51], s40 offen offset:2048 lds
v_mfma_f32_16x16x32_bf16 v[64:67], a[20:23], a[84:87], v[64:67]
ds_read_b64_tr_b16 a[8:9], v5 offset:27712
v_mfma_f32_16x16x32_bf16 v[68:71], a[20:23], a[88:91], v[68:71]
ds_read_b64_tr_b16 a[10:11], v5 offset:30016
s_waitcnt lgkmcnt(6)
v_mfma_f32_16x16x32_bf16 v[72:75], a[24:27], a[84:87], v[72:75]
ds_read_b64_tr_b16 a[12:13], v5 offset:27744
v_mfma_f32_16x16x32_bf16 v[76:79], a[24:27], a[88:91], v[76:79]
ds_read_b64_tr_b16 a[14:15], v5 offset:30048
buffer_load_dwordx4 a[152:155], v8, s[8:11], s29 offen offset:2048
v_mfma_f32_16x16x32_bf16 v[80:83], a[28:31], a[84:87], v[80:83]
ds_read_b64_tr_b16 a[16:17], v5 offset:27776
v_mfma_f32_16x16x32_bf16 v[84:87], a[28:31], a[88:91], v[84:87]
ds_read_b64_tr_b16 a[18:19], v5 offset:30080
v_mfma_f32_16x16x32_bf16 v[88:91], a[32:35], a[84:87], v[88:91]
ds_read_b64_tr_b16 a[20:21], v5 offset:27808
buffer_load_dwordx4 v115, s[48:51], s40 offen offset:3072 lds
v_mfma_f32_16x16x32_bf16 v[92:95], a[32:35], a[88:91], v[92:95]
ds_read_b64_tr_b16 a[22:23], v5 offset:30112
s_waitcnt lgkmcnt(6)
v_mfma_f32_16x16x32_bf16 v[24:27], a[0:3], a[92:95], v[24:27]
ds_read_b64_tr_b16 a[24:25], v5 offset:27840
v_mfma_f32_16x16x32_bf16 v[28:31], a[0:3], a[96:99], v[28:31]
ds_read_b64_tr_b16 a[26:27], v5 offset:30144
s_add_u32 m0, s30, 45056
v_mfma_f32_16x16x32_bf16 v[32:35], a[4:7], a[92:95], v[32:35]
ds_read_b64_tr_b16 a[28:29], v5 offset:27872
v_mfma_f32_16x16x32_bf16 v[36:39], a[4:7], a[96:99], v[36:39]
ds_read_b64_tr_b16 a[30:31], v5 offset:30176
v_mfma_f32_16x16x32_bf16 v[40:43], a[8:11], a[92:95], v[40:43]
ds_read_b64_tr_b16 a[32:33], v5 offset:27904
buffer_load_dwordx4 a[156:159], v7, s[8:11], s29 offen offset:3072
v_mfma_f32_16x16x32_bf16 v[44:47], a[8:11], a[96:99], v[44:47]
ds_read_b64_tr_b16 a[34:35], v5 offset:30208
s_waitcnt vmcnt(15) lgkmcnt(6)
s_barrier
v_mfma_f32_16x16x32_bf16 v[48:51], a[12:15], a[92:95], v[48:51]
ds_read_b64_tr_b16 a[0:1], v2 offset:0
v_mfma_f32_16x16x32_bf16 v[52:55], a[12:15], a[96:99], v[52:55]
ds_read_b64_tr_b16 a[2:3], v2 offset:2304
v_mfma_f32_16x16x32_bf16 v[56:59], a[16:19], a[92:95], v[56:59]
ds_read_b64_tr_b16 a[4:5], v2 offset:32
buffer_load_dwordx4 v116, s[48:51], s40 offen offset:0 lds
v_mfma_f32_16x16x32_bf16 v[60:63], a[16:19], a[96:99], v[60:63]
ds_read_b64_tr_b16 a[6:7], v2 offset:2336
v_mfma_f32_16x16x32_bf16 v[64:67], a[20:23], a[92:95], v[64:67]
ds_read_b64_tr_b16 a[8:9], v2 offset:64
v_mfma_f32_16x16x32_bf16 v[68:71], a[20:23], a[96:99], v[68:71]
ds_read_b64_tr_b16 a[10:11], v2 offset:2368
buffer_load_dwordx4 a[160:163], v8, s[8:11], s29 offen offset:3072
s_waitcnt lgkmcnt(6)
v_mfma_f32_16x16x32_bf16 v[72:75], a[24:27], a[92:95], v[72:75]
ds_read_b64_tr_b16 a[12:13], v2 offset:96
v_mfma_f32_16x16x32_bf16 v[76:79], a[24:27], a[96:99], v[76:79]
ds_read_b64_tr_b16 a[14:15], v2 offset:2400
v_mfma_f32_16x16x32_bf16 v[80:83], a[28:31], a[92:95], v[80:83]
ds_read_b64_tr_b16 a[16:17], v2 offset:128
s_add_u32 s40, s40, 147456
v_mfma_f32_16x16x32_bf16 v[84:87], a[28:31], a[96:99], v[84:87]
ds_read_b64_tr_b16 a[18:19], v2 offset:2432
v_mfma_f32_16x16x32_bf16 v[88:91], a[32:35], a[92:95], v[88:91]
ds_read_b64_tr_b16 a[20:21], v2 offset:160
v_mfma_f32_16x16x32_bf16 v[92:95], a[32:35], a[96:99], v[92:95]
ds_read_b64_tr_b16 a[22:23], v2 offset:2464
s_add_u32 s29, s29, 4096
s_waitcnt lgkmcnt(6)
v_mfma_f32_16x16x32_bf16 v[24:27], a[0:3], a[100:103], v[24:27]
ds_read_b64_tr_b16 a[24:25], v2 offset:192
v_mfma_f32_16x16x32_bf16 v[28:31], a[0:3], a[104:107], v[28:31]
ds_read_b64_tr_b16 a[26:27], v2 offset:2496
v_mfma_f32_16x16x32_bf16 v[32:35], a[4:7], a[100:103], v[32:35]
ds_read_b64_tr_b16 a[28:29], v2 offset:224
v_mfma_f32_16x16x32_bf16 v[36:39], a[4:7], a[104:107], v[36:39]
ds_read_b64_tr_b16 a[30:31], v2 offset:2528
s_add_u32 m0, s30, 73728
v_mfma_f32_16x16x32_bf16 v[40:43], a[8:11], a[100:103], v[40:43]
ds_read_b64_tr_b16 a[32:33], v2 offset:256
v_mfma_f32_16x16x32_bf16 v[44:47], a[8:11], a[104:107], v[44:47]
ds_read_b64_tr_b16 a[34:35], v2 offset:2560
s_waitcnt lgkmcnt(6)
v_mfma_f32_16x16x32_bf16 v[48:51], a[12:15], a[100:103], v[48:51]
ds_read_b64_tr_b16 a[0:1], v2 offset:9216
v_mfma_f32_16x16x32_bf16 v[52:55], a[12:15], a[104:107], v[52:55]
ds_read_b64_tr_b16 a[2:3], v2 offset:11520
buffer_load_dwordx4 v108, s[48:51], s40 offen offset:0 lds
v_mfma_f32_16x16x32_bf16 v[56:59], a[16:19], a[100:103], v[56:59]
ds_read_b64_tr_b16 a[4:5], v2 offset:9248
v_mfma_f32_16x16x32_bf16 v[60:63], a[16:19], a[104:107], v[60:63]
ds_read_b64_tr_b16 a[6:7], v2 offset:11552
v_mfma_f32_16x16x32_bf16 v[64:67], a[20:23], a[100:103], v[64:67]
ds_read_b64_tr_b16 a[8:9], v2 offset:9280
v_mfma_f32_16x16x32_bf16 v[68:71], a[20:23], a[104:107], v[68:71]
ds_read_b64_tr_b16 a[10:11], v2 offset:11584
buffer_load_dwordx4 v109, s[48:51], s40 offen offset:1024 lds
s_waitcnt lgkmcnt(6)
v_mfma_f32_16x16x32_bf16 v[72:75], a[24:27], a[100:103], v[72:75]
ds_read_b64_tr_b16 a[12:13], v2 offset:9312
v_mfma_f32_16x16x32_bf16 v[76:79], a[24:27], a[104:107], v[76:79]
ds_read_b64_tr_b16 a[14:15], v2 offset:11616
v_mfma_f32_16x16x32_bf16 v[80:83], a[28:31], a[100:103], v[80:83]
ds_read_b64_tr_b16 a[16:17], v2 offset:9344
v_mfma_f32_16x16x32_bf16 v[84:87], a[28:31], a[104:107], v[84:87]
ds_read_b64_tr_b16 a[18:19], v2 offset:11648
buffer_load_dwordx4 a[36:39], v7, s[8:11], s29 offen offset:0
v_mfma_f32_16x16x32_bf16 v[88:91], a[32:35], a[100:103], v[88:91]
ds_read_b64_tr_b16 a[20:21], v2 offset:9376
v_mfma_f32_16x16x32_bf16 v[92:95], a[32:35], a[104:107], v[92:95]
ds_read_b64_tr_b16 a[22:23], v2 offset:11680
s_waitcnt lgkmcnt(6)
v_mfma_f32_16x16x32_bf16 v[24:27], a[0:3], a[108:111], v[24:27]
ds_read_b64_tr_b16 a[24:25], v2 offset:9408
v_mfma_f32_16x16x32_bf16 v[28:31], a[0:3], a[112:115], v[28:31]
ds_read_b64_tr_b16 a[26:27], v2 offset:11712
buffer_load_dwordx4 v110, s[48:51], s40 offen offset:2048 lds
v_mfma_f32_16x16x32_bf16 v[32:35], a[4:7], a[108:111], v[32:35]
ds_read_b64_tr_b16 a[28:29], v2 offset:9440
v_mfma_f32_16x16x32_bf16 v[36:39], a[4:7], a[112:115], v[36:39]
ds_read_b64_tr_b16 a[30:31], v2 offset:11744
v_mfma_f32_16x16x32_bf16 v[40:43], a[8:11], a[108:111], v[40:43]
ds_read_b64_tr_b16 a[32:33], v2 offset:9472
v_mfma_f32_16x16x32_bf16 v[44:47], a[8:11], a[112:115], v[44:47]
ds_read_b64_tr_b16 a[34:35], v2 offset:11776
buffer_load_dwordx4 v111, s[48:51], s40 offen offset:3072 lds
s_waitcnt lgkmcnt(6)
v_mfma_f32_16x16x32_bf16 v[48:51], a[12:15], a[108:111], v[48:51]
ds_read_b64_tr_b16 a[0:1], v2 offset:18432
v_mfma_f32_16x16x32_bf16 v[52:55], a[12:15], a[112:115], v[52:55]
ds_read_b64_tr_b16 a[2:3], v2 offset:20736
v_mfma_f32_16x16x32_bf16 v[56:59], a[16:19], a[108:111], v[56:59]
ds_read_b64_tr_b16 a[4:5], v2 offset:18464
v_mfma_f32_16x16x32_bf16 v[60:63], a[16:19], a[112:115], v[60:63]
ds_read_b64_tr_b16 a[6:7], v2 offset:20768
s_add_u32 m0, s30, 77824
v_mfma_f32_16x16x32_bf16 v[64:67], a[20:23], a[108:111], v[64:67]
ds_read_b64_tr_b16 a[8:9], v2 offset:18496
v_mfma_f32_16x16x32_bf16 v[68:71], a[20:23], a[112:115], v[68:71]
ds_read_b64_tr_b16 a[10:11], v2 offset:20800
s_waitcnt lgkmcnt(6)
v_mfma_f32_16x16x32_bf16 v[72:75], a[24:27], a[108:111], v[72:75]
ds_read_b64_tr_b16 a[12:13], v2 offset:18528
v_mfma_f32_16x16x32_bf16 v[76:79], a[24:27], a[112:115], v[76:79]
ds_read_b64_tr_b16 a[14:15], v2 offset:20832
buffer_load_dwordx4 a[40:43], v8, s[8:11], s29 offen offset:0
v_mfma_f32_16x16x32_bf16 v[80:83], a[28:31], a[108:111], v[80:83]
ds_read_b64_tr_b16 a[16:17], v2 offset:18560
v_mfma_f32_16x16x32_bf16 v[84:87], a[28:31], a[112:115], v[84:87]
ds_read_b64_tr_b16 a[18:19], v2 offset:20864
v_mfma_f32_16x16x32_bf16 v[88:91], a[32:35], a[108:111], v[88:91]
ds_read_b64_tr_b16 a[20:21], v2 offset:18592
v_mfma_f32_16x16x32_bf16 v[92:95], a[32:35], a[112:115], v[92:95]
ds_read_b64_tr_b16 a[22:23], v2 offset:20896
buffer_load_dwordx4 v112, s[48:51], s40 offen offset:0 lds
s_waitcnt lgkmcnt(6)
v_mfma_f32_16x16x32_bf16 v[24:27], a[0:3], a[116:119], v[24:27]
ds_read_b64_tr_b16 a[24:25], v2 offset:18624
v_mfma_f32_16x16x32_bf16 v[28:31], a[0:3], a[120:123], v[28:31]
ds_read_b64_tr_b16 a[26:27], v2 offset:20928
v_mfma_f32_16x16x32_bf16 v[32:35], a[4:7], a[116:119], v[32:35]
ds_read_b64_tr_b16 a[28:29], v2 offset:18656
v_mfma_f32_16x16x32_bf16 v[36:39], a[4:7], a[120:123], v[36:39]
ds_read_b64_tr_b16 a[30:31], v2 offset:20960
buffer_load_dwordx4 v113, s[48:51], s40 offen offset:1024 lds
v_mfma_f32_16x16x32_bf16 v[40:43], a[8:11], a[116:119], v[40:43]
ds_read_b64_tr_b16 a[32:33], v2 offset:18688
v_mfma_f32_16x16x32_bf16 v[44:47], a[8:11], a[120:123], v[44:47]
ds_read_b64_tr_b16 a[34:35], v2 offset:20992
s_waitcnt lgkmcnt(6)
v_mfma_f32_16x16x32_bf16 v[48:51], a[12:15], a[116:119], v[48:51]
ds_read_b64_tr_b16 a[0:1], v2 offset:27648
v_mfma_f32_16x16x32_bf16 v[52:55], a[12:15], a[120:123], v[52:55]
ds_read_b64_tr_b16 a[2:3], v2 offset:29952
buffer_load_dwordx4 a[44:47], v7, s[8:11], s29 offen offset:1024
v_mfma_f32_16x16x32_bf16 v[56:59], a[16:19], a[116:119], v[56:59]
ds_read_b64_tr_b16 a[4:5], v2 offset:27680
v_mfma_f32_16x16x32_bf16 v[60:63], a[16:19], a[120:123], v[60:63]
ds_read_b64_tr_b16 a[6:7], v2 offset:29984
v_mfma_f32_16x16x32_bf16 v[64:67], a[20:23], a[116:119], v[64:67]
ds_read_b64_tr_b16 a[8:9], v2 offset:27712
v_mfma_f32_16x16x32_bf16 v[68:71], a[20:23], a[120:123], v[68:71]
ds_read_b64_tr_b16 a[10:11], v2 offset:30016
buffer_load_dwordx4 v114, s[48:51], s40 offen offset:2048 lds
s_waitcnt lgkmcnt(6)
v_mfma_f32_16x16x32_bf16 v[72:75], a[24:27], a[116:119], v[72:75]
ds_read_b64_tr_b16 a[12:13], v2 offset:27744
v_mfma_f32_16x16x32_bf16 v[76:79], a[24:27], a[120:123], v[76:79]
ds_read_b64_tr_b16 a[14:15], v2 offset:30048
v_mfma_f32_16x16x32_bf16 v[80:83], a[28:31], a[116:119], v[80:83]
ds_read_b64_tr_b16 a[16:17], v2 offset:27776
v_mfma_f32_16x16x32_bf16 v[84:87], a[28:31], a[120:123], v[84:87]
ds_read_b64_tr_b16 a[18:19], v2 offset:30080
buffer_load_dwordx4 v115, s[48:51], s40 offen offset:3072 lds
v_mfma_f32_16x16x32_bf16 v[88:91], a[32:35], a[116:119], v[88:91]
ds_read_b64_tr_b16 a[20:21], v2 offset:27808
v_mfma_f32_16x16x32_bf16 v[92:95], a[32:35], a[120:123], v[92:95]
ds_read_b64_tr_b16 a[22:23], v2 offset:30112
s_waitcnt lgkmcnt(6)
v_mfma_f32_16x16x32_bf16 v[24:27], a[0:3], a[124:127], v[24:27]
ds_read_b64_tr_b16 a[24:25], v2 offset:27840
v_mfma_f32_16x16x32_bf16 v[28:31], a[0:3], a[128:131], v[28:31]
ds_read_b64_tr_b16 a[26:27], v2 offset:30144
s_add_u32 m0, s30, 81920
v_mfma_f32_16x16x32_bf16 v[32:35], a[4:7], a[124:127], v[32:35]
ds_read_b64_tr_b16 a[28:29], v2 offset:27872
v_mfma_f32_16x16x32_bf16 v[36:39], a[4:7], a[128:131], v[36:39]
ds_read_b64_tr_b16 a[30:31], v2 offset:30176
v_mfma_f32_16x16x32_bf16 v[40:43], a[8:11], a[124:127], v[40:43]
ds_read_b64_tr_b16 a[32:33], v2 offset:27904
v_mfma_f32_16x16x32_bf16 v[44:47], a[8:11], a[128:131], v[44:47]
ds_read_b64_tr_b16 a[34:35], v2 offset:30208
buffer_load_dwordx4 a[48:51], v8, s[8:11], s29 offen offset:1024
s_waitcnt vmcnt(12) lgkmcnt(6)
s_barrier
v_mfma_f32_16x16x32_bf16 v[48:51], a[12:15], a[124:127], v[48:51]
ds_read_b64_tr_b16 a[0:1], v3 offset:0
v_mfma_f32_16x16x32_bf16 v[52:55], a[12:15], a[128:131], v[52:55]
ds_read_b64_tr_b16 a[2:3], v3 offset:2304
v_mfma_f32_16x16x32_bf16 v[56:59], a[16:19], a[124:127], v[56:59]
ds_read_b64_tr_b16 a[4:5], v3 offset:32
v_mfma_f32_16x16x32_bf16 v[60:63], a[16:19], a[128:131], v[60:63]
ds_read_b64_tr_b16 a[6:7], v3 offset:2336
buffer_load_dwordx4 v116, s[48:51], s40 offen offset:0 lds
v_mfma_f32_16x16x32_bf16 v[64:67], a[20:23], a[124:127], v[64:67]
ds_read_b64_tr_b16 a[8:9], v3 offset:64
v_mfma_f32_16x16x32_bf16 v[68:71], a[20:23], a[128:131], v[68:71]
ds_read_b64_tr_b16 a[10:11], v3 offset:2368
s_waitcnt lgkmcnt(6)
v_mfma_f32_16x16x32_bf16 v[72:75], a[24:27], a[124:127], v[72:75]
ds_read_b64_tr_b16 a[12:13], v3 offset:96
v_mfma_f32_16x16x32_bf16 v[76:79], a[24:27], a[128:131], v[76:79]
ds_read_b64_tr_b16 a[14:15], v3 offset:2400
s_add_u32 s40, s40, 147456
v_mfma_f32_16x16x32_bf16 v[80:83], a[28:31], a[124:127], v[80:83]
ds_read_b64_tr_b16 a[16:17], v3 offset:128
v_mfma_f32_16x16x32_bf16 v[84:87], a[28:31], a[128:131], v[84:87]
ds_read_b64_tr_b16 a[18:19], v3 offset:2432
v_mfma_f32_16x16x32_bf16 v[88:91], a[32:35], a[124:127], v[88:91]
ds_read_b64_tr_b16 a[20:21], v3 offset:160
v_mfma_f32_16x16x32_bf16 v[92:95], a[32:35], a[128:131], v[92:95]
ds_read_b64_tr_b16 a[22:23], v3 offset:2464
s_add_u32 s29, s29, 4096
s_waitcnt lgkmcnt(6)
v_mfma_f32_16x16x32_bf16 v[24:27], a[0:3], a[132:135], v[24:27]
ds_read_b64_tr_b16 a[24:25], v3 offset:192
v_mfma_f32_16x16x32_bf16 v[28:31], a[0:3], a[136:139], v[28:31]
ds_read_b64_tr_b16 a[26:27], v3 offset:2496
v_mfma_f32_16x16x32_bf16 v[32:35], a[4:7], a[132:135], v[32:35]
ds_read_b64_tr_b16 a[28:29], v3 offset:224
v_mfma_f32_16x16x32_bf16 v[36:39], a[4:7], a[136:139], v[36:39]
ds_read_b64_tr_b16 a[30:31], v3 offset:2528
v_mfma_f32_16x16x32_bf16 v[40:43], a[8:11], a[132:135], v[40:43]
ds_read_b64_tr_b16 a[32:33], v3 offset:256
v_mfma_f32_16x16x32_bf16 v[44:47], a[8:11], a[136:139], v[44:47]
ds_read_b64_tr_b16 a[34:35], v3 offset:2560
s_waitcnt lgkmcnt(6)
v_mfma_f32_16x16x32_bf16 v[48:51], a[12:15], a[132:135], v[48:51]
ds_read_b64_tr_b16 a[0:1], v3 offset:9216
v_mfma_f32_16x16x32_bf16 v[52:55], a[12:15], a[136:139], v[52:55]
ds_read_b64_tr_b16 a[2:3], v3 offset:11520
v_mfma_f32_16x16x32_bf16 v[56:59], a[16:19], a[132:135], v[56:59]
ds_read_b64_tr_b16 a[4:5], v3 offset:9248
v_mfma_f32_16x16x32_bf16 v[60:63], a[16:19], a[136:139], v[60:63]
ds_read_b64_tr_b16 a[6:7], v3 offset:11552
v_mfma_f32_16x16x32_bf16 v[64:67], a[20:23], a[132:135], v[64:67]
ds_read_b64_tr_b16 a[8:9], v3 offset:9280
v_mfma_f32_16x16x32_bf16 v[68:71], a[20:23], a[136:139], v[68:71]
ds_read_b64_tr_b16 a[10:11], v3 offset:11584
s_waitcnt lgkmcnt(6)
v_mfma_f32_16x16x32_bf16 v[72:75], a[24:27], a[132:135], v[72:75]
ds_read_b64_tr_b16 a[12:13], v3 offset:9312
v_mfma_f32_16x16x32_bf16 v[76:79], a[24:27], a[136:139], v[76:79]
ds_read_b64_tr_b16 a[14:15], v3 offset:11616
v_mfma_f32_16x16x32_bf16 v[80:83], a[28:31], a[132:135], v[80:83]
ds_read_b64_tr_b16 a[16:17], v3 offset:9344
v_mfma_f32_16x16x32_bf16 v[84:87], a[28:31], a[136:139], v[84:87]
ds_read_b64_tr_b16 a[18:19], v3 offset:11648
v_mfma_f32_16x16x32_bf16 v[88:91], a[32:35], a[132:135], v[88:91]
ds_read_b64_tr_b16 a[20:21], v3 offset:9376
v_mfma_f32_16x16x32_bf16 v[92:95], a[32:35], a[136:139], v[92:95]
ds_read_b64_tr_b16 a[22:23], v3 offset:11680
s_waitcnt lgkmcnt(6)
v_mfma_f32_16x16x32_bf16 v[24:27], a[0:3], a[140:143], v[24:27]
ds_read_b64_tr_b16 a[24:25], v3 offset:9408
v_mfma_f32_16x16x32_bf16 v[28:31], a[0:3], a[144:147], v[28:31]
ds_read_b64_tr_b16 a[26:27], v3 offset:11712
v_mfma_f32_16x16x32_bf16 v[32:35], a[4:7], a[140:143], v[32:35]
ds_read_b64_tr_b16 a[28:29], v3 offset:9440
v_mfma_f32_16x16x32_bf16 v[36:39], a[4:7], a[144:147], v[36:39]
ds_read_b64_tr_b16 a[30:31], v3 offset:11744
v_mfma_f32_16x16x32_bf16 v[40:43], a[8:11], a[140:143], v[40:43]
ds_read_b64_tr_b16 a[32:33], v3 offset:9472
v_mfma_f32_16x16x32_bf16 v[44:47], a[8:11], a[144:147], v[44:47]
ds_read_b64_tr_b16 a[34:35], v3 offset:11776
s_waitcnt lgkmcnt(6)
v_mfma_f32_16x16x32_bf16 v[48:51], a[12:15], a[140:143], v[48:51]
ds_read_b64_tr_b16 a[0:1], v3 offset:18432
v_mfma_f32_16x16x32_bf16 v[52:55], a[12:15], a[144:147], v[52:55]
ds_read_b64_tr_b16 a[2:3], v3 offset:20736
v_mfma_f32_16x16x32_bf16 v[56:59], a[16:19], a[140:143], v[56:59]
ds_read_b64_tr_b16 a[4:5], v3 offset:18464
v_mfma_f32_16x16x32_bf16 v[60:63], a[16:19], a[144:147], v[60:63]
ds_read_b64_tr_b16 a[6:7], v3 offset:20768
v_mfma_f32_16x16x32_bf16 v[64:67], a[20:23], a[140:143], v[64:67]
ds_read_b64_tr_b16 a[8:9], v3 offset:18496
v_mfma_f32_16x16x32_bf16 v[68:71], a[20:23], a[144:147], v[68:71]
ds_read_b64_tr_b16 a[10:11], v3 offset:20800
s_waitcnt lgkmcnt(6)
v_mfma_f32_16x16x32_bf16 v[72:75], a[24:27], a[140:143], v[72:75]
ds_read_b64_tr_b16 a[12:13], v3 offset:18528
v_mfma_f32_16x16x32_bf16 v[76:79], a[24:27], a[144:147], v[76:79]
ds_read_b64_tr_b16 a[14:15], v3 offset:20832
v_mfma_f32_16x16x32_bf16 v[80:83], a[28:31], a[140:143], v[80:83]
ds_read_b64_tr_b16 a[16:17], v3 offset:18560
v_mfma_f32_16x16x32_bf16 v[84:87], a[28:31], a[144:147], v[84:87]
ds_read_b64_tr_b16 a[18:19], v3 offset:20864
v_mfma_f32_16x16x32_bf16 v[88:91], a[32:35], a[140:143], v[88:91]
ds_read_b64_tr_b16 a[20:21], v3 offset:18592
v_mfma_f32_16x16x32_bf16 v[92:95], a[32:35], a[144:147], v[92:95]
ds_read_b64_tr_b16 a[22:23], v3 offset:20896
s_waitcnt lgkmcnt(6)
v_mfma_f32_16x16x32_bf16 v[24:27], a[0:3], a[148:151], v[24:27]
ds_read_b64_tr_b16 a[24:25], v3 offset:18624
v_mfma_f32_16x16x32_bf16 v[28:31], a[0:3], a[152:155], v[28:31]
ds_read_b64_tr_b16 a[26:27], v3 offset:20928
v_mfma_f32_16x16x32_bf16 v[32:35], a[4:7], a[148:151], v[32:35]
ds_read_b64_tr_b16 a[28:29], v3 offset:18656
v_mfma_f32_16x16x32_bf16 v[36:39], a[4:7], a[152:155], v[36:39]
ds_read_b64_tr_b16 a[30:31], v3 offset:20960
v_mfma_f32_16x16x32_bf16 v[40:43], a[8:11], a[148:151], v[40:43]
ds_read_b64_tr_b16 a[32:33], v3 offset:18688
v_mfma_f32_16x16x32_bf16 v[44:47], a[8:11], a[152:155], v[44:47]
ds_read_b64_tr_b16 a[34:35], v3 offset:20992
s_waitcnt lgkmcnt(6)
v_mfma_f32_16x16x32_bf16 v[48:51], a[12:15], a[148:151], v[48:51]
ds_read_b64_tr_b16 a[0:1], v3 offset:27648
v_mfma_f32_16x16x32_bf16 v[52:55], a[12:15], a[152:155], v[52:55]
ds_read_b64_tr_b16 a[2:3], v3 offset:29952
v_mfma_f32_16x16x32_bf16 v[56:59], a[16:19], a[148:151], v[56:59]
ds_read_b64_tr_b16 a[4:5], v3 offset:27680
v_mfma_f32_16x16x32_bf16 v[60:63], a[16:19], a[152:155], v[60:63]
ds_read_b64_tr_b16 a[6:7], v3 offset:29984
v_mfma_f32_16x16x32_bf16 v[64:67], a[20:23], a[148:151], v[64:67]
ds_read_b64_tr_b16 a[8:9], v3 offset:27712
v_mfma_f32_16x16x32_bf16 v[68:71], a[20:23], a[152:155], v[68:71]
ds_read_b64_tr_b16 a[10:11], v3 offset:30016
s_waitcnt lgkmcnt(6)
v_mfma_f32_16x16x32_bf16 v[72:75], a[24:27], a[148:151], v[72:75]
ds_read_b64_tr_b16 a[12:13], v3 offset:27744
v_mfma_f32_16x16x32_bf16 v[76:79], a[24:27], a[152:155], v[76:79]
ds_read_b64_tr_b16 a[14:15], v3 offset:30048
v_mfma_f32_16x16x32_bf16 v[80:83], a[28:31], a[148:151], v[80:83]
ds_read_b64_tr_b16 a[16:17], v3 offset:27776
v_mfma_f32_16x16x32_bf16 v[84:87], a[28:31], a[152:155], v[84:87]
ds_read_b64_tr_b16 a[18:19], v3 offset:30080
v_mfma_f32_16x16x32_bf16 v[88:91], a[32:35], a[148:151], v[88:91]
ds_read_b64_tr_b16 a[20:21], v3 offset:27808
v_mfma_f32_16x16x32_bf16 v[92:95], a[32:35], a[152:155], v[92:95]
ds_read_b64_tr_b16 a[22:23], v3 offset:30112
s_waitcnt lgkmcnt(6)
v_mfma_f32_16x16x32_bf16 v[24:27], a[0:3], a[156:159], v[24:27]
ds_read_b64_tr_b16 a[24:25], v3 offset:27840
v_mfma_f32_16x16x32_bf16 v[28:31], a[0:3], a[160:163], v[28:31]
ds_read_b64_tr_b16 a[26:27], v3 offset:30144
v_mfma_f32_16x16x32_bf16 v[32:35], a[4:7], a[156:159], v[32:35]
ds_read_b64_tr_b16 a[28:29], v3 offset:27872
v_mfma_f32_16x16x32_bf16 v[36:39], a[4:7], a[160:163], v[36:39]
ds_read_b64_tr_b16 a[30:31], v3 offset:30176
v_mfma_f32_16x16x32_bf16 v[40:43], a[8:11], a[156:159], v[40:43]
ds_read_b64_tr_b16 a[32:33], v3 offset:27904
v_mfma_f32_16x16x32_bf16 v[44:47], a[8:11], a[160:163], v[44:47]
ds_read_b64_tr_b16 a[34:35], v3 offset:30208
s_waitcnt vmcnt(0) lgkmcnt(6)
s_barrier
v_mfma_f32_16x16x32_bf16 v[48:51], a[12:15], a[156:159], v[48:51]
ds_read_b64_tr_b16 a[0:1], v4 offset:0
v_mfma_f32_16x16x32_bf16 v[52:55], a[12:15], a[160:163], v[52:55]
ds_read_b64_tr_b16 a[2:3], v4 offset:2304
v_mfma_f32_16x16x32_bf16 v[56:59], a[16:19], a[156:159], v[56:59]
ds_read_b64_tr_b16 a[4:5], v4 offset:32
v_mfma_f32_16x16x32_bf16 v[60:63], a[16:19], a[160:163], v[60:63]
ds_read_b64_tr_b16 a[6:7], v4 offset:2336
v_mfma_f32_16x16x32_bf16 v[64:67], a[20:23], a[156:159], v[64:67]
ds_read_b64_tr_b16 a[8:9], v4 offset:64
v_mfma_f32_16x16x32_bf16 v[68:71], a[20:23], a[160:163], v[68:71]
ds_read_b64_tr_b16 a[10:11], v4 offset:2368
s_waitcnt lgkmcnt(6)
v_mfma_f32_16x16x32_bf16 v[72:75], a[24:27], a[156:159], v[72:75]
ds_read_b64_tr_b16 a[12:13], v4 offset:96
v_mfma_f32_16x16x32_bf16 v[76:79], a[24:27], a[160:163], v[76:79]
ds_read_b64_tr_b16 a[14:15], v4 offset:2400
v_mfma_f32_16x16x32_bf16 v[80:83], a[28:31], a[156:159], v[80:83]
ds_read_b64_tr_b16 a[16:17], v4 offset:128
v_mfma_f32_16x16x32_bf16 v[84:87], a[28:31], a[160:163], v[84:87]
ds_read_b64_tr_b16 a[18:19], v4 offset:2432
v_mfma_f32_16x16x32_bf16 v[88:91], a[32:35], a[156:159], v[88:91]
ds_read_b64_tr_b16 a[20:21], v4 offset:160
v_mfma_f32_16x16x32_bf16 v[92:95], a[32:35], a[160:163], v[92:95]
ds_read_b64_tr_b16 a[22:23], v4 offset:2464
s_waitcnt lgkmcnt(6)
v_mfma_f32_16x16x32_bf16 v[24:27], a[0:3], a[36:39], v[24:27]
ds_read_b64_tr_b16 a[24:25], v4 offset:192
v_mfma_f32_16x16x32_bf16 v[28:31], a[0:3], a[40:43], v[28:31]
ds_read_b64_tr_b16 a[26:27], v4 offset:2496
v_mfma_f32_16x16x32_bf16 v[32:35], a[4:7], a[36:39], v[32:35]
ds_read_b64_tr_b16 a[28:29], v4 offset:224
v_mfma_f32_16x16x32_bf16 v[36:39], a[4:7], a[40:43], v[36:39]
ds_read_b64_tr_b16 a[30:31], v4 offset:2528
v_mfma_f32_16x16x32_bf16 v[40:43], a[8:11], a[36:39], v[40:43]
ds_read_b64_tr_b16 a[32:33], v4 offset:256
v_mfma_f32_16x16x32_bf16 v[44:47], a[8:11], a[40:43], v[44:47]
ds_read_b64_tr_b16 a[34:35], v4 offset:2560
s_waitcnt lgkmcnt(6)
v_mfma_f32_16x16x32_bf16 v[48:51], a[12:15], a[36:39], v[48:51]
ds_read_b64_tr_b16 a[0:1], v4 offset:9216
v_mfma_f32_16x16x32_bf16 v[52:55], a[12:15], a[40:43], v[52:55]
ds_read_b64_tr_b16 a[2:3], v4 offset:11520
v_mfma_f32_16x16x32_bf16 v[56:59], a[16:19], a[36:39], v[56:59]
ds_read_b64_tr_b16 a[4:5], v4 offset:9248
v_mfma_f32_16x16x32_bf16 v[60:63], a[16:19], a[40:43], v[60:63]
ds_read_b64_tr_b16 a[6:7], v4 offset:11552
v_mfma_f32_16x16x32_bf16 v[64:67], a[20:23], a[36:39], v[64:67]
ds_read_b64_tr_b16 a[8:9], v4 offset:9280
v_mfma_f32_16x16x32_bf16 v[68:71], a[20:23], a[40:43], v[68:71]
ds_read_b64_tr_b16 a[10:11], v4 offset:11584
s_waitcnt lgkmcnt(6)
v_mfma_f32_16x16x32_bf16 v[72:75], a[24:27], a[36:39], v[72:75]
ds_read_b64_tr_b16 a[12:13], v4 offset:9312
v_mfma_f32_16x16x32_bf16 v[76:79], a[24:27], a[40:43], v[76:79]
ds_read_b64_tr_b16 a[14:15], v4 offset:11616
v_mfma_f32_16x16x32_bf16 v[80:83], a[28:31], a[36:39], v[80:83]
ds_read_b64_tr_b16 a[16:17], v4 offset:9344
v_mfma_f32_16x16x32_bf16 v[84:87], a[28:31], a[40:43], v[84:87]
ds_read_b64_tr_b16 a[18:19], v4 offset:11648
v_mfma_f32_16x16x32_bf16 v[88:91], a[32:35], a[36:39], v[88:91]
ds_read_b64_tr_b16 a[20:21], v4 offset:9376
v_mfma_f32_16x16x32_bf16 v[92:95], a[32:35], a[40:43], v[92:95]
ds_read_b64_tr_b16 a[22:23], v4 offset:11680
s_waitcnt lgkmcnt(6)
v_mfma_f32_16x16x32_bf16 v[24:27], a[0:3], a[44:47], v[24:27]
ds_read_b64_tr_b16 a[24:25], v4 offset:9408
v_mfma_f32_16x16x32_bf16 v[28:31], a[0:3], a[48:51], v[28:31]
ds_read_b64_tr_b16 a[26:27], v4 offset:11712
v_mfma_f32_16x16x32_bf16 v[32:35], a[4:7], a[44:47], v[32:35]
ds_read_b64_tr_b16 a[28:29], v4 offset:9440
v_mfma_f32_16x16x32_bf16 v[36:39], a[4:7], a[48:51], v[36:39]
ds_read_b64_tr_b16 a[30:31], v4 offset:11744
v_mfma_f32_16x16x32_bf16 v[40:43], a[8:11], a[44:47], v[40:43]
ds_read_b64_tr_b16 a[32:33], v4 offset:9472
v_mfma_f32_16x16x32_bf16 v[44:47], a[8:11], a[48:51], v[44:47]
ds_read_b64_tr_b16 a[34:35], v4 offset:11776
s_waitcnt lgkmcnt(6)
v_mfma_f32_16x16x32_bf16 v[48:51], a[12:15], a[44:47], v[48:51]
v_mfma_f32_16x16x32_bf16 v[52:55], a[12:15], a[48:51], v[52:55]
v_mfma_f32_16x16x32_bf16 v[56:59], a[16:19], a[44:47], v[56:59]
v_mfma_f32_16x16x32_bf16 v[60:63], a[16:19], a[48:51], v[60:63]
v_mfma_f32_16x16x32_bf16 v[64:67], a[20:23], a[44:47], v[64:67]
v_mfma_f32_16x16x32_bf16 v[68:71], a[20:23], a[48:51], v[68:71]
s_waitcnt lgkmcnt(0)
v_mfma_f32_16x16x32_bf16 v[72:75], a[24:27], a[44:47], v[72:75]
v_mfma_f32_16x16x32_bf16 v[76:79], a[24:27], a[48:51], v[76:79]
v_mfma_f32_16x16x32_bf16 v[80:83], a[28:31], a[44:47], v[80:83]
v_mfma_f32_16x16x32_bf16 v[84:87], a[28:31], a[48:51], v[84:87]
v_mfma_f32_16x16x32_bf16 v[88:91], a[32:35], a[44:47], v[88:91]
v_mfma_f32_16x16x32_bf16 v[92:95], a[32:35], a[48:51], v[92:95]
s_load_dwordx2 s[16:17], s[0:1], 96
s_mov_b32 s18, 2359296
s_mov_b32 s19, 0x20000
v_cvt_pk_bf16_f32 v96, v24, v25
v_cvt_pk_bf16_f32 v97, v26, v27
v_cvt_pk_bf16_f32 v98, v32, v33
v_cvt_pk_bf16_f32 v99, v34, v35
s_nop 0
v_permlane16_swap_b32 v96, v98
v_permlane16_swap_b32 v97, v99
buffer_store_dwordx4 v[96:99], v14, s[12:15], s35 offen offset:0 sc0 sc1
v_cvt_pk_bf16_f32 v100, v28, v29
v_cvt_pk_bf16_f32 v101, v30, v31
v_cvt_pk_bf16_f32 v102, v36, v37
v_cvt_pk_bf16_f32 v103, v38, v39
s_nop 0
v_permlane16_swap_b32 v100, v102
v_permlane16_swap_b32 v101, v103
buffer_store_dwordx4 v[100:103], v15, s[12:15], s35 offen offset:0 sc0 sc1
v_cvt_pk_bf16_f32 v104, v40, v41
v_cvt_pk_bf16_f32 v105, v42, v43
v_cvt_pk_bf16_f32 v106, v48, v49
v_cvt_pk_bf16_f32 v107, v50, v51
s_nop 0
v_permlane16_swap_b32 v104, v106
v_permlane16_swap_b32 v105, v107
buffer_store_dwordx4 v[104:107], v14, s[12:15], s35 offen offset:1024 sc0 sc1
v_cvt_pk_bf16_f32 v96, v44, v45
v_cvt_pk_bf16_f32 v97, v46, v47
v_cvt_pk_bf16_f32 v98, v52, v53
v_cvt_pk_bf16_f32 v99, v54, v55
s_nop 0
v_permlane16_swap_b32 v96, v98
v_permlane16_swap_b32 v97, v99
buffer_store_dwordx4 v[96:99], v15, s[12:15], s35 offen offset:1024 sc0 sc1
v_cvt_pk_bf16_f32 v100, v56, v57
v_cvt_pk_bf16_f32 v101, v58, v59
v_cvt_pk_bf16_f32 v102, v64, v65
v_cvt_pk_bf16_f32 v103, v66, v67
s_nop 0
v_permlane16_swap_b32 v100, v102
v_permlane16_swap_b32 v101, v103
buffer_store_dwordx4 v[100:103], v14, s[12:15], s35 offen offset:2048 sc0 sc1
v_cvt_pk_bf16_f32 v104, v60, v61
v_cvt_pk_bf16_f32 v105, v62, v63
v_cvt_pk_bf16_f32 v106, v68, v69
v_cvt_pk_bf16_f32 v107, v70, v71
s_nop 0
v_permlane16_swap_b32 v104, v106
v_permlane16_swap_b32 v105, v107
buffer_store_dwordx4 v[104:107], v15, s[12:15], s35 offen offset:2048 sc0 sc1
v_cvt_pk_bf16_f32 v96, v72, v73
v_cvt_pk_bf16_f32 v97, v74, v75
v_cvt_pk_bf16_f32 v98, v80, v81
v_cvt_pk_bf16_f32 v99, v82, v83
s_nop 0
v_permlane16_swap_b32 v96, v98
v_permlane16_swap_b32 v97, v99
buffer_store_dwordx4 v[96:99], v14, s[12:15], s35 offen offset:3072 sc0 sc1
v_cvt_pk_bf16_f32 v100, v76, v77
v_cvt_pk_bf16_f32 v101, v78, v79
v_cvt_pk_bf16_f32 v102, v84, v85
v_cvt_pk_bf16_f32 v103, v86, v87
s_nop 0
v_permlane16_swap_b32 v100, v102
v_permlane16_swap_b32 v101, v103
buffer_store_dwordx4 v[100:103], v15, s[12:15], s35 offen offset:3072 sc0 sc1
v_cvt_pk_bf16_f32 v104, v88, v89
v_cvt_pk_bf16_f32 v105, v90, v91
v_cvt_pk_bf16_f32 v106, v92, v93
v_cvt_pk_bf16_f32 v107, v94, v95
s_nop 0
v_permlane16_swap_b32 v104, v106
v_permlane16_swap_b32 v105, v107
buffer_store_dwordx4 v[104:107], v16, s[12:15], s35 offen offset:0 sc0 sc1
v_and_b32 v10, 7, v1
v_lshrrev_b32 v11, 3, v1
s_lshl_b32 s3, s24, 3
v_add_u32 v11, s3, v11
s_lshl_b32 s3, s43, 3
v_add_u32 v17, s3, v10
v_mul_u32_u24 v240, 1152, v17
v_lshl_add_u32 v240, v11, 4, v240
s_lshr_b32 s3, s43, 1
s_mul_i32 s3, s3, 18432
v_and_b32 v17, 15, v17
v_lshlrev_b32 v17, 4, v17
v_lshl_add_u32 v243, v11, 8, v17
v_add_u32 v243, s3, v243
v_lshlrev_b32 v246, 5, v11
v_mul_u32_u24 v18, 12, v11
v_sub_u32 v242, v240, v18
v_add_u32 v242, 1024, v242
v_lshlrev_b32 v248, 3, v11
v_add_u32 v248, 2048, v248
v_lshrrev_b32 v18, 2, v11
v_lshl_add_u32 v17, v18, 8, v17
v_and_b32 v18, 3, v11
v_lshl_add_u32 v17, v18, 2, v17
s_add_u32 s3, s3, 16384
v_add_u32 v245, s3, v17
v_add_u32 v241, 512, v240
v_add_u32 v244, 8192, v243
v_add_u32 v247, 1024, v246
s_waitcnt lgkmcnt(0)
v_accvgpr_read_b32 v108, a240
v_accvgpr_read_b32 v109, a241
v_accvgpr_read_b32 v110, a242
v_accvgpr_read_b32 v111, a243
v_accvgpr_read_b32 v112, a244
v_accvgpr_read_b32 v113, a245
v_accvgpr_read_b32 v114, a246
v_accvgpr_read_b32 v115, a247
v_accvgpr_read_b32 v116, a248
s_lshr_b32 s39, s43, 2
s_lshl_b32 s39, s39, 4
s_lshl_b32 s3, s36, 7
s_add_u32 s3, s3, 917504
s_lshl_b32 s38, s39, 7
s_add_u32 s38, s38, 917504
v_and_b32 v21, 15, v1
v_lshlrev_b32 v21, 7, v21
v_mov_b32 v9, 0
s_waitcnt vmcnt(0)
buffer_store_dword v9, v9, s[88:91], s3 offen sc0 sc1
s_mov_b32 s27, 11520
buffer_load_dwordx4 v[120:123], v246, s[96:99], s27 offen offset:0
buffer_load_dwordx4 v[124:127], v246, s[96:99], s27 offen offset:16
buffer_load_dwordx4 v[128:131], v247, s[96:99], s27 offen offset:0
buffer_load_dwordx4 v[132:135], v247, s[96:99], s27 offen offset:16
buffer_load_dwordx2 v[136:137], v248, s[96:99], s27 offen
k3_p4:
buffer_load_dword v6, v21, s[88:91], s38 offen sc0 sc1
s_waitcnt vmcnt(0)
v_cmp_eq_u32 vcc, -1, v6
s_nop 0
s_cbranch_vccnz k3_p4
s_mov_b32 s27, 0
buffer_load_dwordx4 v[24:27], v243, s[12:15], s27 offen
s_mov_b32 s27, 2359296
buffer_load_dwordx4 v[28:31], v243, s[12:15], s27 offen
s_mov_b32 s27, 4718592
buffer_load_dwordx4 v[32:35], v243, s[12:15], s27 offen
s_mov_b32 s27, 7077888
buffer_load_dwordx4 v[36:39], v243, s[12:15], s27 offen
s_mov_b32 s27, 0
buffer_load_dwordx4 v[40:43], v244, s[12:15], s27 offen
s_mov_b32 s27, 2359296
buffer_load_dwordx4 v[44:47], v244, s[12:15], s27 offen
s_mov_b32 s27, 4718592
buffer_load_dwordx4 v[48:51], v244, s[12:15], s27 offen
s_mov_b32 s27, 7077888
buffer_load_dwordx4 v[52:55], v244, s[12:15], s27 offen
s_mov_b32 s27, 0
buffer_load_dword v56, v245, s[12:15], s27 offen
s_mov_b32 s27, 2359296
buffer_load_dword v60, v245, s[12:15], s27 offen
s_mov_b32 s27, 4718592
buffer_load_dword v64, v245, s[12:15], s27 offen
s_mov_b32 s27, 7077888
buffer_load_dword v68, v245, s[12:15], s27 offen
s_waitcnt vmcnt(8)
v_lshlrev_b32 v96, 16, v24
v_and_b32 v97, 0xffff0000, v24
v_lshlrev_b32 v98, 16, v25
v_and_b32 v99, 0xffff0000, v25
v_lshlrev_b32 v100, 16, v26
v_and_b32 v101, 0xffff0000, v26
v_lshlrev_b32 v102, 16, v27
v_and_b32 v103, 0xffff0000, v27
v_lshlrev_b32 v192, 16, v28
v_and_b32 v193, 0xffff0000, v28
v_lshlrev_b32 v194, 16, v29
v_and_b32 v195, 0xffff0000, v29
v_lshlrev_b32 v196, 16, v30
v_and_b32 v197, 0xffff0000, v30
v_lshlrev_b32 v198, 16, v31
v_and_b32 v199, 0xffff0000, v31
v_pk_add_f32 v[96:97], v[96:97], v[192:193]
v_pk_add_f32 v[98:99], v[98:99], v[194:195]
v_pk_add_f32 v[100:101], v[100:101], v[196:197]
v_pk_add_f32 v[102:103], v[102:103], v[198:199]
v_lshlrev_b32 v192, 16, v32
v_and_b32 v193, 0xffff0000, v32
v_lshlrev_b32 v194, 16, v33
v_and_b32 v195, 0xffff0000, v33
v_lshlrev_b32 v196, 16, v34
v_and_b32 v197, 0xffff0000, v34
v_lshlrev_b32 v198, 16, v35
v_and_b32 v199, 0xffff0000, v35
v_pk_add_f32 v[96:97], v[96:97], v[192:193]
v_pk_add_f32 v[98:99], v[98:99], v[194:195]
v_pk_add_f32 v[100:101], v[100:101], v[196:197]
v_pk_add_f32 v[102:103], v[102:103], v[198:199]
v_lshlrev_b32 v192, 16, v36
v_and_b32 v193, 0xffff0000, v36
v_lshlrev_b32 v194, 16, v37
v_and_b32 v195, 0xffff0000, v37
v_lshlrev_b32 v196, 16, v38
v_and_b32 v197, 0xffff0000, v38
v_lshlrev_b32 v198, 16, v39
v_and_b32 v199, 0xffff0000, v39
v_pk_add_f32 v[96:97], v[96:97], v[192:193]
v_pk_add_f32 v[98:99], v[98:99], v[194:195]
v_pk_add_f32 v[100:101], v[100:101], v[196:197]
v_pk_add_f32 v[102:103], v[102:103], v[198:199]
v_lshlrev_b32 v72, 16, v108
v_and_b32 v73, 0xffff0000, v108
v_lshlrev_b32 v74, 16, v109
v_and_b32 v75, 0xffff0000, v109
v_lshlrev_b32 v76, 16, v110
v_and_b32 v77, 0xffff0000, v110
v_lshlrev_b32 v78, 16, v111
v_and_b32 v79, 0xffff0000, v111
v_fmac_f32 v72, v96, v120
v_fmac_f32 v73, v97, v121
v_fmac_f32 v74, v98, v122
v_fmac_f32 v75, v99, v123
v_fmac_f32 v76, v100, v124
v_fmac_f32 v77, v101, v125
v_fmac_f32 v78, v102, v126
v_fmac_f32 v79, v103, v127
v_cvt_pk_bf16_f32 v108, v72, v73
v_cvt_pk_bf16_f32 v109, v74, v75
v_cvt_pk_bf16_f32 v110, v76, v77
v_cvt_pk_bf16_f32 v111, v78, v79
s_waitcnt vmcnt(4)
v_lshlrev_b32 v96, 16, v40
v_and_b32 v97, 0xffff0000, v40
v_lshlrev_b32 v98, 16, v41
v_and_b32 v99, 0xffff0000, v41
v_lshlrev_b32 v100, 16, v42
v_and_b32 v101, 0xffff0000, v42
v_lshlrev_b32 v102, 16, v43
v_and_b32 v103, 0xffff0000, v43
v_lshlrev_b32 v192, 16, v44
v_and_b32 v193, 0xffff0000, v44
v_lshlrev_b32 v194, 16, v45
v_and_b32 v195, 0xffff0000, v45
v_lshlrev_b32 v196, 16, v46
v_and_b32 v197, 0xffff0000, v46
v_lshlrev_b32 v198, 16, v47
v_and_b32 v199, 0xffff0000, v47
v_pk_add_f32 v[96:97], v[96:97], v[192:193]
v_pk_add_f32 v[98:99], v[98:99], v[194:195]
v_pk_add_f32 v[100:101], v[100:101], v[196:197]
v_pk_add_f32 v[102:103], v[102:103], v[198:199]
v_lshlrev_b32 v192, 16, v48
v_and_b32 v193, 0xffff0000, v48
v_lshlrev_b32 v194, 16, v49
v_and_b32 v195, 0xffff0000, v49
v_lshlrev_b32 v196, 16, v50
v_and_b32 v197, 0xffff0000, v50
v_lshlrev_b32 v198, 16, v51
v_and_b32 v199, 0xffff0000, v51
v_pk_add_f32 v[96:97], v[96:97], v[192:193]
v_pk_add_f32 v[98:99], v[98:99], v[194:195]
v_pk_add_f32 v[100:101], v[100:101], v[196:197]
v_pk_add_f32 v[102:103], v[102:103], v[198:199]
v_lshlrev_b32 v192, 16, v52
v_and_b32 v193, 0xffff0000, v52
v_lshlrev_b32 v194, 16, v53
v_and_b32 v195, 0xffff0000, v53
v_lshlrev_b32 v196, 16, v54
v_and_b32 v197, 0xffff0000, v54
v_lshlrev_b32 v198, 16, v55
v_and_b32 v199, 0xffff0000, v55
v_pk_add_f32 v[96:97], v[96:97], v[192:193]
v_pk_add_f32 v[98:99], v[98:99], v[194:195]
v_pk_add_f32 v[100:101], v[100:101], v[196:197]
v_pk_add_f32 v[102:103], v[102:103], v[198:199]
v_lshlrev_b32 v80, 16, v112
v_and_b32 v81, 0xffff0000, v112
v_lshlrev_b32 v82, 16, v113
v_and_b32 v83, 0xffff0000, v113
v_lshlrev_b32 v84, 16, v114
v_and_b32 v85, 0xffff0000, v114
v_lshlrev_b32 v86, 16, v115
v_and_b32 v87, 0xffff0000, v115
v_fmac_f32 v80, v96, v128
v_fmac_f32 v81, v97, v129
v_fmac_f32 v82, v98, v130
v_fmac_f32 v83, v99, v131
v_fmac_f32 v84, v100, v132
v_fmac_f32 v85, v101, v133
v_fmac_f32 v86, v102, v134
v_fmac_f32 v87, v103, v135
v_cvt_pk_bf16_f32 v112, v80, v81
v_cvt_pk_bf16_f32 v113, v82, v83
v_cvt_pk_bf16_f32 v114, v84, v85
v_cvt_pk_bf16_f32 v115, v86, v87
s_waitcnt vmcnt(0)
v_lshlrev_b32 v96, 16, v56
v_and_b32 v97, 0xffff0000, v56
v_lshlrev_b32 v192, 16, v60
v_and_b32 v193, 0xffff0000, v60
v_pk_add_f32 v[96:97], v[96:97], v[192:193]
v_lshlrev_b32 v192, 16, v64
v_and_b32 v193, 0xffff0000, v64
v_pk_add_f32 v[96:97], v[96:97], v[192:193]
v_lshlrev_b32 v192, 16, v68
v_and_b32 v193, 0xffff0000, v68
v_pk_add_f32 v[96:97], v[96:97], v[192:193]
v_lshlrev_b32 v88, 16, v116
v_and_b32 v89, 0xffff0000, v116
v_fmac_f32 v88, v96, v136
v_fmac_f32 v89, v97, v137
v_cvt_pk_bf16_f32 v116, v88, v89
buffer_store_dwordx4 v[108:111], v240, s[16:19], 0 offen
buffer_store_dwordx4 v[112:115], v241, s[16:19], 0 offen
buffer_store_dword v116, v242, s[16:19], 0 offen
k1_kernel_end:
s_endpgm
k1_fix0:
s_nop 7
v_mov_b32 v145, v144
s_nop 1
v_permlane32_swap_b32 v144, v145
v_max_f32 v144, v144, v145
v_add_f32 v144, s45, v144
v_max_f32 v144, 0, v144
v_exp_f32 v145, -v144
v_sub_f32 v64, v64, v144
v_sub_f32 v112, v112, v144
v_sub_f32 v65, v65, v144
v_sub_f32 v113, v113, v144
v_sub_f32 v66, v66, v144
v_sub_f32 v114, v114, v144
v_sub_f32 v67, v67, v144
v_sub_f32 v115, v115, v144
v_sub_f32 v68, v68, v144
v_sub_f32 v116, v116, v144
v_sub_f32 v69, v69, v144
v_sub_f32 v117, v117, v144
v_sub_f32 v70, v70, v144
v_sub_f32 v118, v118, v144
v_sub_f32 v71, v71, v144
v_sub_f32 v119, v119, v144
v_sub_f32 v72, v72, v144
v_sub_f32 v120, v120, v144
v_sub_f32 v73, v73, v144
v_sub_f32 v121, v121, v144
v_sub_f32 v74, v74, v144
v_sub_f32 v122, v122, v144
v_sub_f32 v75, v75, v144
v_sub_f32 v123, v123, v144
v_sub_f32 v76, v76, v144
v_sub_f32 v124, v124, v144
v_sub_f32 v77, v77, v144
v_sub_f32 v125, v125, v144
v_sub_f32 v78, v78, v144
v_sub_f32 v126, v126, v144
v_sub_f32 v79, v79, v144
v_sub_f32 v127, v127, v144
v_mul_f32 v250, v250, v145
v_accvgpr_read_b32 v146, a0
v_mul_f32 v146, v146, v145
v_accvgpr_write_b32 a0, v146
v_accvgpr_read_b32 v146, a1
v_mul_f32 v146, v146, v145
v_accvgpr_write_b32 a1, v146
v_accvgpr_read_b32 v146, a2
v_mul_f32 v146, v146, v145
v_accvgpr_write_b32 a2, v146
v_accvgpr_read_b32 v146, a3
v_mul_f32 v146, v146, v145
v_accvgpr_write_b32 a3, v146
v_accvgpr_read_b32 v146, a4
v_mul_f32 v146, v146, v145
v_accvgpr_write_b32 a4, v146
v_accvgpr_read_b32 v146, a5
v_mul_f32 v146, v146, v145
v_accvgpr_write_b32 a5, v146
v_accvgpr_read_b32 v146, a6
v_mul_f32 v146, v146, v145
v_accvgpr_write_b32 a6, v146
v_accvgpr_read_b32 v146, a7
v_mul_f32 v146, v146, v145
v_accvgpr_write_b32 a7, v146
v_accvgpr_read_b32 v146, a8
v_mul_f32 v146, v146, v145
v_accvgpr_write_b32 a8, v146
v_accvgpr_read_b32 v146, a9
v_mul_f32 v146, v146, v145
v_accvgpr_write_b32 a9, v146
v_accvgpr_read_b32 v146, a10
v_mul_f32 v146, v146, v145
v_accvgpr_write_b32 a10, v146
v_accvgpr_read_b32 v146, a11
v_mul_f32 v146, v146, v145
v_accvgpr_write_b32 a11, v146
v_accvgpr_read_b32 v146, a12
v_mul_f32 v146, v146, v145
v_accvgpr_write_b32 a12, v146
v_accvgpr_read_b32 v146, a13
v_mul_f32 v146, v146, v145
v_accvgpr_write_b32 a13, v146
v_accvgpr_read_b32 v146, a14
v_mul_f32 v146, v146, v145
v_accvgpr_write_b32 a14, v146
v_accvgpr_read_b32 v146, a15
v_mul_f32 v146, v146, v145
v_accvgpr_write_b32 a15, v146
v_accvgpr_read_b32 v146, a16
v_mul_f32 v146, v146, v145
v_accvgpr_write_b32 a16, v146
v_accvgpr_read_b32 v146, a17
v_mul_f32 v146, v146, v145
v_accvgpr_write_b32 a17, v146
v_accvgpr_read_b32 v146, a18
v_mul_f32 v146, v146, v145
v_accvgpr_write_b32 a18, v146
v_accvgpr_read_b32 v146, a19
v_mul_f32 v146, v146, v145
v_accvgpr_write_b32 a19, v146
v_accvgpr_read_b32 v146, a20
v_mul_f32 v146, v146, v145
v_accvgpr_write_b32 a20, v146
v_accvgpr_read_b32 v146, a21
v_mul_f32 v146, v146, v145
v_accvgpr_write_b32 a21, v146
v_accvgpr_read_b32 v146, a22
v_mul_f32 v146, v146, v145
v_accvgpr_write_b32 a22, v146
v_accvgpr_read_b32 v146, a23
v_mul_f32 v146, v146, v145
v_accvgpr_write_b32 a23, v146
v_accvgpr_read_b32 v146, a24
v_mul_f32 v146, v146, v145
v_accvgpr_write_b32 a24, v146
v_accvgpr_read_b32 v146, a25
v_mul_f32 v146, v146, v145
v_accvgpr_write_b32 a25, v146
v_accvgpr_read_b32 v146, a26
v_mul_f32 v146, v146, v145
v_accvgpr_write_b32 a26, v146
v_accvgpr_read_b32 v146, a27
v_mul_f32 v146, v146, v145
v_accvgpr_write_b32 a27, v146
v_accvgpr_read_b32 v146, a28
v_mul_f32 v146, v146, v145
v_accvgpr_write_b32 a28, v146
v_accvgpr_read_b32 v146, a29
v_mul_f32 v146, v146, v145
v_accvgpr_write_b32 a29, v146
v_accvgpr_read_b32 v146, a30
v_mul_f32 v146, v146, v145
v_accvgpr_write_b32 a30, v146
v_accvgpr_read_b32 v146, a31
v_mul_f32 v146, v146, v145
v_accvgpr_write_b32 a31, v146
v_accvgpr_read_b32 v146, a32
v_mul_f32 v146, v146, v145
v_accvgpr_write_b32 a32, v146
v_accvgpr_read_b32 v146, a33
v_mul_f32 v146, v146, v145
v_accvgpr_write_b32 a33, v146
v_accvgpr_read_b32 v146, a34
v_mul_f32 v146, v146, v145
v_accvgpr_write_b32 a34, v146
v_accvgpr_read_b32 v146, a35
v_mul_f32 v146, v146, v145
v_accvgpr_write_b32 a35, v146
v_accvgpr_read_b32 v146, a36
v_mul_f32 v146, v146, v145
v_accvgpr_write_b32 a36, v146
v_accvgpr_read_b32 v146, a37
v_mul_f32 v146, v146, v145
v_accvgpr_write_b32 a37, v146
v_accvgpr_read_b32 v146, a38
v_mul_f32 v146, v146, v145
v_accvgpr_write_b32 a38, v146
v_accvgpr_read_b32 v146, a39
v_mul_f32 v146, v146, v145
v_accvgpr_write_b32 a39, v146
v_accvgpr_read_b32 v146, a40
v_mul_f32 v146, v146, v145
v_accvgpr_write_b32 a40, v146
v_accvgpr_read_b32 v146, a41
v_mul_f32 v146, v146, v145
v_accvgpr_write_b32 a41, v146
v_accvgpr_read_b32 v146, a42
v_mul_f32 v146, v146, v145
v_accvgpr_write_b32 a42, v146
v_accvgpr_read_b32 v146, a43
v_mul_f32 v146, v146, v145
v_accvgpr_write_b32 a43, v146
v_accvgpr_read_b32 v146, a44
v_mul_f32 v146, v146, v145
v_accvgpr_write_b32 a44, v146
v_accvgpr_read_b32 v146, a45
v_mul_f32 v146, v146, v145
v_accvgpr_write_b32 a45, v146
v_accvgpr_read_b32 v146, a46
v_mul_f32 v146, v146, v145
v_accvgpr_write_b32 a46, v146
v_accvgpr_read_b32 v146, a47
v_mul_f32 v146, v146, v145
v_accvgpr_write_b32 a47, v146
v_accvgpr_read_b32 v146, a48
v_mul_f32 v146, v146, v145
v_accvgpr_write_b32 a48, v146
v_accvgpr_read_b32 v146, a49
v_mul_f32 v146, v146, v145
v_accvgpr_write_b32 a49, v146
v_accvgpr_read_b32 v146, a50
v_mul_f32 v146, v146, v145
v_accvgpr_write_b32 a50, v146
v_accvgpr_read_b32 v146, a51
v_mul_f32 v146, v146, v145
v_accvgpr_write_b32 a51, v146
v_accvgpr_read_b32 v146, a52
v_mul_f32 v146, v146, v145
v_accvgpr_write_b32 a52, v146
v_accvgpr_read_b32 v146, a53
v_mul_f32 v146, v146, v145
v_accvgpr_write_b32 a53, v146
v_accvgpr_read_b32 v146, a54
v_mul_f32 v146, v146, v145
v_accvgpr_write_b32 a54, v146
v_accvgpr_read_b32 v146, a55
v_mul_f32 v146, v146, v145
v_accvgpr_write_b32 a55, v146
v_accvgpr_read_b32 v146, a56
v_mul_f32 v146, v146, v145
v_accvgpr_write_b32 a56, v146
v_accvgpr_read_b32 v146, a57
v_mul_f32 v146, v146, v145
v_accvgpr_write_b32 a57, v146
v_accvgpr_read_b32 v146, a58
v_mul_f32 v146, v146, v145
v_accvgpr_write_b32 a58, v146
v_accvgpr_read_b32 v146, a59
v_mul_f32 v146, v146, v145
v_accvgpr_write_b32 a59, v146
v_accvgpr_read_b32 v146, a60
v_mul_f32 v146, v146, v145
v_accvgpr_write_b32 a60, v146
v_accvgpr_read_b32 v146, a61
v_mul_f32 v146, v146, v145
v_accvgpr_write_b32 a61, v146
v_accvgpr_read_b32 v146, a62
v_mul_f32 v146, v146, v145
v_accvgpr_write_b32 a62, v146
v_accvgpr_read_b32 v146, a63
v_mul_f32 v146, v146, v145
v_accvgpr_write_b32 a63, v146
s_cmp_eq_u32 s46, 0
s_cbranch_scc1 k1_r0
s_cmp_eq_u32 s46, 2
s_cbranch_scc1 k1_r2
s_cmp_eq_u32 s46, 4
s_cbranch_scc1 k1_r4
s_cmp_eq_u32 s46, 6
s_cbranch_scc1 k1_r6
s_cmp_eq_u32 s46, 8
s_cbranch_scc1 k1_r8
s_cmp_eq_u32 s46, 10
s_cbranch_scc1 k1_r10
s_cmp_eq_u32 s46, 12
s_cbranch_scc1 k1_r12
s_cmp_eq_u32 s46, 14
s_cbranch_scc1 k1_r14
s_cmp_eq_u32 s46, 16
s_cbranch_scc1 k1_r16
s_cmp_eq_u32 s46, 18
s_cbranch_scc1 k1_r18
s_nop 1
s_branch k1_r20
k1_fix1:
s_nop 7
v_mov_b32 v145, v144
s_nop 1
v_permlane32_swap_b32 v144, v145
v_max_f32 v144, v144, v145
v_add_f32 v144, s45, v144
v_max_f32 v144, 0, v144
v_exp_f32 v145, -v144
v_sub_f32 v80, v80, v144
v_sub_f32 v128, v128, v144
v_sub_f32 v81, v81, v144
v_sub_f32 v129, v129, v144
v_sub_f32 v82, v82, v144
v_sub_f32 v130, v130, v144
v_sub_f32 v83, v83, v144
v_sub_f32 v131, v131, v144
v_sub_f32 v84, v84, v144
v_sub_f32 v132, v132, v144
v_sub_f32 v85, v85, v144
v_sub_f32 v133, v133, v144
v_sub_f32 v86, v86, v144
v_sub_f32 v134, v134, v144
v_sub_f32 v87, v87, v144
v_sub_f32 v135, v135, v144
v_sub_f32 v88, v88, v144
v_sub_f32 v136, v136, v144
v_sub_f32 v89, v89, v144
v_sub_f32 v137, v137, v144
v_sub_f32 v90, v90, v144
v_sub_f32 v138, v138, v144
v_sub_f32 v91, v91, v144
v_sub_f32 v139, v139, v144
v_sub_f32 v92, v92, v144
v_sub_f32 v140, v140, v144
v_sub_f32 v93, v93, v144
v_sub_f32 v141, v141, v144
v_sub_f32 v94, v94, v144
v_sub_f32 v142, v142, v144
v_sub_f32 v95, v95, v144
v_sub_f32 v143, v143, v144
v_mul_f32 v251, v251, v145
v_accvgpr_read_b32 v146, a64
v_mul_f32 v146, v146, v145
v_accvgpr_write_b32 a64, v146
v_accvgpr_read_b32 v146, a65
v_mul_f32 v146, v146, v145
v_accvgpr_write_b32 a65, v146
v_accvgpr_read_b32 v146, a66
v_mul_f32 v146, v146, v145
v_accvgpr_write_b32 a66, v146
v_accvgpr_read_b32 v146, a67
v_mul_f32 v146, v146, v145
v_accvgpr_write_b32 a67, v146
v_accvgpr_read_b32 v146, a68
v_mul_f32 v146, v146, v145
v_accvgpr_write_b32 a68, v146
v_accvgpr_read_b32 v146, a69
v_mul_f32 v146, v146, v145
v_accvgpr_write_b32 a69, v146
v_accvgpr_read_b32 v146, a70
v_mul_f32 v146, v146, v145
v_accvgpr_write_b32 a70, v146
v_accvgpr_read_b32 v146, a71
v_mul_f32 v146, v146, v145
v_accvgpr_write_b32 a71, v146
v_accvgpr_read_b32 v146, a72
v_mul_f32 v146, v146, v145
v_accvgpr_write_b32 a72, v146
v_accvgpr_read_b32 v146, a73
v_mul_f32 v146, v146, v145
v_accvgpr_write_b32 a73, v146
v_accvgpr_read_b32 v146, a74
v_mul_f32 v146, v146, v145
v_accvgpr_write_b32 a74, v146
v_accvgpr_read_b32 v146, a75
v_mul_f32 v146, v146, v145
v_accvgpr_write_b32 a75, v146
v_accvgpr_read_b32 v146, a76
v_mul_f32 v146, v146, v145
v_accvgpr_write_b32 a76, v146
v_accvgpr_read_b32 v146, a77
v_mul_f32 v146, v146, v145
v_accvgpr_write_b32 a77, v146
v_accvgpr_read_b32 v146, a78
v_mul_f32 v146, v146, v145
v_accvgpr_write_b32 a78, v146
v_accvgpr_read_b32 v146, a79
v_mul_f32 v146, v146, v145
v_accvgpr_write_b32 a79, v146
v_accvgpr_read_b32 v146, a80
v_mul_f32 v146, v146, v145
v_accvgpr_write_b32 a80, v146
v_accvgpr_read_b32 v146, a81
v_mul_f32 v146, v146, v145
v_accvgpr_write_b32 a81, v146
v_accvgpr_read_b32 v146, a82
v_mul_f32 v146, v146, v145
v_accvgpr_write_b32 a82, v146
v_accvgpr_read_b32 v146, a83
v_mul_f32 v146, v146, v145
v_accvgpr_write_b32 a83, v146
v_accvgpr_read_b32 v146, a84
v_mul_f32 v146, v146, v145
v_accvgpr_write_b32 a84, v146
v_accvgpr_read_b32 v146, a85
v_mul_f32 v146, v146, v145
v_accvgpr_write_b32 a85, v146
v_accvgpr_read_b32 v146, a86
v_mul_f32 v146, v146, v145
v_accvgpr_write_b32 a86, v146
v_accvgpr_read_b32 v146, a87
v_mul_f32 v146, v146, v145
v_accvgpr_write_b32 a87, v146
v_accvgpr_read_b32 v146, a88
v_mul_f32 v146, v146, v145
v_accvgpr_write_b32 a88, v146
v_accvgpr_read_b32 v146, a89
v_mul_f32 v146, v146, v145
v_accvgpr_write_b32 a89, v146
v_accvgpr_read_b32 v146, a90
v_mul_f32 v146, v146, v145
v_accvgpr_write_b32 a90, v146
v_accvgpr_read_b32 v146, a91
v_mul_f32 v146, v146, v145
v_accvgpr_write_b32 a91, v146
v_accvgpr_read_b32 v146, a92
v_mul_f32 v146, v146, v145
v_accvgpr_write_b32 a92, v146
v_accvgpr_read_b32 v146, a93
v_mul_f32 v146, v146, v145
v_accvgpr_write_b32 a93, v146
v_accvgpr_read_b32 v146, a94
v_mul_f32 v146, v146, v145
v_accvgpr_write_b32 a94, v146
v_accvgpr_read_b32 v146, a95
v_mul_f32 v146, v146, v145
v_accvgpr_write_b32 a95, v146
v_accvgpr_read_b32 v146, a96
v_mul_f32 v146, v146, v145
v_accvgpr_write_b32 a96, v146
v_accvgpr_read_b32 v146, a97
v_mul_f32 v146, v146, v145
v_accvgpr_write_b32 a97, v146
v_accvgpr_read_b32 v146, a98
v_mul_f32 v146, v146, v145
v_accvgpr_write_b32 a98, v146
v_accvgpr_read_b32 v146, a99
v_mul_f32 v146, v146, v145
v_accvgpr_write_b32 a99, v146
v_accvgpr_read_b32 v146, a100
v_mul_f32 v146, v146, v145
v_accvgpr_write_b32 a100, v146
v_accvgpr_read_b32 v146, a101
v_mul_f32 v146, v146, v145
v_accvgpr_write_b32 a101, v146
v_accvgpr_read_b32 v146, a102
v_mul_f32 v146, v146, v145
v_accvgpr_write_b32 a102, v146
v_accvgpr_read_b32 v146, a103
v_mul_f32 v146, v146, v145
v_accvgpr_write_b32 a103, v146
v_accvgpr_read_b32 v146, a104
v_mul_f32 v146, v146, v145
v_accvgpr_write_b32 a104, v146
v_accvgpr_read_b32 v146, a105
v_mul_f32 v146, v146, v145
v_accvgpr_write_b32 a105, v146
v_accvgpr_read_b32 v146, a106
v_mul_f32 v146, v146, v145
v_accvgpr_write_b32 a106, v146
v_accvgpr_read_b32 v146, a107
v_mul_f32 v146, v146, v145
v_accvgpr_write_b32 a107, v146
v_accvgpr_read_b32 v146, a108
v_mul_f32 v146, v146, v145
v_accvgpr_write_b32 a108, v146
v_accvgpr_read_b32 v146, a109
v_mul_f32 v146, v146, v145
v_accvgpr_write_b32 a109, v146
v_accvgpr_read_b32 v146, a110
v_mul_f32 v146, v146, v145
v_accvgpr_write_b32 a110, v146
v_accvgpr_read_b32 v146, a111
v_mul_f32 v146, v146, v145
v_accvgpr_write_b32 a111, v146
v_accvgpr_read_b32 v146, a112
v_mul_f32 v146, v146, v145
v_accvgpr_write_b32 a112, v146
v_accvgpr_read_b32 v146, a113
v_mul_f32 v146, v146, v145
v_accvgpr_write_b32 a113, v146
v_accvgpr_read_b32 v146, a114
v_mul_f32 v146, v146, v145
v_accvgpr_write_b32 a114, v146
v_accvgpr_read_b32 v146, a115
v_mul_f32 v146, v146, v145
v_accvgpr_write_b32 a115, v146
v_accvgpr_read_b32 v146, a116
v_mul_f32 v146, v146, v145
v_accvgpr_write_b32 a116, v146
v_accvgpr_read_b32 v146, a117
v_mul_f32 v146, v146, v145
v_accvgpr_write_b32 a117, v146
v_accvgpr_read_b32 v146, a118
v_mul_f32 v146, v146, v145
v_accvgpr_write_b32 a118, v146
v_accvgpr_read_b32 v146, a119
v_mul_f32 v146, v146, v145
v_accvgpr_write_b32 a119, v146
v_accvgpr_read_b32 v146, a120
v_mul_f32 v146, v146, v145
v_accvgpr_write_b32 a120, v146
v_accvgpr_read_b32 v146, a121
v_mul_f32 v146, v146, v145
v_accvgpr_write_b32 a121, v146
v_accvgpr_read_b32 v146, a122
v_mul_f32 v146, v146, v145
v_accvgpr_write_b32 a122, v146
v_accvgpr_read_b32 v146, a123
v_mul_f32 v146, v146, v145
v_accvgpr_write_b32 a123, v146
v_accvgpr_read_b32 v146, a124
v_mul_f32 v146, v146, v145
v_accvgpr_write_b32 a124, v146
v_accvgpr_read_b32 v146, a125
v_mul_f32 v146, v146, v145
v_accvgpr_write_b32 a125, v146
v_accvgpr_read_b32 v146, a126
v_mul_f32 v146, v146, v145
v_accvgpr_write_b32 a126, v146
v_accvgpr_read_b32 v146, a127
v_mul_f32 v146, v146, v145
v_accvgpr_write_b32 a127, v146
s_cmp_eq_u32 s46, 1
s_cbranch_scc1 k1_r1
s_cmp_eq_u32 s46, 3
s_cbranch_scc1 k1_r3
s_cmp_eq_u32 s46, 5
s_cbranch_scc1 k1_r5
s_cmp_eq_u32 s46, 7
s_cbranch_scc1 k1_r7
s_cmp_eq_u32 s46, 9
s_cbranch_scc1 k1_r9
s_cmp_eq_u32 s46, 11
s_cbranch_scc1 k1_r11
s_cmp_eq_u32 s46, 13
s_cbranch_scc1 k1_r13
s_cmp_eq_u32 s46, 15
s_cbranch_scc1 k1_r15
s_cmp_eq_u32 s46, 17
s_cbranch_scc1 k1_r17
s_cmp_eq_u32 s46, 19
s_cbranch_scc1 k1_r19
s_nop 1
s_branch k1_r21
.section .rodata,"a"
.p2align 6
.amdhsa_kernel k0_kernel
  .amdhsa_next_free_vgpr 64
  .amdhsa_next_free_sgpr 96
  .amdhsa_accum_offset 64
  .amdhsa_group_segment_fixed_size 0
  .amdhsa_kernarg_size 120
  .amdhsa_user_sgpr_count 2
  .amdhsa_user_sgpr_kernarg_segment_ptr 1
  .amdhsa_system_sgpr_workgroup_id_x 1
.end_amdhsa_kernel
.p2align 6
.amdhsa_kernel k1_kernel
  .amdhsa_next_free_vgpr 508
  .amdhsa_next_free_sgpr 96
  .amdhsa_accum_offset 256
  .amdhsa_group_segment_fixed_size 0
  .amdhsa_kernarg_size 120
  .amdhsa_user_sgpr_count 2
  .amdhsa_user_sgpr_kernarg_segment_ptr 1
  .amdhsa_system_sgpr_workgroup_id_x 1
.end_amdhsa_kernel
```
